```python
import torch

def _softmax(x, axis=-1):
    return torch.softmax(x, dim=axis)
def _gelu(x):
    return torch.nn.functional.gelu(x, approximate="tanh")
def _silu(x):
    return torch.nn.functional.silu(x)
def _sigmoid(x):
    return torch.sigmoid(x)
def _layernorm(x, axis=-1, eps=1e-5):
    m = x.mean(dim=axis, keepdim=True)
    v = x.var(dim=axis, keepdim=True, unbiased=False)
    return (x - m) / torch.sqrt(v + eps)
def _scatter_add(tgt, idx, src, axis=0):
    return tgt.clone().index_add_(axis, idx, src)
def _segment_sum(src, seg, n):
    out = torch.zeros((n,) + src.shape[1:], dtype=src.dtype)
    return out.index_add_(0, seg, src)
def _pad(x, pw):
    flat = tuple(v for pair in reversed(pw) for v in pair)
    return torch.nn.functional.pad(x, flat)

kernel_name = 'gated_mix__compressed_kv_cla__mixer_s_mlp__prompt'

def setup_inputs():

    _w = (lambda a: (lambda t: t.to(torch.bfloat16) if t.is_floating_point() else t)(torch.as_tensor(a)))
    def _A_setup():
        B, H, Sq, Sk, D, M = 1, 16, 2048, 2048, 256, 448
        Dc = 4 * D
        return {
            "x": _w((lambda *s: torch.randn(*s, dtype=torch.bfloat16) * 0.05)(B, Sq, M)),
            "c_kv": _w((lambda *s: torch.randn(*s, dtype=torch.bfloat16) * 1.6)(B, Sk, Dc)),
            "w_q": _w((lambda *s: torch.randn(*s, dtype=torch.bfloat16) * 6.4)(M, H, D) * (M ** -0.5)),
            "w_uk": _w((lambda *s: torch.randn(*s, dtype=torch.bfloat16) * 6.4)(Dc, H, D) * (Dc ** -0.5)),
            "w_uv": _w((lambda *s: torch.randn(*s, dtype=torch.bfloat16) * 1.6)(Dc, H, D) * (Dc ** -0.5)),
            "w_o": _w((lambda *s: torch.randn(*s, dtype=torch.bfloat16) * 1.6)(H, D, M) * ((H * D) ** -0.5)),
        }
    _A_in = _A_setup()

    def _B_setup():
        B, S, D, F = 1, 2048, 448, 1792
        return {
            "x":  _w((lambda *s: torch.randn(*s, dtype=torch.bfloat16) * 0.05)(B, S, D)),
            "w1": _w((lambda *s: torch.randn(*s, dtype=torch.bfloat16) * 3.2)(D, D) * (D ** -0.5)),
            "w2": _w((lambda *s: torch.randn(*s, dtype=torch.bfloat16) * 3.2)(D, D) * (D ** -0.5)),
            "w3": _w((lambda *s: torch.randn(*s, dtype=torch.bfloat16) * 3.2)(D, F) * (D ** -0.5)),
            "w4": _w((lambda *s: torch.randn(*s, dtype=torch.bfloat16) * 1.6)(F, D) * (F ** -0.5)),
        }
    _B_in = _B_setup()

    return {
        "A_x": _A_in["x"],
        "A_c_kv": _A_in["c_kv"],
        "A_w_q": _A_in["w_q"],
        "A_w_uk": _A_in["w_uk"],
        "A_w_uv": _A_in["w_uv"],
        "A_w_o": _A_in["w_o"],
        "B_x": _B_in["x"],
        "B_w1": _B_in["w1"],
        "B_w2": _B_in["w2"],
        "B_w3": _B_in["w3"],
        "B_w4": _B_in["w4"],
        "gate_w": _w((lambda *s: torch.randn(*s, dtype=torch.bfloat16) * 0.05)(448) * 16.0),
    }

def reference(A_x, A_c_kv, A_w_q, A_w_uk, A_w_uv, A_w_o, B_x, B_w1, B_w2, B_w3, B_w4, gate_w):
    def _A_ref(x, c_kv, w_q, w_uk, w_uv, w_o):
        B, Sq, M = x.shape[0], x.shape[1], x.shape[2]
        Sk = c_kv.shape[1]
        H, D = w_q.shape[1], w_q.shape[2]
        q = torch.einsum("bqm,mhd->bhqd", x, w_q)
        k = torch.einsum("bkc,chd->bhkd", c_kv, w_uk)
        v = torch.einsum("bkc,chd->bhkd", c_kv, w_uv)
        scores = torch.einsum("bhqd,bhkd->bhqk", q, k) * (D ** -0.5)
        off = Sk - Sq
        qi = torch.arange(Sq)[:, None]
        kj = torch.arange(Sk)[None, :]
        cmask = kj <= (qi + off)
        scores = torch.where(cmask[None, None], scores, -1e9)
        p = _softmax(scores, axis=-1)
        ctx = torch.einsum("bhqk,bhkd->bhqd", p, v)
        return torch.einsum("bhqd,hdm->bqm", ctx, w_o)

    def _B_ref(x, w1, w2, w3, w4):
        B, S, D = x.shape
        h = _gelu(_layernorm(x, axis=-1) @ w1)
        c = D // 4
        g0 = _pad(h[:, :, 0*c:1*c], ((0, 0), (1, 0), (0, 0)))[:, :S, :]
        g1 = _pad(h[:, :, 1*c:2*c], ((0, 0), (0, 1), (0, 0)))[:, 1:, :]
        g2 = _pad(h[:, :, 2*c:3*c], ((0, 0), (2, 0), (0, 0)))[:, :S, :]
        g3 = _pad(h[:, :, 3*c:   ], ((0, 0), (0, 2), (0, 0)))[:, 2:, :]
        hs = torch.concatenate([g0, g1, g2, g3], axis=-1) @ w2
        x1 = x + hs
        h2 = _gelu(_layernorm(x1, axis=-1) @ w3) @ w4
        return x1 + h2

    x = A_x
    g = _sigmoid((x * gate_w).sum(-1, keepdims=True))
    a = _A_ref(x, A_c_kv, A_w_q, A_w_uk, A_w_uv, A_w_o)
    b = _B_ref(x, B_w1, B_w2, B_w3, B_w4)
    return g * a + (1 - g) * b
```

```asm
; @launch grid=(256,1,1) block=(256,1,1) lds=163840
.amdgcn_target "amdgcn-amd-amdhsa--gfx950"
.text
.macro mf d, a, b, c
v_mfma_f32_16x16x32_bf16 \d, \a, \b, \c
.endm
.globl gated_mix__compressed_kv_cla__mixer_s_mlp__prompt_kernel
.p2align 8
.type gated_mix__compressed_kv_cla__mixer_s_mlp__prompt_kernel,@function
gated_mix__compressed_kv_cla__mixer_s_mlp__prompt_kernel:
s_cmp_lt_u32 s2, 256
s_cbranch_scc1 go
s_endpgm
go:
s_load_dwordx8 s[4:11], s[0:1], 8
s_getpc_b64 s[100:101]
s_sub_u32 s100, s100, 12
s_subb_u32 s101, s101, 0
s_and_b32 s12, s2, 7
s_lshr_b32 s42, s2, 3
v_lshrrev_b32 v1, 6, v0
v_and_b32 v255, 63, v0
v_readfirstlane_b32 s16, v1
s_lshl_b32 s17, s42, 2
s_add_u32 s17, s17, s16
s_lshl_b32 s17, s17, 11
v_lshl_add_u32 v2, v255, 5, s17
v_min_u32 v2, code_end-go-4, v2
global_load_dword v3, v2, s[100:101]
s_bfe_u32 s14, s42, 0x10002
s_lshl_b32 s15, s12, 1
s_add_u32 s15, s15, s14
s_lshr_b32 s14, s42, 4
s_xor_b32 s14, s14, 1
s_lshl_b32 s14, s14, 2
s_and_b32 s13, s42, 3
s_add_u32 s14, s14, s13
s_bfe_u32 s13, s42, 0x10003
v_lshrrev_b32 v143, 3, v255
s_lshl_b32 s17, s16, 3
v_add_u32 v143, s17, v143
v_bfe_u32 v144, v143, 1, 3
v_and_b32 v145, 7, v255
v_xor_b32 v144, v144, v145
v_lshlrev_b32 v144, 4, v144
v_mul_u32_u24 v143, 2048, v143
v_add_u32 v138, v143, v144
s_and_b32 s17, s16, 1
s_lshr_b32 s18, s16, 1
s_lshl_b32 s18, s18, 2
s_add_u32 s17, s17, s18
s_lshl_b32 s17, s17, 1
v_lshrrev_b32 v143, 5, v255
v_add_u32 v143, s17, v143
v_and_b32 v144, 3, v143
v_bfe_u32 v145, v143, 3, 1
v_lshl_add_u32 v144, v145, 2, v144
v_lshlrev_b32 v144, 1, v144
v_and_b32 v145, 31, v255
v_xor_b32 v144, v144, v145
v_lshlrev_b32 v144, 4, v144
v_mul_u32_u24 v143, 8192, v143
v_add_u32 v139, v143, v144
s_lshl_b32 s34, s16, 10
s_lshl_b32 s35, s17, 9
s_add_u32 s35, s35, 0x10000
s_lshl_b32 s32, s14, 19
s_lshl_b32 s33, s15, 9
s_waitcnt lgkmcnt(0)
s_mov_b32 s20, s4
s_and_b32 s21, s5, 0xffff
s_mov_b32 s22, 4194304
s_mov_b32 s23, 0x20000
s_cmp_eq_u32 s13, 0
s_cselect_b32 s24, s8, s10
s_cselect_b32 s25, s9, s11
s_and_b32 s25, s25, 0xffff
s_mov_b32 s26, 8388608
s_mov_b32 s27, 0x20000
s_mov_b64 s[46:47], s[6:7]
s_load_dwordx2 s[6:7], s[0:1], 112
s_load_dwordx2 s[68:69], s[0:1], 104
s_load_dwordx2 s[44:45], s[0:1], 0
s_load_dwordx8 s[48:55], s[0:1], 56
s_load_dwordx2 s[56:57], s[0:1], 40
s_add_u32 m0, s34, 0
s_add_u32 s36, s32, 0
buffer_load_dwordx4 v138, s[20:23], s36 offen lds
s_add_u32 m0, s35, 0
s_add_u32 s37, s33, 0
buffer_load_dwordx4 v139, s[24:27], s37 offen lds
s_add_u32 m0, s34, 4096
s_add_u32 s36, s32, 65536
buffer_load_dwordx4 v138, s[20:23], s36 offen lds
s_add_u32 m0, s35, 2048
s_add_u32 s37, s33, 32768
buffer_load_dwordx4 v139, s[24:27], s37 offen lds
s_add_u32 m0, s34, 8192
s_add_u32 s36, s32, 131072
buffer_load_dwordx4 v138, s[20:23], s36 offen lds
s_add_u32 m0, s35, 8192
s_add_u32 s37, s33, 131072
buffer_load_dwordx4 v139, s[24:27], s37 offen lds
s_add_u32 m0, s34, 12288
s_add_u32 s36, s32, 196608
buffer_load_dwordx4 v138, s[20:23], s36 offen lds
s_add_u32 m0, s35, 10240
s_add_u32 s37, s33, 163840
buffer_load_dwordx4 v139, s[24:27], s37 offen lds
s_add_u32 m0, s34, 16384
s_add_u32 s36, s32, 262144
buffer_load_dwordx4 v138, s[20:23], s36 offen lds
s_add_u32 m0, s35, 16384
s_add_u32 s37, s33, 262144
buffer_load_dwordx4 v139, s[24:27], s37 offen lds
s_add_u32 m0, s34, 20480
s_add_u32 s36, s32, 327680
buffer_load_dwordx4 v138, s[20:23], s36 offen lds
s_add_u32 m0, s35, 18432
s_add_u32 s37, s33, 294912
buffer_load_dwordx4 v139, s[24:27], s37 offen lds
s_add_u32 m0, s34, 24576
s_add_u32 s36, s32, 393216
buffer_load_dwordx4 v138, s[20:23], s36 offen lds
s_add_u32 m0, s35, 24576
s_add_u32 s37, s33, 393216
buffer_load_dwordx4 v139, s[24:27], s37 offen lds
s_add_u32 m0, s34, 28672
s_add_u32 s36, s32, 458752
buffer_load_dwordx4 v138, s[20:23], s36 offen lds
s_add_u32 m0, s35, 26624
s_add_u32 s37, s33, 425984
buffer_load_dwordx4 v139, s[24:27], s37 offen lds
s_add_u32 s32, s32, 128
s_add_u32 s33, s33, 524288
s_waitcnt lgkmcnt(0)
s_cmp_lt_u32 s16, 2
s_cbranch_scc1 sw0_2
s_cmp_eq_u32 s16, 2
s_cbranch_scc1 sw1_3
s_mov_b32 s60, s44
s_mov_b32 s61, s45
s_mov_b32 s62, 1835008
s_mov_b32 s18, 0
s_cmp_ge_u32 s2, 35
s_cselect_b32 s60, s46, s60
s_cselect_b32 s61, s47, s61
s_cselect_b32 s62, 3670016, s62
s_cselect_b32 s18, 35, s18
s_cmp_ge_u32 s2, 106
s_cselect_b32 s60, s48, s60
s_cselect_b32 s61, s49, s61
s_cselect_b32 s62, 401408, s62
s_cselect_b32 s18, 106, s18
s_cmp_ge_u32 s2, 114
s_cselect_b32 s60, s50, s60
s_cselect_b32 s61, s51, s61
s_cselect_b32 s62, 401408, s62
s_cselect_b32 s18, 114, s18
s_cmp_ge_u32 s2, 122
s_cselect_b32 s60, s52, s60
s_cselect_b32 s61, s53, s61
s_cselect_b32 s62, 1605632, s62
s_cselect_b32 s18, 122, s18
s_cmp_ge_u32 s2, 153
s_cselect_b32 s60, s54, s60
s_cselect_b32 s61, s55, s61
s_cselect_b32 s62, 1605632, s62
s_cselect_b32 s18, 153, s18
s_cmp_ge_u32 s2, 184
s_cselect_b32 s60, s56, s60
s_cselect_b32 s61, s57, s61
s_cselect_b32 s62, 3670016, s62
s_cselect_b32 s18, 184, s18
s_sub_u32 s17, s2, s18
s_mul_i32 s64, s17, 53248
s_movk_i32 s65, 4096
v_lshlrev_b32 v252, 6, v255
s_branch swd_4
sw0_2:
s_mov_b32 s60, s20
s_mov_b32 s61, s21
s_mov_b32 s62, 4194304
s_bfe_u32 s17, s42, 0x20002
s_lshl_b32 s17, s17, 1
s_add_u32 s17, s17, s16
s_lshl_b32 s17, s17, 16
s_lshl_b32 s64, s14, 19
s_add_u32 s64, s64, s17
s_add_u32 s64, s64, 256
s_movk_i32 s65, 128
v_lshrrev_b32 v252, 1, v255
v_lshlrev_b32 v252, 11, v252
s_branch swd_4
sw1_3:
s_mov_b32 s60, s24
s_mov_b32 s61, s25
s_mov_b32 s62, 8388608
s_lshl_b32 s64, s14, 16
s_lshl_b32 s17, s15, 9
s_add_u32 s64, s64, s17
s_add_u32 s64, s64, 1048576
s_mov_b32 s65, 524288
v_lshrrev_b32 v252, 3, v255
v_lshlrev_b32 v252, 13, v252
v_and_b32 v143, 7, v255
v_lshl_add_u32 v252, v143, 6, v252
swd_4:
s_and_b32 s61, s61, 0xffff
s_mov_b32 s63, 0x20000
s_mov_b32 s28, s6
s_and_b32 s29, s7, 0xffff
s_mov_b32 s30, 134217728
s_mov_b32 s31, 0x20000
s_cmp_ge_u32 s2, 8
s_cbranch_scc1 noclr_5
v_lshlrev_b32 v0, 4, v0
v_mov_b32 v4, 0
v_mov_b32 v5, 0
v_mov_b32 v6, 0
v_mov_b32 v7, 0
s_lshl_b32 s17, s2, 12
s_add_u32 s17, s17, 105906176
buffer_store_dwordx4 v[4:7], v0, s[28:31], s17 offen sc1
noclr_5:
v_lshlrev_b32 v142, 4, v255
s_and_b32 s17, s16, 1
s_lshl_b32 s17, s17, 14
v_and_b32 v143, 15, v255
v_lshrrev_b32 v144, 1, v143
v_lshrrev_b32 v145, 4, v255
v_xor_b32 v144, v144, v145
v_lshlrev_b32 v143, 7, v143
v_add_u32 v143, s17, v143
v_xor_b32 v145, 0, v144
v_lshl_add_u32 v128, v145, 4, v143
v_xor_b32 v145, 4, v144
v_lshl_add_u32 v129, v145, 4, v143
v_lshrrev_b32 v143, 4, v255
v_lshlrev_b32 v143, 3, v143
v_bfe_u32 v144, v255, 2, 2
v_add_u32 v143, v143, v144
v_lshlrev_b32 v143, 9, v143
v_and_b32 v145, 3, v255
v_lshl_add_u32 v143, v145, 3, v143
v_add_u32 v143, 0x10000, v143
v_bfe_u32 v144, v255, 2, 3
s_lshr_b32 s17, s16, 1
s_lshl_b32 s17, s17, 3
s_add_u32 s18, s17, 0
v_xor_b32 v145, s18, v144
v_lshl_add_u32 v130, v145, 5, v143
s_add_u32 s18, s17, 1
v_xor_b32 v145, s18, v144
v_lshl_add_u32 v131, v145, 5, v143
s_add_u32 s18, s17, 2
v_xor_b32 v145, s18, v144
v_lshl_add_u32 v132, v145, 5, v143
s_add_u32 s18, s17, 3
v_xor_b32 v145, s18, v144
v_lshl_add_u32 v133, v145, 5, v143
s_add_u32 s18, s17, 4
v_xor_b32 v145, s18, v144
v_lshl_add_u32 v134, v145, 5, v143
s_add_u32 s18, s17, 5
v_xor_b32 v145, s18, v144
v_lshl_add_u32 v135, v145, 5, v143
s_add_u32 s18, s17, 6
v_xor_b32 v145, s18, v144
v_lshl_add_u32 v136, v145, 5, v143
s_add_u32 s18, s17, 7
v_xor_b32 v145, s18, v144
v_lshl_add_u32 v137, v145, 5, v143
s_and_b32 s17, s16, 1
s_lshr_b32 s18, s16, 1
s_lshl_b32 s39, s15, 20
s_lshl_b32 s40, s14, 17
s_add_u32 s39, s39, s40
s_lshl_b32 s40, s17, 16
s_add_u32 s39, s39, s40
s_add_u32 s17, s13, 12
s_lshl_b32 s40, s18, s17
s_add_u32 s39, s39, s40
s_lshl_b32 s40, s13, 24
s_add_u32 s39, s39, s40
s_lshr_b32 s40, 8192, s13
s_add_u32 s19, s39, s40
s_mov_b32 s66, s13
s_lshl_b32 s15, s12, 1
s_add_u32 s15, s15, s13
s_and_b32 s14, s42, 7
s_lshr_b32 s13, s42, 4
s_lshl_b32 s3, s2, 7
s_add_u32 s3, s3, 105906176
s_lshl_b32 s43, s12, 4
s_and_b32 s17, s42, 15
s_add_u32 s43, s43, s17
s_cmp_eq_u32 s16, 3
s_cbranch_scc1 nopre_6
buffer_load_dword v253, v252, s[60:63], s64 offen
s_add_u32 s64, s64, s65
nopre_6:
s_add_u32 m0, s34, 32768
s_add_u32 s36, s32, 0
buffer_load_dwordx4 v138, s[20:23], s36 offen lds
s_add_u32 m0, s35, 32768
s_add_u32 s37, s33, 0
buffer_load_dwordx4 v139, s[24:27], s37 offen lds
s_add_u32 m0, s34, 36864
s_add_u32 s36, s32, 65536
buffer_load_dwordx4 v138, s[20:23], s36 offen lds
s_add_u32 m0, s35, 34816
s_add_u32 s37, s33, 32768
buffer_load_dwordx4 v139, s[24:27], s37 offen lds
s_add_u32 m0, s34, 40960
s_add_u32 s36, s32, 131072
buffer_load_dwordx4 v138, s[20:23], s36 offen lds
s_add_u32 m0, s35, 40960
s_add_u32 s37, s33, 131072
buffer_load_dwordx4 v139, s[24:27], s37 offen lds
s_add_u32 m0, s34, 45056
s_add_u32 s36, s32, 196608
buffer_load_dwordx4 v138, s[20:23], s36 offen lds
s_add_u32 m0, s35, 43008
s_add_u32 s37, s33, 163840
buffer_load_dwordx4 v139, s[24:27], s37 offen lds
s_add_u32 m0, s34, 49152
s_add_u32 s36, s32, 262144
buffer_load_dwordx4 v138, s[20:23], s36 offen lds
s_add_u32 m0, s35, 49152
s_add_u32 s37, s33, 262144
buffer_load_dwordx4 v139, s[24:27], s37 offen lds
s_add_u32 m0, s34, 53248
s_add_u32 s36, s32, 327680
buffer_load_dwordx4 v138, s[20:23], s36 offen lds
s_add_u32 m0, s35, 51200
s_add_u32 s37, s33, 294912
buffer_load_dwordx4 v139, s[24:27], s37 offen lds
s_add_u32 m0, s34, 57344
s_add_u32 s36, s32, 393216
buffer_load_dwordx4 v138, s[20:23], s36 offen lds
s_add_u32 m0, s35, 57344
s_add_u32 s37, s33, 393216
buffer_load_dwordx4 v139, s[24:27], s37 offen lds
s_add_u32 m0, s34, 61440
s_add_u32 s36, s32, 458752
buffer_load_dwordx4 v138, s[20:23], s36 offen lds
s_add_u32 m0, s35, 59392
s_add_u32 s37, s33, 425984
buffer_load_dwordx4 v139, s[24:27], s37 offen lds
s_cmp_lg_u32 s66, 0
s_cbranch_scc1 vpath_7
s_waitcnt vmcnt(16)
s_barrier
ds_read_b128 a[128:131], v128 offset:0
ds_read_b128 a[132:135], v129 offset:0
ds_read_b128 a[136:139], v128 offset:2048
ds_read_b128 a[140:143], v129 offset:2048
ds_read_b128 a[144:147], v128 offset:4096
ds_read_b128 a[148:151], v129 offset:4096
ds_read_b128 a[152:155], v128 offset:6144
ds_read_b128 a[156:159], v129 offset:6144
ds_read_b64_tr_b16 a[192:193], v130 offset:0
ds_read_b64_tr_b16 a[194:195], v130 offset:2048
ds_read_b64_tr_b16 a[196:197], v130 offset:16384
ds_read_b64_tr_b16 a[198:199], v130 offset:18432
ds_read_b64_tr_b16 a[200:201], v131 offset:0
ds_read_b64_tr_b16 a[202:203], v131 offset:2048
ds_read_b64_tr_b16 a[204:205], v131 offset:16384
ds_read_b64_tr_b16 a[206:207], v131 offset:18432
ds_read_b64_tr_b16 a[208:209], v132 offset:0
ds_read_b64_tr_b16 a[210:211], v132 offset:2048
ds_read_b64_tr_b16 a[212:213], v132 offset:16384
ds_read_b64_tr_b16 a[214:215], v132 offset:18432
ds_read_b64_tr_b16 a[216:217], v133 offset:0
ds_read_b64_tr_b16 a[218:219], v133 offset:2048
ds_read_b64_tr_b16 a[220:221], v133 offset:16384
ds_read_b64_tr_b16 a[222:223], v133 offset:18432
s_waitcnt lgkmcnt(0)
mf v[0:3],a[192:195],a[128:131],0
ds_read_b64_tr_b16 a[224:225], v134 offset:0
mf v[0:3],a[196:199],a[132:135],v[0:3]
buffer_load_dword v253, v252, s[60:63], s64 offen
mf v[32:35],a[196:199],a[140:143],0
ds_read_b64_tr_b16 a[226:227], v134 offset:2048
mf v[32:35],a[192:195],a[136:139],v[32:35]
mf v[64:67],a[192:195],a[144:147],0
ds_read_b64_tr_b16 a[228:229], v134 offset:16384
mf v[64:67],a[196:199],a[148:151],v[64:67]
mf v[96:99],a[196:199],a[156:159],0
ds_read_b64_tr_b16 a[230:231], v134 offset:18432
mf v[96:99],a[192:195],a[152:155],v[96:99]
mf v[100:103],a[200:203],a[152:155],0
ds_read_b64_tr_b16 a[232:233], v135 offset:0
mf v[100:103],a[204:207],a[156:159],v[100:103]
mf v[68:71],a[204:207],a[148:151],0
ds_read_b64_tr_b16 a[234:235], v135 offset:2048
mf v[68:71],a[200:203],a[144:147],v[68:71]
mf v[36:39],a[200:203],a[136:139],0
ds_read_b64_tr_b16 a[236:237], v135 offset:16384
mf v[36:39],a[204:207],a[140:143],v[36:39]
mf v[4:7],a[204:207],a[132:135],0
ds_read_b64_tr_b16 a[238:239], v135 offset:18432
mf v[4:7],a[200:203],a[128:131],v[4:7]
s_add_u32 s64, s64, s65
mf v[8:11],a[208:211],a[128:131],0
ds_read_b64_tr_b16 a[240:241], v136 offset:0
mf v[8:11],a[212:215],a[132:135],v[8:11]
mf v[40:43],a[212:215],a[140:143],0
ds_read_b64_tr_b16 a[242:243], v136 offset:2048
mf v[40:43],a[208:211],a[136:139],v[40:43]
mf v[72:75],a[208:211],a[144:147],0
ds_read_b64_tr_b16 a[244:245], v136 offset:16384
mf v[72:75],a[212:215],a[148:151],v[72:75]
mf v[104:107],a[212:215],a[156:159],0
ds_read_b64_tr_b16 a[246:247], v136 offset:18432
mf v[104:107],a[208:211],a[152:155],v[104:107]
mf v[108:111],a[216:219],a[152:155],0
ds_read_b64_tr_b16 a[248:249], v137 offset:0
mf v[108:111],a[220:223],a[156:159],v[108:111]
mf v[76:79],a[220:223],a[148:151],0
ds_read_b64_tr_b16 a[250:251], v137 offset:2048
mf v[76:79],a[216:219],a[144:147],v[76:79]
mf v[44:47],a[216:219],a[136:139],0
ds_read_b64_tr_b16 a[252:253], v137 offset:16384
mf v[44:47],a[220:223],a[140:143],v[44:47]
mf v[12:15],a[220:223],a[132:135],0
ds_read_b64_tr_b16 a[254:255], v137 offset:18432
s_add_u32 s32, s32, 128
mf v[12:15],a[216:219],a[128:131],v[12:15]
s_waitcnt lgkmcnt(8)
mf v[16:19],a[224:227],a[128:131],0
mf v[16:19],a[228:231],a[132:135],v[16:19]
ds_read_b128 a[160:163], v128 offset:8192
mf v[48:51],a[228:231],a[140:143],0
mf v[48:51],a[224:227],a[136:139],v[48:51]
mf v[80:83],a[224:227],a[144:147],0
ds_read_b128 a[164:167], v129 offset:8192
mf v[80:83],a[228:231],a[148:151],v[80:83]
mf v[112:115],a[228:231],a[156:159],0
mf v[112:115],a[224:227],a[152:155],v[112:115]
ds_read_b128 a[168:171], v128 offset:10240
mf v[116:119],a[232:235],a[152:155],0
mf v[116:119],a[236:239],a[156:159],v[116:119]
mf v[84:87],a[236:239],a[148:151],0
ds_read_b128 a[172:175], v129 offset:10240
mf v[84:87],a[232:235],a[144:147],v[84:87]
mf v[52:55],a[232:235],a[136:139],0
mf v[52:55],a[236:239],a[140:143],v[52:55]
ds_read_b128 a[176:179], v128 offset:12288
s_add_u32 s33, s33, 524288
mf v[20:23],a[236:239],a[132:135],0
mf v[20:23],a[232:235],a[128:131],v[20:23]
s_waitcnt lgkmcnt(5)
mf v[24:27],a[240:243],a[128:131],0
ds_read_b128 a[180:183], v129 offset:12288
mf v[24:27],a[244:247],a[132:135],v[24:27]
mf v[56:59],a[244:247],a[140:143],0
mf v[56:59],a[240:243],a[136:139],v[56:59]
ds_read_b128 a[184:187], v128 offset:14336
mf v[88:91],a[240:243],a[144:147],0
mf v[88:91],a[244:247],a[148:151],v[88:91]
mf v[120:123],a[244:247],a[156:159],0
ds_read_b128 a[188:191], v129 offset:14336
mf v[120:123],a[240:243],a[152:155],v[120:123]
mf v[124:127],a[248:251],a[152:155],0
mf v[124:127],a[252:255],a[156:159],v[124:127]
mf v[92:95],a[252:255],a[148:151],0
mf v[92:95],a[248:251],a[144:147],v[92:95]
mf v[60:63],a[248:251],a[136:139],0
mf v[60:63],a[252:255],a[140:143],v[60:63]
mf v[28:31],a[252:255],a[132:135],0
mf v[28:31],a[248:251],a[128:131],v[28:31]
s_waitcnt lgkmcnt(0) vmcnt(1)
s_barrier
s_lshl_b32 s17, s16, 8
s_add_u32 s17, s17, s2
s_cmp_ge_u32 s17, 8
s_cbranch_scc1 noinit_11
s_mov_b32 s56, s68
s_and_b32 s57, s69, 0xffff
s_mov_b32 s58, 256
s_mov_b32 s59, 0x20000
s_lshl_b32 s17, s2, 2
v_mov_b32 v143, 1
v_mov_b32 v144, 0
s_mov_b64 exec, 1
buffer_store_dword v143, v144, s[56:59], s17 offen sc1
s_mov_b64 exec, -1
noinit_11:
mf a[0:3],a[192:195],a[160:163],0
ds_read_b128 a[128:131], v128 offset:32768
ds_read_b128 a[132:135], v129 offset:32768
mf a[0:3],a[196:199],a[164:167],a[0:3]
s_add_u32 m0, s34, 0
mf a[32:35],a[196:199],a[172:175],0
s_add_u32 s36, s32, 0
mf a[32:35],a[192:195],a[168:171],a[32:35]
buffer_load_dwordx4 v138, s[20:23], s36 offen lds
mf a[64:67],a[192:195],a[176:179],0
ds_read_b128 a[136:139], v128 offset:34816
ds_read_b128 a[140:143], v129 offset:34816
mf a[64:67],a[196:199],a[180:183],a[64:67]
s_add_u32 m0, s35, 0
mf a[96:99],a[196:199],a[188:191],0
s_add_u32 s37, s33, 0
mf a[96:99],a[192:195],a[184:187],a[96:99]
buffer_load_dwordx4 v139, s[24:27], s37 offen lds
mf a[100:103],a[200:203],a[184:187],0
ds_read_b128 a[144:147], v128 offset:36864
ds_read_b128 a[148:151], v129 offset:36864
mf a[100:103],a[204:207],a[188:191],a[100:103]
s_add_u32 m0, s34, 4096
mf a[68:71],a[204:207],a[180:183],0
s_add_u32 s36, s32, 65536
mf a[68:71],a[200:203],a[176:179],a[68:71]
buffer_load_dwordx4 v138, s[20:23], s36 offen lds
mf a[36:39],a[200:203],a[168:171],0
ds_read_b64_tr_b16 a[192:193], v130 offset:32768
ds_read_b64_tr_b16 a[194:195], v130 offset:34816
mf a[36:39],a[204:207],a[172:175],a[36:39]
s_add_u32 m0, s35, 2048
mf a[4:7],a[204:207],a[164:167],0
s_add_u32 s37, s33, 32768
mf a[4:7],a[200:203],a[160:163],a[4:7]
buffer_load_dwordx4 v139, s[24:27], s37 offen lds
mf a[8:11],a[208:211],a[160:163],0
ds_read_b64_tr_b16 a[196:197], v130 offset:49152
ds_read_b64_tr_b16 a[198:199], v130 offset:51200
mf a[8:11],a[212:215],a[164:167],a[8:11]
s_add_u32 m0, s34, 8192
mf a[40:43],a[212:215],a[172:175],0
s_add_u32 s36, s32, 131072
mf a[40:43],a[208:211],a[168:171],a[40:43]
buffer_load_dwordx4 v138, s[20:23], s36 offen lds
mf a[72:75],a[208:211],a[176:179],0
ds_read_b128 a[152:155], v128 offset:38912
ds_read_b128 a[156:159], v129 offset:38912
mf a[72:75],a[212:215],a[180:183],a[72:75]
s_add_u32 m0, s35, 8192
mf a[104:107],a[212:215],a[188:191],0
s_add_u32 s37, s33, 131072
mf a[104:107],a[208:211],a[184:187],a[104:107]
buffer_load_dwordx4 v139, s[24:27], s37 offen lds
mf a[108:111],a[216:219],a[184:187],0
ds_read_b64_tr_b16 a[200:201], v131 offset:32768
ds_read_b64_tr_b16 a[202:203], v131 offset:34816
mf a[108:111],a[220:223],a[188:191],a[108:111]
s_add_u32 m0, s34, 12288
mf a[76:79],a[220:223],a[180:183],0
s_add_u32 s36, s32, 196608
mf a[76:79],a[216:219],a[176:179],a[76:79]
buffer_load_dwordx4 v138, s[20:23], s36 offen lds
mf a[44:47],a[216:219],a[168:171],0
ds_read_b64_tr_b16 a[204:205], v131 offset:49152
ds_read_b64_tr_b16 a[206:207], v131 offset:51200
mf a[44:47],a[220:223],a[172:175],a[44:47]
s_add_u32 m0, s35, 10240
mf a[12:15],a[220:223],a[164:167],0
s_add_u32 s37, s33, 163840
mf a[12:15],a[216:219],a[160:163],a[12:15]
buffer_load_dwordx4 v139, s[24:27], s37 offen lds
mf a[16:19],a[224:227],a[160:163],0
mf a[16:19],a[228:231],a[164:167],a[16:19]
s_add_u32 m0, s34, 16384
mf a[48:51],a[228:231],a[172:175],0
s_add_u32 s36, s32, 262144
mf a[48:51],a[224:227],a[168:171],a[48:51]
buffer_load_dwordx4 v138, s[20:23], s36 offen lds
mf a[80:83],a[224:227],a[176:179],0
ds_read_b64_tr_b16 a[208:209], v132 offset:32768
ds_read_b64_tr_b16 a[210:211], v132 offset:34816
mf a[80:83],a[228:231],a[180:183],a[80:83]
s_add_u32 m0, s35, 16384
mf a[112:115],a[228:231],a[188:191],0
s_add_u32 s37, s33, 262144
mf a[112:115],a[224:227],a[184:187],a[112:115]
buffer_load_dwordx4 v139, s[24:27], s37 offen lds
mf a[116:119],a[232:235],a[184:187],0
ds_read_b64_tr_b16 a[212:213], v132 offset:49152
ds_read_b64_tr_b16 a[214:215], v132 offset:51200
mf a[116:119],a[236:239],a[188:191],a[116:119]
s_add_u32 m0, s34, 20480
mf a[84:87],a[236:239],a[180:183],0
s_add_u32 s36, s32, 327680
mf a[84:87],a[232:235],a[176:179],a[84:87]
buffer_load_dwordx4 v138, s[20:23], s36 offen lds
mf a[52:55],a[232:235],a[168:171],0
mf a[52:55],a[236:239],a[172:175],a[52:55]
s_add_u32 m0, s35, 18432
mf a[20:23],a[236:239],a[164:167],0
s_add_u32 s37, s33, 294912
mf a[20:23],a[232:235],a[160:163],a[20:23]
buffer_load_dwordx4 v139, s[24:27], s37 offen lds
mf a[24:27],a[240:243],a[160:163],0
ds_read_b64_tr_b16 a[216:217], v133 offset:32768
ds_read_b64_tr_b16 a[218:219], v133 offset:34816
mf a[24:27],a[244:247],a[164:167],a[24:27]
s_add_u32 m0, s34, 24576
mf a[56:59],a[244:247],a[172:175],0
s_add_u32 s36, s32, 393216
mf a[56:59],a[240:243],a[168:171],a[56:59]
buffer_load_dwordx4 v138, s[20:23], s36 offen lds
mf a[88:91],a[240:243],a[176:179],0
ds_read_b64_tr_b16 a[220:221], v133 offset:49152
ds_read_b64_tr_b16 a[222:223], v133 offset:51200
mf a[88:91],a[244:247],a[180:183],a[88:91]
s_add_u32 m0, s35, 24576
mf a[120:123],a[244:247],a[188:191],0
s_add_u32 s37, s33, 393216
mf a[120:123],a[240:243],a[184:187],a[120:123]
buffer_load_dwordx4 v139, s[24:27], s37 offen lds
mf a[124:127],a[248:251],a[184:187],0
mf a[124:127],a[252:255],a[188:191],a[124:127]
s_add_u32 m0, s34, 28672
mf a[92:95],a[252:255],a[180:183],0
s_add_u32 s36, s32, 458752
mf a[92:95],a[248:251],a[176:179],a[92:95]
buffer_load_dwordx4 v138, s[20:23], s36 offen lds
mf a[60:63],a[248:251],a[168:171],0
mf a[60:63],a[252:255],a[172:175],a[60:63]
s_add_u32 m0, s35, 26624
mf a[28:31],a[252:255],a[164:167],0
s_add_u32 s37, s33, 425984
mf a[28:31],a[248:251],a[160:163],a[28:31]
buffer_load_dwordx4 v139, s[24:27], s37 offen lds
s_add_u32 s32, s32, 128
s_add_u32 s33, s33, 524288
s_mov_b32 s38, 6
gl_12:
s_waitcnt lgkmcnt(0)
mf v[0:3],a[192:195],a[128:131],v[0:3]
ds_read_b64_tr_b16 a[224:225], v134 offset:32768
mf v[0:3],a[196:199],a[132:135],v[0:3]
buffer_load_dword v253, v252, s[60:63], s64 offen
mf v[32:35],a[196:199],a[140:143],v[32:35]
ds_read_b64_tr_b16 a[226:227], v134 offset:34816
mf v[32:35],a[192:195],a[136:139],v[32:35]
mf v[64:67],a[192:195],a[144:147],v[64:67]
ds_read_b64_tr_b16 a[228:229], v134 offset:49152
mf v[64:67],a[196:199],a[148:151],v[64:67]
mf v[96:99],a[196:199],a[156:159],v[96:99]
ds_read_b64_tr_b16 a[230:231], v134 offset:51200
mf v[96:99],a[192:195],a[152:155],v[96:99]
mf v[100:103],a[200:203],a[152:155],v[100:103]
ds_read_b64_tr_b16 a[232:233], v135 offset:32768
mf v[100:103],a[204:207],a[156:159],v[100:103]
mf v[68:71],a[204:207],a[148:151],v[68:71]
ds_read_b64_tr_b16 a[234:235], v135 offset:34816
mf v[68:71],a[200:203],a[144:147],v[68:71]
mf v[36:39],a[200:203],a[136:139],v[36:39]
ds_read_b64_tr_b16 a[236:237], v135 offset:49152
mf v[36:39],a[204:207],a[140:143],v[36:39]
mf v[4:7],a[204:207],a[132:135],v[4:7]
ds_read_b64_tr_b16 a[238:239], v135 offset:51200
mf v[4:7],a[200:203],a[128:131],v[4:7]
mf v[8:11],a[208:211],a[128:131],v[8:11]
ds_read_b64_tr_b16 a[240:241], v136 offset:32768
mf v[8:11],a[212:215],a[132:135],v[8:11]
mf v[40:43],a[212:215],a[140:143],v[40:43]
ds_read_b64_tr_b16 a[242:243], v136 offset:34816
mf v[40:43],a[208:211],a[136:139],v[40:43]
mf v[72:75],a[208:211],a[144:147],v[72:75]
ds_read_b64_tr_b16 a[244:245], v136 offset:49152
mf v[72:75],a[212:215],a[148:151],v[72:75]
mf v[104:107],a[212:215],a[156:159],v[104:107]
ds_read_b64_tr_b16 a[246:247], v136 offset:51200
mf v[104:107],a[208:211],a[152:155],v[104:107]
mf v[108:111],a[216:219],a[152:155],v[108:111]
ds_read_b64_tr_b16 a[248:249], v137 offset:32768
mf v[108:111],a[220:223],a[156:159],v[108:111]
mf v[76:79],a[220:223],a[148:151],v[76:79]
ds_read_b64_tr_b16 a[250:251], v137 offset:34816
mf v[76:79],a[216:219],a[144:147],v[76:79]
mf v[44:47],a[216:219],a[136:139],v[44:47]
ds_read_b64_tr_b16 a[252:253], v137 offset:49152
mf v[44:47],a[220:223],a[140:143],v[44:47]
mf v[12:15],a[220:223],a[132:135],v[12:15]
ds_read_b64_tr_b16 a[254:255], v137 offset:51200
s_add_u32 s64, s64, s65
mf v[12:15],a[216:219],a[128:131],v[12:15]
s_waitcnt lgkmcnt(8)
mf v[16:19],a[224:227],a[128:131],v[16:19]
mf v[16:19],a[228:231],a[132:135],v[16:19]
ds_read_b128 a[160:163], v128 offset:40960
mf v[48:51],a[228:231],a[140:143],v[48:51]
mf v[48:51],a[224:227],a[136:139],v[48:51]
mf v[80:83],a[224:227],a[144:147],v[80:83]
ds_read_b128 a[164:167], v129 offset:40960
mf v[80:83],a[228:231],a[148:151],v[80:83]
mf v[112:115],a[228:231],a[156:159],v[112:115]
mf v[112:115],a[224:227],a[152:155],v[112:115]
ds_read_b128 a[168:171], v128 offset:43008
mf v[116:119],a[232:235],a[152:155],v[116:119]
mf v[116:119],a[236:239],a[156:159],v[116:119]
mf v[84:87],a[236:239],a[148:151],v[84:87]
ds_read_b128 a[172:175], v129 offset:43008
mf v[84:87],a[232:235],a[144:147],v[84:87]
mf v[52:55],a[232:235],a[136:139],v[52:55]
mf v[52:55],a[236:239],a[140:143],v[52:55]
ds_read_b128 a[176:179], v128 offset:45056
mf v[20:23],a[236:239],a[132:135],v[20:23]
mf v[20:23],a[232:235],a[128:131],v[20:23]
s_waitcnt lgkmcnt(5)
mf v[24:27],a[240:243],a[128:131],v[24:27]
ds_read_b128 a[180:183], v129 offset:45056
mf v[24:27],a[244:247],a[132:135],v[24:27]
mf v[56:59],a[244:247],a[140:143],v[56:59]
mf v[56:59],a[240:243],a[136:139],v[56:59]
ds_read_b128 a[184:187], v128 offset:47104
mf v[88:91],a[240:243],a[144:147],v[88:91]
mf v[88:91],a[244:247],a[148:151],v[88:91]
mf v[120:123],a[244:247],a[156:159],v[120:123]
ds_read_b128 a[188:191], v129 offset:47104
mf v[120:123],a[240:243],a[152:155],v[120:123]
mf v[124:127],a[248:251],a[152:155],v[124:127]
mf v[124:127],a[252:255],a[156:159],v[124:127]
mf v[92:95],a[252:255],a[148:151],v[92:95]
mf v[92:95],a[248:251],a[144:147],v[92:95]
mf v[60:63],a[248:251],a[136:139],v[60:63]
mf v[60:63],a[252:255],a[140:143],v[60:63]
mf v[28:31],a[252:255],a[132:135],v[28:31]
mf v[28:31],a[248:251],a[128:131],v[28:31]
s_waitcnt lgkmcnt(0) vmcnt(1)
s_barrier
mf a[0:3],a[192:195],a[160:163],a[0:3]
ds_read_b128 a[128:131], v128 offset:0
ds_read_b128 a[132:135], v129 offset:0
mf a[0:3],a[196:199],a[164:167],a[0:3]
s_add_u32 m0, s34, 32768
mf a[32:35],a[196:199],a[172:175],a[32:35]
s_add_u32 s36, s32, 0
mf a[32:35],a[192:195],a[168:171],a[32:35]
buffer_load_dwordx4 v138, s[20:23], s36 offen lds
mf a[64:67],a[192:195],a[176:179],a[64:67]
ds_read_b128 a[136:139], v128 offset:2048
ds_read_b128 a[140:143], v129 offset:2048
mf a[64:67],a[196:199],a[180:183],a[64:67]
s_add_u32 m0, s35, 32768
mf a[96:99],a[196:199],a[188:191],a[96:99]
s_add_u32 s37, s33, 0
mf a[96:99],a[192:195],a[184:187],a[96:99]
buffer_load_dwordx4 v139, s[24:27], s37 offen lds
mf a[100:103],a[200:203],a[184:187],a[100:103]
ds_read_b128 a[144:147], v128 offset:4096
ds_read_b128 a[148:151], v129 offset:4096
mf a[100:103],a[204:207],a[188:191],a[100:103]
s_add_u32 m0, s34, 36864
mf a[68:71],a[204:207],a[180:183],a[68:71]
s_add_u32 s36, s32, 65536
mf a[68:71],a[200:203],a[176:179],a[68:71]
buffer_load_dwordx4 v138, s[20:23], s36 offen lds
mf a[36:39],a[200:203],a[168:171],a[36:39]
ds_read_b64_tr_b16 a[192:193], v130 offset:0
ds_read_b64_tr_b16 a[194:195], v130 offset:2048
mf a[36:39],a[204:207],a[172:175],a[36:39]
s_add_u32 m0, s35, 34816
mf a[4:7],a[204:207],a[164:167],a[4:7]
s_add_u32 s37, s33, 32768
mf a[4:7],a[200:203],a[160:163],a[4:7]
buffer_load_dwordx4 v139, s[24:27], s37 offen lds
mf a[8:11],a[208:211],a[160:163],a[8:11]
ds_read_b64_tr_b16 a[196:197], v130 offset:16384
ds_read_b64_tr_b16 a[198:199], v130 offset:18432
mf a[8:11],a[212:215],a[164:167],a[8:11]
s_add_u32 m0, s34, 40960
mf a[40:43],a[212:215],a[172:175],a[40:43]
s_add_u32 s36, s32, 131072
mf a[40:43],a[208:211],a[168:171],a[40:43]
buffer_load_dwordx4 v138, s[20:23], s36 offen lds
mf a[72:75],a[208:211],a[176:179],a[72:75]
ds_read_b128 a[152:155], v128 offset:6144
ds_read_b128 a[156:159], v129 offset:6144
mf a[72:75],a[212:215],a[180:183],a[72:75]
s_add_u32 m0, s35, 40960
mf a[104:107],a[212:215],a[188:191],a[104:107]
s_add_u32 s37, s33, 131072
mf a[104:107],a[208:211],a[184:187],a[104:107]
buffer_load_dwordx4 v139, s[24:27], s37 offen lds
mf a[108:111],a[216:219],a[184:187],a[108:111]
ds_read_b64_tr_b16 a[200:201], v131 offset:0
ds_read_b64_tr_b16 a[202:203], v131 offset:2048
mf a[108:111],a[220:223],a[188:191],a[108:111]
s_add_u32 m0, s34, 45056
mf a[76:79],a[220:223],a[180:183],a[76:79]
s_add_u32 s36, s32, 196608
mf a[76:79],a[216:219],a[176:179],a[76:79]
buffer_load_dwordx4 v138, s[20:23], s36 offen lds
mf a[44:47],a[216:219],a[168:171],a[44:47]
ds_read_b64_tr_b16 a[204:205], v131 offset:16384
ds_read_b64_tr_b16 a[206:207], v131 offset:18432
mf a[44:47],a[220:223],a[172:175],a[44:47]
s_add_u32 m0, s35, 43008
mf a[12:15],a[220:223],a[164:167],a[12:15]
s_add_u32 s37, s33, 163840
mf a[12:15],a[216:219],a[160:163],a[12:15]
buffer_load_dwordx4 v139, s[24:27], s37 offen lds
mf a[16:19],a[224:227],a[160:163],a[16:19]
mf a[16:19],a[228:231],a[164:167],a[16:19]
s_add_u32 m0, s34, 49152
mf a[48:51],a[228:231],a[172:175],a[48:51]
s_add_u32 s36, s32, 262144
mf a[48:51],a[224:227],a[168:171],a[48:51]
buffer_load_dwordx4 v138, s[20:23], s36 offen lds
mf a[80:83],a[224:227],a[176:179],a[80:83]
ds_read_b64_tr_b16 a[208:209], v132 offset:0
ds_read_b64_tr_b16 a[210:211], v132 offset:2048
mf a[80:83],a[228:231],a[180:183],a[80:83]
s_add_u32 m0, s35, 49152
mf a[112:115],a[228:231],a[188:191],a[112:115]
s_add_u32 s37, s33, 262144
mf a[112:115],a[224:227],a[184:187],a[112:115]
buffer_load_dwordx4 v139, s[24:27], s37 offen lds
mf a[116:119],a[232:235],a[184:187],a[116:119]
ds_read_b64_tr_b16 a[212:213], v132 offset:16384
ds_read_b64_tr_b16 a[214:215], v132 offset:18432
mf a[116:119],a[236:239],a[188:191],a[116:119]
s_add_u32 m0, s34, 53248
mf a[84:87],a[236:239],a[180:183],a[84:87]
s_add_u32 s36, s32, 327680
mf a[84:87],a[232:235],a[176:179],a[84:87]
buffer_load_dwordx4 v138, s[20:23], s36 offen lds
mf a[52:55],a[232:235],a[168:171],a[52:55]
mf a[52:55],a[236:239],a[172:175],a[52:55]
s_add_u32 m0, s35, 51200
mf a[20:23],a[236:239],a[164:167],a[20:23]
s_add_u32 s37, s33, 294912
mf a[20:23],a[232:235],a[160:163],a[20:23]
buffer_load_dwordx4 v139, s[24:27], s37 offen lds
mf a[24:27],a[240:243],a[160:163],a[24:27]
ds_read_b64_tr_b16 a[216:217], v133 offset:0
ds_read_b64_tr_b16 a[218:219], v133 offset:2048
mf a[24:27],a[244:247],a[164:167],a[24:27]
s_add_u32 m0, s34, 57344
mf a[56:59],a[244:247],a[172:175],a[56:59]
s_add_u32 s36, s32, 393216
mf a[56:59],a[240:243],a[168:171],a[56:59]
buffer_load_dwordx4 v138, s[20:23], s36 offen lds
mf a[88:91],a[240:243],a[176:179],a[88:91]
ds_read_b64_tr_b16 a[220:221], v133 offset:16384
ds_read_b64_tr_b16 a[222:223], v133 offset:18432
mf a[88:91],a[244:247],a[180:183],a[88:91]
s_add_u32 m0, s35, 57344
mf a[120:123],a[244:247],a[188:191],a[120:123]
s_add_u32 s37, s33, 393216
mf a[120:123],a[240:243],a[184:187],a[120:123]
buffer_load_dwordx4 v139, s[24:27], s37 offen lds
mf a[124:127],a[248:251],a[184:187],a[124:127]
mf a[124:127],a[252:255],a[188:191],a[124:127]
s_add_u32 m0, s34, 61440
mf a[92:95],a[252:255],a[180:183],a[92:95]
s_add_u32 s36, s32, 458752
mf a[92:95],a[248:251],a[176:179],a[92:95]
buffer_load_dwordx4 v138, s[20:23], s36 offen lds
mf a[60:63],a[248:251],a[168:171],a[60:63]
mf a[60:63],a[252:255],a[172:175],a[60:63]
s_add_u32 m0, s35, 59392
mf a[28:31],a[252:255],a[164:167],a[28:31]
s_add_u32 s37, s33, 425984
mf a[28:31],a[248:251],a[160:163],a[28:31]
buffer_load_dwordx4 v139, s[24:27], s37 offen lds
s_add_u32 s32, s32, 128
s_add_u32 s33, s33, 524288
s_waitcnt lgkmcnt(0)
mf v[0:3],a[192:195],a[128:131],v[0:3]
ds_read_b64_tr_b16 a[224:225], v134 offset:0
mf v[0:3],a[196:199],a[132:135],v[0:3]
buffer_load_dword v253, v252, s[60:63], s64 offen
mf v[32:35],a[196:199],a[140:143],v[32:35]
ds_read_b64_tr_b16 a[226:227], v134 offset:2048
mf v[32:35],a[192:195],a[136:139],v[32:35]
mf v[64:67],a[192:195],a[144:147],v[64:67]
ds_read_b64_tr_b16 a[228:229], v134 offset:16384
mf v[64:67],a[196:199],a[148:151],v[64:67]
mf v[96:99],a[196:199],a[156:159],v[96:99]
ds_read_b64_tr_b16 a[230:231], v134 offset:18432
mf v[96:99],a[192:195],a[152:155],v[96:99]
mf v[100:103],a[200:203],a[152:155],v[100:103]
ds_read_b64_tr_b16 a[232:233], v135 offset:0
mf v[100:103],a[204:207],a[156:159],v[100:103]
mf v[68:71],a[204:207],a[148:151],v[68:71]
ds_read_b64_tr_b16 a[234:235], v135 offset:2048
mf v[68:71],a[200:203],a[144:147],v[68:71]
mf v[36:39],a[200:203],a[136:139],v[36:39]
ds_read_b64_tr_b16 a[236:237], v135 offset:16384
mf v[36:39],a[204:207],a[140:143],v[36:39]
mf v[4:7],a[204:207],a[132:135],v[4:7]
ds_read_b64_tr_b16 a[238:239], v135 offset:18432
mf v[4:7],a[200:203],a[128:131],v[4:7]
mf v[8:11],a[208:211],a[128:131],v[8:11]
ds_read_b64_tr_b16 a[240:241], v136 offset:0
mf v[8:11],a[212:215],a[132:135],v[8:11]
mf v[40:43],a[212:215],a[140:143],v[40:43]
ds_read_b64_tr_b16 a[242:243], v136 offset:2048
mf v[40:43],a[208:211],a[136:139],v[40:43]
mf v[72:75],a[208:211],a[144:147],v[72:75]
ds_read_b64_tr_b16 a[244:245], v136 offset:16384
mf v[72:75],a[212:215],a[148:151],v[72:75]
mf v[104:107],a[212:215],a[156:159],v[104:107]
ds_read_b64_tr_b16 a[246:247], v136 offset:18432
mf v[104:107],a[208:211],a[152:155],v[104:107]
mf v[108:111],a[216:219],a[152:155],v[108:111]
ds_read_b64_tr_b16 a[248:249], v137 offset:0
mf v[108:111],a[220:223],a[156:159],v[108:111]
mf v[76:79],a[220:223],a[148:151],v[76:79]
ds_read_b64_tr_b16 a[250:251], v137 offset:2048
mf v[76:79],a[216:219],a[144:147],v[76:79]
mf v[44:47],a[216:219],a[136:139],v[44:47]
ds_read_b64_tr_b16 a[252:253], v137 offset:16384
mf v[44:47],a[220:223],a[140:143],v[44:47]
mf v[12:15],a[220:223],a[132:135],v[12:15]
ds_read_b64_tr_b16 a[254:255], v137 offset:18432
s_add_u32 s64, s64, s65
mf v[12:15],a[216:219],a[128:131],v[12:15]
s_waitcnt lgkmcnt(8)
mf v[16:19],a[224:227],a[128:131],v[16:19]
mf v[16:19],a[228:231],a[132:135],v[16:19]
ds_read_b128 a[160:163], v128 offset:8192
mf v[48:51],a[228:231],a[140:143],v[48:51]
mf v[48:51],a[224:227],a[136:139],v[48:51]
mf v[80:83],a[224:227],a[144:147],v[80:83]
ds_read_b128 a[164:167], v129 offset:8192
mf v[80:83],a[228:231],a[148:151],v[80:83]
mf v[112:115],a[228:231],a[156:159],v[112:115]
mf v[112:115],a[224:227],a[152:155],v[112:115]
ds_read_b128 a[168:171], v128 offset:10240
mf v[116:119],a[232:235],a[152:155],v[116:119]
mf v[116:119],a[236:239],a[156:159],v[116:119]
mf v[84:87],a[236:239],a[148:151],v[84:87]
ds_read_b128 a[172:175], v129 offset:10240
mf v[84:87],a[232:235],a[144:147],v[84:87]
mf v[52:55],a[232:235],a[136:139],v[52:55]
mf v[52:55],a[236:239],a[140:143],v[52:55]
ds_read_b128 a[176:179], v128 offset:12288
mf v[20:23],a[236:239],a[132:135],v[20:23]
mf v[20:23],a[232:235],a[128:131],v[20:23]
s_waitcnt lgkmcnt(5)
mf v[24:27],a[240:243],a[128:131],v[24:27]
ds_read_b128 a[180:183], v129 offset:12288
mf v[24:27],a[244:247],a[132:135],v[24:27]
mf v[56:59],a[244:247],a[140:143],v[56:59]
mf v[56:59],a[240:243],a[136:139],v[56:59]
ds_read_b128 a[184:187], v128 offset:14336
mf v[88:91],a[240:243],a[144:147],v[88:91]
mf v[88:91],a[244:247],a[148:151],v[88:91]
mf v[120:123],a[244:247],a[156:159],v[120:123]
ds_read_b128 a[188:191], v129 offset:14336
mf v[120:123],a[240:243],a[152:155],v[120:123]
mf v[124:127],a[248:251],a[152:155],v[124:127]
mf v[124:127],a[252:255],a[156:159],v[124:127]
mf v[92:95],a[252:255],a[148:151],v[92:95]
mf v[92:95],a[248:251],a[144:147],v[92:95]
mf v[60:63],a[248:251],a[136:139],v[60:63]
mf v[60:63],a[252:255],a[140:143],v[60:63]
mf v[28:31],a[252:255],a[132:135],v[28:31]
mf v[28:31],a[248:251],a[128:131],v[28:31]
s_waitcnt lgkmcnt(0) vmcnt(1)
s_barrier
mf a[0:3],a[192:195],a[160:163],a[0:3]
ds_read_b128 a[128:131], v128 offset:32768
ds_read_b128 a[132:135], v129 offset:32768
mf a[0:3],a[196:199],a[164:167],a[0:3]
s_add_u32 m0, s34, 0
mf a[32:35],a[196:199],a[172:175],a[32:35]
s_add_u32 s36, s32, 0
mf a[32:35],a[192:195],a[168:171],a[32:35]
buffer_load_dwordx4 v138, s[20:23], s36 offen lds
mf a[64:67],a[192:195],a[176:179],a[64:67]
ds_read_b128 a[136:139], v128 offset:34816
ds_read_b128 a[140:143], v129 offset:34816
mf a[64:67],a[196:199],a[180:183],a[64:67]
s_add_u32 m0, s35, 0
mf a[96:99],a[196:199],a[188:191],a[96:99]
s_add_u32 s37, s33, 0
mf a[96:99],a[192:195],a[184:187],a[96:99]
buffer_load_dwordx4 v139, s[24:27], s37 offen lds
mf a[100:103],a[200:203],a[184:187],a[100:103]
ds_read_b128 a[144:147], v128 offset:36864
ds_read_b128 a[148:151], v129 offset:36864
mf a[100:103],a[204:207],a[188:191],a[100:103]
s_add_u32 m0, s34, 4096
mf a[68:71],a[204:207],a[180:183],a[68:71]
s_add_u32 s36, s32, 65536
mf a[68:71],a[200:203],a[176:179],a[68:71]
buffer_load_dwordx4 v138, s[20:23], s36 offen lds
mf a[36:39],a[200:203],a[168:171],a[36:39]
ds_read_b64_tr_b16 a[192:193], v130 offset:32768
ds_read_b64_tr_b16 a[194:195], v130 offset:34816
mf a[36:39],a[204:207],a[172:175],a[36:39]
s_add_u32 m0, s35, 2048
mf a[4:7],a[204:207],a[164:167],a[4:7]
s_add_u32 s37, s33, 32768
mf a[4:7],a[200:203],a[160:163],a[4:7]
buffer_load_dwordx4 v139, s[24:27], s37 offen lds
mf a[8:11],a[208:211],a[160:163],a[8:11]
ds_read_b64_tr_b16 a[196:197], v130 offset:49152
ds_read_b64_tr_b16 a[198:199], v130 offset:51200
mf a[8:11],a[212:215],a[164:167],a[8:11]
s_add_u32 m0, s34, 8192
mf a[40:43],a[212:215],a[172:175],a[40:43]
s_add_u32 s36, s32, 131072
mf a[40:43],a[208:211],a[168:171],a[40:43]
buffer_load_dwordx4 v138, s[20:23], s36 offen lds
mf a[72:75],a[208:211],a[176:179],a[72:75]
ds_read_b128 a[152:155], v128 offset:38912
ds_read_b128 a[156:159], v129 offset:38912
mf a[72:75],a[212:215],a[180:183],a[72:75]
s_add_u32 m0, s35, 8192
mf a[104:107],a[212:215],a[188:191],a[104:107]
s_add_u32 s37, s33, 131072
mf a[104:107],a[208:211],a[184:187],a[104:107]
buffer_load_dwordx4 v139, s[24:27], s37 offen lds
mf a[108:111],a[216:219],a[184:187],a[108:111]
ds_read_b64_tr_b16 a[200:201], v131 offset:32768
ds_read_b64_tr_b16 a[202:203], v131 offset:34816
mf a[108:111],a[220:223],a[188:191],a[108:111]
s_add_u32 m0, s34, 12288
mf a[76:79],a[220:223],a[180:183],a[76:79]
s_add_u32 s36, s32, 196608
mf a[76:79],a[216:219],a[176:179],a[76:79]
buffer_load_dwordx4 v138, s[20:23], s36 offen lds
mf a[44:47],a[216:219],a[168:171],a[44:47]
ds_read_b64_tr_b16 a[204:205], v131 offset:49152
ds_read_b64_tr_b16 a[206:207], v131 offset:51200
mf a[44:47],a[220:223],a[172:175],a[44:47]
s_add_u32 m0, s35, 10240
mf a[12:15],a[220:223],a[164:167],a[12:15]
s_add_u32 s37, s33, 163840
mf a[12:15],a[216:219],a[160:163],a[12:15]
buffer_load_dwordx4 v139, s[24:27], s37 offen lds
mf a[16:19],a[224:227],a[160:163],a[16:19]
mf a[16:19],a[228:231],a[164:167],a[16:19]
s_add_u32 m0, s34, 16384
mf a[48:51],a[228:231],a[172:175],a[48:51]
s_add_u32 s36, s32, 262144
mf a[48:51],a[224:227],a[168:171],a[48:51]
buffer_load_dwordx4 v138, s[20:23], s36 offen lds
mf a[80:83],a[224:227],a[176:179],a[80:83]
ds_read_b64_tr_b16 a[208:209], v132 offset:32768
ds_read_b64_tr_b16 a[210:211], v132 offset:34816
mf a[80:83],a[228:231],a[180:183],a[80:83]
s_add_u32 m0, s35, 16384
mf a[112:115],a[228:231],a[188:191],a[112:115]
s_add_u32 s37, s33, 262144
mf a[112:115],a[224:227],a[184:187],a[112:115]
buffer_load_dwordx4 v139, s[24:27], s37 offen lds
mf a[116:119],a[232:235],a[184:187],a[116:119]
ds_read_b64_tr_b16 a[212:213], v132 offset:49152
ds_read_b64_tr_b16 a[214:215], v132 offset:51200
mf a[116:119],a[236:239],a[188:191],a[116:119]
s_add_u32 m0, s34, 20480
mf a[84:87],a[236:239],a[180:183],a[84:87]
s_add_u32 s36, s32, 327680
mf a[84:87],a[232:235],a[176:179],a[84:87]
buffer_load_dwordx4 v138, s[20:23], s36 offen lds
mf a[52:55],a[232:235],a[168:171],a[52:55]
mf a[52:55],a[236:239],a[172:175],a[52:55]
s_add_u32 m0, s35, 18432
mf a[20:23],a[236:239],a[164:167],a[20:23]
s_add_u32 s37, s33, 294912
mf a[20:23],a[232:235],a[160:163],a[20:23]
buffer_load_dwordx4 v139, s[24:27], s37 offen lds
mf a[24:27],a[240:243],a[160:163],a[24:27]
ds_read_b64_tr_b16 a[216:217], v133 offset:32768
ds_read_b64_tr_b16 a[218:219], v133 offset:34816
mf a[24:27],a[244:247],a[164:167],a[24:27]
s_add_u32 m0, s34, 24576
mf a[56:59],a[244:247],a[172:175],a[56:59]
s_add_u32 s36, s32, 393216
mf a[56:59],a[240:243],a[168:171],a[56:59]
buffer_load_dwordx4 v138, s[20:23], s36 offen lds
mf a[88:91],a[240:243],a[176:179],a[88:91]
ds_read_b64_tr_b16 a[220:221], v133 offset:49152
ds_read_b64_tr_b16 a[222:223], v133 offset:51200
mf a[88:91],a[244:247],a[180:183],a[88:91]
s_add_u32 m0, s35, 24576
mf a[120:123],a[244:247],a[188:191],a[120:123]
s_add_u32 s37, s33, 393216
mf a[120:123],a[240:243],a[184:187],a[120:123]
buffer_load_dwordx4 v139, s[24:27], s37 offen lds
mf a[124:127],a[248:251],a[184:187],a[124:127]
mf a[124:127],a[252:255],a[188:191],a[124:127]
s_add_u32 m0, s34, 28672
mf a[92:95],a[252:255],a[180:183],a[92:95]
s_add_u32 s36, s32, 458752
mf a[92:95],a[248:251],a[176:179],a[92:95]
buffer_load_dwordx4 v138, s[20:23], s36 offen lds
mf a[60:63],a[248:251],a[168:171],a[60:63]
mf a[60:63],a[252:255],a[172:175],a[60:63]
s_add_u32 m0, s35, 26624
mf a[28:31],a[252:255],a[164:167],a[28:31]
s_add_u32 s37, s33, 425984
mf a[28:31],a[248:251],a[160:163],a[28:31]
buffer_load_dwordx4 v139, s[24:27], s37 offen lds
s_add_u32 s32, s32, 128
s_add_u32 s33, s33, 524288
s_sub_u32 s38, s38, 1
s_cmp_lg_u32 s38, 0
s_cbranch_scc1 gl_12
s_waitcnt lgkmcnt(0)
mf v[0:3],a[192:195],a[128:131],v[0:3]
ds_read_b64_tr_b16 a[224:225], v134 offset:32768
mf v[0:3],a[196:199],a[132:135],v[0:3]
s_mov_b32 s56, s68
mf v[32:35],a[196:199],a[140:143],v[32:35]
ds_read_b64_tr_b16 a[226:227], v134 offset:34816
s_and_b32 s57, s69, 0xffff
mf v[32:35],a[192:195],a[136:139],v[32:35]
s_mov_b32 s58, 256
mf v[64:67],a[192:195],a[144:147],v[64:67]
ds_read_b64_tr_b16 a[228:229], v134 offset:49152
s_mov_b32 s59, 0x20000
mf v[64:67],a[196:199],a[148:151],v[64:67]
v_lshlrev_b32 v252, 2, v255
mf v[96:99],a[196:199],a[156:159],v[96:99]
ds_read_b64_tr_b16 a[230:231], v134 offset:51200
buffer_load_dword v254, v252, s[56:59], 0 offen sc1
mf v[96:99],a[192:195],a[152:155],v[96:99]
s_lshl_b32 s17, s42, 2
mf v[100:103],a[200:203],a[152:155],v[100:103]
ds_read_b64_tr_b16 a[232:233], v135 offset:32768
s_add_u32 s17, s17, s16
mf v[100:103],a[204:207],a[156:159],v[100:103]
s_lshl_b32 s17, s17, 11
mf v[68:71],a[204:207],a[148:151],v[68:71]
ds_read_b64_tr_b16 a[234:235], v135 offset:34816
mf v[68:71],a[200:203],a[144:147],v[68:71]
v_lshl_add_u32 v146, v255, 5, s17
mf v[36:39],a[200:203],a[136:139],v[36:39]
ds_read_b64_tr_b16 a[236:237], v135 offset:49152
v_min_u32 v146, code_end-go-4, v146
mf v[36:39],a[204:207],a[140:143],v[36:39]
global_load_dword v253, v146, s[100:101]
mf v[4:7],a[204:207],a[132:135],v[4:7]
ds_read_b64_tr_b16 a[238:239], v135 offset:51200
s_load_dwordx2 s[8:9], s[0:1], 88
mf v[4:7],a[200:203],a[128:131],v[4:7]
mf v[8:11],a[208:211],a[128:131],v[8:11]
ds_read_b64_tr_b16 a[240:241], v136 offset:32768
mf v[8:11],a[212:215],a[132:135],v[8:11]
mf v[40:43],a[212:215],a[140:143],v[40:43]
ds_read_b64_tr_b16 a[242:243], v136 offset:34816
mf v[40:43],a[208:211],a[136:139],v[40:43]
mf v[72:75],a[208:211],a[144:147],v[72:75]
ds_read_b64_tr_b16 a[244:245], v136 offset:49152
mf v[72:75],a[212:215],a[148:151],v[72:75]
mf v[104:107],a[212:215],a[156:159],v[104:107]
ds_read_b64_tr_b16 a[246:247], v136 offset:51200
mf v[104:107],a[208:211],a[152:155],v[104:107]
mf v[108:111],a[216:219],a[152:155],v[108:111]
ds_read_b64_tr_b16 a[248:249], v137 offset:32768
mf v[108:111],a[220:223],a[156:159],v[108:111]
mf v[76:79],a[220:223],a[148:151],v[76:79]
ds_read_b64_tr_b16 a[250:251], v137 offset:34816
mf v[76:79],a[216:219],a[144:147],v[76:79]
mf v[44:47],a[216:219],a[136:139],v[44:47]
ds_read_b64_tr_b16 a[252:253], v137 offset:49152
mf v[44:47],a[220:223],a[140:143],v[44:47]
mf v[12:15],a[220:223],a[132:135],v[12:15]
ds_read_b64_tr_b16 a[254:255], v137 offset:51200
mf v[12:15],a[216:219],a[128:131],v[12:15]
s_waitcnt lgkmcnt(8)
mf v[16:19],a[224:227],a[128:131],v[16:19]
mf v[16:19],a[228:231],a[132:135],v[16:19]
ds_read_b128 a[160:163], v128 offset:40960
mf v[48:51],a[228:231],a[140:143],v[48:51]
mf v[48:51],a[224:227],a[136:139],v[48:51]
mf v[80:83],a[224:227],a[144:147],v[80:83]
ds_read_b128 a[164:167], v129 offset:40960
mf v[80:83],a[228:231],a[148:151],v[80:83]
mf v[112:115],a[228:231],a[156:159],v[112:115]
mf v[112:115],a[224:227],a[152:155],v[112:115]
ds_read_b128 a[168:171], v128 offset:43008
mf v[116:119],a[232:235],a[152:155],v[116:119]
mf v[116:119],a[236:239],a[156:159],v[116:119]
mf v[84:87],a[236:239],a[148:151],v[84:87]
ds_read_b128 a[172:175], v129 offset:43008
mf v[84:87],a[232:235],a[144:147],v[84:87]
mf v[52:55],a[232:235],a[136:139],v[52:55]
mf v[52:55],a[236:239],a[140:143],v[52:55]
ds_read_b128 a[176:179], v128 offset:45056
mf v[20:23],a[236:239],a[132:135],v[20:23]
mf v[20:23],a[232:235],a[128:131],v[20:23]
s_waitcnt lgkmcnt(5)
mf v[24:27],a[240:243],a[128:131],v[24:27]
ds_read_b128 a[180:183], v129 offset:45056
mf v[24:27],a[244:247],a[132:135],v[24:27]
mf v[56:59],a[244:247],a[140:143],v[56:59]
mf v[56:59],a[240:243],a[136:139],v[56:59]
ds_read_b128 a[184:187], v128 offset:47104
mf v[88:91],a[240:243],a[144:147],v[88:91]
mf v[88:91],a[244:247],a[148:151],v[88:91]
mf v[120:123],a[244:247],a[156:159],v[120:123]
ds_read_b128 a[188:191], v129 offset:47104
mf v[120:123],a[240:243],a[152:155],v[120:123]
mf v[124:127],a[248:251],a[152:155],v[124:127]
mf v[124:127],a[252:255],a[156:159],v[124:127]
mf v[92:95],a[252:255],a[148:151],v[92:95]
mf v[92:95],a[248:251],a[144:147],v[92:95]
mf v[60:63],a[248:251],a[136:139],v[60:63]
mf v[60:63],a[252:255],a[140:143],v[60:63]
mf v[28:31],a[252:255],a[132:135],v[28:31]
mf v[28:31],a[248:251],a[128:131],v[28:31]
s_waitcnt lgkmcnt(0) vmcnt(1)
s_barrier
s_mov_b64 exec, 0xff
v_cmp_gt_u32 vcc, 1, v254
s_mov_b64 exec, -1
s_cbranch_vccz chk_13
s_mov_b32 s67, 0x80000
s_mov_b64 exec, 0xff
poll_14:
buffer_load_dword v254, v252, s[56:59], 0 offen sc1
s_waitcnt vmcnt(0)
v_cmp_gt_u32 vcc, 1, v254
s_cbranch_vccz pollok_15
s_sleep 2
s_sub_u32 s67, s67, 1
s_cmp_lg_u32 s67, 0
s_cbranch_scc1 poll_14
pollok_15:
s_mov_b64 exec, -1
chk_13:
mf a[0:3],a[192:195],a[160:163],a[0:3]
ds_read_b128 a[128:131], v128 offset:0
ds_read_b128 a[132:135], v129 offset:0
mf a[0:3],a[196:199],a[164:167],a[0:3]
s_add_u32 m0, s34, 32768
mf a[32:35],a[196:199],a[172:175],a[32:35]
s_add_u32 s36, s32, 0
mf a[32:35],a[192:195],a[168:171],a[32:35]
buffer_load_dwordx4 v138, s[20:23], s36 offen lds
mf a[64:67],a[192:195],a[176:179],a[64:67]
ds_read_b128 a[136:139], v128 offset:2048
ds_read_b128 a[140:143], v129 offset:2048
mf a[64:67],a[196:199],a[180:183],a[64:67]
s_add_u32 m0, s35, 32768
mf a[96:99],a[196:199],a[188:191],a[96:99]
s_add_u32 s37, s33, 0
mf a[96:99],a[192:195],a[184:187],a[96:99]
buffer_load_dwordx4 v139, s[24:27], s37 offen lds
mf a[100:103],a[200:203],a[184:187],a[100:103]
ds_read_b128 a[144:147], v128 offset:4096
ds_read_b128 a[148:151], v129 offset:4096
mf a[100:103],a[204:207],a[188:191],a[100:103]
s_add_u32 m0, s34, 36864
mf a[68:71],a[204:207],a[180:183],a[68:71]
s_add_u32 s36, s32, 65536
mf a[68:71],a[200:203],a[176:179],a[68:71]
buffer_load_dwordx4 v138, s[20:23], s36 offen lds
mf a[36:39],a[200:203],a[168:171],a[36:39]
ds_read_b64_tr_b16 a[192:193], v130 offset:0
ds_read_b64_tr_b16 a[194:195], v130 offset:2048
mf a[36:39],a[204:207],a[172:175],a[36:39]
s_add_u32 m0, s35, 34816
mf a[4:7],a[204:207],a[164:167],a[4:7]
s_add_u32 s37, s33, 32768
mf a[4:7],a[200:203],a[160:163],a[4:7]
buffer_load_dwordx4 v139, s[24:27], s37 offen lds
mf a[8:11],a[208:211],a[160:163],a[8:11]
ds_read_b64_tr_b16 a[196:197], v130 offset:16384
ds_read_b64_tr_b16 a[198:199], v130 offset:18432
mf a[8:11],a[212:215],a[164:167],a[8:11]
s_add_u32 m0, s34, 40960
mf a[40:43],a[212:215],a[172:175],a[40:43]
s_add_u32 s36, s32, 131072
mf a[40:43],a[208:211],a[168:171],a[40:43]
buffer_load_dwordx4 v138, s[20:23], s36 offen lds
mf a[72:75],a[208:211],a[176:179],a[72:75]
ds_read_b128 a[152:155], v128 offset:6144
ds_read_b128 a[156:159], v129 offset:6144
mf a[72:75],a[212:215],a[180:183],a[72:75]
s_add_u32 m0, s35, 40960
mf a[104:107],a[212:215],a[188:191],a[104:107]
s_add_u32 s37, s33, 131072
mf a[104:107],a[208:211],a[184:187],a[104:107]
buffer_load_dwordx4 v139, s[24:27], s37 offen lds
mf a[108:111],a[216:219],a[184:187],a[108:111]
ds_read_b64_tr_b16 a[200:201], v131 offset:0
ds_read_b64_tr_b16 a[202:203], v131 offset:2048
mf a[108:111],a[220:223],a[188:191],a[108:111]
s_add_u32 m0, s34, 45056
mf a[76:79],a[220:223],a[180:183],a[76:79]
s_add_u32 s36, s32, 196608
mf a[76:79],a[216:219],a[176:179],a[76:79]
buffer_load_dwordx4 v138, s[20:23], s36 offen lds
mf a[44:47],a[216:219],a[168:171],a[44:47]
ds_read_b64_tr_b16 a[204:205], v131 offset:16384
ds_read_b64_tr_b16 a[206:207], v131 offset:18432
mf a[44:47],a[220:223],a[172:175],a[44:47]
s_add_u32 m0, s35, 43008
mf a[12:15],a[220:223],a[164:167],a[12:15]
s_add_u32 s37, s33, 163840
mf a[12:15],a[216:219],a[160:163],a[12:15]
buffer_load_dwordx4 v139, s[24:27], s37 offen lds
mf a[16:19],a[224:227],a[160:163],a[16:19]
mf a[16:19],a[228:231],a[164:167],a[16:19]
s_add_u32 m0, s34, 49152
mf a[48:51],a[228:231],a[172:175],a[48:51]
s_add_u32 s36, s32, 262144
mf a[48:51],a[224:227],a[168:171],a[48:51]
buffer_load_dwordx4 v138, s[20:23], s36 offen lds
mf a[80:83],a[224:227],a[176:179],a[80:83]
ds_read_b64_tr_b16 a[208:209], v132 offset:0
ds_read_b64_tr_b16 a[210:211], v132 offset:2048
mf a[80:83],a[228:231],a[180:183],a[80:83]
s_add_u32 m0, s35, 49152
mf a[112:115],a[228:231],a[188:191],a[112:115]
s_add_u32 s37, s33, 262144
mf a[112:115],a[224:227],a[184:187],a[112:115]
buffer_load_dwordx4 v139, s[24:27], s37 offen lds
mf a[116:119],a[232:235],a[184:187],a[116:119]
ds_read_b64_tr_b16 a[212:213], v132 offset:16384
ds_read_b64_tr_b16 a[214:215], v132 offset:18432
mf a[116:119],a[236:239],a[188:191],a[116:119]
s_add_u32 m0, s34, 53248
mf a[84:87],a[236:239],a[180:183],a[84:87]
s_add_u32 s36, s32, 327680
mf a[84:87],a[232:235],a[176:179],a[84:87]
buffer_load_dwordx4 v138, s[20:23], s36 offen lds
mf a[52:55],a[232:235],a[168:171],a[52:55]
mf a[52:55],a[236:239],a[172:175],a[52:55]
s_add_u32 m0, s35, 51200
mf a[20:23],a[236:239],a[164:167],a[20:23]
s_add_u32 s37, s33, 294912
mf a[20:23],a[232:235],a[160:163],a[20:23]
buffer_load_dwordx4 v139, s[24:27], s37 offen lds
mf a[24:27],a[240:243],a[160:163],a[24:27]
ds_read_b64_tr_b16 a[216:217], v133 offset:0
ds_read_b64_tr_b16 a[218:219], v133 offset:2048
mf a[24:27],a[244:247],a[164:167],a[24:27]
s_add_u32 m0, s34, 57344
mf a[56:59],a[244:247],a[172:175],a[56:59]
s_add_u32 s36, s32, 393216
mf a[56:59],a[240:243],a[168:171],a[56:59]
buffer_load_dwordx4 v138, s[20:23], s36 offen lds
mf a[88:91],a[240:243],a[176:179],a[88:91]
ds_read_b64_tr_b16 a[220:221], v133 offset:16384
ds_read_b64_tr_b16 a[222:223], v133 offset:18432
mf a[88:91],a[244:247],a[180:183],a[88:91]
s_add_u32 m0, s35, 57344
mf a[120:123],a[244:247],a[188:191],a[120:123]
s_add_u32 s37, s33, 393216
mf a[120:123],a[240:243],a[184:187],a[120:123]
buffer_load_dwordx4 v139, s[24:27], s37 offen lds
mf a[124:127],a[248:251],a[184:187],a[124:127]
mf a[124:127],a[252:255],a[188:191],a[124:127]
s_add_u32 m0, s34, 61440
mf a[92:95],a[252:255],a[180:183],a[92:95]
s_add_u32 s36, s32, 458752
mf a[92:95],a[248:251],a[176:179],a[92:95]
buffer_load_dwordx4 v138, s[20:23], s36 offen lds
mf a[60:63],a[248:251],a[168:171],a[60:63]
mf a[60:63],a[252:255],a[172:175],a[60:63]
s_add_u32 m0, s35, 59392
mf a[28:31],a[252:255],a[164:167],a[28:31]
s_add_u32 s37, s33, 425984
mf a[28:31],a[248:251],a[160:163],a[28:31]
buffer_load_dwordx4 v139, s[24:27], s37 offen lds
s_add_u32 s32, s32, 128
s_add_u32 s33, s33, 524288
s_cmp_ge_u32 s42, 16
s_cbranch_scc1 atype_16
s_waitcnt lgkmcnt(0)
mf v[0:3],a[192:195],a[128:131],v[0:3]
ds_read_b64_tr_b16 a[224:225], v134 offset:0
mf v[0:3],a[196:199],a[132:135],v[0:3]
s_mov_b32 s60, s44
mf v[32:35],a[196:199],a[140:143],v[32:35]
ds_read_b64_tr_b16 a[226:227], v134 offset:2048
s_and_b32 s61, s45, 0xffff
mf v[32:35],a[192:195],a[136:139],v[32:35]
s_mov_b32 s62, 1835008
mf v[64:67],a[192:195],a[144:147],v[64:67]
ds_read_b64_tr_b16 a[228:229], v134 offset:16384
s_mov_b32 s63, 0x20000
mf v[64:67],a[196:199],a[148:151],v[64:67]
s_sub_u32 s64, 15, s14
mf v[96:99],a[196:199],a[156:159],v[96:99]
ds_read_b64_tr_b16 a[230:231], v134 offset:18432
s_bitcmp1_b32 s15, 0
mf v[96:99],a[192:195],a[152:155],v[96:99]
s_cselect_b32 s64, s14, s64
mf v[100:103],a[200:203],a[152:155],v[100:103]
ds_read_b64_tr_b16 a[232:233], v135 offset:0
s_mul_i32 s64, s64, 114688
mf v[100:103],a[204:207],a[156:159],v[100:103]
s_mul_i32 s65, s16, 28672
mf v[68:71],a[204:207],a[148:151],v[68:71]
ds_read_b64_tr_b16 a[234:235], v135 offset:2048
s_add_u32 s64, s64, s65
mf v[68:71],a[200:203],a[144:147],v[68:71]
v_lshlrev_b32 v148, 7, v255
mf v[36:39],a[200:203],a[136:139],v[36:39]
ds_read_b64_tr_b16 a[236:237], v135 offset:16384
buffer_load_dword v149, v148, s[60:63], s64 offen
mf v[36:39],a[204:207],a[140:143],v[36:39]
s_add_u32 s64, s64, 7168
mf v[4:7],a[204:207],a[132:135],v[4:7]
ds_read_b64_tr_b16 a[238:239], v135 offset:18432
s_mov_b64 s[58:59], s[46:47]
mf v[4:7],a[200:203],a[128:131],v[4:7]
s_mov_b32 s44, s44
mf v[8:11],a[208:211],a[128:131],v[8:11]
ds_read_b64_tr_b16 a[240:241], v136 offset:0
s_and_b32 s45, s45, 0xffff
mf v[8:11],a[212:215],a[132:135],v[8:11]
s_mov_b32 s46, 1835008
mf v[40:43],a[212:215],a[140:143],v[40:43]
ds_read_b64_tr_b16 a[242:243], v136 offset:2048
s_mov_b32 s47, 0x20000
mf v[40:43],a[208:211],a[136:139],v[40:43]
s_mov_b32 s48, s58
mf v[72:75],a[208:211],a[144:147],v[72:75]
ds_read_b64_tr_b16 a[244:245], v136 offset:16384
s_and_b32 s49, s59, 0xffff
mf v[72:75],a[212:215],a[148:151],v[72:75]
s_mov_b32 s50, 3670016
mf v[104:107],a[212:215],a[156:159],v[104:107]
ds_read_b64_tr_b16 a[246:247], v136 offset:18432
s_mov_b32 s51, 0x20000
mf v[104:107],a[208:211],a[152:155],v[104:107]
v_lshrrev_b32 v143, 3, v255
mf v[108:111],a[216:219],a[152:155],v[108:111]
ds_read_b64_tr_b16 a[248:249], v137 offset:0
s_lshl_b32 s17, s16, 3
mf v[108:111],a[220:223],a[156:159],v[108:111]
v_add_u32 v143, s17, v143
mf v[76:79],a[220:223],a[148:151],v[76:79]
ds_read_b64_tr_b16 a[250:251], v137 offset:2048
v_bfe_u32 v144, v143, 1, 3
mf v[76:79],a[216:219],a[144:147],v[76:79]
v_and_b32 v145, 7, v255
mf v[44:47],a[216:219],a[136:139],v[44:47]
ds_read_b64_tr_b16 a[252:253], v137 offset:16384
v_xor_b32 v144, v144, v145
mf v[44:47],a[220:223],a[140:143],v[44:47]
v_lshlrev_b32 v144, 4, v144
mf v[12:15],a[220:223],a[132:135],v[12:15]
ds_read_b64_tr_b16 a[254:255], v137 offset:18432
mf v[12:15],a[216:219],a[128:131],v[12:15]
v_mul_u32_u24 v143, 896, v143
s_waitcnt lgkmcnt(8)
mf v[16:19],a[224:227],a[128:131],v[16:19]
v_add_u32 v140, v143, v144
mf v[16:19],a[228:231],a[132:135],v[16:19]
ds_read_b128 a[160:163], v128 offset:8192
s_and_b32 s17, s16, 1
mf v[48:51],a[228:231],a[140:143],v[48:51]
s_lshr_b32 s18, s16, 1
mf v[48:51],a[224:227],a[136:139],v[48:51]
buffer_load_dword v149, v148, s[60:63], s64 offen
mf v[80:83],a[224:227],a[144:147],v[80:83]
ds_read_b128 a[164:167], v129 offset:8192
s_add_u32 s64, s64, 7168
mf v[80:83],a[228:231],a[148:151],v[80:83]
s_lshl_b32 s18, s18, 2
mf v[112:115],a[228:231],a[156:159],v[112:115]
s_add_u32 s17, s17, s18
mf v[112:115],a[224:227],a[152:155],v[112:115]
ds_read_b128 a[168:171], v128 offset:10240
s_lshl_b32 s17, s17, 1
mf v[116:119],a[232:235],a[152:155],v[116:119]
v_lshrrev_b32 v143, 5, v255
mf v[116:119],a[236:239],a[156:159],v[116:119]
v_add_u32 v143, s17, v143
mf v[84:87],a[236:239],a[148:151],v[84:87]
ds_read_b128 a[172:175], v129 offset:10240
v_and_b32 v144, 3, v143
mf v[84:87],a[232:235],a[144:147],v[84:87]
v_bfe_u32 v145, v143, 3, 1
mf v[52:55],a[232:235],a[136:139],v[52:55]
v_lshl_add_u32 v144, v145, 2, v144
mf v[52:55],a[236:239],a[140:143],v[52:55]
ds_read_b128 a[176:179], v128 offset:12288
v_lshlrev_b32 v144, 1, v144
mf v[20:23],a[236:239],a[132:135],v[20:23]
v_and_b32 v145, 31, v255
mf v[20:23],a[232:235],a[128:131],v[20:23]
v_xor_b32 v144, v144, v145
s_waitcnt lgkmcnt(5)
mf v[24:27],a[240:243],a[128:131],v[24:27]
ds_read_b128 a[180:183], v129 offset:12288
v_lshlrev_b32 v144, 4, v144
mf v[24:27],a[244:247],a[132:135],v[24:27]
v_mul_u32_u24 v143, 8192, v143
mf v[56:59],a[244:247],a[140:143],v[56:59]
v_add_u32 v141, v143, v144
mf v[56:59],a[240:243],a[136:139],v[56:59]
ds_read_b128 a[184:187], v128 offset:14336
s_lshl_b32 s34, s16, 10
mf v[88:91],a[240:243],a[144:147],v[88:91]
s_lshl_b32 s35, s17, 9
mf v[88:91],a[244:247],a[148:151],v[88:91]
s_add_u32 s35, s35, 0x10000
mf v[120:123],a[244:247],a[156:159],v[120:123]
ds_read_b128 a[188:191], v129 offset:14336
s_mul_i32 s56, s14, 114688
mf v[120:123],a[240:243],a[152:155],v[120:123]
s_sub_u32 s52, 1720320, s56
mf v[124:127],a[248:251],a[152:155],v[124:127]
s_lshl_b32 s53, s15, 9
mf v[124:127],a[252:255],a[156:159],v[124:127]
s_mov_b32 s54, 0x3db8aa3b
mf v[92:95],a[252:255],a[148:151],v[92:95]
s_mov_b32 s55, s54
mf v[92:95],a[248:251],a[144:147],v[92:95]
mf v[60:63],a[248:251],a[136:139],v[60:63]
mf v[60:63],a[252:255],a[140:143],v[60:63]
mf v[28:31],a[252:255],a[132:135],v[28:31]
mf v[28:31],a[248:251],a[128:131],v[28:31]
s_waitcnt lgkmcnt(0) vmcnt(2)
s_barrier
mf a[0:3],a[192:195],a[160:163],a[0:3]
ds_read_b128 a[128:131], v128 offset:32768
ds_read_b128 a[132:135], v129 offset:32768
mf a[0:3],a[196:199],a[164:167],a[0:3]
s_add_u32 m0, s34, 0
mf a[32:35],a[196:199],a[172:175],a[32:35]
s_add_u32 s36, s52, 0
mf a[32:35],a[192:195],a[168:171],a[32:35]
buffer_load_dwordx4 v140, s[44:47], s36 offen lds
mf a[64:67],a[192:195],a[176:179],a[64:67]
ds_read_b128 a[136:139], v128 offset:34816
ds_read_b128 a[140:143], v129 offset:34816
mf a[64:67],a[196:199],a[180:183],a[64:67]
s_add_u32 m0, s35, 0
mf a[96:99],a[196:199],a[188:191],a[96:99]
s_add_u32 s37, s53, 0
mf a[96:99],a[192:195],a[184:187],a[96:99]
buffer_load_dwordx4 v141, s[48:51], s37 offen lds
mf a[100:103],a[200:203],a[184:187],a[100:103]
ds_read_b128 a[144:147], v128 offset:36864
ds_read_b128 a[148:151], v129 offset:36864
mf a[100:103],a[204:207],a[188:191],a[100:103]
s_add_u32 m0, s34, 4096
mf a[68:71],a[204:207],a[180:183],a[68:71]
s_add_u32 s36, s52, 28672
mf a[68:71],a[200:203],a[176:179],a[68:71]
buffer_load_dwordx4 v140, s[44:47], s36 offen lds
mf a[36:39],a[200:203],a[168:171],a[36:39]
ds_read_b64_tr_b16 a[192:193], v130 offset:32768
ds_read_b64_tr_b16 a[194:195], v130 offset:34816
mf a[36:39],a[204:207],a[172:175],a[36:39]
s_add_u32 m0, s35, 2048
mf a[4:7],a[204:207],a[164:167],a[4:7]
s_add_u32 s37, s53, 32768
mf a[4:7],a[200:203],a[160:163],a[4:7]
buffer_load_dwordx4 v141, s[48:51], s37 offen lds
mf a[8:11],a[208:211],a[160:163],a[8:11]
ds_read_b64_tr_b16 a[196:197], v130 offset:49152
ds_read_b64_tr_b16 a[198:199], v130 offset:51200
mf a[8:11],a[212:215],a[164:167],a[8:11]
s_add_u32 m0, s34, 8192
mf a[40:43],a[212:215],a[172:175],a[40:43]
s_add_u32 s36, s56, 0
mf a[40:43],a[208:211],a[168:171],a[40:43]
buffer_load_dwordx4 v140, s[44:47], s36 offen lds
mf a[72:75],a[208:211],a[176:179],a[72:75]
ds_read_b128 a[152:155], v128 offset:38912
ds_read_b128 a[156:159], v129 offset:38912
mf a[72:75],a[212:215],a[180:183],a[72:75]
s_add_u32 m0, s35, 8192
mf a[104:107],a[212:215],a[188:191],a[104:107]
s_add_u32 s37, s53, 131072
mf a[104:107],a[208:211],a[184:187],a[104:107]
buffer_load_dwordx4 v141, s[48:51], s37 offen lds
mf a[108:111],a[216:219],a[184:187],a[108:111]
ds_read_b64_tr_b16 a[200:201], v131 offset:32768
ds_read_b64_tr_b16 a[202:203], v131 offset:34816
mf a[108:111],a[220:223],a[188:191],a[108:111]
s_add_u32 m0, s34, 12288
mf a[76:79],a[220:223],a[180:183],a[76:79]
s_add_u32 s36, s56, 28672
mf a[76:79],a[216:219],a[176:179],a[76:79]
buffer_load_dwordx4 v140, s[44:47], s36 offen lds
mf a[44:47],a[216:219],a[168:171],a[44:47]
ds_read_b64_tr_b16 a[204:205], v131 offset:49152
ds_read_b64_tr_b16 a[206:207], v131 offset:51200
mf a[44:47],a[220:223],a[172:175],a[44:47]
s_add_u32 m0, s35, 10240
mf a[12:15],a[220:223],a[164:167],a[12:15]
s_add_u32 s37, s53, 163840
mf a[12:15],a[216:219],a[160:163],a[12:15]
buffer_load_dwordx4 v141, s[48:51], s37 offen lds
mf a[16:19],a[224:227],a[160:163],a[16:19]
mf a[16:19],a[228:231],a[164:167],a[16:19]
s_add_u32 m0, s34, 16384
mf a[48:51],a[228:231],a[172:175],a[48:51]
s_add_u32 s36, s52, 57344
mf a[48:51],a[224:227],a[168:171],a[48:51]
buffer_load_dwordx4 v140, s[44:47], s36 offen lds
mf a[80:83],a[224:227],a[176:179],a[80:83]
ds_read_b64_tr_b16 a[208:209], v132 offset:32768
ds_read_b64_tr_b16 a[210:211], v132 offset:34816
mf a[80:83],a[228:231],a[180:183],a[80:83]
s_add_u32 m0, s35, 16384
mf a[112:115],a[228:231],a[188:191],a[112:115]
s_add_u32 s37, s53, 262144
mf a[112:115],a[224:227],a[184:187],a[112:115]
buffer_load_dwordx4 v141, s[48:51], s37 offen lds
mf a[116:119],a[232:235],a[184:187],a[116:119]
ds_read_b64_tr_b16 a[212:213], v132 offset:49152
ds_read_b64_tr_b16 a[214:215], v132 offset:51200
mf a[116:119],a[236:239],a[188:191],a[116:119]
s_add_u32 m0, s34, 20480
mf a[84:87],a[236:239],a[180:183],a[84:87]
s_add_u32 s36, s52, 86016
mf a[84:87],a[232:235],a[176:179],a[84:87]
buffer_load_dwordx4 v140, s[44:47], s36 offen lds
mf a[52:55],a[232:235],a[168:171],a[52:55]
mf a[52:55],a[236:239],a[172:175],a[52:55]
s_add_u32 m0, s35, 18432
mf a[20:23],a[236:239],a[164:167],a[20:23]
s_add_u32 s37, s53, 294912
mf a[20:23],a[232:235],a[160:163],a[20:23]
buffer_load_dwordx4 v141, s[48:51], s37 offen lds
mf a[24:27],a[240:243],a[160:163],a[24:27]
ds_read_b64_tr_b16 a[216:217], v133 offset:32768
ds_read_b64_tr_b16 a[218:219], v133 offset:34816
mf a[24:27],a[244:247],a[164:167],a[24:27]
s_add_u32 m0, s34, 24576
mf a[56:59],a[244:247],a[172:175],a[56:59]
s_add_u32 s36, s56, 57344
mf a[56:59],a[240:243],a[168:171],a[56:59]
buffer_load_dwordx4 v140, s[44:47], s36 offen lds
mf a[88:91],a[240:243],a[176:179],a[88:91]
ds_read_b64_tr_b16 a[220:221], v133 offset:49152
ds_read_b64_tr_b16 a[222:223], v133 offset:51200
mf a[88:91],a[244:247],a[180:183],a[88:91]
s_add_u32 m0, s35, 24576
mf a[120:123],a[244:247],a[188:191],a[120:123]
s_add_u32 s37, s53, 393216
mf a[120:123],a[240:243],a[184:187],a[120:123]
buffer_load_dwordx4 v141, s[48:51], s37 offen lds
mf a[124:127],a[248:251],a[184:187],a[124:127]
mf a[124:127],a[252:255],a[188:191],a[124:127]
s_add_u32 m0, s34, 28672
mf a[92:95],a[252:255],a[180:183],a[92:95]
s_add_u32 s36, s56, 86016
mf a[92:95],a[248:251],a[176:179],a[92:95]
buffer_load_dwordx4 v140, s[44:47], s36 offen lds
mf a[60:63],a[248:251],a[168:171],a[60:63]
mf a[60:63],a[252:255],a[172:175],a[60:63]
s_add_u32 m0, s35, 26624
mf a[28:31],a[252:255],a[164:167],a[28:31]
s_add_u32 s37, s53, 425984
mf a[28:31],a[248:251],a[160:163],a[28:31]
buffer_load_dwordx4 v141, s[48:51], s37 offen lds
s_add_u32 s52, s52, 128
s_add_u32 s53, s53, 524288
s_add_u32 s56, s56, 128
s_waitcnt lgkmcnt(0)
mf v[0:3],a[192:195],a[128:131],v[0:3]
ds_read_b64_tr_b16 a[224:225], v134 offset:32768
mf v[0:3],a[196:199],a[132:135],v[0:3]
buffer_load_dword v254, v148, s[60:63], s64 offen
mf v[32:35],a[196:199],a[140:143],v[32:35]
ds_read_b64_tr_b16 a[226:227], v134 offset:34816
mf v[32:35],a[192:195],a[136:139],v[32:35]
s_add_u32 s64, s64, 7168
mf v[64:67],a[192:195],a[144:147],v[64:67]
ds_read_b64_tr_b16 a[228:229], v134 offset:49152
mf v[64:67],a[196:199],a[148:151],v[64:67]
mf v[96:99],a[196:199],a[156:159],v[96:99]
ds_read_b64_tr_b16 a[230:231], v134 offset:51200
v_and_b32 v252, 3, v255
mf v[96:99],a[192:195],a[152:155],v[96:99]
mf v[100:103],a[200:203],a[152:155],v[100:103]
ds_read_b64_tr_b16 a[232:233], v135 offset:32768
mf v[100:103],a[204:207],a[156:159],v[100:103]
v_and_b32 v143, 12, v255
mf v[68:71],a[204:207],a[148:151],v[68:71]
ds_read_b64_tr_b16 a[234:235], v135 offset:34816
mf v[68:71],a[200:203],a[144:147],v[68:71]
mf v[36:39],a[200:203],a[136:139],v[36:39]
ds_read_b64_tr_b16 a[236:237], v135 offset:49152
v_xor_b32 v143, 8, v143
mf v[36:39],a[204:207],a[140:143],v[36:39]
mf v[4:7],a[204:207],a[132:135],v[4:7]
ds_read_b64_tr_b16 a[238:239], v135 offset:51200
mf v[4:7],a[200:203],a[128:131],v[4:7]
v_lshl_add_u32 v252, v143, 1, v252
mf v[8:11],a[208:211],a[128:131],v[8:11]
ds_read_b64_tr_b16 a[240:241], v136 offset:32768
mf v[8:11],a[212:215],a[132:135],v[8:11]
s_and_b32 s17, s15, 1
mf v[40:43],a[212:215],a[140:143],v[40:43]
ds_read_b64_tr_b16 a[242:243], v136 offset:34816
mf v[40:43],a[208:211],a[136:139],v[40:43]
mf v[72:75],a[208:211],a[144:147],v[72:75]
ds_read_b64_tr_b16 a[244:245], v136 offset:49152
s_lshl_b32 s17, s17, 5
mf v[72:75],a[212:215],a[148:151],v[72:75]
mf v[104:107],a[212:215],a[156:159],v[104:107]
ds_read_b64_tr_b16 a[246:247], v136 offset:51200
mf v[104:107],a[208:211],a[152:155],v[104:107]
buffer_load_dword v254, v148, s[60:63], s64 offen
mf v[108:111],a[216:219],a[152:155],v[108:111]
ds_read_b64_tr_b16 a[248:249], v137 offset:32768
mf v[108:111],a[220:223],a[156:159],v[108:111]
mf v[76:79],a[220:223],a[148:151],v[76:79]
ds_read_b64_tr_b16 a[250:251], v137 offset:34816
s_add_u32 s17, s17, s12
mf v[76:79],a[216:219],a[144:147],v[76:79]
mf v[44:47],a[216:219],a[136:139],v[44:47]
ds_read_b64_tr_b16 a[252:253], v137 offset:49152
mf v[44:47],a[220:223],a[140:143],v[44:47]
v_lshl_add_u32 v252, v252, 3, s17
mf v[12:15],a[220:223],a[132:135],v[12:15]
ds_read_b64_tr_b16 a[254:255], v137 offset:51200
mf v[12:15],a[216:219],a[128:131],v[12:15]
v_bfe_u32 v253, v255, 3, 1
s_waitcnt lgkmcnt(8)
mf v[16:19],a[224:227],a[128:131],v[16:19]
mf v[16:19],a[228:231],a[132:135],v[16:19]
ds_read_b128 a[160:163], v128 offset:40960
mf v[48:51],a[228:231],a[140:143],v[48:51]
v_add_u32 v253, 1, v253
mf v[48:51],a[224:227],a[136:139],v[48:51]
mf v[80:83],a[224:227],a[144:147],v[80:83]
ds_read_b128 a[164:167], v129 offset:40960
mf v[80:83],a[228:231],a[148:151],v[80:83]
s_and_b32 s17, s2, 127
mf v[112:115],a[228:231],a[156:159],v[112:115]
mf v[112:115],a[224:227],a[152:155],v[112:115]
ds_read_b128 a[168:171], v128 offset:43008
mf v[116:119],a[232:235],a[152:155],v[116:119]
v_writelane_b32 v252, s17, 16
mf v[116:119],a[236:239],a[156:159],v[116:119]
mf v[84:87],a[236:239],a[148:151],v[84:87]
ds_read_b128 a[172:175], v129 offset:43008
mf v[84:87],a[232:235],a[144:147],v[84:87]
v_writelane_b32 v253, 2, 16
mf v[52:55],a[232:235],a[136:139],v[52:55]
mf v[52:55],a[236:239],a[140:143],v[52:55]
ds_read_b128 a[176:179], v128 offset:45056
v_lshlrev_b32 v252, 7, v252
mf v[20:23],a[236:239],a[132:135],v[20:23]
mf v[20:23],a[232:235],a[128:131],v[20:23]
s_waitcnt lgkmcnt(5)
mf v[24:27],a[240:243],a[128:131],v[24:27]
ds_read_b128 a[180:183], v129 offset:45056
v_add_u32 v252, 105906176, v252
mf v[24:27],a[244:247],a[132:135],v[24:27]
mf v[56:59],a[244:247],a[140:143],v[56:59]
mf v[56:59],a[240:243],a[136:139],v[56:59]
ds_read_b128 a[184:187], v128 offset:47104
s_lshl_b32 s17, s16, 13
mf v[88:91],a[240:243],a[144:147],v[88:91]
mf v[88:91],a[244:247],a[148:151],v[88:91]
mf v[120:123],a[244:247],a[156:159],v[120:123]
ds_read_b128 a[188:191], v129 offset:47104
s_add_u32 s17, s17, 0x20000
mf v[120:123],a[240:243],a[152:155],v[120:123]
mf v[124:127],a[248:251],a[152:155],v[124:127]
mf v[124:127],a[252:255],a[156:159],v[124:127]
v_add_u32 v147, s17, v142
mf v[92:95],a[252:255],a[148:151],v[92:95]
mf v[92:95],a[248:251],a[144:147],v[92:95]
mf v[60:63],a[248:251],a[136:139],v[60:63]
mf v[60:63],a[252:255],a[140:143],v[60:63]
mf v[28:31],a[252:255],a[132:135],v[28:31]
mf v[28:31],a[248:251],a[128:131],v[28:31]
s_waitcnt lgkmcnt(0) vmcnt(2)
s_barrier
mf a[0:3],a[192:195],a[160:163],a[0:3]
ds_read_b128 a[128:131], v128 offset:0
ds_read_b128 a[132:135], v129 offset:0
mf a[0:3],a[196:199],a[164:167],a[0:3]
s_add_u32 m0, s34, 32768
mf a[32:35],a[196:199],a[172:175],a[32:35]
s_add_u32 s36, s52, 0
mf a[32:35],a[192:195],a[168:171],a[32:35]
buffer_load_dwordx4 v140, s[44:47], s36 offen lds
mf a[64:67],a[192:195],a[176:179],a[64:67]
ds_read_b128 a[136:139], v128 offset:2048
ds_read_b128 a[140:143], v129 offset:2048
mf a[64:67],a[196:199],a[180:183],a[64:67]
s_add_u32 m0, s35, 32768
v_cvt_pk_bf16_f32 v220, v0, v1
mf a[96:99],a[196:199],a[188:191],a[96:99]
s_add_u32 s37, s53, 0
v_cvt_pk_bf16_f32 v221, v2, v3
mf a[96:99],a[192:195],a[184:187],a[96:99]
buffer_load_dwordx4 v141, s[48:51], s37 offen lds
mf a[100:103],a[200:203],a[184:187],a[100:103]
ds_read_b128 a[144:147], v128 offset:4096
ds_read_b128 a[148:151], v129 offset:4096
mf a[100:103],a[204:207],a[188:191],a[100:103]
s_add_u32 m0, s34, 36864
v_cvt_pk_bf16_f32 v222, v4, v5
mf a[68:71],a[204:207],a[180:183],a[68:71]
s_add_u32 s36, s52, 28672
v_cvt_pk_bf16_f32 v223, v6, v7
mf a[68:71],a[200:203],a[176:179],a[68:71]
buffer_load_dwordx4 v140, s[44:47], s36 offen lds
mf a[36:39],a[200:203],a[168:171],a[36:39]
ds_read_b64_tr_b16 a[192:193], v130 offset:0
ds_read_b64_tr_b16 a[194:195], v130 offset:2048
mf a[36:39],a[204:207],a[172:175],a[36:39]
s_add_u32 m0, s35, 34816
ds_write_b128 v147, v[220:223] offset:0
mf a[4:7],a[204:207],a[164:167],a[4:7]
s_add_u32 s37, s53, 32768
v_cvt_pk_bf16_f32 v224, v8, v9
mf a[4:7],a[200:203],a[160:163],a[4:7]
buffer_load_dwordx4 v141, s[48:51], s37 offen lds
mf a[8:11],a[208:211],a[160:163],a[8:11]
ds_read_b64_tr_b16 a[196:197], v130 offset:16384
ds_read_b64_tr_b16 a[198:199], v130 offset:18432
mf a[8:11],a[212:215],a[164:167],a[8:11]
s_add_u32 m0, s34, 40960
v_cvt_pk_bf16_f32 v225, v10, v11
mf a[40:43],a[212:215],a[172:175],a[40:43]
s_add_u32 s36, s56, 0
v_cvt_pk_bf16_f32 v226, v12, v13
mf a[40:43],a[208:211],a[168:171],a[40:43]
buffer_load_dwordx4 v140, s[44:47], s36 offen lds
mf a[72:75],a[208:211],a[176:179],a[72:75]
ds_read_b128 a[152:155], v128 offset:6144
ds_read_b128 a[156:159], v129 offset:6144
mf a[72:75],a[212:215],a[180:183],a[72:75]
s_add_u32 m0, s35, 40960
v_cvt_pk_bf16_f32 v227, v14, v15
mf a[104:107],a[212:215],a[188:191],a[104:107]
s_add_u32 s37, s53, 131072
ds_write_b128 v147, v[224:227] offset:1024
mf a[104:107],a[208:211],a[184:187],a[104:107]
buffer_load_dwordx4 v141, s[48:51], s37 offen lds
mf a[108:111],a[216:219],a[184:187],a[108:111]
ds_read_b64_tr_b16 a[200:201], v131 offset:0
ds_read_b64_tr_b16 a[202:203], v131 offset:2048
mf a[108:111],a[220:223],a[188:191],a[108:111]
s_add_u32 m0, s34, 45056
v_cvt_pk_bf16_f32 v228, v16, v17
mf a[76:79],a[220:223],a[180:183],a[76:79]
s_add_u32 s36, s56, 28672
v_cvt_pk_bf16_f32 v229, v18, v19
mf a[76:79],a[216:219],a[176:179],a[76:79]
buffer_load_dwordx4 v140, s[44:47], s36 offen lds
mf a[44:47],a[216:219],a[168:171],a[44:47]
ds_read_b64_tr_b16 a[204:205], v131 offset:16384
ds_read_b64_tr_b16 a[206:207], v131 offset:18432
mf a[44:47],a[220:223],a[172:175],a[44:47]
s_add_u32 m0, s35, 43008
v_cvt_pk_bf16_f32 v230, v20, v21
mf a[12:15],a[220:223],a[164:167],a[12:15]
s_add_u32 s37, s53, 163840
v_cvt_pk_bf16_f32 v231, v22, v23
mf a[12:15],a[216:219],a[160:163],a[12:15]
buffer_load_dwordx4 v141, s[48:51], s37 offen lds
mf a[16:19],a[224:227],a[160:163],a[16:19]
ds_write_b128 v147, v[228:231] offset:2048
v_cvt_pk_bf16_f32 v232, v24, v25
mf a[16:19],a[228:231],a[164:167],a[16:19]
s_add_u32 m0, s34, 49152
v_cvt_pk_bf16_f32 v233, v26, v27
mf a[48:51],a[228:231],a[172:175],a[48:51]
s_add_u32 s36, s52, 57344
v_cvt_pk_bf16_f32 v234, v28, v29
mf a[48:51],a[224:227],a[168:171],a[48:51]
buffer_load_dwordx4 v140, s[44:47], s36 offen lds
mf a[80:83],a[224:227],a[176:179],a[80:83]
ds_read_b64_tr_b16 a[208:209], v132 offset:0
ds_read_b64_tr_b16 a[210:211], v132 offset:2048
mf a[80:83],a[228:231],a[180:183],a[80:83]
s_add_u32 m0, s35, 49152
v_cvt_pk_bf16_f32 v235, v30, v31
mf a[112:115],a[228:231],a[188:191],a[112:115]
s_add_u32 s37, s53, 262144
ds_write_b128 v147, v[232:235] offset:3072
mf a[112:115],a[224:227],a[184:187],a[112:115]
buffer_load_dwordx4 v141, s[48:51], s37 offen lds
mf a[116:119],a[232:235],a[184:187],a[116:119]
ds_read_b64_tr_b16 a[212:213], v132 offset:16384
ds_read_b64_tr_b16 a[214:215], v132 offset:18432
mf a[116:119],a[236:239],a[188:191],a[116:119]
s_add_u32 m0, s34, 53248
v_cvt_pk_bf16_f32 v236, v32, v33
mf a[84:87],a[236:239],a[180:183],a[84:87]
s_add_u32 s36, s52, 86016
v_cvt_pk_bf16_f32 v237, v34, v35
mf a[84:87],a[232:235],a[176:179],a[84:87]
buffer_load_dwordx4 v140, s[44:47], s36 offen lds
mf a[52:55],a[232:235],a[168:171],a[52:55]
v_cvt_pk_bf16_f32 v238, v36, v37
v_cvt_pk_bf16_f32 v239, v38, v39
mf a[52:55],a[236:239],a[172:175],a[52:55]
s_add_u32 m0, s35, 51200
ds_write_b128 v147, v[236:239] offset:4096
mf a[20:23],a[236:239],a[164:167],a[20:23]
s_add_u32 s37, s53, 294912
v_cvt_pk_bf16_f32 v240, v40, v41
mf a[20:23],a[232:235],a[160:163],a[20:23]
buffer_load_dwordx4 v141, s[48:51], s37 offen lds
mf a[24:27],a[240:243],a[160:163],a[24:27]
ds_read_b64_tr_b16 a[216:217], v133 offset:0
ds_read_b64_tr_b16 a[218:219], v133 offset:2048
mf a[24:27],a[244:247],a[164:167],a[24:27]
s_add_u32 m0, s34, 57344
v_cvt_pk_bf16_f32 v241, v42, v43
mf a[56:59],a[244:247],a[172:175],a[56:59]
s_add_u32 s36, s56, 57344
v_cvt_pk_bf16_f32 v242, v44, v45
mf a[56:59],a[240:243],a[168:171],a[56:59]
buffer_load_dwordx4 v140, s[44:47], s36 offen lds
mf a[88:91],a[240:243],a[176:179],a[88:91]
ds_read_b64_tr_b16 a[220:221], v133 offset:16384
ds_read_b64_tr_b16 a[222:223], v133 offset:18432
mf a[88:91],a[244:247],a[180:183],a[88:91]
s_add_u32 m0, s35, 57344
v_cvt_pk_bf16_f32 v243, v46, v47
mf a[120:123],a[244:247],a[188:191],a[120:123]
s_add_u32 s37, s53, 393216
ds_write_b128 v147, v[240:243] offset:5120
mf a[120:123],a[240:243],a[184:187],a[120:123]
buffer_load_dwordx4 v141, s[48:51], s37 offen lds
mf a[124:127],a[248:251],a[184:187],a[124:127]
v_cvt_pk_bf16_f32 v244, v48, v49
v_cvt_pk_bf16_f32 v245, v50, v51
mf a[124:127],a[252:255],a[188:191],a[124:127]
s_add_u32 m0, s34, 61440
v_cvt_pk_bf16_f32 v246, v52, v53
mf a[92:95],a[252:255],a[180:183],a[92:95]
s_add_u32 s36, s56, 86016
v_cvt_pk_bf16_f32 v247, v54, v55
mf a[92:95],a[248:251],a[176:179],a[92:95]
buffer_load_dwordx4 v140, s[44:47], s36 offen lds
mf a[60:63],a[248:251],a[168:171],a[60:63]
ds_write_b128 v147, v[244:247] offset:6144
v_cvt_pk_bf16_f32 v248, v56, v57
mf a[60:63],a[252:255],a[172:175],a[60:63]
s_add_u32 m0, s35, 59392
v_cvt_pk_bf16_f32 v249, v58, v59
mf a[28:31],a[252:255],a[164:167],a[28:31]
s_add_u32 s37, s53, 425984
v_cvt_pk_bf16_f32 v250, v60, v61
v_cvt_pk_bf16_f32 v251, v62, v63
ds_write_b128 v147, v[248:251] offset:7168
v_cvt_pk_bf16_f32 v156, v64, v65
v_cvt_pk_bf16_f32 v157, v66, v67
v_cvt_pk_bf16_f32 v158, v68, v69
v_cvt_pk_bf16_f32 v159, v70, v71
v_cvt_pk_bf16_f32 v160, v72, v73
v_cvt_pk_bf16_f32 v161, v74, v75
v_cvt_pk_bf16_f32 v162, v76, v77
v_cvt_pk_bf16_f32 v163, v78, v79
v_cvt_pk_bf16_f32 v164, v80, v81
v_cvt_pk_bf16_f32 v165, v82, v83
v_cvt_pk_bf16_f32 v166, v84, v85
v_cvt_pk_bf16_f32 v167, v86, v87
v_cvt_pk_bf16_f32 v168, v88, v89
v_cvt_pk_bf16_f32 v169, v90, v91
v_cvt_pk_bf16_f32 v170, v92, v93
v_cvt_pk_bf16_f32 v171, v94, v95
v_cvt_pk_bf16_f32 v172, v96, v97
v_cvt_pk_bf16_f32 v173, v98, v99
v_cvt_pk_bf16_f32 v174, v100, v101
v_cvt_pk_bf16_f32 v175, v102, v103
v_cvt_pk_bf16_f32 v176, v104, v105
v_cvt_pk_bf16_f32 v177, v106, v107
v_cvt_pk_bf16_f32 v178, v108, v109
v_cvt_pk_bf16_f32 v179, v110, v111
v_cvt_pk_bf16_f32 v180, v112, v113
v_cvt_pk_bf16_f32 v181, v114, v115
v_cvt_pk_bf16_f32 v182, v116, v117
v_cvt_pk_bf16_f32 v183, v118, v119
v_cvt_pk_bf16_f32 v184, v120, v121
v_cvt_pk_bf16_f32 v185, v122, v123
v_cvt_pk_bf16_f32 v186, v124, v125
v_cvt_pk_bf16_f32 v187, v126, v127
mf a[28:31],a[248:251],a[160:163],a[28:31]
buffer_load_dwordx4 v141, s[48:51], s37 offen lds
s_add_u32 s52, s52, 128
s_add_u32 s53, s53, 524288
s_add_u32 s56, s56, 128
s_waitcnt lgkmcnt(0)
mf v[0:3],a[192:195],a[128:131],0
ds_read_b64_tr_b16 a[224:225], v134 offset:0
mf v[0:3],a[196:199],a[132:135],v[0:3]
mf v[32:35],a[196:199],a[140:143],0
ds_read_b64_tr_b16 a[226:227], v134 offset:2048
mf v[32:35],a[192:195],a[136:139],v[32:35]
mf v[64:67],a[192:195],a[144:147],0
ds_read_b64_tr_b16 a[228:229], v134 offset:16384
v_accvgpr_read_b32 v148, a0
mf v[64:67],a[196:199],a[148:151],v[64:67]
v_accvgpr_read_b32 v149, a1
v_accvgpr_read_b32 v150, a2
mf v[96:99],a[196:199],a[156:159],0
ds_read_b64_tr_b16 a[230:231], v134 offset:18432
v_accvgpr_read_b32 v151, a3
mf v[96:99],a[192:195],a[152:155],v[96:99]
v_accvgpr_read_b32 v152, a4
v_accvgpr_read_b32 v153, a5
mf v[100:103],a[200:203],a[152:155],0
ds_read_b64_tr_b16 a[232:233], v135 offset:0
v_accvgpr_read_b32 v154, a6
mf v[100:103],a[204:207],a[156:159],v[100:103]
v_accvgpr_read_b32 v155, a7
v_cvt_pk_bf16_f32 v188, v148, v149
mf v[68:71],a[204:207],a[148:151],0
ds_read_b64_tr_b16 a[234:235], v135 offset:2048
v_cvt_pk_bf16_f32 v189, v150, v151
mf v[68:71],a[200:203],a[144:147],v[68:71]
v_cvt_pk_bf16_f32 v190, v152, v153
v_cvt_pk_bf16_f32 v191, v154, v155
mf v[36:39],a[200:203],a[136:139],0
ds_read_b64_tr_b16 a[236:237], v135 offset:16384
v_accvgpr_read_b32 v148, a32
mf v[36:39],a[204:207],a[140:143],v[36:39]
v_accvgpr_read_b32 v149, a33
v_accvgpr_read_b32 v150, a34
mf v[4:7],a[204:207],a[132:135],0
ds_read_b64_tr_b16 a[238:239], v135 offset:18432
v_accvgpr_read_b32 v151, a35
mf v[4:7],a[200:203],a[128:131],v[4:7]
v_accvgpr_read_b32 v152, a36
v_accvgpr_read_b32 v153, a37
mf v[8:11],a[208:211],a[128:131],0
ds_read_b64_tr_b16 a[240:241], v136 offset:0
v_accvgpr_read_b32 v154, a38
mf v[8:11],a[212:215],a[132:135],v[8:11]
v_accvgpr_read_b32 v155, a39
v_cvt_pk_bf16_f32 v204, v148, v149
mf v[40:43],a[212:215],a[140:143],0
ds_read_b64_tr_b16 a[242:243], v136 offset:2048
v_cvt_pk_bf16_f32 v205, v150, v151
mf v[40:43],a[208:211],a[136:139],v[40:43]
v_cvt_pk_bf16_f32 v206, v152, v153
v_cvt_pk_bf16_f32 v207, v154, v155
mf v[72:75],a[208:211],a[144:147],0
ds_read_b64_tr_b16 a[244:245], v136 offset:16384
v_accvgpr_read_b32 v148, a64
mf v[72:75],a[212:215],a[148:151],v[72:75]
v_accvgpr_read_b32 v149, a65
v_accvgpr_read_b32 v150, a66
mf v[104:107],a[212:215],a[156:159],0
ds_read_b64_tr_b16 a[246:247], v136 offset:18432
v_accvgpr_read_b32 v151, a67
mf v[104:107],a[208:211],a[152:155],v[104:107]
v_accvgpr_read_b32 v152, a68
v_accvgpr_read_b32 v153, a69
mf v[108:111],a[216:219],a[152:155],0
ds_read_b64_tr_b16 a[248:249], v137 offset:0
v_accvgpr_read_b32 v154, a70
mf v[108:111],a[220:223],a[156:159],v[108:111]
v_accvgpr_read_b32 v155, a71
v_cvt_pk_bf16_f32 v220, v148, v149
mf v[76:79],a[220:223],a[148:151],0
ds_read_b64_tr_b16 a[250:251], v137 offset:2048
v_cvt_pk_bf16_f32 v221, v150, v151
mf v[76:79],a[216:219],a[144:147],v[76:79]
v_cvt_pk_bf16_f32 v222, v152, v153
v_cvt_pk_bf16_f32 v223, v154, v155
mf v[44:47],a[216:219],a[136:139],0
ds_read_b64_tr_b16 a[252:253], v137 offset:16384
v_accvgpr_read_b32 v148, a96
mf v[44:47],a[220:223],a[140:143],v[44:47]
v_accvgpr_read_b32 v149, a97
v_accvgpr_read_b32 v150, a98
mf v[12:15],a[220:223],a[132:135],0
ds_read_b64_tr_b16 a[254:255], v137 offset:18432
v_accvgpr_read_b32 v151, a99
mf v[12:15],a[216:219],a[128:131],v[12:15]
v_accvgpr_read_b32 v152, a100
s_waitcnt lgkmcnt(8)
mf v[16:19],a[224:227],a[128:131],0
v_accvgpr_read_b32 v153, a101
v_accvgpr_read_b32 v154, a102
mf v[16:19],a[228:231],a[132:135],v[16:19]
ds_read_b128 a[160:163], v128 offset:8192
v_accvgpr_read_b32 v155, a103
mf v[48:51],a[228:231],a[140:143],0
v_cvt_pk_bf16_f32 v236, v148, v149
v_cvt_pk_bf16_f32 v237, v150, v151
mf v[48:51],a[224:227],a[136:139],v[48:51]
v_cvt_pk_bf16_f32 v238, v152, v153
v_cvt_pk_bf16_f32 v239, v154, v155
mf v[80:83],a[224:227],a[144:147],0
ds_read_b128 a[164:167], v129 offset:8192
v_accvgpr_read_b32 v148, a8
mf v[80:83],a[228:231],a[148:151],v[80:83]
v_accvgpr_read_b32 v149, a9
v_accvgpr_read_b32 v150, a10
mf v[112:115],a[228:231],a[156:159],0
v_accvgpr_read_b32 v151, a11
v_accvgpr_read_b32 v152, a12
mf v[112:115],a[224:227],a[152:155],v[112:115]
ds_read_b128 a[168:171], v128 offset:10240
v_accvgpr_read_b32 v153, a13
mf v[116:119],a[232:235],a[152:155],0
v_accvgpr_read_b32 v154, a14
v_accvgpr_read_b32 v155, a15
mf v[116:119],a[236:239],a[156:159],v[116:119]
v_cvt_pk_bf16_f32 v192, v148, v149
v_cvt_pk_bf16_f32 v193, v150, v151
mf v[84:87],a[236:239],a[148:151],0
ds_read_b128 a[172:175], v129 offset:10240
v_cvt_pk_bf16_f32 v194, v152, v153
mf v[84:87],a[232:235],a[144:147],v[84:87]
v_cvt_pk_bf16_f32 v195, v154, v155
v_accvgpr_read_b32 v148, a40
mf v[52:55],a[232:235],a[136:139],0
v_accvgpr_read_b32 v149, a41
v_accvgpr_read_b32 v150, a42
mf v[52:55],a[236:239],a[140:143],v[52:55]
ds_read_b128 a[176:179], v128 offset:12288
v_accvgpr_read_b32 v151, a43
mf v[20:23],a[236:239],a[132:135],0
v_accvgpr_read_b32 v152, a44
v_accvgpr_read_b32 v153, a45
mf v[20:23],a[232:235],a[128:131],v[20:23]
v_accvgpr_read_b32 v154, a46
s_waitcnt lgkmcnt(5)
mf v[24:27],a[240:243],a[128:131],0
ds_read_b128 a[180:183], v129 offset:12288
v_accvgpr_read_b32 v155, a47
mf v[24:27],a[244:247],a[132:135],v[24:27]
v_cvt_pk_bf16_f32 v208, v148, v149
v_cvt_pk_bf16_f32 v209, v150, v151
mf v[56:59],a[244:247],a[140:143],0
v_cvt_pk_bf16_f32 v210, v152, v153
v_cvt_pk_bf16_f32 v211, v154, v155
mf v[56:59],a[240:243],a[136:139],v[56:59]
ds_read_b128 a[184:187], v128 offset:14336
v_accvgpr_read_b32 v148, a72
mf v[88:91],a[240:243],a[144:147],0
v_accvgpr_read_b32 v149, a73
v_accvgpr_read_b32 v150, a74
mf v[88:91],a[244:247],a[148:151],v[88:91]
v_accvgpr_read_b32 v151, a75
v_accvgpr_read_b32 v152, a76
mf v[120:123],a[244:247],a[156:159],0
ds_read_b128 a[188:191], v129 offset:14336
v_accvgpr_read_b32 v153, a77
mf v[120:123],a[240:243],a[152:155],v[120:123]
v_accvgpr_read_b32 v154, a78
v_accvgpr_read_b32 v155, a79
mf v[124:127],a[248:251],a[152:155],0
v_cvt_pk_bf16_f32 v224, v148, v149
v_cvt_pk_bf16_f32 v225, v150, v151
mf v[124:127],a[252:255],a[156:159],v[124:127]
v_cvt_pk_bf16_f32 v226, v152, v153
v_cvt_pk_bf16_f32 v227, v154, v155
mf v[92:95],a[252:255],a[148:151],0
v_accvgpr_read_b32 v148, a104
v_accvgpr_read_b32 v149, a105
mf v[92:95],a[248:251],a[144:147],v[92:95]
v_accvgpr_read_b32 v150, a106
v_accvgpr_read_b32 v151, a107
mf v[60:63],a[248:251],a[136:139],0
v_accvgpr_read_b32 v152, a108
v_accvgpr_read_b32 v153, a109
mf v[60:63],a[252:255],a[140:143],v[60:63]
v_accvgpr_read_b32 v154, a110
v_accvgpr_read_b32 v155, a111
mf v[28:31],a[252:255],a[132:135],0
v_cvt_pk_bf16_f32 v240, v148, v149
v_cvt_pk_bf16_f32 v241, v150, v151
mf v[28:31],a[248:251],a[128:131],v[28:31]
v_cvt_pk_bf16_f32 v242, v152, v153
v_cvt_pk_bf16_f32 v243, v154, v155
v_accvgpr_read_b32 v148, a16
v_accvgpr_read_b32 v149, a17
v_accvgpr_read_b32 v150, a18
v_accvgpr_read_b32 v151, a19
v_accvgpr_read_b32 v152, a20
v_accvgpr_read_b32 v153, a21
v_accvgpr_read_b32 v154, a22
v_accvgpr_read_b32 v155, a23
v_cvt_pk_bf16_f32 v196, v148, v149
v_cvt_pk_bf16_f32 v197, v150, v151
v_cvt_pk_bf16_f32 v198, v152, v153
v_cvt_pk_bf16_f32 v199, v154, v155
v_accvgpr_read_b32 v148, a48
v_accvgpr_read_b32 v149, a49
v_accvgpr_read_b32 v150, a50
v_accvgpr_read_b32 v151, a51
v_accvgpr_read_b32 v152, a52
v_accvgpr_read_b32 v153, a53
v_accvgpr_read_b32 v154, a54
v_accvgpr_read_b32 v155, a55
v_cvt_pk_bf16_f32 v212, v148, v149
v_cvt_pk_bf16_f32 v213, v150, v151
v_cvt_pk_bf16_f32 v214, v152, v153
v_cvt_pk_bf16_f32 v215, v154, v155
v_accvgpr_read_b32 v148, a80
v_accvgpr_read_b32 v149, a81
v_accvgpr_read_b32 v150, a82
v_accvgpr_read_b32 v151, a83
v_accvgpr_read_b32 v152, a84
v_accvgpr_read_b32 v153, a85
v_accvgpr_read_b32 v154, a86
v_accvgpr_read_b32 v155, a87
v_cvt_pk_bf16_f32 v228, v148, v149
v_cvt_pk_bf16_f32 v229, v150, v151
v_cvt_pk_bf16_f32 v230, v152, v153
v_cvt_pk_bf16_f32 v231, v154, v155
s_waitcnt lgkmcnt(0) vmcnt(0)
s_barrier
mf a[0:3],a[192:195],a[160:163],0
ds_read_b128 a[128:131], v128 offset:32768
ds_read_b128 a[132:135], v129 offset:32768
v_accvgpr_read_b32 v148, a112
mf a[0:3],a[196:199],a[164:167],a[0:3]
s_add_u32 m0, s34, 0
v_accvgpr_read_b32 v149, a113
mf a[32:35],a[196:199],a[172:175],0
s_add_u32 s36, s52, 0
v_accvgpr_read_b32 v150, a114
mf a[32:35],a[192:195],a[168:171],a[32:35]
buffer_load_dwordx4 v140, s[44:47], s36 offen lds
v_accvgpr_read_b32 v151, a115
mf a[64:67],a[192:195],a[176:179],0
ds_read_b128 a[136:139], v128 offset:34816
ds_read_b128 a[140:143], v129 offset:34816
v_accvgpr_read_b32 v152, a116
mf a[64:67],a[196:199],a[180:183],a[64:67]
s_add_u32 m0, s35, 0
v_accvgpr_read_b32 v153, a117
mf a[96:99],a[196:199],a[188:191],0
s_add_u32 s37, s53, 0
v_accvgpr_read_b32 v154, a118
mf a[96:99],a[192:195],a[184:187],a[96:99]
buffer_load_dwordx4 v141, s[48:51], s37 offen lds
v_accvgpr_read_b32 v155, a119
mf a[100:103],a[200:203],a[184:187],0
ds_read_b128 a[144:147], v128 offset:36864
ds_read_b128 a[148:151], v129 offset:36864
v_cvt_pk_bf16_f32 v244, v148, v149
mf a[100:103],a[204:207],a[188:191],a[100:103]
s_add_u32 m0, s34, 4096
v_cvt_pk_bf16_f32 v245, v150, v151
mf a[68:71],a[204:207],a[180:183],0
s_add_u32 s36, s52, 28672
v_cvt_pk_bf16_f32 v246, v152, v153
mf a[68:71],a[200:203],a[176:179],a[68:71]
buffer_load_dwordx4 v140, s[44:47], s36 offen lds
v_cvt_pk_bf16_f32 v247, v154, v155
mf a[36:39],a[200:203],a[168:171],0
ds_read_b64_tr_b16 a[192:193], v130 offset:32768
ds_read_b64_tr_b16 a[194:195], v130 offset:34816
v_accvgpr_read_b32 v148, a24
mf a[36:39],a[204:207],a[172:175],a[36:39]
s_add_u32 m0, s35, 2048
v_accvgpr_read_b32 v149, a25
mf a[4:7],a[204:207],a[164:167],0
s_add_u32 s37, s53, 32768
v_accvgpr_read_b32 v150, a26
mf a[4:7],a[200:203],a[160:163],a[4:7]
buffer_load_dwordx4 v141, s[48:51], s37 offen lds
v_accvgpr_read_b32 v151, a27
mf a[8:11],a[208:211],a[160:163],0
ds_read_b64_tr_b16 a[196:197], v130 offset:49152
ds_read_b64_tr_b16 a[198:199], v130 offset:51200
v_accvgpr_read_b32 v152, a28
mf a[8:11],a[212:215],a[164:167],a[8:11]
s_add_u32 m0, s34, 8192
v_accvgpr_read_b32 v153, a29
mf a[40:43],a[212:215],a[172:175],0
s_add_u32 s36, s56, 0
v_accvgpr_read_b32 v154, a30
mf a[40:43],a[208:211],a[168:171],a[40:43]
buffer_load_dwordx4 v140, s[44:47], s36 offen lds
v_accvgpr_read_b32 v155, a31
mf a[72:75],a[208:211],a[176:179],0
ds_read_b128 a[152:155], v128 offset:38912
ds_read_b128 a[156:159], v129 offset:38912
v_cvt_pk_bf16_f32 v200, v148, v149
mf a[72:75],a[212:215],a[180:183],a[72:75]
s_add_u32 m0, s35, 8192
v_cvt_pk_bf16_f32 v201, v150, v151
mf a[104:107],a[212:215],a[188:191],0
s_add_u32 s37, s53, 131072
v_cvt_pk_bf16_f32 v202, v152, v153
mf a[104:107],a[208:211],a[184:187],a[104:107]
buffer_load_dwordx4 v141, s[48:51], s37 offen lds
v_cvt_pk_bf16_f32 v203, v154, v155
mf a[108:111],a[216:219],a[184:187],0
ds_read_b64_tr_b16 a[200:201], v131 offset:32768
ds_read_b64_tr_b16 a[202:203], v131 offset:34816
v_accvgpr_read_b32 v148, a56
mf a[108:111],a[220:223],a[188:191],a[108:111]
s_add_u32 m0, s34, 12288
v_accvgpr_read_b32 v149, a57
mf a[76:79],a[220:223],a[180:183],0
s_add_u32 s36, s56, 28672
v_accvgpr_read_b32 v150, a58
mf a[76:79],a[216:219],a[176:179],a[76:79]
buffer_load_dwordx4 v140, s[44:47], s36 offen lds
v_accvgpr_read_b32 v151, a59
mf a[44:47],a[216:219],a[168:171],0
ds_read_b64_tr_b16 a[204:205], v131 offset:49152
ds_read_b64_tr_b16 a[206:207], v131 offset:51200
v_accvgpr_read_b32 v152, a60
mf a[44:47],a[220:223],a[172:175],a[44:47]
s_add_u32 m0, s35, 10240
v_accvgpr_read_b32 v153, a61
mf a[12:15],a[220:223],a[164:167],0
s_add_u32 s37, s53, 163840
v_accvgpr_read_b32 v154, a62
mf a[12:15],a[216:219],a[160:163],a[12:15]
buffer_load_dwordx4 v141, s[48:51], s37 offen lds
v_accvgpr_read_b32 v155, a63
mf a[16:19],a[224:227],a[160:163],0
v_cvt_pk_bf16_f32 v216, v148, v149
mf a[16:19],a[228:231],a[164:167],a[16:19]
s_add_u32 m0, s34, 16384
v_cvt_pk_bf16_f32 v217, v150, v151
mf a[48:51],a[228:231],a[172:175],0
s_add_u32 s36, s52, 57344
v_cvt_pk_bf16_f32 v218, v152, v153
mf a[48:51],a[224:227],a[168:171],a[48:51]
buffer_load_dwordx4 v140, s[44:47], s36 offen lds
v_cvt_pk_bf16_f32 v219, v154, v155
mf a[80:83],a[224:227],a[176:179],0
ds_read_b64_tr_b16 a[208:209], v132 offset:32768
ds_read_b64_tr_b16 a[210:211], v132 offset:34816
v_accvgpr_read_b32 v148, a88
mf a[80:83],a[228:231],a[180:183],a[80:83]
s_add_u32 m0, s35, 16384
v_accvgpr_read_b32 v149, a89
mf a[112:115],a[228:231],a[188:191],0
s_add_u32 s37, s53, 262144
v_accvgpr_read_b32 v150, a90
mf a[112:115],a[224:227],a[184:187],a[112:115]
buffer_load_dwordx4 v141, s[48:51], s37 offen lds
v_accvgpr_read_b32 v151, a91
mf a[116:119],a[232:235],a[184:187],0
ds_read_b64_tr_b16 a[212:213], v132 offset:49152
ds_read_b64_tr_b16 a[214:215], v132 offset:51200
v_accvgpr_read_b32 v152, a92
mf a[116:119],a[236:239],a[188:191],a[116:119]
s_add_u32 m0, s34, 20480
v_accvgpr_read_b32 v153, a93
mf a[84:87],a[236:239],a[180:183],0
s_add_u32 s36, s52, 86016
v_accvgpr_read_b32 v154, a94
mf a[84:87],a[232:235],a[176:179],a[84:87]
buffer_load_dwordx4 v140, s[44:47], s36 offen lds
v_accvgpr_read_b32 v155, a95
mf a[52:55],a[232:235],a[168:171],0
v_cvt_pk_bf16_f32 v232, v148, v149
mf a[52:55],a[236:239],a[172:175],a[52:55]
s_add_u32 m0, s35, 18432
v_cvt_pk_bf16_f32 v233, v150, v151
mf a[20:23],a[236:239],a[164:167],0
s_add_u32 s37, s53, 294912
v_cvt_pk_bf16_f32 v234, v152, v153
mf a[20:23],a[232:235],a[160:163],a[20:23]
buffer_load_dwordx4 v141, s[48:51], s37 offen lds
v_cvt_pk_bf16_f32 v235, v154, v155
mf a[24:27],a[240:243],a[160:163],0
ds_read_b64_tr_b16 a[216:217], v133 offset:32768
ds_read_b64_tr_b16 a[218:219], v133 offset:34816
v_accvgpr_read_b32 v148, a120
mf a[24:27],a[244:247],a[164:167],a[24:27]
s_add_u32 m0, s34, 24576
v_accvgpr_read_b32 v149, a121
mf a[56:59],a[244:247],a[172:175],0
s_add_u32 s36, s56, 57344
v_accvgpr_read_b32 v150, a122
mf a[56:59],a[240:243],a[168:171],a[56:59]
buffer_load_dwordx4 v140, s[44:47], s36 offen lds
v_accvgpr_read_b32 v151, a123
mf a[88:91],a[240:243],a[176:179],0
ds_read_b64_tr_b16 a[220:221], v133 offset:49152
ds_read_b64_tr_b16 a[222:223], v133 offset:51200
v_accvgpr_read_b32 v152, a124
mf a[88:91],a[244:247],a[180:183],a[88:91]
s_add_u32 m0, s35, 24576
v_accvgpr_read_b32 v153, a125
v_accvgpr_read_b32 v154, a126
v_accvgpr_read_b32 v155, a127
v_cvt_pk_bf16_f32 v248, v148, v149
v_cvt_pk_bf16_f32 v249, v150, v151
v_cvt_pk_bf16_f32 v250, v152, v153
v_cvt_pk_bf16_f32 v251, v154, v155
mf a[120:123],a[244:247],a[188:191],0
s_add_u32 s37, s53, 393216
mf a[120:123],a[240:243],a[184:187],a[120:123]
buffer_load_dwordx4 v141, s[48:51], s37 offen lds
mf a[124:127],a[248:251],a[184:187],0
mf a[124:127],a[252:255],a[188:191],a[124:127]
s_add_u32 m0, s34, 28672
mf a[92:95],a[252:255],a[180:183],0
s_add_u32 s36, s56, 86016
mf a[92:95],a[248:251],a[176:179],a[92:95]
buffer_load_dwordx4 v140, s[44:47], s36 offen lds
mf a[60:63],a[248:251],a[168:171],0
mf a[60:63],a[252:255],a[172:175],a[60:63]
s_add_u32 m0, s35, 26624
mf a[28:31],a[252:255],a[164:167],0
s_add_u32 s37, s53, 425984
mf a[28:31],a[248:251],a[160:163],a[28:31]
buffer_load_dwordx4 v141, s[48:51], s37 offen lds
s_add_u32 s52, s52, 128
s_add_u32 s53, s53, 524288
s_add_u32 s56, s56, 128
s_branch qrest_9
atype_16:
s_waitcnt lgkmcnt(0)
mf v[0:3],a[192:195],a[128:131],v[0:3]
ds_read_b64_tr_b16 a[224:225], v134 offset:0
mf v[0:3],a[196:199],a[132:135],v[0:3]
s_mov_b32 s56, s48
s_and_b32 s57, s49, 0xffff
mf v[32:35],a[196:199],a[140:143],v[32:35]
ds_read_b64_tr_b16 a[226:227], v134 offset:2048
s_mov_b32 s58, 401408
mf v[32:35],a[192:195],a[136:139],v[32:35]
s_mov_b32 s59, 0x20000
s_and_b32 s17, s42, 15
mf v[64:67],a[192:195],a[144:147],v[64:67]
ds_read_b64_tr_b16 a[228:229], v134 offset:16384
s_lshl_b32 s17, s17, 2
mf v[64:67],a[196:199],a[148:151],v[64:67]
s_add_u32 s17, s17, s16
s_mul_i32 s23, s17, 6272
mf v[96:99],a[196:199],a[156:159],v[96:99]
ds_read_b64_tr_b16 a[230:231], v134 offset:18432
v_lshlrev_b32 v157, 7, v255
mf v[96:99],a[192:195],a[152:155],v[96:99]
buffer_load_dword v254, v157, s[56:59], s23 offen
s_mov_b32 s52, s44
mf v[100:103],a[200:203],a[152:155],v[100:103]
ds_read_b64_tr_b16 a[232:233], v135 offset:0
s_and_b32 s53, s45, 0xffff
mf v[100:103],a[204:207],a[156:159],v[100:103]
s_mov_b32 s54, 1835008
s_mov_b32 s55, 0x20000
mf v[68:71],a[204:207],a[148:151],v[68:71]
ds_read_b64_tr_b16 a[234:235], v135 offset:2048
s_mov_b32 s56, s48
mf v[68:71],a[200:203],a[144:147],v[68:71]
s_and_b32 s57, s49, 0xffff
s_mov_b32 s58, 401408
mf v[36:39],a[200:203],a[136:139],v[36:39]
ds_read_b64_tr_b16 a[236:237], v135 offset:16384
s_mov_b32 s59, 0x20000
mf v[36:39],a[204:207],a[140:143],v[36:39]
s_mov_b32 s60, s50
s_and_b32 s61, s51, 0xffff
mf v[4:7],a[204:207],a[132:135],v[4:7]
ds_read_b64_tr_b16 a[238:239], v135 offset:18432
s_mov_b32 s62, 401408
mf v[4:7],a[200:203],a[128:131],v[4:7]
s_mov_b32 s63, 0x20000
s_mov_b32 s64, s8
mf v[8:11],a[208:211],a[128:131],v[8:11]
ds_read_b64_tr_b16 a[240:241], v136 offset:0
s_and_b32 s65, s9, 0xffff
mf v[8:11],a[212:215],a[132:135],v[8:11]
s_mov_b32 s66, 896
s_mov_b32 s67, 0x20000
mf v[40:43],a[212:215],a[140:143],v[40:43]
ds_read_b64_tr_b16 a[242:243], v136 offset:2048
v_and_b32 v160, 15, v255
mf v[40:43],a[208:211],a[136:139],v[40:43]
v_add_u32 v162, -2, v160
v_add_u32 v163, 14, v160
mf v[72:75],a[208:211],a[144:147],v[72:75]
ds_read_b64_tr_b16 a[244:245], v136 offset:16384
v_cmp_gt_u32 vcc, 2, v160
mf v[72:75],a[212:215],a[148:151],v[72:75]
v_mov_b32 v164, 0x10000
s_nop 0
mf v[104:107],a[212:215],a[156:159],v[104:107]
ds_read_b64_tr_b16 a[246:247], v136 offset:18432
v_cndmask_b32 v162, v163, v162, vcc
mf v[104:107],a[208:211],a[152:155],v[104:107]
v_cmp_gt_u32 vcc, 4, v160
s_lshl_b32 s20, s43, 4
mf v[108:111],a[216:219],a[152:155],v[108:111]
ds_read_b64_tr_b16 a[248:249], v137 offset:0
s_nop 0
mf v[108:111],a[220:223],a[156:159],v[108:111]
v_cndmask_b32 v146, v164, v162, vcc
s_bitcmp1_b32 s16, 0
mf v[76:79],a[220:223],a[148:151],v[76:79]
ds_read_b64_tr_b16 a[250:251], v137 offset:2048
s_cselect_b64 vcc, -1, 0
mf v[76:79],a[216:219],a[144:147],v[76:79]
v_cndmask_b32 v161, v160, v146, vcc
v_add_u32 v161, s20, v161
mf v[44:47],a[216:219],a[136:139],v[44:47]
ds_read_b64_tr_b16 a[252:253], v137 offset:16384
s_movk_i32 s17, 896
mf v[44:47],a[220:223],a[140:143],v[44:47]
v_mul_lo_u32 v161, v161, s17
v_lshrrev_b32 v147, 4, v255
mf v[12:15],a[220:223],a[132:135],v[12:15]
ds_read_b64_tr_b16 a[254:255], v137 offset:18432
v_lshlrev_b32 v147, 4, v147
mf v[12:15],a[216:219],a[128:131],v[12:15]
v_add_u32 v156, v161, v147
s_waitcnt lgkmcnt(8)
mf v[16:19],a[224:227],a[128:131],v[16:19]
s_and_b32 s17, s16, 1
s_mul_i32 s21, s17, 14336
mf v[16:19],a[228:231],a[132:135],v[16:19]
ds_read_b128 a[160:163], v128 offset:8192
s_lshl_b32 s17, s17, 2
mf v[48:51],a[228:231],a[140:143],v[48:51]
v_add_u32 v160, 0, v255
v_mul_u32_u24 v161, 1171, v160
mf v[48:51],a[224:227],a[136:139],v[48:51]
v_lshrrev_b32 v161, 16, v161
v_and_b32 v163, 2, v161
mf v[80:83],a[224:227],a[144:147],v[80:83]
ds_read_b128 a[164:167], v129 offset:8192
v_or_b32 v163, s17, v163
mf v[80:83],a[228:231],a[148:151],v[80:83]
v_xor_b32 v160, v255, v163
v_lshlrev_b32 v138, 4, v160
mf v[112:115],a[228:231],a[156:159],v[112:115]
v_add_u32 v160, 64, v255
v_mul_u32_u24 v161, 1171, v160
mf v[112:115],a[224:227],a[152:155],v[112:115]
ds_read_b128 a[168:171], v128 offset:10240
v_lshrrev_b32 v161, 16, v161
mf v[116:119],a[232:235],a[152:155],v[116:119]
v_and_b32 v163, 2, v161
v_or_b32 v163, s17, v163
mf v[116:119],a[236:239],a[156:159],v[116:119]
v_xor_b32 v160, v255, v163
v_lshlrev_b32 v139, 4, v160
mf v[84:87],a[236:239],a[148:151],v[84:87]
ds_read_b128 a[172:175], v129 offset:10240
v_add_u32 v160, 128, v255
mf v[84:87],a[232:235],a[144:147],v[84:87]
v_mul_u32_u24 v161, 1171, v160
v_lshrrev_b32 v161, 16, v161
mf v[52:55],a[232:235],a[136:139],v[52:55]
v_and_b32 v163, 2, v161
v_or_b32 v163, s17, v163
mf v[52:55],a[236:239],a[140:143],v[52:55]
ds_read_b128 a[176:179], v128 offset:12288
v_xor_b32 v160, v255, v163
mf v[20:23],a[236:239],a[132:135],v[20:23]
v_lshlrev_b32 v140, 4, v160
v_add_u32 v160, 192, v255
mf v[20:23],a[232:235],a[128:131],v[20:23]
v_mul_u32_u24 v161, 1171, v160
s_waitcnt lgkmcnt(5)
mf v[24:27],a[240:243],a[128:131],v[24:27]
ds_read_b128 a[180:183], v129 offset:12288
v_lshrrev_b32 v161, 16, v161
mf v[24:27],a[244:247],a[132:135],v[24:27]
v_and_b32 v163, 2, v161
v_or_b32 v163, s17, v163
mf v[56:59],a[244:247],a[140:143],v[56:59]
v_xor_b32 v160, v255, v163
v_lshlrev_b32 v141, 4, v160
mf v[56:59],a[240:243],a[136:139],v[56:59]
ds_read_b128 a[184:187], v128 offset:14336
v_add_u32 v160, 256, v255
mf v[88:91],a[240:243],a[144:147],v[88:91]
v_mul_u32_u24 v161, 1171, v160
v_lshrrev_b32 v161, 16, v161
mf v[88:91],a[244:247],a[148:151],v[88:91]
v_and_b32 v163, 2, v161
v_or_b32 v163, s17, v163
mf v[120:123],a[244:247],a[156:159],v[120:123]
ds_read_b128 a[188:191], v129 offset:14336
v_xor_b32 v160, v255, v163
mf v[120:123],a[240:243],a[152:155],v[120:123]
v_lshlrev_b32 v143, 4, v160
v_add_u32 v160, 320, v255
mf v[124:127],a[248:251],a[152:155],v[124:127]
v_mul_u32_u24 v161, 1171, v160
v_lshrrev_b32 v161, 16, v161
mf v[124:127],a[252:255],a[156:159],v[124:127]
v_and_b32 v163, 2, v161
v_or_b32 v163, s17, v163
mf v[92:95],a[252:255],a[148:151],v[92:95]
v_xor_b32 v160, v255, v163
v_lshlrev_b32 v144, 4, v160
mf v[92:95],a[248:251],a[144:147],v[92:95]
v_add_u32 v160, 384, v255
v_mul_u32_u24 v161, 1171, v160
v_lshrrev_b32 v161, 16, v161
v_and_b32 v163, 2, v161
v_or_b32 v163, s17, v163
v_xor_b32 v160, v255, v163
v_lshlrev_b32 v145, 4, v160
s_mul_i32 s18, s16, 7168
s_lshr_b32 s17, s16, 1
s_mul_i32 s22, s17, 448
s_mul_i32 s17, s17, 7168
s_add_u32 s21, s21, s17
v_mov_b32 v160, 0x3f803f80
v_mov_b32 v161, 0x3f803f80
v_mov_b32 v162, 0x3f803f80
v_mov_b32 v163, 0x3f803f80
v_add_u32 v164, 160768, v142
ds_write_b128 v164, v[160:163]
v_min_u32 v164, 55, v255
v_lshlrev_b32 v164, 8, v164
v_add_u32 v164, 145472, v164
ds_write_b128 v164, v[160:163]
s_bitcmp1_b32 s16, 0
s_cselect_b32 s26, 0xffefffef, -1
s_mov_b32 s27, s26
mf v[60:63],a[248:251],a[136:139],v[60:63]
mf v[60:63],a[252:255],a[140:143],v[60:63]
mf v[28:31],a[252:255],a[132:135],v[28:31]
mf v[28:31],a[248:251],a[128:131],v[28:31]
s_waitcnt lgkmcnt(0) vmcnt(1)
s_barrier
mf a[0:3],a[192:195],a[160:163],a[0:3]
ds_read_b128 a[128:131], v128 offset:32768
ds_read_b128 a[132:135], v129 offset:32768
mf a[0:3],a[196:199],a[164:167],a[0:3]
s_add_u32 m0, s21, 131072
s_add_u32 s20, s22, 0
mf a[32:35],a[196:199],a[172:175],a[32:35]
mf a[32:35],a[192:195],a[168:171],a[32:35]
s_mov_b64 exec, s[26:27]
buffer_load_dwordx4 v156, s[52:55], s20 offen lds
s_mov_b64 exec, -1
mf a[64:67],a[192:195],a[176:179],a[64:67]
ds_read_b128 a[136:139], v128 offset:34816
ds_read_b128 a[140:143], v129 offset:34816
mf a[64:67],a[196:199],a[180:183],a[64:67]
s_add_u32 m0, s21, 132096
mf a[96:99],a[196:199],a[188:191],a[96:99]
s_add_u32 s20, s22, 64
mf a[96:99],a[192:195],a[184:187],a[96:99]
mf a[100:103],a[200:203],a[184:187],a[100:103]
ds_read_b128 a[144:147], v128 offset:36864
ds_read_b128 a[148:151], v129 offset:36864
mf a[100:103],a[204:207],a[188:191],a[100:103]
s_mov_b64 exec, s[26:27]
buffer_load_dwordx4 v156, s[52:55], s20 offen lds
s_mov_b64 exec, -1
mf a[68:71],a[204:207],a[180:183],a[68:71]
s_add_u32 m0, s21, 133120
mf a[68:71],a[200:203],a[176:179],a[68:71]
s_add_u32 s20, s22, 128
mf a[36:39],a[200:203],a[168:171],a[36:39]
ds_read_b64_tr_b16 a[192:193], v130 offset:32768
ds_read_b64_tr_b16 a[194:195], v130 offset:34816
mf a[36:39],a[204:207],a[172:175],a[36:39]
s_mov_b64 exec, s[26:27]
buffer_load_dwordx4 v156, s[52:55], s20 offen lds
s_mov_b64 exec, -1
mf a[4:7],a[204:207],a[164:167],a[4:7]
mf a[4:7],a[200:203],a[160:163],a[4:7]
s_add_u32 m0, s21, 134144
mf a[8:11],a[208:211],a[160:163],a[8:11]
ds_read_b64_tr_b16 a[196:197], v130 offset:49152
ds_read_b64_tr_b16 a[198:199], v130 offset:51200
mf a[8:11],a[212:215],a[164:167],a[8:11]
s_add_u32 s20, s22, 192
mf a[40:43],a[212:215],a[172:175],a[40:43]
s_mov_b64 exec, s[26:27]
buffer_load_dwordx4 v156, s[52:55], s20 offen lds
s_mov_b64 exec, -1
mf a[40:43],a[208:211],a[168:171],a[40:43]
mf a[72:75],a[208:211],a[176:179],a[72:75]
ds_read_b128 a[152:155], v128 offset:38912
ds_read_b128 a[156:159], v129 offset:38912
mf a[72:75],a[212:215],a[180:183],a[72:75]
s_add_u32 m0, s21, 135168
s_add_u32 s20, s22, 256
mf a[104:107],a[212:215],a[188:191],a[104:107]
mf a[104:107],a[208:211],a[184:187],a[104:107]
s_mov_b64 exec, s[26:27]
buffer_load_dwordx4 v156, s[52:55], s20 offen lds
s_mov_b64 exec, -1
mf a[108:111],a[216:219],a[184:187],a[108:111]
ds_read_b64_tr_b16 a[200:201], v131 offset:32768
ds_read_b64_tr_b16 a[202:203], v131 offset:34816
mf a[108:111],a[220:223],a[188:191],a[108:111]
s_add_u32 m0, s21, 136192
mf a[76:79],a[220:223],a[180:183],a[76:79]
s_add_u32 s20, s22, 320
mf a[76:79],a[216:219],a[176:179],a[76:79]
mf a[44:47],a[216:219],a[168:171],a[44:47]
ds_read_b64_tr_b16 a[204:205], v131 offset:49152
ds_read_b64_tr_b16 a[206:207], v131 offset:51200
mf a[44:47],a[220:223],a[172:175],a[44:47]
s_mov_b64 exec, s[26:27]
buffer_load_dwordx4 v156, s[52:55], s20 offen lds
s_mov_b64 exec, -1
mf a[12:15],a[220:223],a[164:167],a[12:15]
s_add_u32 m0, s21, 137216
mf a[12:15],a[216:219],a[160:163],a[12:15]
s_add_u32 s20, s22, 384
mf a[16:19],a[224:227],a[160:163],a[16:19]
mf a[16:19],a[228:231],a[164:167],a[16:19]
s_mov_b64 exec, s[26:27]
buffer_load_dwordx4 v156, s[52:55], s20 offen lds
s_mov_b64 exec, -1
mf a[48:51],a[228:231],a[172:175],a[48:51]
mf a[48:51],a[224:227],a[168:171],a[48:51]
s_mov_b32 m0, 159744
mf a[80:83],a[224:227],a[176:179],a[80:83]
ds_read_b64_tr_b16 a[208:209], v132 offset:32768
ds_read_b64_tr_b16 a[210:211], v132 offset:34816
mf a[80:83],a[228:231],a[180:183],a[80:83]
s_nop 0
mf a[112:115],a[228:231],a[188:191],a[112:115]
buffer_load_dwordx4 v142, s[64:67], 0 offen lds
mf a[112:115],a[224:227],a[184:187],a[112:115]
mf a[116:119],a[232:235],a[184:187],a[116:119]
ds_read_b64_tr_b16 a[212:213], v132 offset:49152
ds_read_b64_tr_b16 a[214:215], v132 offset:51200
mf a[116:119],a[236:239],a[188:191],a[116:119]
s_add_u32 m0, s18, 0
s_add_u32 s20, s18, 0
mf a[84:87],a[236:239],a[180:183],a[84:87]
mf a[84:87],a[232:235],a[176:179],a[84:87]
buffer_load_dwordx4 v138, s[56:59], s20 offen offset:0 lds
mf a[52:55],a[232:235],a[168:171],a[52:55]
mf a[52:55],a[236:239],a[172:175],a[52:55]
buffer_load_dwordx4 v139, s[56:59], s20 offen offset:1024 lds
mf a[20:23],a[236:239],a[164:167],a[20:23]
buffer_load_dwordx4 v140, s[56:59], s20 offen offset:2048 lds
mf a[20:23],a[232:235],a[160:163],a[20:23]
mf a[24:27],a[240:243],a[160:163],a[24:27]
ds_read_b64_tr_b16 a[216:217], v133 offset:32768
ds_read_b64_tr_b16 a[218:219], v133 offset:34816
mf a[24:27],a[244:247],a[164:167],a[24:27]
buffer_load_dwordx4 v141, s[56:59], s20 offen offset:3072 lds
mf a[56:59],a[244:247],a[172:175],a[56:59]
s_add_u32 m0, s18, 4096
mf a[56:59],a[240:243],a[168:171],a[56:59]
s_add_u32 s20, s18, 4096
mf a[88:91],a[240:243],a[176:179],a[88:91]
ds_read_b64_tr_b16 a[220:221], v133 offset:49152
ds_read_b64_tr_b16 a[222:223], v133 offset:51200
mf a[88:91],a[244:247],a[180:183],a[88:91]
buffer_load_dwordx4 v143, s[56:59], s20 offen offset:0 lds
mf a[120:123],a[244:247],a[188:191],a[120:123]
mf a[120:123],a[240:243],a[184:187],a[120:123]
buffer_load_dwordx4 v144, s[56:59], s20 offen offset:1024 lds
mf a[124:127],a[248:251],a[184:187],a[124:127]
buffer_load_dwordx4 v145, s[56:59], s20 offen offset:2048 lds
mf a[124:127],a[252:255],a[188:191],a[124:127]
mf a[92:95],a[252:255],a[180:183],a[92:95]
buffer_load_dword v254, v157, s[60:63], s23 offen
mf a[92:95],a[248:251],a[176:179],a[92:95]
mf a[60:63],a[248:251],a[168:171],a[60:63]
mf a[60:63],a[252:255],a[172:175],a[60:63]
mf a[28:31],a[252:255],a[164:167],a[28:31]
mf a[28:31],a[248:251],a[160:163],a[28:31]
s_waitcnt lgkmcnt(0)
mf v[0:3],a[192:195],a[128:131],v[0:3]
ds_read_b64_tr_b16 a[224:225], v134 offset:32768
mf v[0:3],a[196:199],a[132:135],v[0:3]
s_add_u32 m0, s18, 65536
mf v[32:35],a[196:199],a[140:143],v[32:35]
ds_read_b64_tr_b16 a[226:227], v134 offset:34816
mf v[32:35],a[192:195],a[136:139],v[32:35]
s_add_u32 s20, s18, 28672
mf v[64:67],a[192:195],a[144:147],v[64:67]
ds_read_b64_tr_b16 a[228:229], v134 offset:49152
mf v[64:67],a[196:199],a[148:151],v[64:67]
buffer_load_dwordx4 v138, s[56:59], s20 offen offset:0 lds
mf v[96:99],a[196:199],a[156:159],v[96:99]
ds_read_b64_tr_b16 a[230:231], v134 offset:51200
mf v[96:99],a[192:195],a[152:155],v[96:99]
buffer_load_dwordx4 v139, s[56:59], s20 offen offset:1024 lds
mf v[100:103],a[200:203],a[152:155],v[100:103]
ds_read_b64_tr_b16 a[232:233], v135 offset:32768
mf v[100:103],a[204:207],a[156:159],v[100:103]
mf v[68:71],a[204:207],a[148:151],v[68:71]
ds_read_b64_tr_b16 a[234:235], v135 offset:34816
buffer_load_dwordx4 v140, s[56:59], s20 offen offset:2048 lds
mf v[68:71],a[200:203],a[144:147],v[68:71]
mf v[36:39],a[200:203],a[136:139],v[36:39]
ds_read_b64_tr_b16 a[236:237], v135 offset:49152
buffer_load_dwordx4 v141, s[56:59], s20 offen offset:3072 lds
mf v[36:39],a[204:207],a[140:143],v[36:39]
mf v[4:7],a[204:207],a[132:135],v[4:7]
ds_read_b64_tr_b16 a[238:239], v135 offset:51200
s_add_u32 m0, s18, 69632
mf v[4:7],a[200:203],a[128:131],v[4:7]
mf v[8:11],a[208:211],a[128:131],v[8:11]
ds_read_b64_tr_b16 a[240:241], v136 offset:32768
s_add_u32 s20, s18, 32768
mf v[8:11],a[212:215],a[132:135],v[8:11]
mf v[40:43],a[212:215],a[140:143],v[40:43]
ds_read_b64_tr_b16 a[242:243], v136 offset:34816
mf v[40:43],a[208:211],a[136:139],v[40:43]
buffer_load_dwordx4 v143, s[56:59], s20 offen offset:0 lds
mf v[72:75],a[208:211],a[144:147],v[72:75]
ds_read_b64_tr_b16 a[244:245], v136 offset:49152
mf v[72:75],a[212:215],a[148:151],v[72:75]
buffer_load_dwordx4 v144, s[56:59], s20 offen offset:1024 lds
mf v[104:107],a[212:215],a[156:159],v[104:107]
ds_read_b64_tr_b16 a[246:247], v136 offset:51200
mf v[104:107],a[208:211],a[152:155],v[104:107]
buffer_load_dwordx4 v145, s[56:59], s20 offen offset:2048 lds
mf v[108:111],a[216:219],a[152:155],v[108:111]
ds_read_b64_tr_b16 a[248:249], v137 offset:32768
mf v[108:111],a[220:223],a[156:159],v[108:111]
v_and_b32 v252, 3, v255
mf v[76:79],a[220:223],a[148:151],v[76:79]
ds_read_b64_tr_b16 a[250:251], v137 offset:34816
mf v[76:79],a[216:219],a[144:147],v[76:79]
mf v[44:47],a[216:219],a[136:139],v[44:47]
ds_read_b64_tr_b16 a[252:253], v137 offset:49152
v_and_b32 v158, 12, v255
mf v[44:47],a[220:223],a[140:143],v[44:47]
mf v[12:15],a[220:223],a[132:135],v[12:15]
ds_read_b64_tr_b16 a[254:255], v137 offset:51200
v_xor_b32 v158, 8, v158
mf v[12:15],a[216:219],a[128:131],v[12:15]
s_waitcnt lgkmcnt(8)
mf v[16:19],a[224:227],a[128:131],v[16:19]
v_lshl_add_u32 v252, v158, 1, v252
mf v[16:19],a[228:231],a[132:135],v[16:19]
ds_read_b128 a[160:163], v128 offset:40960
mf v[48:51],a[228:231],a[140:143],v[48:51]
mf v[48:51],a[224:227],a[136:139],v[48:51]
s_and_b32 s17, s15, 1
mf v[80:83],a[224:227],a[144:147],v[80:83]
ds_read_b128 a[164:167], v129 offset:40960
mf v[80:83],a[228:231],a[148:151],v[80:83]
s_lshl_b32 s17, s17, 5
mf v[112:115],a[228:231],a[156:159],v[112:115]
mf v[112:115],a[224:227],a[152:155],v[112:115]
ds_read_b128 a[168:171], v128 offset:43008
s_add_u32 s17, s17, s12
mf v[116:119],a[232:235],a[152:155],v[116:119]
mf v[116:119],a[236:239],a[156:159],v[116:119]
v_lshl_add_u32 v252, v252, 3, s17
mf v[84:87],a[236:239],a[148:151],v[84:87]
ds_read_b128 a[172:175], v129 offset:43008
mf v[84:87],a[232:235],a[144:147],v[84:87]
mf v[52:55],a[232:235],a[136:139],v[52:55]
v_bfe_u32 v253, v255, 3, 1
mf v[52:55],a[236:239],a[140:143],v[52:55]
ds_read_b128 a[176:179], v128 offset:45056
mf v[20:23],a[236:239],a[132:135],v[20:23]
v_add_u32 v253, 1, v253
mf v[20:23],a[232:235],a[128:131],v[20:23]
s_waitcnt lgkmcnt(5)
mf v[24:27],a[240:243],a[128:131],v[24:27]
ds_read_b128 a[180:183], v129 offset:45056
s_and_b32 s17, s2, 127
mf v[24:27],a[244:247],a[132:135],v[24:27]
mf v[56:59],a[244:247],a[140:143],v[56:59]
v_writelane_b32 v252, s17, 16
mf v[56:59],a[240:243],a[136:139],v[56:59]
ds_read_b128 a[184:187], v128 offset:47104
mf v[88:91],a[240:243],a[144:147],v[88:91]
mf v[88:91],a[244:247],a[148:151],v[88:91]
v_writelane_b32 v253, 2, 16
mf v[120:123],a[244:247],a[156:159],v[120:123]
ds_read_b128 a[188:191], v129 offset:47104
mf v[120:123],a[240:243],a[152:155],v[120:123]
v_lshlrev_b32 v252, 7, v252
mf v[124:127],a[248:251],a[152:155],v[124:127]
mf v[124:127],a[252:255],a[156:159],v[124:127]
v_add_u32 v252, 105906176, v252
mf v[92:95],a[252:255],a[148:151],v[92:95]
mf v[92:95],a[248:251],a[144:147],v[92:95]
mf v[60:63],a[248:251],a[136:139],v[60:63]
mf v[60:63],a[252:255],a[140:143],v[60:63]
mf v[28:31],a[252:255],a[132:135],v[28:31]
mf v[28:31],a[248:251],a[128:131],v[28:31]
s_waitcnt lgkmcnt(0)
s_barrier
mf a[0:3],a[192:195],a[160:163],a[0:3]
s_add_u32 m0, s18, 32768
s_add_u32 s20, s18, 57344
buffer_load_dwordx4 v138, s[56:59], s20 offen offset:0 lds
buffer_load_dwordx4 v139, s[56:59], s20 offen offset:1024 lds
mf a[0:3],a[196:199],a[164:167],a[0:3]
buffer_load_dwordx4 v140, s[56:59], s20 offen offset:2048 lds
buffer_load_dwordx4 v141, s[56:59], s20 offen offset:3072 lds
s_add_u32 m0, s18, 36864
s_add_u32 s20, s18, 61440
mf a[32:35],a[196:199],a[172:175],a[32:35]
buffer_load_dwordx4 v143, s[56:59], s20 offen offset:0 lds
buffer_load_dwordx4 v144, s[56:59], s20 offen offset:1024 lds
buffer_load_dwordx4 v145, s[56:59], s20 offen offset:2048 lds
s_add_u32 m0, s18, 98304
mf a[32:35],a[192:195],a[168:171],a[32:35]
s_add_u32 s20, s18, 86016
buffer_load_dwordx4 v138, s[56:59], s20 offen offset:0 lds
buffer_load_dwordx4 v139, s[56:59], s20 offen offset:1024 lds
buffer_load_dwordx4 v140, s[56:59], s20 offen offset:2048 lds
mf a[64:67],a[192:195],a[176:179],a[64:67]
buffer_load_dwordx4 v141, s[56:59], s20 offen offset:3072 lds
s_add_u32 m0, s18, 102400
s_add_u32 s20, s18, 90112
buffer_load_dwordx4 v143, s[56:59], s20 offen offset:0 lds
mf a[64:67],a[196:199],a[180:183],a[64:67]
buffer_load_dwordx4 v144, s[56:59], s20 offen offset:1024 lds
buffer_load_dwordx4 v145, s[56:59], s20 offen offset:2048 lds
v_cvt_pk_bf16_f32 v0, v0, v1
v_cvt_pk_bf16_f32 v1, v2, v3
mf a[96:99],a[196:199],a[188:191],a[96:99]
v_cvt_pk_bf16_f32 v2, v4, v5
v_cvt_pk_bf16_f32 v3, v6, v7
s_add_u32 s36, s39, 0
buffer_store_dwordx4 v[0:3], v142, s[28:31], s36 offen offset:0 sc1
mf a[96:99],a[192:195],a[184:187],a[96:99]
v_cvt_pk_bf16_f32 v4, v8, v9
v_cvt_pk_bf16_f32 v5, v10, v11
v_cvt_pk_bf16_f32 v6, v12, v13
v_cvt_pk_bf16_f32 v7, v14, v15
mf a[100:103],a[200:203],a[184:187],a[100:103]
s_add_u32 s36, s39, 0
buffer_store_dwordx4 v[4:7], v142, s[28:31], s36 offen offset:1024 sc1
v_cvt_pk_bf16_f32 v8, v16, v17
v_cvt_pk_bf16_f32 v9, v18, v19
mf a[100:103],a[204:207],a[188:191],a[100:103]
v_cvt_pk_bf16_f32 v10, v20, v21
v_cvt_pk_bf16_f32 v11, v22, v23
s_add_u32 s36, s39, 0
buffer_store_dwordx4 v[8:11], v142, s[28:31], s36 offen offset:2048 sc1
mf a[68:71],a[204:207],a[180:183],a[68:71]
v_cvt_pk_bf16_f32 v12, v24, v25
v_cvt_pk_bf16_f32 v13, v26, v27
v_cvt_pk_bf16_f32 v14, v28, v29
v_cvt_pk_bf16_f32 v15, v30, v31
mf a[68:71],a[200:203],a[176:179],a[68:71]
s_add_u32 s36, s39, 0
buffer_store_dwordx4 v[12:15], v142, s[28:31], s36 offen offset:3072 sc1
v_cvt_pk_bf16_f32 v16, v32, v33
v_cvt_pk_bf16_f32 v17, v34, v35
mf a[36:39],a[200:203],a[168:171],a[36:39]
v_cvt_pk_bf16_f32 v18, v36, v37
v_cvt_pk_bf16_f32 v19, v38, v39
s_add_u32 s36, s19, 0
buffer_store_dwordx4 v[16:19], v142, s[28:31], s36 offen offset:0 sc1
mf a[36:39],a[204:207],a[172:175],a[36:39]
v_cvt_pk_bf16_f32 v20, v40, v41
v_cvt_pk_bf16_f32 v21, v42, v43
v_cvt_pk_bf16_f32 v22, v44, v45
v_cvt_pk_bf16_f32 v23, v46, v47
mf a[4:7],a[204:207],a[164:167],a[4:7]
s_add_u32 s36, s19, 0
buffer_store_dwordx4 v[20:23], v142, s[28:31], s36 offen offset:1024 sc1
v_cvt_pk_bf16_f32 v24, v48, v49
v_cvt_pk_bf16_f32 v25, v50, v51
mf a[4:7],a[200:203],a[160:163],a[4:7]
v_cvt_pk_bf16_f32 v26, v52, v53
v_cvt_pk_bf16_f32 v27, v54, v55
s_add_u32 s36, s19, 0
buffer_store_dwordx4 v[24:27], v142, s[28:31], s36 offen offset:2048 sc1
mf a[8:11],a[208:211],a[160:163],a[8:11]
v_cvt_pk_bf16_f32 v28, v56, v57
v_cvt_pk_bf16_f32 v29, v58, v59
v_cvt_pk_bf16_f32 v30, v60, v61
v_cvt_pk_bf16_f32 v31, v62, v63
mf a[8:11],a[212:215],a[164:167],a[8:11]
s_add_u32 s36, s19, 0
buffer_store_dwordx4 v[28:31], v142, s[28:31], s36 offen offset:3072 sc1
v_cvt_pk_bf16_f32 v32, v64, v65
v_cvt_pk_bf16_f32 v33, v66, v67
mf a[40:43],a[212:215],a[172:175],a[40:43]
v_cvt_pk_bf16_f32 v34, v68, v69
v_cvt_pk_bf16_f32 v35, v70, v71
s_add_u32 s36, s39, 16384
buffer_store_dwordx4 v[32:35], v142, s[28:31], s36 offen offset:0 sc1
mf a[40:43],a[208:211],a[168:171],a[40:43]
v_cvt_pk_bf16_f32 v36, v72, v73
v_cvt_pk_bf16_f32 v37, v74, v75
v_cvt_pk_bf16_f32 v38, v76, v77
v_cvt_pk_bf16_f32 v39, v78, v79
mf a[72:75],a[208:211],a[176:179],a[72:75]
s_add_u32 s36, s39, 16384
buffer_store_dwordx4 v[36:39], v142, s[28:31], s36 offen offset:1024 sc1
v_cvt_pk_bf16_f32 v40, v80, v81
v_cvt_pk_bf16_f32 v41, v82, v83
mf a[72:75],a[212:215],a[180:183],a[72:75]
v_cvt_pk_bf16_f32 v42, v84, v85
v_cvt_pk_bf16_f32 v43, v86, v87
s_add_u32 s36, s39, 16384
buffer_store_dwordx4 v[40:43], v142, s[28:31], s36 offen offset:2048 sc1
mf a[104:107],a[212:215],a[188:191],a[104:107]
v_cvt_pk_bf16_f32 v44, v88, v89
v_cvt_pk_bf16_f32 v45, v90, v91
v_cvt_pk_bf16_f32 v46, v92, v93
v_cvt_pk_bf16_f32 v47, v94, v95
mf a[104:107],a[208:211],a[184:187],a[104:107]
s_add_u32 s36, s39, 16384
buffer_store_dwordx4 v[44:47], v142, s[28:31], s36 offen offset:3072 sc1
v_cvt_pk_bf16_f32 v48, v96, v97
v_cvt_pk_bf16_f32 v49, v98, v99
mf a[108:111],a[216:219],a[184:187],a[108:111]
v_cvt_pk_bf16_f32 v50, v100, v101
v_cvt_pk_bf16_f32 v51, v102, v103
s_add_u32 s36, s19, 16384
buffer_store_dwordx4 v[48:51], v142, s[28:31], s36 offen offset:0 sc1
mf a[108:111],a[220:223],a[188:191],a[108:111]
v_cvt_pk_bf16_f32 v52, v104, v105
v_cvt_pk_bf16_f32 v53, v106, v107
v_cvt_pk_bf16_f32 v54, v108, v109
v_cvt_pk_bf16_f32 v55, v110, v111
mf a[76:79],a[220:223],a[180:183],a[76:79]
s_add_u32 s36, s19, 16384
buffer_store_dwordx4 v[52:55], v142, s[28:31], s36 offen offset:1024 sc1
v_cvt_pk_bf16_f32 v56, v112, v113
v_cvt_pk_bf16_f32 v57, v114, v115
mf a[76:79],a[216:219],a[176:179],a[76:79]
v_cvt_pk_bf16_f32 v58, v116, v117
v_cvt_pk_bf16_f32 v59, v118, v119
s_add_u32 s36, s19, 16384
buffer_store_dwordx4 v[56:59], v142, s[28:31], s36 offen offset:2048 sc1
mf a[44:47],a[216:219],a[168:171],a[44:47]
v_cvt_pk_bf16_f32 v60, v120, v121
v_cvt_pk_bf16_f32 v61, v122, v123
v_cvt_pk_bf16_f32 v62, v124, v125
v_cvt_pk_bf16_f32 v63, v126, v127
mf a[44:47],a[220:223],a[172:175],a[44:47]
s_add_u32 s36, s19, 16384
buffer_store_dwordx4 v[60:63], v142, s[28:31], s36 offen offset:3072 sc1
v_accvgpr_read_b32 v148, a96
v_accvgpr_read_b32 v149, a97
mf a[12:15],a[220:223],a[164:167],a[12:15]
v_accvgpr_read_b32 v150, a98
v_accvgpr_read_b32 v151, a99
v_accvgpr_read_b32 v152, a100
v_accvgpr_read_b32 v153, a101
mf a[12:15],a[216:219],a[160:163],a[12:15]
v_accvgpr_read_b32 v154, a102
v_accvgpr_read_b32 v155, a103
v_cvt_pk_bf16_f32 v112, v148, v149
v_cvt_pk_bf16_f32 v113, v150, v151
mf a[16:19],a[224:227],a[160:163],a[16:19]
v_cvt_pk_bf16_f32 v114, v152, v153
v_cvt_pk_bf16_f32 v115, v154, v155
s_add_u32 s36, s19, 49152
buffer_store_dwordx4 v[112:115], v142, s[28:31], s36 offen offset:0 sc1
mf a[16:19],a[228:231],a[164:167],a[16:19]
v_accvgpr_read_b32 v148, a64
v_accvgpr_read_b32 v149, a65
v_accvgpr_read_b32 v150, a66
v_accvgpr_read_b32 v151, a67
mf a[48:51],a[228:231],a[172:175],a[48:51]
v_accvgpr_read_b32 v152, a68
v_accvgpr_read_b32 v153, a69
v_accvgpr_read_b32 v154, a70
v_accvgpr_read_b32 v155, a71
mf a[48:51],a[224:227],a[168:171],a[48:51]
v_cvt_pk_bf16_f32 v96, v148, v149
v_cvt_pk_bf16_f32 v97, v150, v151
v_cvt_pk_bf16_f32 v98, v152, v153
v_cvt_pk_bf16_f32 v99, v154, v155
mf a[80:83],a[224:227],a[176:179],a[80:83]
s_add_u32 s36, s39, 49152
buffer_store_dwordx4 v[96:99], v142, s[28:31], s36 offen offset:0 sc1
v_accvgpr_read_b32 v148, a32
v_accvgpr_read_b32 v149, a33
mf a[80:83],a[228:231],a[180:183],a[80:83]
v_accvgpr_read_b32 v150, a34
v_accvgpr_read_b32 v151, a35
v_accvgpr_read_b32 v152, a36
v_accvgpr_read_b32 v153, a37
mf a[112:115],a[228:231],a[188:191],a[112:115]
v_accvgpr_read_b32 v154, a38
v_accvgpr_read_b32 v155, a39
v_cvt_pk_bf16_f32 v80, v148, v149
v_cvt_pk_bf16_f32 v81, v150, v151
mf a[112:115],a[224:227],a[184:187],a[112:115]
v_cvt_pk_bf16_f32 v82, v152, v153
v_cvt_pk_bf16_f32 v83, v154, v155
s_add_u32 s36, s19, 32768
buffer_store_dwordx4 v[80:83], v142, s[28:31], s36 offen offset:0 sc1
mf a[116:119],a[232:235],a[184:187],a[116:119]
v_accvgpr_read_b32 v148, a0
v_accvgpr_read_b32 v149, a1
v_accvgpr_read_b32 v150, a2
v_accvgpr_read_b32 v151, a3
mf a[116:119],a[236:239],a[188:191],a[116:119]
v_accvgpr_read_b32 v152, a4
v_accvgpr_read_b32 v153, a5
v_accvgpr_read_b32 v154, a6
v_accvgpr_read_b32 v155, a7
mf a[84:87],a[236:239],a[180:183],a[84:87]
v_cvt_pk_bf16_f32 v64, v148, v149
v_cvt_pk_bf16_f32 v65, v150, v151
v_cvt_pk_bf16_f32 v66, v152, v153
v_cvt_pk_bf16_f32 v67, v154, v155
mf a[84:87],a[232:235],a[176:179],a[84:87]
s_add_u32 s36, s39, 32768
buffer_store_dwordx4 v[64:67], v142, s[28:31], s36 offen offset:0 sc1
v_accvgpr_read_b32 v148, a104
v_accvgpr_read_b32 v149, a105
mf a[52:55],a[232:235],a[168:171],a[52:55]
v_accvgpr_read_b32 v150, a106
v_accvgpr_read_b32 v151, a107
v_accvgpr_read_b32 v152, a108
v_accvgpr_read_b32 v153, a109
mf a[52:55],a[236:239],a[172:175],a[52:55]
v_accvgpr_read_b32 v154, a110
v_accvgpr_read_b32 v155, a111
v_cvt_pk_bf16_f32 v116, v148, v149
v_cvt_pk_bf16_f32 v117, v150, v151
mf a[20:23],a[236:239],a[164:167],a[20:23]
v_cvt_pk_bf16_f32 v118, v152, v153
v_cvt_pk_bf16_f32 v119, v154, v155
s_add_u32 s36, s19, 49152
buffer_store_dwordx4 v[116:119], v142, s[28:31], s36 offen offset:1024 sc1
mf a[20:23],a[232:235],a[160:163],a[20:23]
v_accvgpr_read_b32 v148, a72
v_accvgpr_read_b32 v149, a73
v_accvgpr_read_b32 v150, a74
v_accvgpr_read_b32 v151, a75
mf a[24:27],a[240:243],a[160:163],a[24:27]
v_accvgpr_read_b32 v152, a76
v_accvgpr_read_b32 v153, a77
v_accvgpr_read_b32 v154, a78
v_accvgpr_read_b32 v155, a79
mf a[24:27],a[244:247],a[164:167],a[24:27]
v_cvt_pk_bf16_f32 v100, v148, v149
v_cvt_pk_bf16_f32 v101, v150, v151
v_cvt_pk_bf16_f32 v102, v152, v153
v_cvt_pk_bf16_f32 v103, v154, v155
mf a[56:59],a[244:247],a[172:175],a[56:59]
s_add_u32 s36, s39, 49152
buffer_store_dwordx4 v[100:103], v142, s[28:31], s36 offen offset:1024 sc1
v_accvgpr_read_b32 v148, a40
v_accvgpr_read_b32 v149, a41
mf a[56:59],a[240:243],a[168:171],a[56:59]
v_accvgpr_read_b32 v150, a42
v_accvgpr_read_b32 v151, a43
v_accvgpr_read_b32 v152, a44
v_accvgpr_read_b32 v153, a45
mf a[88:91],a[240:243],a[176:179],a[88:91]
v_accvgpr_read_b32 v154, a46
v_accvgpr_read_b32 v155, a47
v_cvt_pk_bf16_f32 v84, v148, v149
v_cvt_pk_bf16_f32 v85, v150, v151
mf a[88:91],a[244:247],a[180:183],a[88:91]
v_cvt_pk_bf16_f32 v86, v152, v153
v_cvt_pk_bf16_f32 v87, v154, v155
s_add_u32 s36, s19, 32768
buffer_store_dwordx4 v[84:87], v142, s[28:31], s36 offen offset:1024 sc1
mf a[120:123],a[244:247],a[188:191],a[120:123]
v_accvgpr_read_b32 v148, a8
v_accvgpr_read_b32 v149, a9
v_accvgpr_read_b32 v150, a10
v_accvgpr_read_b32 v151, a11
mf a[120:123],a[240:243],a[184:187],a[120:123]
v_accvgpr_read_b32 v152, a12
v_accvgpr_read_b32 v153, a13
v_accvgpr_read_b32 v154, a14
v_accvgpr_read_b32 v155, a15
mf a[124:127],a[248:251],a[184:187],a[124:127]
v_cvt_pk_bf16_f32 v68, v148, v149
v_cvt_pk_bf16_f32 v69, v150, v151
v_cvt_pk_bf16_f32 v70, v152, v153
v_cvt_pk_bf16_f32 v71, v154, v155
mf a[124:127],a[252:255],a[188:191],a[124:127]
s_add_u32 s36, s39, 32768
buffer_store_dwordx4 v[68:71], v142, s[28:31], s36 offen offset:1024 sc1
mf a[92:95],a[252:255],a[180:183],a[92:95]
mf a[92:95],a[248:251],a[176:179],a[92:95]
mf a[60:63],a[248:251],a[168:171],a[60:63]
mf a[60:63],a[252:255],a[172:175],a[60:63]
mf a[28:31],a[252:255],a[164:167],a[28:31]
mf a[28:31],a[248:251],a[160:163],a[28:31]
s_nop 3
v_accvgpr_read_b32 v148, a112
v_accvgpr_read_b32 v149, a113
v_accvgpr_read_b32 v150, a114
v_accvgpr_read_b32 v151, a115
v_accvgpr_read_b32 v152, a116
v_accvgpr_read_b32 v153, a117
v_accvgpr_read_b32 v154, a118
v_accvgpr_read_b32 v155, a119
v_cvt_pk_bf16_f32 v120, v148, v149
v_cvt_pk_bf16_f32 v121, v150, v151
v_cvt_pk_bf16_f32 v122, v152, v153
v_cvt_pk_bf16_f32 v123, v154, v155
s_add_u32 s36, s19, 49152
buffer_store_dwordx4 v[120:123], v142, s[28:31], s36 offen offset:2048 sc1
v_accvgpr_read_b32 v148, a80
v_accvgpr_read_b32 v149, a81
v_accvgpr_read_b32 v150, a82
v_accvgpr_read_b32 v151, a83
v_accvgpr_read_b32 v152, a84
v_accvgpr_read_b32 v153, a85
v_accvgpr_read_b32 v154, a86
v_accvgpr_read_b32 v155, a87
v_cvt_pk_bf16_f32 v104, v148, v149
v_cvt_pk_bf16_f32 v105, v150, v151
v_cvt_pk_bf16_f32 v106, v152, v153
v_cvt_pk_bf16_f32 v107, v154, v155
s_add_u32 s36, s39, 49152
buffer_store_dwordx4 v[104:107], v142, s[28:31], s36 offen offset:2048 sc1
v_accvgpr_read_b32 v148, a48
v_accvgpr_read_b32 v149, a49
v_accvgpr_read_b32 v150, a50
v_accvgpr_read_b32 v151, a51
v_accvgpr_read_b32 v152, a52
v_accvgpr_read_b32 v153, a53
v_accvgpr_read_b32 v154, a54
v_accvgpr_read_b32 v155, a55
v_cvt_pk_bf16_f32 v88, v148, v149
v_cvt_pk_bf16_f32 v89, v150, v151
v_cvt_pk_bf16_f32 v90, v152, v153
v_cvt_pk_bf16_f32 v91, v154, v155
s_add_u32 s36, s19, 32768
buffer_store_dwordx4 v[88:91], v142, s[28:31], s36 offen offset:2048 sc1
v_accvgpr_read_b32 v148, a16
v_accvgpr_read_b32 v149, a17
v_accvgpr_read_b32 v150, a18
v_accvgpr_read_b32 v151, a19
v_accvgpr_read_b32 v152, a20
v_accvgpr_read_b32 v153, a21
v_accvgpr_read_b32 v154, a22
v_accvgpr_read_b32 v155, a23
v_cvt_pk_bf16_f32 v72, v148, v149
v_cvt_pk_bf16_f32 v73, v150, v151
v_cvt_pk_bf16_f32 v74, v152, v153
v_cvt_pk_bf16_f32 v75, v154, v155
s_add_u32 s36, s39, 32768
buffer_store_dwordx4 v[72:75], v142, s[28:31], s36 offen offset:2048 sc1
v_accvgpr_read_b32 v148, a120
v_accvgpr_read_b32 v149, a121
v_accvgpr_read_b32 v150, a122
v_accvgpr_read_b32 v151, a123
v_accvgpr_read_b32 v152, a124
v_accvgpr_read_b32 v153, a125
v_accvgpr_read_b32 v154, a126
v_accvgpr_read_b32 v155, a127
v_cvt_pk_bf16_f32 v124, v148, v149
v_cvt_pk_bf16_f32 v125, v150, v151
v_cvt_pk_bf16_f32 v126, v152, v153
v_cvt_pk_bf16_f32 v127, v154, v155
s_add_u32 s36, s19, 49152
buffer_store_dwordx4 v[124:127], v142, s[28:31], s36 offen offset:3072 sc1
v_accvgpr_read_b32 v148, a88
v_accvgpr_read_b32 v149, a89
v_accvgpr_read_b32 v150, a90
v_accvgpr_read_b32 v151, a91
v_accvgpr_read_b32 v152, a92
v_accvgpr_read_b32 v153, a93
v_accvgpr_read_b32 v154, a94
v_accvgpr_read_b32 v155, a95
v_cvt_pk_bf16_f32 v108, v148, v149
v_cvt_pk_bf16_f32 v109, v150, v151
v_cvt_pk_bf16_f32 v110, v152, v153
v_cvt_pk_bf16_f32 v111, v154, v155
s_add_u32 s36, s39, 49152
buffer_store_dwordx4 v[108:111], v142, s[28:31], s36 offen offset:3072 sc1
v_accvgpr_read_b32 v148, a56
v_accvgpr_read_b32 v149, a57
v_accvgpr_read_b32 v150, a58
v_accvgpr_read_b32 v151, a59
v_accvgpr_read_b32 v152, a60
v_accvgpr_read_b32 v153, a61
v_accvgpr_read_b32 v154, a62
v_accvgpr_read_b32 v155, a63
v_cvt_pk_bf16_f32 v92, v148, v149
v_cvt_pk_bf16_f32 v93, v150, v151
v_cvt_pk_bf16_f32 v94, v152, v153
v_cvt_pk_bf16_f32 v95, v154, v155
s_add_u32 s36, s19, 32768
buffer_store_dwordx4 v[92:95], v142, s[28:31], s36 offen offset:3072 sc1
v_accvgpr_read_b32 v148, a24
v_accvgpr_read_b32 v149, a25
v_accvgpr_read_b32 v150, a26
v_accvgpr_read_b32 v151, a27
v_accvgpr_read_b32 v152, a28
v_accvgpr_read_b32 v153, a29
v_accvgpr_read_b32 v154, a30
v_accvgpr_read_b32 v155, a31
v_cvt_pk_bf16_f32 v76, v148, v149
v_cvt_pk_bf16_f32 v77, v150, v151
v_cvt_pk_bf16_f32 v78, v152, v153
v_cvt_pk_bf16_f32 v79, v154, v155
s_add_u32 s36, s39, 32768
buffer_store_dwordx4 v[76:79], v142, s[28:31], s36 offen offset:3072 sc1
s_branch b12_10
vpath_7:
s_waitcnt vmcnt(16)
s_barrier
ds_read_b128 a[128:131], v128 offset:0
ds_read_b128 a[132:135], v129 offset:0
ds_read_b128 a[136:139], v128 offset:2048
ds_read_b128 a[140:143], v129 offset:2048
ds_read_b128 a[144:147], v128 offset:4096
ds_read_b128 a[148:151], v129 offset:4096
ds_read_b128 a[152:155], v128 offset:6144
ds_read_b128 a[156:159], v129 offset:6144
ds_read_b64_tr_b16 a[192:193], v130 offset:0
ds_read_b64_tr_b16 a[194:195], v130 offset:2048
ds_read_b64_tr_b16 a[196:197], v130 offset:16384
ds_read_b64_tr_b16 a[198:199], v130 offset:18432
ds_read_b64_tr_b16 a[200:201], v131 offset:0
ds_read_b64_tr_b16 a[202:203], v131 offset:2048
ds_read_b64_tr_b16 a[204:205], v131 offset:16384
ds_read_b64_tr_b16 a[206:207], v131 offset:18432
ds_read_b64_tr_b16 a[208:209], v132 offset:0
ds_read_b64_tr_b16 a[210:211], v132 offset:2048
ds_read_b64_tr_b16 a[212:213], v132 offset:16384
ds_read_b64_tr_b16 a[214:215], v132 offset:18432
ds_read_b64_tr_b16 a[216:217], v133 offset:0
ds_read_b64_tr_b16 a[218:219], v133 offset:2048
ds_read_b64_tr_b16 a[220:221], v133 offset:16384
ds_read_b64_tr_b16 a[222:223], v133 offset:18432
s_waitcnt lgkmcnt(0)
mf v[0:3],a[128:131],a[192:195],0
ds_read_b64_tr_b16 a[224:225], v134 offset:0
mf v[0:3],a[132:135],a[196:199],v[0:3]
buffer_load_dword v253, v252, s[60:63], s64 offen
mf v[32:35],a[140:143],a[196:199],0
ds_read_b64_tr_b16 a[226:227], v134 offset:2048
mf v[32:35],a[136:139],a[192:195],v[32:35]
mf v[64:67],a[144:147],a[192:195],0
ds_read_b64_tr_b16 a[228:229], v134 offset:16384
mf v[64:67],a[148:151],a[196:199],v[64:67]
mf v[96:99],a[156:159],a[196:199],0
ds_read_b64_tr_b16 a[230:231], v134 offset:18432
mf v[96:99],a[152:155],a[192:195],v[96:99]
mf v[100:103],a[152:155],a[200:203],0
ds_read_b64_tr_b16 a[232:233], v135 offset:0
mf v[100:103],a[156:159],a[204:207],v[100:103]
mf v[68:71],a[148:151],a[204:207],0
ds_read_b64_tr_b16 a[234:235], v135 offset:2048
mf v[68:71],a[144:147],a[200:203],v[68:71]
mf v[36:39],a[136:139],a[200:203],0
ds_read_b64_tr_b16 a[236:237], v135 offset:16384
mf v[36:39],a[140:143],a[204:207],v[36:39]
mf v[4:7],a[132:135],a[204:207],0
ds_read_b64_tr_b16 a[238:239], v135 offset:18432
mf v[4:7],a[128:131],a[200:203],v[4:7]
s_add_u32 s64, s64, s65
mf v[8:11],a[128:131],a[208:211],0
ds_read_b64_tr_b16 a[240:241], v136 offset:0
mf v[8:11],a[132:135],a[212:215],v[8:11]
mf v[40:43],a[140:143],a[212:215],0
ds_read_b64_tr_b16 a[242:243], v136 offset:2048
mf v[40:43],a[136:139],a[208:211],v[40:43]
mf v[72:75],a[144:147],a[208:211],0
ds_read_b64_tr_b16 a[244:245], v136 offset:16384
mf v[72:75],a[148:151],a[212:215],v[72:75]
mf v[104:107],a[156:159],a[212:215],0
ds_read_b64_tr_b16 a[246:247], v136 offset:18432
mf v[104:107],a[152:155],a[208:211],v[104:107]
mf v[108:111],a[152:155],a[216:219],0
ds_read_b64_tr_b16 a[248:249], v137 offset:0
mf v[108:111],a[156:159],a[220:223],v[108:111]
mf v[76:79],a[148:151],a[220:223],0
ds_read_b64_tr_b16 a[250:251], v137 offset:2048
mf v[76:79],a[144:147],a[216:219],v[76:79]
mf v[44:47],a[136:139],a[216:219],0
ds_read_b64_tr_b16 a[252:253], v137 offset:16384
mf v[44:47],a[140:143],a[220:223],v[44:47]
mf v[12:15],a[132:135],a[220:223],0
ds_read_b64_tr_b16 a[254:255], v137 offset:18432
s_add_u32 s32, s32, 128
mf v[12:15],a[128:131],a[216:219],v[12:15]
s_waitcnt lgkmcnt(8)
mf v[16:19],a[128:131],a[224:227],0
mf v[16:19],a[132:135],a[228:231],v[16:19]
ds_read_b128 a[160:163], v128 offset:8192
mf v[48:51],a[140:143],a[228:231],0
mf v[48:51],a[136:139],a[224:227],v[48:51]
mf v[80:83],a[144:147],a[224:227],0
ds_read_b128 a[164:167], v129 offset:8192
mf v[80:83],a[148:151],a[228:231],v[80:83]
mf v[112:115],a[156:159],a[228:231],0
mf v[112:115],a[152:155],a[224:227],v[112:115]
ds_read_b128 a[168:171], v128 offset:10240
mf v[116:119],a[152:155],a[232:235],0
mf v[116:119],a[156:159],a[236:239],v[116:119]
mf v[84:87],a[148:151],a[236:239],0
ds_read_b128 a[172:175], v129 offset:10240
mf v[84:87],a[144:147],a[232:235],v[84:87]
mf v[52:55],a[136:139],a[232:235],0
mf v[52:55],a[140:143],a[236:239],v[52:55]
ds_read_b128 a[176:179], v128 offset:12288
s_add_u32 s33, s33, 524288
mf v[20:23],a[132:135],a[236:239],0
mf v[20:23],a[128:131],a[232:235],v[20:23]
s_waitcnt lgkmcnt(5)
mf v[24:27],a[128:131],a[240:243],0
ds_read_b128 a[180:183], v129 offset:12288
mf v[24:27],a[132:135],a[244:247],v[24:27]
mf v[56:59],a[140:143],a[244:247],0
mf v[56:59],a[136:139],a[240:243],v[56:59]
ds_read_b128 a[184:187], v128 offset:14336
mf v[88:91],a[144:147],a[240:243],0
mf v[88:91],a[148:151],a[244:247],v[88:91]
mf v[120:123],a[156:159],a[244:247],0
ds_read_b128 a[188:191], v129 offset:14336
mf v[120:123],a[152:155],a[240:243],v[120:123]
mf v[124:127],a[152:155],a[248:251],0
mf v[124:127],a[156:159],a[252:255],v[124:127]
mf v[92:95],a[148:151],a[252:255],0
mf v[92:95],a[144:147],a[248:251],v[92:95]
mf v[60:63],a[136:139],a[248:251],0
mf v[60:63],a[140:143],a[252:255],v[60:63]
mf v[28:31],a[132:135],a[252:255],0
mf v[28:31],a[128:131],a[248:251],v[28:31]
s_waitcnt lgkmcnt(0) vmcnt(1)
s_barrier
s_lshl_b32 s17, s16, 8
s_add_u32 s17, s17, s2
s_cmp_ge_u32 s17, 8
s_cbranch_scc1 noinit_17
s_mov_b32 s56, s68
s_and_b32 s57, s69, 0xffff
s_mov_b32 s58, 256
s_mov_b32 s59, 0x20000
s_lshl_b32 s17, s2, 2
v_mov_b32 v143, 1
v_mov_b32 v144, 0
s_mov_b64 exec, 1
buffer_store_dword v143, v144, s[56:59], s17 offen sc1
s_mov_b64 exec, -1
noinit_17:
mf a[0:3],a[160:163],a[192:195],0
ds_read_b128 a[128:131], v128 offset:32768
ds_read_b128 a[132:135], v129 offset:32768
mf a[0:3],a[164:167],a[196:199],a[0:3]
s_add_u32 m0, s34, 0
mf a[32:35],a[172:175],a[196:199],0
s_add_u32 s36, s32, 0
mf a[32:35],a[168:171],a[192:195],a[32:35]
buffer_load_dwordx4 v138, s[20:23], s36 offen lds
mf a[64:67],a[176:179],a[192:195],0
ds_read_b128 a[136:139], v128 offset:34816
ds_read_b128 a[140:143], v129 offset:34816
mf a[64:67],a[180:183],a[196:199],a[64:67]
s_add_u32 m0, s35, 0
mf a[96:99],a[188:191],a[196:199],0
s_add_u32 s37, s33, 0
mf a[96:99],a[184:187],a[192:195],a[96:99]
buffer_load_dwordx4 v139, s[24:27], s37 offen lds
mf a[100:103],a[184:187],a[200:203],0
ds_read_b128 a[144:147], v128 offset:36864
ds_read_b128 a[148:151], v129 offset:36864
mf a[100:103],a[188:191],a[204:207],a[100:103]
s_add_u32 m0, s34, 4096
mf a[68:71],a[180:183],a[204:207],0
s_add_u32 s36, s32, 65536
mf a[68:71],a[176:179],a[200:203],a[68:71]
buffer_load_dwordx4 v138, s[20:23], s36 offen lds
mf a[36:39],a[168:171],a[200:203],0
ds_read_b64_tr_b16 a[192:193], v130 offset:32768
ds_read_b64_tr_b16 a[194:195], v130 offset:34816
mf a[36:39],a[172:175],a[204:207],a[36:39]
s_add_u32 m0, s35, 2048
mf a[4:7],a[164:167],a[204:207],0
s_add_u32 s37, s33, 32768
mf a[4:7],a[160:163],a[200:203],a[4:7]
buffer_load_dwordx4 v139, s[24:27], s37 offen lds
mf a[8:11],a[160:163],a[208:211],0
ds_read_b64_tr_b16 a[196:197], v130 offset:49152
ds_read_b64_tr_b16 a[198:199], v130 offset:51200
mf a[8:11],a[164:167],a[212:215],a[8:11]
s_add_u32 m0, s34, 8192
mf a[40:43],a[172:175],a[212:215],0
s_add_u32 s36, s32, 131072
mf a[40:43],a[168:171],a[208:211],a[40:43]
buffer_load_dwordx4 v138, s[20:23], s36 offen lds
mf a[72:75],a[176:179],a[208:211],0
ds_read_b128 a[152:155], v128 offset:38912
ds_read_b128 a[156:159], v129 offset:38912
mf a[72:75],a[180:183],a[212:215],a[72:75]
s_add_u32 m0, s35, 8192
mf a[104:107],a[188:191],a[212:215],0
s_add_u32 s37, s33, 131072
mf a[104:107],a[184:187],a[208:211],a[104:107]
buffer_load_dwordx4 v139, s[24:27], s37 offen lds
mf a[108:111],a[184:187],a[216:219],0
ds_read_b64_tr_b16 a[200:201], v131 offset:32768
ds_read_b64_tr_b16 a[202:203], v131 offset:34816
mf a[108:111],a[188:191],a[220:223],a[108:111]
s_add_u32 m0, s34, 12288
mf a[76:79],a[180:183],a[220:223],0
s_add_u32 s36, s32, 196608
mf a[76:79],a[176:179],a[216:219],a[76:79]
buffer_load_dwordx4 v138, s[20:23], s36 offen lds
mf a[44:47],a[168:171],a[216:219],0
ds_read_b64_tr_b16 a[204:205], v131 offset:49152
ds_read_b64_tr_b16 a[206:207], v131 offset:51200
mf a[44:47],a[172:175],a[220:223],a[44:47]
s_add_u32 m0, s35, 10240
mf a[12:15],a[164:167],a[220:223],0
s_add_u32 s37, s33, 163840
mf a[12:15],a[160:163],a[216:219],a[12:15]
buffer_load_dwordx4 v139, s[24:27], s37 offen lds
mf a[16:19],a[160:163],a[224:227],0
mf a[16:19],a[164:167],a[228:231],a[16:19]
s_add_u32 m0, s34, 16384
mf a[48:51],a[172:175],a[228:231],0
s_add_u32 s36, s32, 262144
mf a[48:51],a[168:171],a[224:227],a[48:51]
buffer_load_dwordx4 v138, s[20:23], s36 offen lds
mf a[80:83],a[176:179],a[224:227],0
ds_read_b64_tr_b16 a[208:209], v132 offset:32768
ds_read_b64_tr_b16 a[210:211], v132 offset:34816
mf a[80:83],a[180:183],a[228:231],a[80:83]
s_add_u32 m0, s35, 16384
mf a[112:115],a[188:191],a[228:231],0
s_add_u32 s37, s33, 262144
mf a[112:115],a[184:187],a[224:227],a[112:115]
buffer_load_dwordx4 v139, s[24:27], s37 offen lds
mf a[116:119],a[184:187],a[232:235],0
ds_read_b64_tr_b16 a[212:213], v132 offset:49152
ds_read_b64_tr_b16 a[214:215], v132 offset:51200
mf a[116:119],a[188:191],a[236:239],a[116:119]
s_add_u32 m0, s34, 20480
mf a[84:87],a[180:183],a[236:239],0
s_add_u32 s36, s32, 327680
mf a[84:87],a[176:179],a[232:235],a[84:87]
buffer_load_dwordx4 v138, s[20:23], s36 offen lds
mf a[52:55],a[168:171],a[232:235],0
mf a[52:55],a[172:175],a[236:239],a[52:55]
s_add_u32 m0, s35, 18432
mf a[20:23],a[164:167],a[236:239],0
s_add_u32 s37, s33, 294912
mf a[20:23],a[160:163],a[232:235],a[20:23]
buffer_load_dwordx4 v139, s[24:27], s37 offen lds
mf a[24:27],a[160:163],a[240:243],0
ds_read_b64_tr_b16 a[216:217], v133 offset:32768
ds_read_b64_tr_b16 a[218:219], v133 offset:34816
mf a[24:27],a[164:167],a[244:247],a[24:27]
s_add_u32 m0, s34, 24576
mf a[56:59],a[172:175],a[244:247],0
s_add_u32 s36, s32, 393216
mf a[56:59],a[168:171],a[240:243],a[56:59]
buffer_load_dwordx4 v138, s[20:23], s36 offen lds
mf a[88:91],a[176:179],a[240:243],0
ds_read_b64_tr_b16 a[220:221], v133 offset:49152
ds_read_b64_tr_b16 a[222:223], v133 offset:51200
mf a[88:91],a[180:183],a[244:247],a[88:91]
s_add_u32 m0, s35, 24576
mf a[120:123],a[188:191],a[244:247],0
s_add_u32 s37, s33, 393216
mf a[120:123],a[184:187],a[240:243],a[120:123]
buffer_load_dwordx4 v139, s[24:27], s37 offen lds
mf a[124:127],a[184:187],a[248:251],0
mf a[124:127],a[188:191],a[252:255],a[124:127]
s_add_u32 m0, s34, 28672
mf a[92:95],a[180:183],a[252:255],0
s_add_u32 s36, s32, 458752
mf a[92:95],a[176:179],a[248:251],a[92:95]
buffer_load_dwordx4 v138, s[20:23], s36 offen lds
mf a[60:63],a[168:171],a[248:251],0
mf a[60:63],a[172:175],a[252:255],a[60:63]
s_add_u32 m0, s35, 26624
mf a[28:31],a[164:167],a[252:255],0
s_add_u32 s37, s33, 425984
mf a[28:31],a[160:163],a[248:251],a[28:31]
buffer_load_dwordx4 v139, s[24:27], s37 offen lds
s_add_u32 s32, s32, 128
s_add_u32 s33, s33, 524288
s_mov_b32 s38, 6
gl_18:
s_waitcnt lgkmcnt(0)
mf v[0:3],a[128:131],a[192:195],v[0:3]
ds_read_b64_tr_b16 a[224:225], v134 offset:32768
mf v[0:3],a[132:135],a[196:199],v[0:3]
buffer_load_dword v253, v252, s[60:63], s64 offen
mf v[32:35],a[140:143],a[196:199],v[32:35]
ds_read_b64_tr_b16 a[226:227], v134 offset:34816
mf v[32:35],a[136:139],a[192:195],v[32:35]
mf v[64:67],a[144:147],a[192:195],v[64:67]
ds_read_b64_tr_b16 a[228:229], v134 offset:49152
mf v[64:67],a[148:151],a[196:199],v[64:67]
mf v[96:99],a[156:159],a[196:199],v[96:99]
ds_read_b64_tr_b16 a[230:231], v134 offset:51200
mf v[96:99],a[152:155],a[192:195],v[96:99]
mf v[100:103],a[152:155],a[200:203],v[100:103]
ds_read_b64_tr_b16 a[232:233], v135 offset:32768
mf v[100:103],a[156:159],a[204:207],v[100:103]
mf v[68:71],a[148:151],a[204:207],v[68:71]
ds_read_b64_tr_b16 a[234:235], v135 offset:34816
mf v[68:71],a[144:147],a[200:203],v[68:71]
mf v[36:39],a[136:139],a[200:203],v[36:39]
ds_read_b64_tr_b16 a[236:237], v135 offset:49152
mf v[36:39],a[140:143],a[204:207],v[36:39]
mf v[4:7],a[132:135],a[204:207],v[4:7]
ds_read_b64_tr_b16 a[238:239], v135 offset:51200
mf v[4:7],a[128:131],a[200:203],v[4:7]
mf v[8:11],a[128:131],a[208:211],v[8:11]
ds_read_b64_tr_b16 a[240:241], v136 offset:32768
mf v[8:11],a[132:135],a[212:215],v[8:11]
mf v[40:43],a[140:143],a[212:215],v[40:43]
ds_read_b64_tr_b16 a[242:243], v136 offset:34816
mf v[40:43],a[136:139],a[208:211],v[40:43]
mf v[72:75],a[144:147],a[208:211],v[72:75]
ds_read_b64_tr_b16 a[244:245], v136 offset:49152
mf v[72:75],a[148:151],a[212:215],v[72:75]
mf v[104:107],a[156:159],a[212:215],v[104:107]
ds_read_b64_tr_b16 a[246:247], v136 offset:51200
mf v[104:107],a[152:155],a[208:211],v[104:107]
mf v[108:111],a[152:155],a[216:219],v[108:111]
ds_read_b64_tr_b16 a[248:249], v137 offset:32768
mf v[108:111],a[156:159],a[220:223],v[108:111]
mf v[76:79],a[148:151],a[220:223],v[76:79]
ds_read_b64_tr_b16 a[250:251], v137 offset:34816
mf v[76:79],a[144:147],a[216:219],v[76:79]
mf v[44:47],a[136:139],a[216:219],v[44:47]
ds_read_b64_tr_b16 a[252:253], v137 offset:49152
mf v[44:47],a[140:143],a[220:223],v[44:47]
mf v[12:15],a[132:135],a[220:223],v[12:15]
ds_read_b64_tr_b16 a[254:255], v137 offset:51200
s_add_u32 s64, s64, s65
mf v[12:15],a[128:131],a[216:219],v[12:15]
s_waitcnt lgkmcnt(8)
mf v[16:19],a[128:131],a[224:227],v[16:19]
mf v[16:19],a[132:135],a[228:231],v[16:19]
ds_read_b128 a[160:163], v128 offset:40960
mf v[48:51],a[140:143],a[228:231],v[48:51]
mf v[48:51],a[136:139],a[224:227],v[48:51]
mf v[80:83],a[144:147],a[224:227],v[80:83]
ds_read_b128 a[164:167], v129 offset:40960
mf v[80:83],a[148:151],a[228:231],v[80:83]
mf v[112:115],a[156:159],a[228:231],v[112:115]
mf v[112:115],a[152:155],a[224:227],v[112:115]
ds_read_b128 a[168:171], v128 offset:43008
mf v[116:119],a[152:155],a[232:235],v[116:119]
mf v[116:119],a[156:159],a[236:239],v[116:119]
mf v[84:87],a[148:151],a[236:239],v[84:87]
ds_read_b128 a[172:175], v129 offset:43008
mf v[84:87],a[144:147],a[232:235],v[84:87]
mf v[52:55],a[136:139],a[232:235],v[52:55]
mf v[52:55],a[140:143],a[236:239],v[52:55]
ds_read_b128 a[176:179], v128 offset:45056
mf v[20:23],a[132:135],a[236:239],v[20:23]
mf v[20:23],a[128:131],a[232:235],v[20:23]
s_waitcnt lgkmcnt(5)
mf v[24:27],a[128:131],a[240:243],v[24:27]
ds_read_b128 a[180:183], v129 offset:45056
mf v[24:27],a[132:135],a[244:247],v[24:27]
mf v[56:59],a[140:143],a[244:247],v[56:59]
mf v[56:59],a[136:139],a[240:243],v[56:59]
ds_read_b128 a[184:187], v128 offset:47104
mf v[88:91],a[144:147],a[240:243],v[88:91]
mf v[88:91],a[148:151],a[244:247],v[88:91]
mf v[120:123],a[156:159],a[244:247],v[120:123]
ds_read_b128 a[188:191], v129 offset:47104
mf v[120:123],a[152:155],a[240:243],v[120:123]
mf v[124:127],a[152:155],a[248:251],v[124:127]
mf v[124:127],a[156:159],a[252:255],v[124:127]
mf v[92:95],a[148:151],a[252:255],v[92:95]
mf v[92:95],a[144:147],a[248:251],v[92:95]
mf v[60:63],a[136:139],a[248:251],v[60:63]
mf v[60:63],a[140:143],a[252:255],v[60:63]
mf v[28:31],a[132:135],a[252:255],v[28:31]
mf v[28:31],a[128:131],a[248:251],v[28:31]
s_waitcnt lgkmcnt(0) vmcnt(1)
s_barrier
mf a[0:3],a[160:163],a[192:195],a[0:3]
ds_read_b128 a[128:131], v128 offset:0
ds_read_b128 a[132:135], v129 offset:0
mf a[0:3],a[164:167],a[196:199],a[0:3]
s_add_u32 m0, s34, 32768
mf a[32:35],a[172:175],a[196:199],a[32:35]
s_add_u32 s36, s32, 0
mf a[32:35],a[168:171],a[192:195],a[32:35]
buffer_load_dwordx4 v138, s[20:23], s36 offen lds
mf a[64:67],a[176:179],a[192:195],a[64:67]
ds_read_b128 a[136:139], v128 offset:2048
ds_read_b128 a[140:143], v129 offset:2048
mf a[64:67],a[180:183],a[196:199],a[64:67]
s_add_u32 m0, s35, 32768
mf a[96:99],a[188:191],a[196:199],a[96:99]
s_add_u32 s37, s33, 0
mf a[96:99],a[184:187],a[192:195],a[96:99]
buffer_load_dwordx4 v139, s[24:27], s37 offen lds
mf a[100:103],a[184:187],a[200:203],a[100:103]
ds_read_b128 a[144:147], v128 offset:4096
ds_read_b128 a[148:151], v129 offset:4096
mf a[100:103],a[188:191],a[204:207],a[100:103]
s_add_u32 m0, s34, 36864
mf a[68:71],a[180:183],a[204:207],a[68:71]
s_add_u32 s36, s32, 65536
mf a[68:71],a[176:179],a[200:203],a[68:71]
buffer_load_dwordx4 v138, s[20:23], s36 offen lds
mf a[36:39],a[168:171],a[200:203],a[36:39]
ds_read_b64_tr_b16 a[192:193], v130 offset:0
ds_read_b64_tr_b16 a[194:195], v130 offset:2048
mf a[36:39],a[172:175],a[204:207],a[36:39]
s_add_u32 m0, s35, 34816
mf a[4:7],a[164:167],a[204:207],a[4:7]
s_add_u32 s37, s33, 32768
mf a[4:7],a[160:163],a[200:203],a[4:7]
buffer_load_dwordx4 v139, s[24:27], s37 offen lds
mf a[8:11],a[160:163],a[208:211],a[8:11]
ds_read_b64_tr_b16 a[196:197], v130 offset:16384
ds_read_b64_tr_b16 a[198:199], v130 offset:18432
mf a[8:11],a[164:167],a[212:215],a[8:11]
s_add_u32 m0, s34, 40960
mf a[40:43],a[172:175],a[212:215],a[40:43]
s_add_u32 s36, s32, 131072
mf a[40:43],a[168:171],a[208:211],a[40:43]
buffer_load_dwordx4 v138, s[20:23], s36 offen lds
mf a[72:75],a[176:179],a[208:211],a[72:75]
ds_read_b128 a[152:155], v128 offset:6144
ds_read_b128 a[156:159], v129 offset:6144
mf a[72:75],a[180:183],a[212:215],a[72:75]
s_add_u32 m0, s35, 40960
mf a[104:107],a[188:191],a[212:215],a[104:107]
s_add_u32 s37, s33, 131072
mf a[104:107],a[184:187],a[208:211],a[104:107]
buffer_load_dwordx4 v139, s[24:27], s37 offen lds
mf a[108:111],a[184:187],a[216:219],a[108:111]
ds_read_b64_tr_b16 a[200:201], v131 offset:0
ds_read_b64_tr_b16 a[202:203], v131 offset:2048
mf a[108:111],a[188:191],a[220:223],a[108:111]
s_add_u32 m0, s34, 45056
mf a[76:79],a[180:183],a[220:223],a[76:79]
s_add_u32 s36, s32, 196608
mf a[76:79],a[176:179],a[216:219],a[76:79]
buffer_load_dwordx4 v138, s[20:23], s36 offen lds
mf a[44:47],a[168:171],a[216:219],a[44:47]
ds_read_b64_tr_b16 a[204:205], v131 offset:16384
ds_read_b64_tr_b16 a[206:207], v131 offset:18432
mf a[44:47],a[172:175],a[220:223],a[44:47]
s_add_u32 m0, s35, 43008
mf a[12:15],a[164:167],a[220:223],a[12:15]
s_add_u32 s37, s33, 163840
mf a[12:15],a[160:163],a[216:219],a[12:15]
buffer_load_dwordx4 v139, s[24:27], s37 offen lds
mf a[16:19],a[160:163],a[224:227],a[16:19]
mf a[16:19],a[164:167],a[228:231],a[16:19]
s_add_u32 m0, s34, 49152
mf a[48:51],a[172:175],a[228:231],a[48:51]
s_add_u32 s36, s32, 262144
mf a[48:51],a[168:171],a[224:227],a[48:51]
buffer_load_dwordx4 v138, s[20:23], s36 offen lds
mf a[80:83],a[176:179],a[224:227],a[80:83]
ds_read_b64_tr_b16 a[208:209], v132 offset:0
ds_read_b64_tr_b16 a[210:211], v132 offset:2048
mf a[80:83],a[180:183],a[228:231],a[80:83]
s_add_u32 m0, s35, 49152
mf a[112:115],a[188:191],a[228:231],a[112:115]
s_add_u32 s37, s33, 262144
mf a[112:115],a[184:187],a[224:227],a[112:115]
buffer_load_dwordx4 v139, s[24:27], s37 offen lds
mf a[116:119],a[184:187],a[232:235],a[116:119]
ds_read_b64_tr_b16 a[212:213], v132 offset:16384
ds_read_b64_tr_b16 a[214:215], v132 offset:18432
mf a[116:119],a[188:191],a[236:239],a[116:119]
s_add_u32 m0, s34, 53248
mf a[84:87],a[180:183],a[236:239],a[84:87]
s_add_u32 s36, s32, 327680
mf a[84:87],a[176:179],a[232:235],a[84:87]
buffer_load_dwordx4 v138, s[20:23], s36 offen lds
mf a[52:55],a[168:171],a[232:235],a[52:55]
mf a[52:55],a[172:175],a[236:239],a[52:55]
s_add_u32 m0, s35, 51200
mf a[20:23],a[164:167],a[236:239],a[20:23]
s_add_u32 s37, s33, 294912
mf a[20:23],a[160:163],a[232:235],a[20:23]
buffer_load_dwordx4 v139, s[24:27], s37 offen lds
mf a[24:27],a[160:163],a[240:243],a[24:27]
ds_read_b64_tr_b16 a[216:217], v133 offset:0
ds_read_b64_tr_b16 a[218:219], v133 offset:2048
mf a[24:27],a[164:167],a[244:247],a[24:27]
s_add_u32 m0, s34, 57344
mf a[56:59],a[172:175],a[244:247],a[56:59]
s_add_u32 s36, s32, 393216
mf a[56:59],a[168:171],a[240:243],a[56:59]
buffer_load_dwordx4 v138, s[20:23], s36 offen lds
mf a[88:91],a[176:179],a[240:243],a[88:91]
ds_read_b64_tr_b16 a[220:221], v133 offset:16384
ds_read_b64_tr_b16 a[222:223], v133 offset:18432
mf a[88:91],a[180:183],a[244:247],a[88:91]
s_add_u32 m0, s35, 57344
mf a[120:123],a[188:191],a[244:247],a[120:123]
s_add_u32 s37, s33, 393216
mf a[120:123],a[184:187],a[240:243],a[120:123]
buffer_load_dwordx4 v139, s[24:27], s37 offen lds
mf a[124:127],a[184:187],a[248:251],a[124:127]
mf a[124:127],a[188:191],a[252:255],a[124:127]
s_add_u32 m0, s34, 61440
mf a[92:95],a[180:183],a[252:255],a[92:95]
s_add_u32 s36, s32, 458752
mf a[92:95],a[176:179],a[248:251],a[92:95]
buffer_load_dwordx4 v138, s[20:23], s36 offen lds
mf a[60:63],a[168:171],a[248:251],a[60:63]
mf a[60:63],a[172:175],a[252:255],a[60:63]
s_add_u32 m0, s35, 59392
mf a[28:31],a[164:167],a[252:255],a[28:31]
s_add_u32 s37, s33, 425984
mf a[28:31],a[160:163],a[248:251],a[28:31]
buffer_load_dwordx4 v139, s[24:27], s37 offen lds
s_add_u32 s32, s32, 128
s_add_u32 s33, s33, 524288
s_waitcnt lgkmcnt(0)
mf v[0:3],a[128:131],a[192:195],v[0:3]
ds_read_b64_tr_b16 a[224:225], v134 offset:0
mf v[0:3],a[132:135],a[196:199],v[0:3]
buffer_load_dword v253, v252, s[60:63], s64 offen
mf v[32:35],a[140:143],a[196:199],v[32:35]
ds_read_b64_tr_b16 a[226:227], v134 offset:2048
mf v[32:35],a[136:139],a[192:195],v[32:35]
mf v[64:67],a[144:147],a[192:195],v[64:67]
ds_read_b64_tr_b16 a[228:229], v134 offset:16384
mf v[64:67],a[148:151],a[196:199],v[64:67]
mf v[96:99],a[156:159],a[196:199],v[96:99]
ds_read_b64_tr_b16 a[230:231], v134 offset:18432
mf v[96:99],a[152:155],a[192:195],v[96:99]
mf v[100:103],a[152:155],a[200:203],v[100:103]
ds_read_b64_tr_b16 a[232:233], v135 offset:0
mf v[100:103],a[156:159],a[204:207],v[100:103]
mf v[68:71],a[148:151],a[204:207],v[68:71]
ds_read_b64_tr_b16 a[234:235], v135 offset:2048
mf v[68:71],a[144:147],a[200:203],v[68:71]
mf v[36:39],a[136:139],a[200:203],v[36:39]
ds_read_b64_tr_b16 a[236:237], v135 offset:16384
mf v[36:39],a[140:143],a[204:207],v[36:39]
mf v[4:7],a[132:135],a[204:207],v[4:7]
ds_read_b64_tr_b16 a[238:239], v135 offset:18432
mf v[4:7],a[128:131],a[200:203],v[4:7]
mf v[8:11],a[128:131],a[208:211],v[8:11]
ds_read_b64_tr_b16 a[240:241], v136 offset:0
mf v[8:11],a[132:135],a[212:215],v[8:11]
mf v[40:43],a[140:143],a[212:215],v[40:43]
ds_read_b64_tr_b16 a[242:243], v136 offset:2048
mf v[40:43],a[136:139],a[208:211],v[40:43]
mf v[72:75],a[144:147],a[208:211],v[72:75]
ds_read_b64_tr_b16 a[244:245], v136 offset:16384
mf v[72:75],a[148:151],a[212:215],v[72:75]
mf v[104:107],a[156:159],a[212:215],v[104:107]
ds_read_b64_tr_b16 a[246:247], v136 offset:18432
mf v[104:107],a[152:155],a[208:211],v[104:107]
mf v[108:111],a[152:155],a[216:219],v[108:111]
ds_read_b64_tr_b16 a[248:249], v137 offset:0
mf v[108:111],a[156:159],a[220:223],v[108:111]
mf v[76:79],a[148:151],a[220:223],v[76:79]
ds_read_b64_tr_b16 a[250:251], v137 offset:2048
mf v[76:79],a[144:147],a[216:219],v[76:79]
mf v[44:47],a[136:139],a[216:219],v[44:47]
ds_read_b64_tr_b16 a[252:253], v137 offset:16384
mf v[44:47],a[140:143],a[220:223],v[44:47]
mf v[12:15],a[132:135],a[220:223],v[12:15]
ds_read_b64_tr_b16 a[254:255], v137 offset:18432
s_add_u32 s64, s64, s65
mf v[12:15],a[128:131],a[216:219],v[12:15]
s_waitcnt lgkmcnt(8)
mf v[16:19],a[128:131],a[224:227],v[16:19]
mf v[16:19],a[132:135],a[228:231],v[16:19]
ds_read_b128 a[160:163], v128 offset:8192
mf v[48:51],a[140:143],a[228:231],v[48:51]
mf v[48:51],a[136:139],a[224:227],v[48:51]
mf v[80:83],a[144:147],a[224:227],v[80:83]
ds_read_b128 a[164:167], v129 offset:8192
mf v[80:83],a[148:151],a[228:231],v[80:83]
mf v[112:115],a[156:159],a[228:231],v[112:115]
mf v[112:115],a[152:155],a[224:227],v[112:115]
ds_read_b128 a[168:171], v128 offset:10240
mf v[116:119],a[152:155],a[232:235],v[116:119]
mf v[116:119],a[156:159],a[236:239],v[116:119]
mf v[84:87],a[148:151],a[236:239],v[84:87]
ds_read_b128 a[172:175], v129 offset:10240
mf v[84:87],a[144:147],a[232:235],v[84:87]
mf v[52:55],a[136:139],a[232:235],v[52:55]
mf v[52:55],a[140:143],a[236:239],v[52:55]
ds_read_b128 a[176:179], v128 offset:12288
mf v[20:23],a[132:135],a[236:239],v[20:23]
mf v[20:23],a[128:131],a[232:235],v[20:23]
s_waitcnt lgkmcnt(5)
mf v[24:27],a[128:131],a[240:243],v[24:27]
ds_read_b128 a[180:183], v129 offset:12288
mf v[24:27],a[132:135],a[244:247],v[24:27]
mf v[56:59],a[140:143],a[244:247],v[56:59]
mf v[56:59],a[136:139],a[240:243],v[56:59]
ds_read_b128 a[184:187], v128 offset:14336
mf v[88:91],a[144:147],a[240:243],v[88:91]
mf v[88:91],a[148:151],a[244:247],v[88:91]
mf v[120:123],a[156:159],a[244:247],v[120:123]
ds_read_b128 a[188:191], v129 offset:14336
mf v[120:123],a[152:155],a[240:243],v[120:123]
mf v[124:127],a[152:155],a[248:251],v[124:127]
mf v[124:127],a[156:159],a[252:255],v[124:127]
mf v[92:95],a[148:151],a[252:255],v[92:95]
mf v[92:95],a[144:147],a[248:251],v[92:95]
mf v[60:63],a[136:139],a[248:251],v[60:63]
mf v[60:63],a[140:143],a[252:255],v[60:63]
mf v[28:31],a[132:135],a[252:255],v[28:31]
mf v[28:31],a[128:131],a[248:251],v[28:31]
s_waitcnt lgkmcnt(0) vmcnt(1)
s_barrier
mf a[0:3],a[160:163],a[192:195],a[0:3]
ds_read_b128 a[128:131], v128 offset:32768
ds_read_b128 a[132:135], v129 offset:32768
mf a[0:3],a[164:167],a[196:199],a[0:3]
s_add_u32 m0, s34, 0
mf a[32:35],a[172:175],a[196:199],a[32:35]
s_add_u32 s36, s32, 0
mf a[32:35],a[168:171],a[192:195],a[32:35]
buffer_load_dwordx4 v138, s[20:23], s36 offen lds
mf a[64:67],a[176:179],a[192:195],a[64:67]
ds_read_b128 a[136:139], v128 offset:34816
ds_read_b128 a[140:143], v129 offset:34816
mf a[64:67],a[180:183],a[196:199],a[64:67]
s_add_u32 m0, s35, 0
mf a[96:99],a[188:191],a[196:199],a[96:99]
s_add_u32 s37, s33, 0
mf a[96:99],a[184:187],a[192:195],a[96:99]
buffer_load_dwordx4 v139, s[24:27], s37 offen lds
mf a[100:103],a[184:187],a[200:203],a[100:103]
ds_read_b128 a[144:147], v128 offset:36864
ds_read_b128 a[148:151], v129 offset:36864
mf a[100:103],a[188:191],a[204:207],a[100:103]
s_add_u32 m0, s34, 4096
mf a[68:71],a[180:183],a[204:207],a[68:71]
s_add_u32 s36, s32, 65536
mf a[68:71],a[176:179],a[200:203],a[68:71]
buffer_load_dwordx4 v138, s[20:23], s36 offen lds
mf a[36:39],a[168:171],a[200:203],a[36:39]
ds_read_b64_tr_b16 a[192:193], v130 offset:32768
ds_read_b64_tr_b16 a[194:195], v130 offset:34816
mf a[36:39],a[172:175],a[204:207],a[36:39]
s_add_u32 m0, s35, 2048
mf a[4:7],a[164:167],a[204:207],a[4:7]
s_add_u32 s37, s33, 32768
mf a[4:7],a[160:163],a[200:203],a[4:7]
buffer_load_dwordx4 v139, s[24:27], s37 offen lds
mf a[8:11],a[160:163],a[208:211],a[8:11]
ds_read_b64_tr_b16 a[196:197], v130 offset:49152
ds_read_b64_tr_b16 a[198:199], v130 offset:51200
mf a[8:11],a[164:167],a[212:215],a[8:11]
s_add_u32 m0, s34, 8192
mf a[40:43],a[172:175],a[212:215],a[40:43]
s_add_u32 s36, s32, 131072
mf a[40:43],a[168:171],a[208:211],a[40:43]
buffer_load_dwordx4 v138, s[20:23], s36 offen lds
mf a[72:75],a[176:179],a[208:211],a[72:75]
ds_read_b128 a[152:155], v128 offset:38912
ds_read_b128 a[156:159], v129 offset:38912
mf a[72:75],a[180:183],a[212:215],a[72:75]
s_add_u32 m0, s35, 8192
mf a[104:107],a[188:191],a[212:215],a[104:107]
s_add_u32 s37, s33, 131072
mf a[104:107],a[184:187],a[208:211],a[104:107]
buffer_load_dwordx4 v139, s[24:27], s37 offen lds
mf a[108:111],a[184:187],a[216:219],a[108:111]
ds_read_b64_tr_b16 a[200:201], v131 offset:32768
ds_read_b64_tr_b16 a[202:203], v131 offset:34816
mf a[108:111],a[188:191],a[220:223],a[108:111]
s_add_u32 m0, s34, 12288
mf a[76:79],a[180:183],a[220:223],a[76:79]
s_add_u32 s36, s32, 196608
mf a[76:79],a[176:179],a[216:219],a[76:79]
buffer_load_dwordx4 v138, s[20:23], s36 offen lds
mf a[44:47],a[168:171],a[216:219],a[44:47]
ds_read_b64_tr_b16 a[204:205], v131 offset:49152
ds_read_b64_tr_b16 a[206:207], v131 offset:51200
mf a[44:47],a[172:175],a[220:223],a[44:47]
s_add_u32 m0, s35, 10240
mf a[12:15],a[164:167],a[220:223],a[12:15]
s_add_u32 s37, s33, 163840
mf a[12:15],a[160:163],a[216:219],a[12:15]
buffer_load_dwordx4 v139, s[24:27], s37 offen lds
mf a[16:19],a[160:163],a[224:227],a[16:19]
mf a[16:19],a[164:167],a[228:231],a[16:19]
s_add_u32 m0, s34, 16384
mf a[48:51],a[172:175],a[228:231],a[48:51]
s_add_u32 s36, s32, 262144
mf a[48:51],a[168:171],a[224:227],a[48:51]
buffer_load_dwordx4 v138, s[20:23], s36 offen lds
mf a[80:83],a[176:179],a[224:227],a[80:83]
ds_read_b64_tr_b16 a[208:209], v132 offset:32768
ds_read_b64_tr_b16 a[210:211], v132 offset:34816
mf a[80:83],a[180:183],a[228:231],a[80:83]
s_add_u32 m0, s35, 16384
mf a[112:115],a[188:191],a[228:231],a[112:115]
s_add_u32 s37, s33, 262144
mf a[112:115],a[184:187],a[224:227],a[112:115]
buffer_load_dwordx4 v139, s[24:27], s37 offen lds
mf a[116:119],a[184:187],a[232:235],a[116:119]
ds_read_b64_tr_b16 a[212:213], v132 offset:49152
ds_read_b64_tr_b16 a[214:215], v132 offset:51200
mf a[116:119],a[188:191],a[236:239],a[116:119]
s_add_u32 m0, s34, 20480
mf a[84:87],a[180:183],a[236:239],a[84:87]
s_add_u32 s36, s32, 327680
mf a[84:87],a[176:179],a[232:235],a[84:87]
buffer_load_dwordx4 v138, s[20:23], s36 offen lds
mf a[52:55],a[168:171],a[232:235],a[52:55]
mf a[52:55],a[172:175],a[236:239],a[52:55]
s_add_u32 m0, s35, 18432
mf a[20:23],a[164:167],a[236:239],a[20:23]
s_add_u32 s37, s33, 294912
mf a[20:23],a[160:163],a[232:235],a[20:23]
buffer_load_dwordx4 v139, s[24:27], s37 offen lds
mf a[24:27],a[160:163],a[240:243],a[24:27]
ds_read_b64_tr_b16 a[216:217], v133 offset:32768
ds_read_b64_tr_b16 a[218:219], v133 offset:34816
mf a[24:27],a[164:167],a[244:247],a[24:27]
s_add_u32 m0, s34, 24576
mf a[56:59],a[172:175],a[244:247],a[56:59]
s_add_u32 s36, s32, 393216
mf a[56:59],a[168:171],a[240:243],a[56:59]
buffer_load_dwordx4 v138, s[20:23], s36 offen lds
mf a[88:91],a[176:179],a[240:243],a[88:91]
ds_read_b64_tr_b16 a[220:221], v133 offset:49152
ds_read_b64_tr_b16 a[222:223], v133 offset:51200
mf a[88:91],a[180:183],a[244:247],a[88:91]
s_add_u32 m0, s35, 24576
mf a[120:123],a[188:191],a[244:247],a[120:123]
s_add_u32 s37, s33, 393216
mf a[120:123],a[184:187],a[240:243],a[120:123]
buffer_load_dwordx4 v139, s[24:27], s37 offen lds
mf a[124:127],a[184:187],a[248:251],a[124:127]
mf a[124:127],a[188:191],a[252:255],a[124:127]
s_add_u32 m0, s34, 28672
mf a[92:95],a[180:183],a[252:255],a[92:95]
s_add_u32 s36, s32, 458752
mf a[92:95],a[176:179],a[248:251],a[92:95]
buffer_load_dwordx4 v138, s[20:23], s36 offen lds
mf a[60:63],a[168:171],a[248:251],a[60:63]
mf a[60:63],a[172:175],a[252:255],a[60:63]
s_add_u32 m0, s35, 26624
mf a[28:31],a[164:167],a[252:255],a[28:31]
s_add_u32 s37, s33, 425984
mf a[28:31],a[160:163],a[248:251],a[28:31]
buffer_load_dwordx4 v139, s[24:27], s37 offen lds
s_add_u32 s32, s32, 128
s_add_u32 s33, s33, 524288
s_sub_u32 s38, s38, 1
s_cmp_lg_u32 s38, 0
s_cbranch_scc1 gl_18
s_waitcnt lgkmcnt(0)
mf v[0:3],a[128:131],a[192:195],v[0:3]
ds_read_b64_tr_b16 a[224:225], v134 offset:32768
mf v[0:3],a[132:135],a[196:199],v[0:3]
s_mov_b32 s56, s68
mf v[32:35],a[140:143],a[196:199],v[32:35]
ds_read_b64_tr_b16 a[226:227], v134 offset:34816
s_and_b32 s57, s69, 0xffff
mf v[32:35],a[136:139],a[192:195],v[32:35]
s_mov_b32 s58, 256
mf v[64:67],a[144:147],a[192:195],v[64:67]
ds_read_b64_tr_b16 a[228:229], v134 offset:49152
s_mov_b32 s59, 0x20000
mf v[64:67],a[148:151],a[196:199],v[64:67]
v_lshlrev_b32 v252, 2, v255
mf v[96:99],a[156:159],a[196:199],v[96:99]
ds_read_b64_tr_b16 a[230:231], v134 offset:51200
buffer_load_dword v254, v252, s[56:59], 0 offen sc1
mf v[96:99],a[152:155],a[192:195],v[96:99]
s_lshl_b32 s17, s42, 2
mf v[100:103],a[152:155],a[200:203],v[100:103]
ds_read_b64_tr_b16 a[232:233], v135 offset:32768
s_add_u32 s17, s17, s16
mf v[100:103],a[156:159],a[204:207],v[100:103]
s_lshl_b32 s17, s17, 11
mf v[68:71],a[148:151],a[204:207],v[68:71]
ds_read_b64_tr_b16 a[234:235], v135 offset:34816
mf v[68:71],a[144:147],a[200:203],v[68:71]
v_lshl_add_u32 v146, v255, 5, s17
mf v[36:39],a[136:139],a[200:203],v[36:39]
ds_read_b64_tr_b16 a[236:237], v135 offset:49152
v_min_u32 v146, code_end-go-4, v146
mf v[36:39],a[140:143],a[204:207],v[36:39]
global_load_dword v253, v146, s[100:101]
mf v[4:7],a[132:135],a[204:207],v[4:7]
ds_read_b64_tr_b16 a[238:239], v135 offset:51200
s_load_dwordx2 s[8:9], s[0:1], 88
mf v[4:7],a[128:131],a[200:203],v[4:7]
mf v[8:11],a[128:131],a[208:211],v[8:11]
ds_read_b64_tr_b16 a[240:241], v136 offset:32768
mf v[8:11],a[132:135],a[212:215],v[8:11]
mf v[40:43],a[140:143],a[212:215],v[40:43]
ds_read_b64_tr_b16 a[242:243], v136 offset:34816
mf v[40:43],a[136:139],a[208:211],v[40:43]
mf v[72:75],a[144:147],a[208:211],v[72:75]
ds_read_b64_tr_b16 a[244:245], v136 offset:49152
mf v[72:75],a[148:151],a[212:215],v[72:75]
mf v[104:107],a[156:159],a[212:215],v[104:107]
ds_read_b64_tr_b16 a[246:247], v136 offset:51200
mf v[104:107],a[152:155],a[208:211],v[104:107]
mf v[108:111],a[152:155],a[216:219],v[108:111]
ds_read_b64_tr_b16 a[248:249], v137 offset:32768
mf v[108:111],a[156:159],a[220:223],v[108:111]
mf v[76:79],a[148:151],a[220:223],v[76:79]
ds_read_b64_tr_b16 a[250:251], v137 offset:34816
mf v[76:79],a[144:147],a[216:219],v[76:79]
mf v[44:47],a[136:139],a[216:219],v[44:47]
ds_read_b64_tr_b16 a[252:253], v137 offset:49152
mf v[44:47],a[140:143],a[220:223],v[44:47]
mf v[12:15],a[132:135],a[220:223],v[12:15]
ds_read_b64_tr_b16 a[254:255], v137 offset:51200
mf v[12:15],a[128:131],a[216:219],v[12:15]
s_waitcnt lgkmcnt(8)
mf v[16:19],a[128:131],a[224:227],v[16:19]
mf v[16:19],a[132:135],a[228:231],v[16:19]
ds_read_b128 a[160:163], v128 offset:40960
mf v[48:51],a[140:143],a[228:231],v[48:51]
mf v[48:51],a[136:139],a[224:227],v[48:51]
mf v[80:83],a[144:147],a[224:227],v[80:83]
ds_read_b128 a[164:167], v129 offset:40960
mf v[80:83],a[148:151],a[228:231],v[80:83]
mf v[112:115],a[156:159],a[228:231],v[112:115]
mf v[112:115],a[152:155],a[224:227],v[112:115]
ds_read_b128 a[168:171], v128 offset:43008
mf v[116:119],a[152:155],a[232:235],v[116:119]
mf v[116:119],a[156:159],a[236:239],v[116:119]
mf v[84:87],a[148:151],a[236:239],v[84:87]
ds_read_b128 a[172:175], v129 offset:43008
mf v[84:87],a[144:147],a[232:235],v[84:87]
mf v[52:55],a[136:139],a[232:235],v[52:55]
mf v[52:55],a[140:143],a[236:239],v[52:55]
ds_read_b128 a[176:179], v128 offset:45056
mf v[20:23],a[132:135],a[236:239],v[20:23]
mf v[20:23],a[128:131],a[232:235],v[20:23]
s_waitcnt lgkmcnt(5)
mf v[24:27],a[128:131],a[240:243],v[24:27]
ds_read_b128 a[180:183], v129 offset:45056
mf v[24:27],a[132:135],a[244:247],v[24:27]
mf v[56:59],a[140:143],a[244:247],v[56:59]
mf v[56:59],a[136:139],a[240:243],v[56:59]
ds_read_b128 a[184:187], v128 offset:47104
mf v[88:91],a[144:147],a[240:243],v[88:91]
mf v[88:91],a[148:151],a[244:247],v[88:91]
mf v[120:123],a[156:159],a[244:247],v[120:123]
ds_read_b128 a[188:191], v129 offset:47104
mf v[120:123],a[152:155],a[240:243],v[120:123]
mf v[124:127],a[152:155],a[248:251],v[124:127]
mf v[124:127],a[156:159],a[252:255],v[124:127]
mf v[92:95],a[148:151],a[252:255],v[92:95]
mf v[92:95],a[144:147],a[248:251],v[92:95]
mf v[60:63],a[136:139],a[248:251],v[60:63]
mf v[60:63],a[140:143],a[252:255],v[60:63]
mf v[28:31],a[132:135],a[252:255],v[28:31]
mf v[28:31],a[128:131],a[248:251],v[28:31]
s_waitcnt lgkmcnt(0) vmcnt(1)
s_barrier
s_mov_b64 exec, 0xff
v_cmp_gt_u32 vcc, 1, v254
s_mov_b64 exec, -1
s_cbranch_vccz chk_19
s_mov_b32 s67, 0x80000
s_mov_b64 exec, 0xff
poll_20:
buffer_load_dword v254, v252, s[56:59], 0 offen sc1
s_waitcnt vmcnt(0)
v_cmp_gt_u32 vcc, 1, v254
s_cbranch_vccz pollok_21
s_sleep 2
s_sub_u32 s67, s67, 1
s_cmp_lg_u32 s67, 0
s_cbranch_scc1 poll_20
pollok_21:
s_mov_b64 exec, -1
chk_19:
mf a[0:3],a[160:163],a[192:195],a[0:3]
ds_read_b128 a[128:131], v128 offset:0
ds_read_b128 a[132:135], v129 offset:0
mf a[0:3],a[164:167],a[196:199],a[0:3]
s_add_u32 m0, s34, 32768
mf a[32:35],a[172:175],a[196:199],a[32:35]
s_add_u32 s36, s32, 0
mf a[32:35],a[168:171],a[192:195],a[32:35]
buffer_load_dwordx4 v138, s[20:23], s36 offen lds
mf a[64:67],a[176:179],a[192:195],a[64:67]
ds_read_b128 a[136:139], v128 offset:2048
ds_read_b128 a[140:143], v129 offset:2048
mf a[64:67],a[180:183],a[196:199],a[64:67]
s_add_u32 m0, s35, 32768
mf a[96:99],a[188:191],a[196:199],a[96:99]
s_add_u32 s37, s33, 0
mf a[96:99],a[184:187],a[192:195],a[96:99]
buffer_load_dwordx4 v139, s[24:27], s37 offen lds
mf a[100:103],a[184:187],a[200:203],a[100:103]
ds_read_b128 a[144:147], v128 offset:4096
ds_read_b128 a[148:151], v129 offset:4096
mf a[100:103],a[188:191],a[204:207],a[100:103]
s_add_u32 m0, s34, 36864
mf a[68:71],a[180:183],a[204:207],a[68:71]
s_add_u32 s36, s32, 65536
mf a[68:71],a[176:179],a[200:203],a[68:71]
buffer_load_dwordx4 v138, s[20:23], s36 offen lds
mf a[36:39],a[168:171],a[200:203],a[36:39]
ds_read_b64_tr_b16 a[192:193], v130 offset:0
ds_read_b64_tr_b16 a[194:195], v130 offset:2048
mf a[36:39],a[172:175],a[204:207],a[36:39]
s_add_u32 m0, s35, 34816
mf a[4:7],a[164:167],a[204:207],a[4:7]
s_add_u32 s37, s33, 32768
mf a[4:7],a[160:163],a[200:203],a[4:7]
buffer_load_dwordx4 v139, s[24:27], s37 offen lds
mf a[8:11],a[160:163],a[208:211],a[8:11]
ds_read_b64_tr_b16 a[196:197], v130 offset:16384
ds_read_b64_tr_b16 a[198:199], v130 offset:18432
mf a[8:11],a[164:167],a[212:215],a[8:11]
s_add_u32 m0, s34, 40960
mf a[40:43],a[172:175],a[212:215],a[40:43]
s_add_u32 s36, s32, 131072
mf a[40:43],a[168:171],a[208:211],a[40:43]
buffer_load_dwordx4 v138, s[20:23], s36 offen lds
mf a[72:75],a[176:179],a[208:211],a[72:75]
ds_read_b128 a[152:155], v128 offset:6144
ds_read_b128 a[156:159], v129 offset:6144
mf a[72:75],a[180:183],a[212:215],a[72:75]
s_add_u32 m0, s35, 40960
mf a[104:107],a[188:191],a[212:215],a[104:107]
s_add_u32 s37, s33, 131072
mf a[104:107],a[184:187],a[208:211],a[104:107]
buffer_load_dwordx4 v139, s[24:27], s37 offen lds
mf a[108:111],a[184:187],a[216:219],a[108:111]
ds_read_b64_tr_b16 a[200:201], v131 offset:0
ds_read_b64_tr_b16 a[202:203], v131 offset:2048
mf a[108:111],a[188:191],a[220:223],a[108:111]
s_add_u32 m0, s34, 45056
mf a[76:79],a[180:183],a[220:223],a[76:79]
s_add_u32 s36, s32, 196608
mf a[76:79],a[176:179],a[216:219],a[76:79]
buffer_load_dwordx4 v138, s[20:23], s36 offen lds
mf a[44:47],a[168:171],a[216:219],a[44:47]
ds_read_b64_tr_b16 a[204:205], v131 offset:16384
ds_read_b64_tr_b16 a[206:207], v131 offset:18432
mf a[44:47],a[172:175],a[220:223],a[44:47]
s_add_u32 m0, s35, 43008
mf a[12:15],a[164:167],a[220:223],a[12:15]
s_add_u32 s37, s33, 163840
mf a[12:15],a[160:163],a[216:219],a[12:15]
buffer_load_dwordx4 v139, s[24:27], s37 offen lds
mf a[16:19],a[160:163],a[224:227],a[16:19]
mf a[16:19],a[164:167],a[228:231],a[16:19]
s_add_u32 m0, s34, 49152
mf a[48:51],a[172:175],a[228:231],a[48:51]
s_add_u32 s36, s32, 262144
mf a[48:51],a[168:171],a[224:227],a[48:51]
buffer_load_dwordx4 v138, s[20:23], s36 offen lds
mf a[80:83],a[176:179],a[224:227],a[80:83]
ds_read_b64_tr_b16 a[208:209], v132 offset:0
ds_read_b64_tr_b16 a[210:211], v132 offset:2048
mf a[80:83],a[180:183],a[228:231],a[80:83]
s_add_u32 m0, s35, 49152
mf a[112:115],a[188:191],a[228:231],a[112:115]
s_add_u32 s37, s33, 262144
mf a[112:115],a[184:187],a[224:227],a[112:115]
buffer_load_dwordx4 v139, s[24:27], s37 offen lds
mf a[116:119],a[184:187],a[232:235],a[116:119]
ds_read_b64_tr_b16 a[212:213], v132 offset:16384
ds_read_b64_tr_b16 a[214:215], v132 offset:18432
mf a[116:119],a[188:191],a[236:239],a[116:119]
s_add_u32 m0, s34, 53248
mf a[84:87],a[180:183],a[236:239],a[84:87]
s_add_u32 s36, s32, 327680
mf a[84:87],a[176:179],a[232:235],a[84:87]
buffer_load_dwordx4 v138, s[20:23], s36 offen lds
mf a[52:55],a[168:171],a[232:235],a[52:55]
mf a[52:55],a[172:175],a[236:239],a[52:55]
s_add_u32 m0, s35, 51200
mf a[20:23],a[164:167],a[236:239],a[20:23]
s_add_u32 s37, s33, 294912
mf a[20:23],a[160:163],a[232:235],a[20:23]
buffer_load_dwordx4 v139, s[24:27], s37 offen lds
mf a[24:27],a[160:163],a[240:243],a[24:27]
ds_read_b64_tr_b16 a[216:217], v133 offset:0
ds_read_b64_tr_b16 a[218:219], v133 offset:2048
mf a[24:27],a[164:167],a[244:247],a[24:27]
s_add_u32 m0, s34, 57344
mf a[56:59],a[172:175],a[244:247],a[56:59]
s_add_u32 s36, s32, 393216
mf a[56:59],a[168:171],a[240:243],a[56:59]
buffer_load_dwordx4 v138, s[20:23], s36 offen lds
mf a[88:91],a[176:179],a[240:243],a[88:91]
ds_read_b64_tr_b16 a[220:221], v133 offset:16384
ds_read_b64_tr_b16 a[222:223], v133 offset:18432
mf a[88:91],a[180:183],a[244:247],a[88:91]
s_add_u32 m0, s35, 57344
mf a[120:123],a[188:191],a[244:247],a[120:123]
s_add_u32 s37, s33, 393216
mf a[120:123],a[184:187],a[240:243],a[120:123]
buffer_load_dwordx4 v139, s[24:27], s37 offen lds
mf a[124:127],a[184:187],a[248:251],a[124:127]
mf a[124:127],a[188:191],a[252:255],a[124:127]
s_add_u32 m0, s34, 61440
mf a[92:95],a[180:183],a[252:255],a[92:95]
s_add_u32 s36, s32, 458752
mf a[92:95],a[176:179],a[248:251],a[92:95]
buffer_load_dwordx4 v138, s[20:23], s36 offen lds
mf a[60:63],a[168:171],a[248:251],a[60:63]
mf a[60:63],a[172:175],a[252:255],a[60:63]
s_add_u32 m0, s35, 59392
mf a[28:31],a[164:167],a[252:255],a[28:31]
s_add_u32 s37, s33, 425984
mf a[28:31],a[160:163],a[248:251],a[28:31]
buffer_load_dwordx4 v139, s[24:27], s37 offen lds
s_add_u32 s32, s32, 128
s_add_u32 s33, s33, 524288
s_cmp_ge_u32 s42, 16
s_cbranch_scc1 atype_22
s_waitcnt lgkmcnt(0)
mf v[0:3],a[128:131],a[192:195],v[0:3]
ds_read_b64_tr_b16 a[224:225], v134 offset:0
mf v[0:3],a[132:135],a[196:199],v[0:3]
s_mov_b32 s60, s44
mf v[32:35],a[140:143],a[196:199],v[32:35]
ds_read_b64_tr_b16 a[226:227], v134 offset:2048
s_and_b32 s61, s45, 0xffff
mf v[32:35],a[136:139],a[192:195],v[32:35]
s_mov_b32 s62, 1835008
mf v[64:67],a[144:147],a[192:195],v[64:67]
ds_read_b64_tr_b16 a[228:229], v134 offset:16384
s_mov_b32 s63, 0x20000
mf v[64:67],a[148:151],a[196:199],v[64:67]
s_sub_u32 s64, 15, s14
mf v[96:99],a[156:159],a[196:199],v[96:99]
ds_read_b64_tr_b16 a[230:231], v134 offset:18432
s_bitcmp1_b32 s15, 0
mf v[96:99],a[152:155],a[192:195],v[96:99]
s_cselect_b32 s64, s14, s64
mf v[100:103],a[152:155],a[200:203],v[100:103]
ds_read_b64_tr_b16 a[232:233], v135 offset:0
s_mul_i32 s64, s64, 114688
mf v[100:103],a[156:159],a[204:207],v[100:103]
s_mul_i32 s65, s16, 28672
mf v[68:71],a[148:151],a[204:207],v[68:71]
ds_read_b64_tr_b16 a[234:235], v135 offset:2048
s_add_u32 s64, s64, s65
mf v[68:71],a[144:147],a[200:203],v[68:71]
v_lshlrev_b32 v148, 7, v255
mf v[36:39],a[136:139],a[200:203],v[36:39]
ds_read_b64_tr_b16 a[236:237], v135 offset:16384
buffer_load_dword v149, v148, s[60:63], s64 offen
mf v[36:39],a[140:143],a[204:207],v[36:39]
s_add_u32 s64, s64, 7168
mf v[4:7],a[132:135],a[204:207],v[4:7]
ds_read_b64_tr_b16 a[238:239], v135 offset:18432
s_mov_b64 s[58:59], s[46:47]
mf v[4:7],a[128:131],a[200:203],v[4:7]
s_mov_b32 s44, s44
mf v[8:11],a[128:131],a[208:211],v[8:11]
ds_read_b64_tr_b16 a[240:241], v136 offset:0
s_and_b32 s45, s45, 0xffff
mf v[8:11],a[132:135],a[212:215],v[8:11]
s_mov_b32 s46, 1835008
mf v[40:43],a[140:143],a[212:215],v[40:43]
ds_read_b64_tr_b16 a[242:243], v136 offset:2048
s_mov_b32 s47, 0x20000
mf v[40:43],a[136:139],a[208:211],v[40:43]
s_mov_b32 s48, s58
mf v[72:75],a[144:147],a[208:211],v[72:75]
ds_read_b64_tr_b16 a[244:245], v136 offset:16384
s_and_b32 s49, s59, 0xffff
mf v[72:75],a[148:151],a[212:215],v[72:75]
s_mov_b32 s50, 3670016
mf v[104:107],a[156:159],a[212:215],v[104:107]
ds_read_b64_tr_b16 a[246:247], v136 offset:18432
s_mov_b32 s51, 0x20000
mf v[104:107],a[152:155],a[208:211],v[104:107]
v_lshrrev_b32 v143, 3, v255
mf v[108:111],a[152:155],a[216:219],v[108:111]
ds_read_b64_tr_b16 a[248:249], v137 offset:0
s_lshl_b32 s17, s16, 3
mf v[108:111],a[156:159],a[220:223],v[108:111]
v_add_u32 v143, s17, v143
mf v[76:79],a[148:151],a[220:223],v[76:79]
ds_read_b64_tr_b16 a[250:251], v137 offset:2048
v_bfe_u32 v144, v143, 1, 3
mf v[76:79],a[144:147],a[216:219],v[76:79]
v_and_b32 v145, 7, v255
mf v[44:47],a[136:139],a[216:219],v[44:47]
ds_read_b64_tr_b16 a[252:253], v137 offset:16384
v_xor_b32 v144, v144, v145
mf v[44:47],a[140:143],a[220:223],v[44:47]
v_lshlrev_b32 v144, 4, v144
mf v[12:15],a[132:135],a[220:223],v[12:15]
ds_read_b64_tr_b16 a[254:255], v137 offset:18432
mf v[12:15],a[128:131],a[216:219],v[12:15]
v_mul_u32_u24 v143, 896, v143
s_waitcnt lgkmcnt(8)
mf v[16:19],a[128:131],a[224:227],v[16:19]
v_add_u32 v140, v143, v144
mf v[16:19],a[132:135],a[228:231],v[16:19]
ds_read_b128 a[160:163], v128 offset:8192
s_and_b32 s17, s16, 1
mf v[48:51],a[140:143],a[228:231],v[48:51]
s_lshr_b32 s18, s16, 1
mf v[48:51],a[136:139],a[224:227],v[48:51]
buffer_load_dword v149, v148, s[60:63], s64 offen
mf v[80:83],a[144:147],a[224:227],v[80:83]
ds_read_b128 a[164:167], v129 offset:8192
s_add_u32 s64, s64, 7168
mf v[80:83],a[148:151],a[228:231],v[80:83]
s_lshl_b32 s18, s18, 2
mf v[112:115],a[156:159],a[228:231],v[112:115]
s_add_u32 s17, s17, s18
mf v[112:115],a[152:155],a[224:227],v[112:115]
ds_read_b128 a[168:171], v128 offset:10240
s_lshl_b32 s17, s17, 1
mf v[116:119],a[152:155],a[232:235],v[116:119]
v_lshrrev_b32 v143, 5, v255
mf v[116:119],a[156:159],a[236:239],v[116:119]
v_add_u32 v143, s17, v143
mf v[84:87],a[148:151],a[236:239],v[84:87]
ds_read_b128 a[172:175], v129 offset:10240
v_and_b32 v144, 3, v143
mf v[84:87],a[144:147],a[232:235],v[84:87]
v_bfe_u32 v145, v143, 3, 1
mf v[52:55],a[136:139],a[232:235],v[52:55]
v_lshl_add_u32 v144, v145, 2, v144
mf v[52:55],a[140:143],a[236:239],v[52:55]
ds_read_b128 a[176:179], v128 offset:12288
v_lshlrev_b32 v144, 1, v144
mf v[20:23],a[132:135],a[236:239],v[20:23]
v_and_b32 v145, 31, v255
mf v[20:23],a[128:131],a[232:235],v[20:23]
v_xor_b32 v144, v144, v145
s_waitcnt lgkmcnt(5)
mf v[24:27],a[128:131],a[240:243],v[24:27]
ds_read_b128 a[180:183], v129 offset:12288
v_lshlrev_b32 v144, 4, v144
mf v[24:27],a[132:135],a[244:247],v[24:27]
v_mul_u32_u24 v143, 8192, v143
mf v[56:59],a[140:143],a[244:247],v[56:59]
v_add_u32 v141, v143, v144
mf v[56:59],a[136:139],a[240:243],v[56:59]
ds_read_b128 a[184:187], v128 offset:14336
s_lshl_b32 s34, s16, 10
mf v[88:91],a[144:147],a[240:243],v[88:91]
s_lshl_b32 s35, s17, 9
mf v[88:91],a[148:151],a[244:247],v[88:91]
s_add_u32 s35, s35, 0x10000
mf v[120:123],a[156:159],a[244:247],v[120:123]
ds_read_b128 a[188:191], v129 offset:14336
s_mul_i32 s56, s14, 114688
mf v[120:123],a[152:155],a[240:243],v[120:123]
s_sub_u32 s52, 1720320, s56
mf v[124:127],a[152:155],a[248:251],v[124:127]
s_lshl_b32 s53, s15, 9
mf v[124:127],a[156:159],a[252:255],v[124:127]
s_mov_b32 s54, 0x3db8aa3b
mf v[92:95],a[148:151],a[252:255],v[92:95]
s_mov_b32 s55, s54
mf v[92:95],a[144:147],a[248:251],v[92:95]
mf v[60:63],a[136:139],a[248:251],v[60:63]
mf v[60:63],a[140:143],a[252:255],v[60:63]
mf v[28:31],a[132:135],a[252:255],v[28:31]
mf v[28:31],a[128:131],a[248:251],v[28:31]
s_waitcnt lgkmcnt(0) vmcnt(2)
s_barrier
mf a[0:3],a[160:163],a[192:195],a[0:3]
ds_read_b128 a[128:131], v128 offset:32768
ds_read_b128 a[132:135], v129 offset:32768
mf a[0:3],a[164:167],a[196:199],a[0:3]
s_add_u32 m0, s34, 0
mf a[32:35],a[172:175],a[196:199],a[32:35]
s_add_u32 s36, s52, 0
mf a[32:35],a[168:171],a[192:195],a[32:35]
buffer_load_dwordx4 v140, s[44:47], s36 offen lds
mf a[64:67],a[176:179],a[192:195],a[64:67]
ds_read_b128 a[136:139], v128 offset:34816
ds_read_b128 a[140:143], v129 offset:34816
mf a[64:67],a[180:183],a[196:199],a[64:67]
s_add_u32 m0, s35, 0
mf a[96:99],a[188:191],a[196:199],a[96:99]
s_add_u32 s37, s53, 0
mf a[96:99],a[184:187],a[192:195],a[96:99]
buffer_load_dwordx4 v141, s[48:51], s37 offen lds
mf a[100:103],a[184:187],a[200:203],a[100:103]
ds_read_b128 a[144:147], v128 offset:36864
ds_read_b128 a[148:151], v129 offset:36864
mf a[100:103],a[188:191],a[204:207],a[100:103]
s_add_u32 m0, s34, 4096
mf a[68:71],a[180:183],a[204:207],a[68:71]
s_add_u32 s36, s52, 28672
mf a[68:71],a[176:179],a[200:203],a[68:71]
buffer_load_dwordx4 v140, s[44:47], s36 offen lds
mf a[36:39],a[168:171],a[200:203],a[36:39]
ds_read_b64_tr_b16 a[192:193], v130 offset:32768
ds_read_b64_tr_b16 a[194:195], v130 offset:34816
mf a[36:39],a[172:175],a[204:207],a[36:39]
s_add_u32 m0, s35, 2048
mf a[4:7],a[164:167],a[204:207],a[4:7]
s_add_u32 s37, s53, 32768
mf a[4:7],a[160:163],a[200:203],a[4:7]
buffer_load_dwordx4 v141, s[48:51], s37 offen lds
mf a[8:11],a[160:163],a[208:211],a[8:11]
ds_read_b64_tr_b16 a[196:197], v130 offset:49152
ds_read_b64_tr_b16 a[198:199], v130 offset:51200
mf a[8:11],a[164:167],a[212:215],a[8:11]
s_add_u32 m0, s34, 8192
mf a[40:43],a[172:175],a[212:215],a[40:43]
s_add_u32 s36, s56, 0
mf a[40:43],a[168:171],a[208:211],a[40:43]
buffer_load_dwordx4 v140, s[44:47], s36 offen lds
mf a[72:75],a[176:179],a[208:211],a[72:75]
ds_read_b128 a[152:155], v128 offset:38912
ds_read_b128 a[156:159], v129 offset:38912
mf a[72:75],a[180:183],a[212:215],a[72:75]
s_add_u32 m0, s35, 8192
mf a[104:107],a[188:191],a[212:215],a[104:107]
s_add_u32 s37, s53, 131072
mf a[104:107],a[184:187],a[208:211],a[104:107]
buffer_load_dwordx4 v141, s[48:51], s37 offen lds
mf a[108:111],a[184:187],a[216:219],a[108:111]
ds_read_b64_tr_b16 a[200:201], v131 offset:32768
ds_read_b64_tr_b16 a[202:203], v131 offset:34816
mf a[108:111],a[188:191],a[220:223],a[108:111]
s_add_u32 m0, s34, 12288
mf a[76:79],a[180:183],a[220:223],a[76:79]
s_add_u32 s36, s56, 28672
mf a[76:79],a[176:179],a[216:219],a[76:79]
buffer_load_dwordx4 v140, s[44:47], s36 offen lds
mf a[44:47],a[168:171],a[216:219],a[44:47]
ds_read_b64_tr_b16 a[204:205], v131 offset:49152
ds_read_b64_tr_b16 a[206:207], v131 offset:51200
mf a[44:47],a[172:175],a[220:223],a[44:47]
s_add_u32 m0, s35, 10240
mf a[12:15],a[164:167],a[220:223],a[12:15]
s_add_u32 s37, s53, 163840
mf a[12:15],a[160:163],a[216:219],a[12:15]
buffer_load_dwordx4 v141, s[48:51], s37 offen lds
mf a[16:19],a[160:163],a[224:227],a[16:19]
mf a[16:19],a[164:167],a[228:231],a[16:19]
s_add_u32 m0, s34, 16384
mf a[48:51],a[172:175],a[228:231],a[48:51]
s_add_u32 s36, s52, 57344
mf a[48:51],a[168:171],a[224:227],a[48:51]
buffer_load_dwordx4 v140, s[44:47], s36 offen lds
mf a[80:83],a[176:179],a[224:227],a[80:83]
ds_read_b64_tr_b16 a[208:209], v132 offset:32768
ds_read_b64_tr_b16 a[210:211], v132 offset:34816
mf a[80:83],a[180:183],a[228:231],a[80:83]
s_add_u32 m0, s35, 16384
mf a[112:115],a[188:191],a[228:231],a[112:115]
s_add_u32 s37, s53, 262144
mf a[112:115],a[184:187],a[224:227],a[112:115]
buffer_load_dwordx4 v141, s[48:51], s37 offen lds
mf a[116:119],a[184:187],a[232:235],a[116:119]
ds_read_b64_tr_b16 a[212:213], v132 offset:49152
ds_read_b64_tr_b16 a[214:215], v132 offset:51200
mf a[116:119],a[188:191],a[236:239],a[116:119]
s_add_u32 m0, s34, 20480
mf a[84:87],a[180:183],a[236:239],a[84:87]
s_add_u32 s36, s52, 86016
mf a[84:87],a[176:179],a[232:235],a[84:87]
buffer_load_dwordx4 v140, s[44:47], s36 offen lds
mf a[52:55],a[168:171],a[232:235],a[52:55]
mf a[52:55],a[172:175],a[236:239],a[52:55]
s_add_u32 m0, s35, 18432
mf a[20:23],a[164:167],a[236:239],a[20:23]
s_add_u32 s37, s53, 294912
mf a[20:23],a[160:163],a[232:235],a[20:23]
buffer_load_dwordx4 v141, s[48:51], s37 offen lds
mf a[24:27],a[160:163],a[240:243],a[24:27]
ds_read_b64_tr_b16 a[216:217], v133 offset:32768
ds_read_b64_tr_b16 a[218:219], v133 offset:34816
mf a[24:27],a[164:167],a[244:247],a[24:27]
s_add_u32 m0, s34, 24576
mf a[56:59],a[172:175],a[244:247],a[56:59]
s_add_u32 s36, s56, 57344
mf a[56:59],a[168:171],a[240:243],a[56:59]
buffer_load_dwordx4 v140, s[44:47], s36 offen lds
mf a[88:91],a[176:179],a[240:243],a[88:91]
ds_read_b64_tr_b16 a[220:221], v133 offset:49152
ds_read_b64_tr_b16 a[222:223], v133 offset:51200
mf a[88:91],a[180:183],a[244:247],a[88:91]
s_add_u32 m0, s35, 24576
mf a[120:123],a[188:191],a[244:247],a[120:123]
s_add_u32 s37, s53, 393216
mf a[120:123],a[184:187],a[240:243],a[120:123]
buffer_load_dwordx4 v141, s[48:51], s37 offen lds
mf a[124:127],a[184:187],a[248:251],a[124:127]
mf a[124:127],a[188:191],a[252:255],a[124:127]
s_add_u32 m0, s34, 28672
mf a[92:95],a[180:183],a[252:255],a[92:95]
s_add_u32 s36, s56, 86016
mf a[92:95],a[176:179],a[248:251],a[92:95]
buffer_load_dwordx4 v140, s[44:47], s36 offen lds
mf a[60:63],a[168:171],a[248:251],a[60:63]
mf a[60:63],a[172:175],a[252:255],a[60:63]
s_add_u32 m0, s35, 26624
mf a[28:31],a[164:167],a[252:255],a[28:31]
s_add_u32 s37, s53, 425984
mf a[28:31],a[160:163],a[248:251],a[28:31]
buffer_load_dwordx4 v141, s[48:51], s37 offen lds
s_add_u32 s52, s52, 128
s_add_u32 s53, s53, 524288
s_add_u32 s56, s56, 128
s_waitcnt lgkmcnt(0)
mf v[0:3],a[128:131],a[192:195],v[0:3]
ds_read_b64_tr_b16 a[224:225], v134 offset:32768
mf v[0:3],a[132:135],a[196:199],v[0:3]
buffer_load_dword v254, v148, s[60:63], s64 offen
mf v[32:35],a[140:143],a[196:199],v[32:35]
ds_read_b64_tr_b16 a[226:227], v134 offset:34816
mf v[32:35],a[136:139],a[192:195],v[32:35]
s_add_u32 s64, s64, 7168
mf v[64:67],a[144:147],a[192:195],v[64:67]
ds_read_b64_tr_b16 a[228:229], v134 offset:49152
mf v[64:67],a[148:151],a[196:199],v[64:67]
mf v[96:99],a[156:159],a[196:199],v[96:99]
ds_read_b64_tr_b16 a[230:231], v134 offset:51200
v_and_b32 v252, 3, v255
mf v[96:99],a[152:155],a[192:195],v[96:99]
mf v[100:103],a[152:155],a[200:203],v[100:103]
ds_read_b64_tr_b16 a[232:233], v135 offset:32768
mf v[100:103],a[156:159],a[204:207],v[100:103]
v_and_b32 v143, 12, v255
mf v[68:71],a[148:151],a[204:207],v[68:71]
ds_read_b64_tr_b16 a[234:235], v135 offset:34816
mf v[68:71],a[144:147],a[200:203],v[68:71]
mf v[36:39],a[136:139],a[200:203],v[36:39]
ds_read_b64_tr_b16 a[236:237], v135 offset:49152
v_xor_b32 v143, 8, v143
mf v[36:39],a[140:143],a[204:207],v[36:39]
mf v[4:7],a[132:135],a[204:207],v[4:7]
ds_read_b64_tr_b16 a[238:239], v135 offset:51200
mf v[4:7],a[128:131],a[200:203],v[4:7]
v_lshl_add_u32 v252, v143, 1, v252
mf v[8:11],a[128:131],a[208:211],v[8:11]
ds_read_b64_tr_b16 a[240:241], v136 offset:32768
mf v[8:11],a[132:135],a[212:215],v[8:11]
s_and_b32 s17, s15, 1
mf v[40:43],a[140:143],a[212:215],v[40:43]
ds_read_b64_tr_b16 a[242:243], v136 offset:34816
mf v[40:43],a[136:139],a[208:211],v[40:43]
mf v[72:75],a[144:147],a[208:211],v[72:75]
ds_read_b64_tr_b16 a[244:245], v136 offset:49152
s_lshl_b32 s17, s17, 5
mf v[72:75],a[148:151],a[212:215],v[72:75]
mf v[104:107],a[156:159],a[212:215],v[104:107]
ds_read_b64_tr_b16 a[246:247], v136 offset:51200
mf v[104:107],a[152:155],a[208:211],v[104:107]
buffer_load_dword v254, v148, s[60:63], s64 offen
mf v[108:111],a[152:155],a[216:219],v[108:111]
ds_read_b64_tr_b16 a[248:249], v137 offset:32768
mf v[108:111],a[156:159],a[220:223],v[108:111]
mf v[76:79],a[148:151],a[220:223],v[76:79]
ds_read_b64_tr_b16 a[250:251], v137 offset:34816
s_add_u32 s17, s17, s12
mf v[76:79],a[144:147],a[216:219],v[76:79]
mf v[44:47],a[136:139],a[216:219],v[44:47]
ds_read_b64_tr_b16 a[252:253], v137 offset:49152
mf v[44:47],a[140:143],a[220:223],v[44:47]
v_lshl_add_u32 v252, v252, 3, s17
mf v[12:15],a[132:135],a[220:223],v[12:15]
ds_read_b64_tr_b16 a[254:255], v137 offset:51200
mf v[12:15],a[128:131],a[216:219],v[12:15]
v_bfe_u32 v253, v255, 3, 1
s_waitcnt lgkmcnt(8)
mf v[16:19],a[128:131],a[224:227],v[16:19]
mf v[16:19],a[132:135],a[228:231],v[16:19]
ds_read_b128 a[160:163], v128 offset:40960
mf v[48:51],a[140:143],a[228:231],v[48:51]
v_add_u32 v253, 1, v253
mf v[48:51],a[136:139],a[224:227],v[48:51]
mf v[80:83],a[144:147],a[224:227],v[80:83]
ds_read_b128 a[164:167], v129 offset:40960
mf v[80:83],a[148:151],a[228:231],v[80:83]
s_and_b32 s17, s2, 127
mf v[112:115],a[156:159],a[228:231],v[112:115]
mf v[112:115],a[152:155],a[224:227],v[112:115]
ds_read_b128 a[168:171], v128 offset:43008
mf v[116:119],a[152:155],a[232:235],v[116:119]
v_writelane_b32 v252, s17, 16
mf v[116:119],a[156:159],a[236:239],v[116:119]
mf v[84:87],a[148:151],a[236:239],v[84:87]
ds_read_b128 a[172:175], v129 offset:43008
mf v[84:87],a[144:147],a[232:235],v[84:87]
v_writelane_b32 v253, 2, 16
mf v[52:55],a[136:139],a[232:235],v[52:55]
mf v[52:55],a[140:143],a[236:239],v[52:55]
ds_read_b128 a[176:179], v128 offset:45056
v_lshlrev_b32 v252, 7, v252
mf v[20:23],a[132:135],a[236:239],v[20:23]
mf v[20:23],a[128:131],a[232:235],v[20:23]
s_waitcnt lgkmcnt(5)
mf v[24:27],a[128:131],a[240:243],v[24:27]
ds_read_b128 a[180:183], v129 offset:45056
v_add_u32 v252, 105906176, v252
mf v[24:27],a[132:135],a[244:247],v[24:27]
mf v[56:59],a[140:143],a[244:247],v[56:59]
mf v[56:59],a[136:139],a[240:243],v[56:59]
ds_read_b128 a[184:187], v128 offset:47104
s_lshl_b32 s17, s16, 13
mf v[88:91],a[144:147],a[240:243],v[88:91]
mf v[88:91],a[148:151],a[244:247],v[88:91]
mf v[120:123],a[156:159],a[244:247],v[120:123]
ds_read_b128 a[188:191], v129 offset:47104
s_add_u32 s17, s17, 0x20000
mf v[120:123],a[152:155],a[240:243],v[120:123]
mf v[124:127],a[152:155],a[248:251],v[124:127]
mf v[124:127],a[156:159],a[252:255],v[124:127]
v_add_u32 v147, s17, v142
mf v[92:95],a[148:151],a[252:255],v[92:95]
mf v[92:95],a[144:147],a[248:251],v[92:95]
mf v[60:63],a[136:139],a[248:251],v[60:63]
mf v[60:63],a[140:143],a[252:255],v[60:63]
mf v[28:31],a[132:135],a[252:255],v[28:31]
mf v[28:31],a[128:131],a[248:251],v[28:31]
s_waitcnt lgkmcnt(0) vmcnt(2)
s_barrier
mf a[0:3],a[160:163],a[192:195],a[0:3]
ds_read_b128 a[128:131], v128 offset:0
ds_read_b128 a[132:135], v129 offset:0
mf a[0:3],a[164:167],a[196:199],a[0:3]
s_add_u32 m0, s34, 32768
mf a[32:35],a[172:175],a[196:199],a[32:35]
s_add_u32 s36, s52, 0
mf a[32:35],a[168:171],a[192:195],a[32:35]
buffer_load_dwordx4 v140, s[44:47], s36 offen lds
mf a[64:67],a[176:179],a[192:195],a[64:67]
ds_read_b128 a[136:139], v128 offset:2048
ds_read_b128 a[140:143], v129 offset:2048
mf a[64:67],a[180:183],a[196:199],a[64:67]
s_add_u32 m0, s35, 32768
v_cvt_pk_bf16_f32 v220, v0, v1
mf a[96:99],a[188:191],a[196:199],a[96:99]
s_add_u32 s37, s53, 0
v_cvt_pk_bf16_f32 v221, v2, v3
mf a[96:99],a[184:187],a[192:195],a[96:99]
buffer_load_dwordx4 v141, s[48:51], s37 offen lds
mf a[100:103],a[184:187],a[200:203],a[100:103]
ds_read_b128 a[144:147], v128 offset:4096
ds_read_b128 a[148:151], v129 offset:4096
mf a[100:103],a[188:191],a[204:207],a[100:103]
s_add_u32 m0, s34, 36864
v_cvt_pk_bf16_f32 v222, v32, v33
mf a[68:71],a[180:183],a[204:207],a[68:71]
s_add_u32 s36, s52, 28672
v_cvt_pk_bf16_f32 v223, v34, v35
mf a[68:71],a[176:179],a[200:203],a[68:71]
buffer_load_dwordx4 v140, s[44:47], s36 offen lds
mf a[36:39],a[168:171],a[200:203],a[36:39]
ds_read_b64_tr_b16 a[192:193], v130 offset:0
ds_read_b64_tr_b16 a[194:195], v130 offset:2048
mf a[36:39],a[172:175],a[204:207],a[36:39]
s_add_u32 m0, s35, 34816
ds_write_b128 v147, v[220:223] offset:0
mf a[4:7],a[164:167],a[204:207],a[4:7]
s_add_u32 s37, s53, 32768
v_cvt_pk_bf16_f32 v224, v4, v5
mf a[4:7],a[160:163],a[200:203],a[4:7]
buffer_load_dwordx4 v141, s[48:51], s37 offen lds
mf a[8:11],a[160:163],a[208:211],a[8:11]
ds_read_b64_tr_b16 a[196:197], v130 offset:16384
ds_read_b64_tr_b16 a[198:199], v130 offset:18432
mf a[8:11],a[164:167],a[212:215],a[8:11]
s_add_u32 m0, s34, 40960
v_cvt_pk_bf16_f32 v225, v6, v7
mf a[40:43],a[172:175],a[212:215],a[40:43]
s_add_u32 s36, s56, 0
v_cvt_pk_bf16_f32 v226, v36, v37
mf a[40:43],a[168:171],a[208:211],a[40:43]
buffer_load_dwordx4 v140, s[44:47], s36 offen lds
mf a[72:75],a[176:179],a[208:211],a[72:75]
ds_read_b128 a[152:155], v128 offset:6144
ds_read_b128 a[156:159], v129 offset:6144
mf a[72:75],a[180:183],a[212:215],a[72:75]
s_add_u32 m0, s35, 40960
v_cvt_pk_bf16_f32 v227, v38, v39
mf a[104:107],a[188:191],a[212:215],a[104:107]
s_add_u32 s37, s53, 131072
ds_write_b128 v147, v[224:227] offset:1024
mf a[104:107],a[184:187],a[208:211],a[104:107]
buffer_load_dwordx4 v141, s[48:51], s37 offen lds
mf a[108:111],a[184:187],a[216:219],a[108:111]
ds_read_b64_tr_b16 a[200:201], v131 offset:0
ds_read_b64_tr_b16 a[202:203], v131 offset:2048
mf a[108:111],a[188:191],a[220:223],a[108:111]
s_add_u32 m0, s34, 45056
v_cvt_pk_bf16_f32 v228, v8, v9
mf a[76:79],a[180:183],a[220:223],a[76:79]
s_add_u32 s36, s56, 28672
v_cvt_pk_bf16_f32 v229, v10, v11
mf a[76:79],a[176:179],a[216:219],a[76:79]
buffer_load_dwordx4 v140, s[44:47], s36 offen lds
mf a[44:47],a[168:171],a[216:219],a[44:47]
ds_read_b64_tr_b16 a[204:205], v131 offset:16384
ds_read_b64_tr_b16 a[206:207], v131 offset:18432
mf a[44:47],a[172:175],a[220:223],a[44:47]
s_add_u32 m0, s35, 43008
v_cvt_pk_bf16_f32 v230, v40, v41
mf a[12:15],a[164:167],a[220:223],a[12:15]
s_add_u32 s37, s53, 163840
v_cvt_pk_bf16_f32 v231, v42, v43
mf a[12:15],a[160:163],a[216:219],a[12:15]
buffer_load_dwordx4 v141, s[48:51], s37 offen lds
mf a[16:19],a[160:163],a[224:227],a[16:19]
ds_write_b128 v147, v[228:231] offset:2048
v_cvt_pk_bf16_f32 v232, v12, v13
mf a[16:19],a[164:167],a[228:231],a[16:19]
s_add_u32 m0, s34, 49152
v_cvt_pk_bf16_f32 v233, v14, v15
mf a[48:51],a[172:175],a[228:231],a[48:51]
s_add_u32 s36, s52, 57344
v_cvt_pk_bf16_f32 v234, v44, v45
mf a[48:51],a[168:171],a[224:227],a[48:51]
buffer_load_dwordx4 v140, s[44:47], s36 offen lds
mf a[80:83],a[176:179],a[224:227],a[80:83]
ds_read_b64_tr_b16 a[208:209], v132 offset:0
ds_read_b64_tr_b16 a[210:211], v132 offset:2048
mf a[80:83],a[180:183],a[228:231],a[80:83]
s_add_u32 m0, s35, 49152
v_cvt_pk_bf16_f32 v235, v46, v47
mf a[112:115],a[188:191],a[228:231],a[112:115]
s_add_u32 s37, s53, 262144
ds_write_b128 v147, v[232:235] offset:3072
mf a[112:115],a[184:187],a[224:227],a[112:115]
buffer_load_dwordx4 v141, s[48:51], s37 offen lds
mf a[116:119],a[184:187],a[232:235],a[116:119]
ds_read_b64_tr_b16 a[212:213], v132 offset:16384
ds_read_b64_tr_b16 a[214:215], v132 offset:18432
mf a[116:119],a[188:191],a[236:239],a[116:119]
s_add_u32 m0, s34, 53248
v_cvt_pk_bf16_f32 v236, v16, v17
mf a[84:87],a[180:183],a[236:239],a[84:87]
s_add_u32 s36, s52, 86016
v_cvt_pk_bf16_f32 v237, v18, v19
mf a[84:87],a[176:179],a[232:235],a[84:87]
buffer_load_dwordx4 v140, s[44:47], s36 offen lds
mf a[52:55],a[168:171],a[232:235],a[52:55]
v_cvt_pk_bf16_f32 v238, v48, v49
v_cvt_pk_bf16_f32 v239, v50, v51
mf a[52:55],a[172:175],a[236:239],a[52:55]
s_add_u32 m0, s35, 51200
ds_write_b128 v147, v[236:239] offset:4096
mf a[20:23],a[164:167],a[236:239],a[20:23]
s_add_u32 s37, s53, 294912
v_cvt_pk_bf16_f32 v240, v20, v21
mf a[20:23],a[160:163],a[232:235],a[20:23]
buffer_load_dwordx4 v141, s[48:51], s37 offen lds
mf a[24:27],a[160:163],a[240:243],a[24:27]
ds_read_b64_tr_b16 a[216:217], v133 offset:0
ds_read_b64_tr_b16 a[218:219], v133 offset:2048
mf a[24:27],a[164:167],a[244:247],a[24:27]
s_add_u32 m0, s34, 57344
v_cvt_pk_bf16_f32 v241, v22, v23
mf a[56:59],a[172:175],a[244:247],a[56:59]
s_add_u32 s36, s56, 57344
v_cvt_pk_bf16_f32 v242, v52, v53
mf a[56:59],a[168:171],a[240:243],a[56:59]
buffer_load_dwordx4 v140, s[44:47], s36 offen lds
mf a[88:91],a[176:179],a[240:243],a[88:91]
ds_read_b64_tr_b16 a[220:221], v133 offset:16384
ds_read_b64_tr_b16 a[222:223], v133 offset:18432
mf a[88:91],a[180:183],a[244:247],a[88:91]
s_add_u32 m0, s35, 57344
v_cvt_pk_bf16_f32 v243, v54, v55
mf a[120:123],a[188:191],a[244:247],a[120:123]
s_add_u32 s37, s53, 393216
ds_write_b128 v147, v[240:243] offset:5120
mf a[120:123],a[184:187],a[240:243],a[120:123]
buffer_load_dwordx4 v141, s[48:51], s37 offen lds
mf a[124:127],a[184:187],a[248:251],a[124:127]
v_cvt_pk_bf16_f32 v244, v24, v25
v_cvt_pk_bf16_f32 v245, v26, v27
mf a[124:127],a[188:191],a[252:255],a[124:127]
s_add_u32 m0, s34, 61440
v_cvt_pk_bf16_f32 v246, v56, v57
mf a[92:95],a[180:183],a[252:255],a[92:95]
s_add_u32 s36, s56, 86016
v_cvt_pk_bf16_f32 v247, v58, v59
mf a[92:95],a[176:179],a[248:251],a[92:95]
buffer_load_dwordx4 v140, s[44:47], s36 offen lds
mf a[60:63],a[168:171],a[248:251],a[60:63]
ds_write_b128 v147, v[244:247] offset:6144
v_cvt_pk_bf16_f32 v248, v28, v29
mf a[60:63],a[172:175],a[252:255],a[60:63]
s_add_u32 m0, s35, 59392
v_cvt_pk_bf16_f32 v249, v30, v31
mf a[28:31],a[164:167],a[252:255],a[28:31]
s_add_u32 s37, s53, 425984
v_cvt_pk_bf16_f32 v250, v60, v61
v_cvt_pk_bf16_f32 v251, v62, v63
ds_write_b128 v147, v[248:251] offset:7168
v_cvt_pk_bf16_f32 v156, v64, v65
v_cvt_pk_bf16_f32 v157, v66, v67
v_cvt_pk_bf16_f32 v158, v96, v97
v_cvt_pk_bf16_f32 v159, v98, v99
v_cvt_pk_bf16_f32 v160, v68, v69
v_cvt_pk_bf16_f32 v161, v70, v71
v_cvt_pk_bf16_f32 v162, v100, v101
v_cvt_pk_bf16_f32 v163, v102, v103
v_cvt_pk_bf16_f32 v164, v72, v73
v_cvt_pk_bf16_f32 v165, v74, v75
v_cvt_pk_bf16_f32 v166, v104, v105
v_cvt_pk_bf16_f32 v167, v106, v107
v_cvt_pk_bf16_f32 v168, v76, v77
v_cvt_pk_bf16_f32 v169, v78, v79
v_cvt_pk_bf16_f32 v170, v108, v109
v_cvt_pk_bf16_f32 v171, v110, v111
v_cvt_pk_bf16_f32 v172, v80, v81
v_cvt_pk_bf16_f32 v173, v82, v83
v_cvt_pk_bf16_f32 v174, v112, v113
v_cvt_pk_bf16_f32 v175, v114, v115
v_cvt_pk_bf16_f32 v176, v84, v85
v_cvt_pk_bf16_f32 v177, v86, v87
v_cvt_pk_bf16_f32 v178, v116, v117
v_cvt_pk_bf16_f32 v179, v118, v119
v_cvt_pk_bf16_f32 v180, v88, v89
v_cvt_pk_bf16_f32 v181, v90, v91
v_cvt_pk_bf16_f32 v182, v120, v121
v_cvt_pk_bf16_f32 v183, v122, v123
v_cvt_pk_bf16_f32 v184, v92, v93
v_cvt_pk_bf16_f32 v185, v94, v95
v_cvt_pk_bf16_f32 v186, v124, v125
v_cvt_pk_bf16_f32 v187, v126, v127
mf a[28:31],a[160:163],a[248:251],a[28:31]
buffer_load_dwordx4 v141, s[48:51], s37 offen lds
s_add_u32 s52, s52, 128
s_add_u32 s53, s53, 524288
s_add_u32 s56, s56, 128
s_waitcnt lgkmcnt(0)
mf v[0:3],a[192:195],a[128:131],0
ds_read_b64_tr_b16 a[224:225], v134 offset:0
mf v[0:3],a[196:199],a[132:135],v[0:3]
mf v[32:35],a[196:199],a[140:143],0
ds_read_b64_tr_b16 a[226:227], v134 offset:2048
mf v[32:35],a[192:195],a[136:139],v[32:35]
mf v[64:67],a[192:195],a[144:147],0
ds_read_b64_tr_b16 a[228:229], v134 offset:16384
v_accvgpr_read_b32 v148, a0
mf v[64:67],a[196:199],a[148:151],v[64:67]
v_accvgpr_read_b32 v149, a1
v_accvgpr_read_b32 v150, a2
mf v[96:99],a[196:199],a[156:159],0
ds_read_b64_tr_b16 a[230:231], v134 offset:18432
v_accvgpr_read_b32 v151, a3
mf v[96:99],a[192:195],a[152:155],v[96:99]
v_accvgpr_read_b32 v152, a32
v_accvgpr_read_b32 v153, a33
mf v[100:103],a[200:203],a[152:155],0
ds_read_b64_tr_b16 a[232:233], v135 offset:0
v_accvgpr_read_b32 v154, a34
mf v[100:103],a[204:207],a[156:159],v[100:103]
v_accvgpr_read_b32 v155, a35
v_cvt_pk_bf16_f32 v188, v148, v149
mf v[68:71],a[204:207],a[148:151],0
ds_read_b64_tr_b16 a[234:235], v135 offset:2048
v_cvt_pk_bf16_f32 v189, v150, v151
mf v[68:71],a[200:203],a[144:147],v[68:71]
v_cvt_pk_bf16_f32 v190, v152, v153
v_cvt_pk_bf16_f32 v191, v154, v155
mf v[36:39],a[200:203],a[136:139],0
ds_read_b64_tr_b16 a[236:237], v135 offset:16384
v_accvgpr_read_b32 v148, a64
mf v[36:39],a[204:207],a[140:143],v[36:39]
v_accvgpr_read_b32 v149, a65
v_accvgpr_read_b32 v150, a66
mf v[4:7],a[204:207],a[132:135],0
ds_read_b64_tr_b16 a[238:239], v135 offset:18432
v_accvgpr_read_b32 v151, a67
mf v[4:7],a[200:203],a[128:131],v[4:7]
v_accvgpr_read_b32 v152, a96
v_accvgpr_read_b32 v153, a97
mf v[8:11],a[208:211],a[128:131],0
ds_read_b64_tr_b16 a[240:241], v136 offset:0
v_accvgpr_read_b32 v154, a98
mf v[8:11],a[212:215],a[132:135],v[8:11]
v_accvgpr_read_b32 v155, a99
v_cvt_pk_bf16_f32 v220, v148, v149
mf v[40:43],a[212:215],a[140:143],0
ds_read_b64_tr_b16 a[242:243], v136 offset:2048
v_cvt_pk_bf16_f32 v221, v150, v151
mf v[40:43],a[208:211],a[136:139],v[40:43]
v_cvt_pk_bf16_f32 v222, v152, v153
v_cvt_pk_bf16_f32 v223, v154, v155
mf v[72:75],a[208:211],a[144:147],0
ds_read_b64_tr_b16 a[244:245], v136 offset:16384
v_accvgpr_read_b32 v148, a68
mf v[72:75],a[212:215],a[148:151],v[72:75]
v_accvgpr_read_b32 v149, a69
v_accvgpr_read_b32 v150, a70
mf v[104:107],a[212:215],a[156:159],0
ds_read_b64_tr_b16 a[246:247], v136 offset:18432
v_accvgpr_read_b32 v151, a71
mf v[104:107],a[208:211],a[152:155],v[104:107]
v_accvgpr_read_b32 v152, a100
v_accvgpr_read_b32 v153, a101
mf v[108:111],a[216:219],a[152:155],0
ds_read_b64_tr_b16 a[248:249], v137 offset:0
v_accvgpr_read_b32 v154, a102
mf v[108:111],a[220:223],a[156:159],v[108:111]
v_accvgpr_read_b32 v155, a103
v_cvt_pk_bf16_f32 v224, v148, v149
mf v[76:79],a[220:223],a[148:151],0
ds_read_b64_tr_b16 a[250:251], v137 offset:2048
v_cvt_pk_bf16_f32 v225, v150, v151
mf v[76:79],a[216:219],a[144:147],v[76:79]
v_cvt_pk_bf16_f32 v226, v152, v153
v_cvt_pk_bf16_f32 v227, v154, v155
mf v[44:47],a[216:219],a[136:139],0
ds_read_b64_tr_b16 a[252:253], v137 offset:16384
v_accvgpr_read_b32 v148, a4
mf v[44:47],a[220:223],a[140:143],v[44:47]
v_accvgpr_read_b32 v149, a5
v_accvgpr_read_b32 v150, a6
mf v[12:15],a[220:223],a[132:135],0
ds_read_b64_tr_b16 a[254:255], v137 offset:18432
v_accvgpr_read_b32 v151, a7
mf v[12:15],a[216:219],a[128:131],v[12:15]
v_accvgpr_read_b32 v152, a36
s_waitcnt lgkmcnt(8)
mf v[16:19],a[224:227],a[128:131],0
v_accvgpr_read_b32 v153, a37
v_accvgpr_read_b32 v154, a38
mf v[16:19],a[228:231],a[132:135],v[16:19]
ds_read_b128 a[160:163], v128 offset:8192
v_accvgpr_read_b32 v155, a39
mf v[48:51],a[228:231],a[140:143],0
v_cvt_pk_bf16_f32 v192, v148, v149
v_cvt_pk_bf16_f32 v193, v150, v151
mf v[48:51],a[224:227],a[136:139],v[48:51]
v_cvt_pk_bf16_f32 v194, v152, v153
v_cvt_pk_bf16_f32 v195, v154, v155
mf v[80:83],a[224:227],a[144:147],0
ds_read_b128 a[164:167], v129 offset:8192
v_accvgpr_read_b32 v148, a8
mf v[80:83],a[228:231],a[148:151],v[80:83]
v_accvgpr_read_b32 v149, a9
v_accvgpr_read_b32 v150, a10
mf v[112:115],a[228:231],a[156:159],0
v_accvgpr_read_b32 v151, a11
v_accvgpr_read_b32 v152, a40
mf v[112:115],a[224:227],a[152:155],v[112:115]
ds_read_b128 a[168:171], v128 offset:10240
v_accvgpr_read_b32 v153, a41
mf v[116:119],a[232:235],a[152:155],0
v_accvgpr_read_b32 v154, a42
v_accvgpr_read_b32 v155, a43
mf v[116:119],a[236:239],a[156:159],v[116:119]
v_cvt_pk_bf16_f32 v196, v148, v149
v_cvt_pk_bf16_f32 v197, v150, v151
mf v[84:87],a[236:239],a[148:151],0
ds_read_b128 a[172:175], v129 offset:10240
v_cvt_pk_bf16_f32 v198, v152, v153
mf v[84:87],a[232:235],a[144:147],v[84:87]
v_cvt_pk_bf16_f32 v199, v154, v155
v_accvgpr_read_b32 v148, a72
mf v[52:55],a[232:235],a[136:139],0
v_accvgpr_read_b32 v149, a73
v_accvgpr_read_b32 v150, a74
mf v[52:55],a[236:239],a[140:143],v[52:55]
ds_read_b128 a[176:179], v128 offset:12288
v_accvgpr_read_b32 v151, a75
mf v[20:23],a[236:239],a[132:135],0
v_accvgpr_read_b32 v152, a104
v_accvgpr_read_b32 v153, a105
mf v[20:23],a[232:235],a[128:131],v[20:23]
v_accvgpr_read_b32 v154, a106
s_waitcnt lgkmcnt(5)
mf v[24:27],a[240:243],a[128:131],0
ds_read_b128 a[180:183], v129 offset:12288
v_accvgpr_read_b32 v155, a107
mf v[24:27],a[244:247],a[132:135],v[24:27]
v_cvt_pk_bf16_f32 v228, v148, v149
v_cvt_pk_bf16_f32 v229, v150, v151
mf v[56:59],a[244:247],a[140:143],0
v_cvt_pk_bf16_f32 v230, v152, v153
v_cvt_pk_bf16_f32 v231, v154, v155
mf v[56:59],a[240:243],a[136:139],v[56:59]
ds_read_b128 a[184:187], v128 offset:14336
v_accvgpr_read_b32 v148, a76
mf v[88:91],a[240:243],a[144:147],0
v_accvgpr_read_b32 v149, a77
v_accvgpr_read_b32 v150, a78
mf v[88:91],a[244:247],a[148:151],v[88:91]
v_accvgpr_read_b32 v151, a79
v_accvgpr_read_b32 v152, a108
mf v[120:123],a[244:247],a[156:159],0
ds_read_b128 a[188:191], v129 offset:14336
v_accvgpr_read_b32 v153, a109
mf v[120:123],a[240:243],a[152:155],v[120:123]
v_accvgpr_read_b32 v154, a110
v_accvgpr_read_b32 v155, a111
mf v[124:127],a[248:251],a[152:155],0
v_cvt_pk_bf16_f32 v232, v148, v149
v_cvt_pk_bf16_f32 v233, v150, v151
mf v[124:127],a[252:255],a[156:159],v[124:127]
v_cvt_pk_bf16_f32 v234, v152, v153
v_cvt_pk_bf16_f32 v235, v154, v155
mf v[92:95],a[252:255],a[148:151],0
v_accvgpr_read_b32 v148, a12
v_accvgpr_read_b32 v149, a13
mf v[92:95],a[248:251],a[144:147],v[92:95]
v_accvgpr_read_b32 v150, a14
v_accvgpr_read_b32 v151, a15
mf v[60:63],a[248:251],a[136:139],0
v_accvgpr_read_b32 v152, a44
v_accvgpr_read_b32 v153, a45
mf v[60:63],a[252:255],a[140:143],v[60:63]
v_accvgpr_read_b32 v154, a46
v_accvgpr_read_b32 v155, a47
mf v[28:31],a[252:255],a[132:135],0
v_cvt_pk_bf16_f32 v200, v148, v149
v_cvt_pk_bf16_f32 v201, v150, v151
mf v[28:31],a[248:251],a[128:131],v[28:31]
v_cvt_pk_bf16_f32 v202, v152, v153
v_cvt_pk_bf16_f32 v203, v154, v155
v_accvgpr_read_b32 v148, a16
v_accvgpr_read_b32 v149, a17
v_accvgpr_read_b32 v150, a18
v_accvgpr_read_b32 v151, a19
v_accvgpr_read_b32 v152, a48
v_accvgpr_read_b32 v153, a49
v_accvgpr_read_b32 v154, a50
v_accvgpr_read_b32 v155, a51
v_cvt_pk_bf16_f32 v204, v148, v149
v_cvt_pk_bf16_f32 v205, v150, v151
v_cvt_pk_bf16_f32 v206, v152, v153
v_cvt_pk_bf16_f32 v207, v154, v155
v_accvgpr_read_b32 v148, a80
v_accvgpr_read_b32 v149, a81
v_accvgpr_read_b32 v150, a82
v_accvgpr_read_b32 v151, a83
v_accvgpr_read_b32 v152, a112
v_accvgpr_read_b32 v153, a113
v_accvgpr_read_b32 v154, a114
v_accvgpr_read_b32 v155, a115
v_cvt_pk_bf16_f32 v236, v148, v149
v_cvt_pk_bf16_f32 v237, v150, v151
v_cvt_pk_bf16_f32 v238, v152, v153
v_cvt_pk_bf16_f32 v239, v154, v155
v_accvgpr_read_b32 v148, a84
v_accvgpr_read_b32 v149, a85
v_accvgpr_read_b32 v150, a86
v_accvgpr_read_b32 v151, a87
v_accvgpr_read_b32 v152, a116
v_accvgpr_read_b32 v153, a117
v_accvgpr_read_b32 v154, a118
v_accvgpr_read_b32 v155, a119
v_cvt_pk_bf16_f32 v240, v148, v149
v_cvt_pk_bf16_f32 v241, v150, v151
v_cvt_pk_bf16_f32 v242, v152, v153
v_cvt_pk_bf16_f32 v243, v154, v155
s_waitcnt lgkmcnt(0) vmcnt(0)
s_barrier
mf a[0:3],a[192:195],a[160:163],0
ds_read_b128 a[128:131], v128 offset:32768
ds_read_b128 a[132:135], v129 offset:32768
v_accvgpr_read_b32 v148, a20
mf a[0:3],a[196:199],a[164:167],a[0:3]
s_add_u32 m0, s34, 0
v_accvgpr_read_b32 v149, a21
mf a[32:35],a[196:199],a[172:175],0
s_add_u32 s36, s52, 0
v_accvgpr_read_b32 v150, a22
mf a[32:35],a[192:195],a[168:171],a[32:35]
buffer_load_dwordx4 v140, s[44:47], s36 offen lds
v_accvgpr_read_b32 v151, a23
mf a[64:67],a[192:195],a[176:179],0
ds_read_b128 a[136:139], v128 offset:34816
ds_read_b128 a[140:143], v129 offset:34816
v_accvgpr_read_b32 v152, a52
mf a[64:67],a[196:199],a[180:183],a[64:67]
s_add_u32 m0, s35, 0
v_accvgpr_read_b32 v153, a53
mf a[96:99],a[196:199],a[188:191],0
s_add_u32 s37, s53, 0
v_accvgpr_read_b32 v154, a54
mf a[96:99],a[192:195],a[184:187],a[96:99]
buffer_load_dwordx4 v141, s[48:51], s37 offen lds
v_accvgpr_read_b32 v155, a55
mf a[100:103],a[200:203],a[184:187],0
ds_read_b128 a[144:147], v128 offset:36864
ds_read_b128 a[148:151], v129 offset:36864
v_cvt_pk_bf16_f32 v208, v148, v149
mf a[100:103],a[204:207],a[188:191],a[100:103]
s_add_u32 m0, s34, 4096
v_cvt_pk_bf16_f32 v209, v150, v151
mf a[68:71],a[204:207],a[180:183],0
s_add_u32 s36, s52, 28672
v_cvt_pk_bf16_f32 v210, v152, v153
mf a[68:71],a[200:203],a[176:179],a[68:71]
buffer_load_dwordx4 v140, s[44:47], s36 offen lds
v_cvt_pk_bf16_f32 v211, v154, v155
mf a[36:39],a[200:203],a[168:171],0
ds_read_b64_tr_b16 a[192:193], v130 offset:32768
ds_read_b64_tr_b16 a[194:195], v130 offset:34816
v_accvgpr_read_b32 v148, a24
mf a[36:39],a[204:207],a[172:175],a[36:39]
s_add_u32 m0, s35, 2048
v_accvgpr_read_b32 v149, a25
mf a[4:7],a[204:207],a[164:167],0
s_add_u32 s37, s53, 32768
v_accvgpr_read_b32 v150, a26
mf a[4:7],a[200:203],a[160:163],a[4:7]
buffer_load_dwordx4 v141, s[48:51], s37 offen lds
v_accvgpr_read_b32 v151, a27
mf a[8:11],a[208:211],a[160:163],0
ds_read_b64_tr_b16 a[196:197], v130 offset:49152
ds_read_b64_tr_b16 a[198:199], v130 offset:51200
v_accvgpr_read_b32 v152, a56
mf a[8:11],a[212:215],a[164:167],a[8:11]
s_add_u32 m0, s34, 8192
v_accvgpr_read_b32 v153, a57
mf a[40:43],a[212:215],a[172:175],0
s_add_u32 s36, s56, 0
v_accvgpr_read_b32 v154, a58
mf a[40:43],a[208:211],a[168:171],a[40:43]
buffer_load_dwordx4 v140, s[44:47], s36 offen lds
v_accvgpr_read_b32 v155, a59
mf a[72:75],a[208:211],a[176:179],0
ds_read_b128 a[152:155], v128 offset:38912
ds_read_b128 a[156:159], v129 offset:38912
v_cvt_pk_bf16_f32 v212, v148, v149
mf a[72:75],a[212:215],a[180:183],a[72:75]
s_add_u32 m0, s35, 8192
v_cvt_pk_bf16_f32 v213, v150, v151
mf a[104:107],a[212:215],a[188:191],0
s_add_u32 s37, s53, 131072
v_cvt_pk_bf16_f32 v214, v152, v153
mf a[104:107],a[208:211],a[184:187],a[104:107]
buffer_load_dwordx4 v141, s[48:51], s37 offen lds
v_cvt_pk_bf16_f32 v215, v154, v155
mf a[108:111],a[216:219],a[184:187],0
ds_read_b64_tr_b16 a[200:201], v131 offset:32768
ds_read_b64_tr_b16 a[202:203], v131 offset:34816
v_accvgpr_read_b32 v148, a88
mf a[108:111],a[220:223],a[188:191],a[108:111]
s_add_u32 m0, s34, 12288
v_accvgpr_read_b32 v149, a89
mf a[76:79],a[220:223],a[180:183],0
s_add_u32 s36, s56, 28672
v_accvgpr_read_b32 v150, a90
mf a[76:79],a[216:219],a[176:179],a[76:79]
buffer_load_dwordx4 v140, s[44:47], s36 offen lds
v_accvgpr_read_b32 v151, a91
mf a[44:47],a[216:219],a[168:171],0
ds_read_b64_tr_b16 a[204:205], v131 offset:49152
ds_read_b64_tr_b16 a[206:207], v131 offset:51200
v_accvgpr_read_b32 v152, a120
mf a[44:47],a[220:223],a[172:175],a[44:47]
s_add_u32 m0, s35, 10240
v_accvgpr_read_b32 v153, a121
mf a[12:15],a[220:223],a[164:167],0
s_add_u32 s37, s53, 163840
v_accvgpr_read_b32 v154, a122
mf a[12:15],a[216:219],a[160:163],a[12:15]
buffer_load_dwordx4 v141, s[48:51], s37 offen lds
v_accvgpr_read_b32 v155, a123
mf a[16:19],a[224:227],a[160:163],0
v_cvt_pk_bf16_f32 v244, v148, v149
mf a[16:19],a[228:231],a[164:167],a[16:19]
s_add_u32 m0, s34, 16384
v_cvt_pk_bf16_f32 v245, v150, v151
mf a[48:51],a[228:231],a[172:175],0
s_add_u32 s36, s52, 57344
v_cvt_pk_bf16_f32 v246, v152, v153
mf a[48:51],a[224:227],a[168:171],a[48:51]
buffer_load_dwordx4 v140, s[44:47], s36 offen lds
v_cvt_pk_bf16_f32 v247, v154, v155
mf a[80:83],a[224:227],a[176:179],0
ds_read_b64_tr_b16 a[208:209], v132 offset:32768
ds_read_b64_tr_b16 a[210:211], v132 offset:34816
v_accvgpr_read_b32 v148, a92
mf a[80:83],a[228:231],a[180:183],a[80:83]
s_add_u32 m0, s35, 16384
v_accvgpr_read_b32 v149, a93
mf a[112:115],a[228:231],a[188:191],0
s_add_u32 s37, s53, 262144
v_accvgpr_read_b32 v150, a94
mf a[112:115],a[224:227],a[184:187],a[112:115]
buffer_load_dwordx4 v141, s[48:51], s37 offen lds
v_accvgpr_read_b32 v151, a95
mf a[116:119],a[232:235],a[184:187],0
ds_read_b64_tr_b16 a[212:213], v132 offset:49152
ds_read_b64_tr_b16 a[214:215], v132 offset:51200
v_accvgpr_read_b32 v152, a124
mf a[116:119],a[236:239],a[188:191],a[116:119]
s_add_u32 m0, s34, 20480
v_accvgpr_read_b32 v153, a125
mf a[84:87],a[236:239],a[180:183],0
s_add_u32 s36, s52, 86016
v_accvgpr_read_b32 v154, a126
mf a[84:87],a[232:235],a[176:179],a[84:87]
buffer_load_dwordx4 v140, s[44:47], s36 offen lds
v_accvgpr_read_b32 v155, a127
mf a[52:55],a[232:235],a[168:171],0
v_cvt_pk_bf16_f32 v248, v148, v149
mf a[52:55],a[236:239],a[172:175],a[52:55]
s_add_u32 m0, s35, 18432
v_cvt_pk_bf16_f32 v249, v150, v151
mf a[20:23],a[236:239],a[164:167],0
s_add_u32 s37, s53, 294912
v_cvt_pk_bf16_f32 v250, v152, v153
mf a[20:23],a[232:235],a[160:163],a[20:23]
buffer_load_dwordx4 v141, s[48:51], s37 offen lds
v_cvt_pk_bf16_f32 v251, v154, v155
mf a[24:27],a[240:243],a[160:163],0
ds_read_b64_tr_b16 a[216:217], v133 offset:32768
ds_read_b64_tr_b16 a[218:219], v133 offset:34816
v_accvgpr_read_b32 v148, a28
mf a[24:27],a[244:247],a[164:167],a[24:27]
s_add_u32 m0, s34, 24576
v_accvgpr_read_b32 v149, a29
mf a[56:59],a[244:247],a[172:175],0
s_add_u32 s36, s56, 57344
v_accvgpr_read_b32 v150, a30
mf a[56:59],a[240:243],a[168:171],a[56:59]
buffer_load_dwordx4 v140, s[44:47], s36 offen lds
v_accvgpr_read_b32 v151, a31
mf a[88:91],a[240:243],a[176:179],0
ds_read_b64_tr_b16 a[220:221], v133 offset:49152
ds_read_b64_tr_b16 a[222:223], v133 offset:51200
v_accvgpr_read_b32 v152, a60
mf a[88:91],a[244:247],a[180:183],a[88:91]
s_add_u32 m0, s35, 24576
v_accvgpr_read_b32 v153, a61
mf a[120:123],a[244:247],a[188:191],0
s_add_u32 s37, s53, 393216
v_accvgpr_read_b32 v154, a62
mf a[120:123],a[240:243],a[184:187],a[120:123]
buffer_load_dwordx4 v141, s[48:51], s37 offen lds
v_accvgpr_read_b32 v155, a63
mf a[124:127],a[248:251],a[184:187],0
v_cvt_pk_bf16_f32 v216, v148, v149
mf a[124:127],a[252:255],a[188:191],a[124:127]
s_add_u32 m0, s34, 28672
v_cvt_pk_bf16_f32 v217, v150, v151
mf a[92:95],a[252:255],a[180:183],0
s_add_u32 s36, s56, 86016
v_cvt_pk_bf16_f32 v218, v152, v153
mf a[92:95],a[248:251],a[176:179],a[92:95]
buffer_load_dwordx4 v140, s[44:47], s36 offen lds
v_cvt_pk_bf16_f32 v219, v154, v155
mf a[60:63],a[248:251],a[168:171],0
mf a[60:63],a[252:255],a[172:175],a[60:63]
s_add_u32 m0, s35, 26624
mf a[28:31],a[252:255],a[164:167],0
s_add_u32 s37, s53, 425984
mf a[28:31],a[248:251],a[160:163],a[28:31]
buffer_load_dwordx4 v141, s[48:51], s37 offen lds
s_add_u32 s52, s52, 128
s_add_u32 s53, s53, 524288
s_add_u32 s56, s56, 128
s_branch qrest_9
atype_22:
s_waitcnt lgkmcnt(0)
mf v[0:3],a[128:131],a[192:195],v[0:3]
ds_read_b64_tr_b16 a[224:225], v134 offset:0
mf v[0:3],a[132:135],a[196:199],v[0:3]
s_mov_b32 s56, s48
s_and_b32 s57, s49, 0xffff
mf v[32:35],a[140:143],a[196:199],v[32:35]
ds_read_b64_tr_b16 a[226:227], v134 offset:2048
s_mov_b32 s58, 401408
mf v[32:35],a[136:139],a[192:195],v[32:35]
s_mov_b32 s59, 0x20000
s_and_b32 s17, s42, 15
mf v[64:67],a[144:147],a[192:195],v[64:67]
ds_read_b64_tr_b16 a[228:229], v134 offset:16384
s_lshl_b32 s17, s17, 2
mf v[64:67],a[148:151],a[196:199],v[64:67]
s_add_u32 s17, s17, s16
s_mul_i32 s23, s17, 6272
mf v[96:99],a[156:159],a[196:199],v[96:99]
ds_read_b64_tr_b16 a[230:231], v134 offset:18432
v_lshlrev_b32 v157, 7, v255
mf v[96:99],a[152:155],a[192:195],v[96:99]
buffer_load_dword v254, v157, s[56:59], s23 offen
s_mov_b32 s52, s44
mf v[100:103],a[152:155],a[200:203],v[100:103]
ds_read_b64_tr_b16 a[232:233], v135 offset:0
s_and_b32 s53, s45, 0xffff
mf v[100:103],a[156:159],a[204:207],v[100:103]
s_mov_b32 s54, 1835008
s_mov_b32 s55, 0x20000
mf v[68:71],a[148:151],a[204:207],v[68:71]
ds_read_b64_tr_b16 a[234:235], v135 offset:2048
s_mov_b32 s56, s48
mf v[68:71],a[144:147],a[200:203],v[68:71]
s_and_b32 s57, s49, 0xffff
s_mov_b32 s58, 401408
mf v[36:39],a[136:139],a[200:203],v[36:39]
ds_read_b64_tr_b16 a[236:237], v135 offset:16384
s_mov_b32 s59, 0x20000
mf v[36:39],a[140:143],a[204:207],v[36:39]
s_mov_b32 s60, s50
s_and_b32 s61, s51, 0xffff
mf v[4:7],a[132:135],a[204:207],v[4:7]
ds_read_b64_tr_b16 a[238:239], v135 offset:18432
s_mov_b32 s62, 401408
mf v[4:7],a[128:131],a[200:203],v[4:7]
s_mov_b32 s63, 0x20000
s_mov_b32 s64, s8
mf v[8:11],a[128:131],a[208:211],v[8:11]
ds_read_b64_tr_b16 a[240:241], v136 offset:0
s_and_b32 s65, s9, 0xffff
mf v[8:11],a[132:135],a[212:215],v[8:11]
s_mov_b32 s66, 896
s_mov_b32 s67, 0x20000
mf v[40:43],a[140:143],a[212:215],v[40:43]
ds_read_b64_tr_b16 a[242:243], v136 offset:2048
v_and_b32 v160, 15, v255
mf v[40:43],a[136:139],a[208:211],v[40:43]
v_add_u32 v162, -2, v160
v_add_u32 v163, 14, v160
mf v[72:75],a[144:147],a[208:211],v[72:75]
ds_read_b64_tr_b16 a[244:245], v136 offset:16384
v_cmp_gt_u32 vcc, 2, v160
mf v[72:75],a[148:151],a[212:215],v[72:75]
v_mov_b32 v164, 0x10000
s_nop 0
mf v[104:107],a[156:159],a[212:215],v[104:107]
ds_read_b64_tr_b16 a[246:247], v136 offset:18432
v_cndmask_b32 v162, v163, v162, vcc
mf v[104:107],a[152:155],a[208:211],v[104:107]
v_cmp_gt_u32 vcc, 4, v160
s_lshl_b32 s20, s43, 4
mf v[108:111],a[152:155],a[216:219],v[108:111]
ds_read_b64_tr_b16 a[248:249], v137 offset:0
s_nop 0
mf v[108:111],a[156:159],a[220:223],v[108:111]
v_cndmask_b32 v146, v164, v162, vcc
s_bitcmp1_b32 s16, 0
mf v[76:79],a[148:151],a[220:223],v[76:79]
ds_read_b64_tr_b16 a[250:251], v137 offset:2048
s_cselect_b64 vcc, -1, 0
mf v[76:79],a[144:147],a[216:219],v[76:79]
v_cndmask_b32 v161, v160, v146, vcc
v_add_u32 v161, s20, v161
mf v[44:47],a[136:139],a[216:219],v[44:47]
ds_read_b64_tr_b16 a[252:253], v137 offset:16384
s_movk_i32 s17, 896
mf v[44:47],a[140:143],a[220:223],v[44:47]
v_mul_lo_u32 v161, v161, s17
v_lshrrev_b32 v147, 4, v255
mf v[12:15],a[132:135],a[220:223],v[12:15]
ds_read_b64_tr_b16 a[254:255], v137 offset:18432
v_lshlrev_b32 v147, 4, v147
mf v[12:15],a[128:131],a[216:219],v[12:15]
v_add_u32 v156, v161, v147
s_waitcnt lgkmcnt(8)
mf v[16:19],a[128:131],a[224:227],v[16:19]
s_and_b32 s17, s16, 1
s_mul_i32 s21, s17, 14336
mf v[16:19],a[132:135],a[228:231],v[16:19]
ds_read_b128 a[160:163], v128 offset:8192
s_lshl_b32 s17, s17, 2
mf v[48:51],a[140:143],a[228:231],v[48:51]
v_add_u32 v160, 0, v255
v_mul_u32_u24 v161, 1171, v160
mf v[48:51],a[136:139],a[224:227],v[48:51]
v_lshrrev_b32 v161, 16, v161
v_and_b32 v163, 2, v161
mf v[80:83],a[144:147],a[224:227],v[80:83]
ds_read_b128 a[164:167], v129 offset:8192
v_or_b32 v163, s17, v163
mf v[80:83],a[148:151],a[228:231],v[80:83]
v_xor_b32 v160, v255, v163
v_lshlrev_b32 v138, 4, v160
mf v[112:115],a[156:159],a[228:231],v[112:115]
v_add_u32 v160, 64, v255
v_mul_u32_u24 v161, 1171, v160
mf v[112:115],a[152:155],a[224:227],v[112:115]
ds_read_b128 a[168:171], v128 offset:10240
v_lshrrev_b32 v161, 16, v161
mf v[116:119],a[152:155],a[232:235],v[116:119]
v_and_b32 v163, 2, v161
v_or_b32 v163, s17, v163
mf v[116:119],a[156:159],a[236:239],v[116:119]
v_xor_b32 v160, v255, v163
v_lshlrev_b32 v139, 4, v160
mf v[84:87],a[148:151],a[236:239],v[84:87]
ds_read_b128 a[172:175], v129 offset:10240
v_add_u32 v160, 128, v255
mf v[84:87],a[144:147],a[232:235],v[84:87]
v_mul_u32_u24 v161, 1171, v160
v_lshrrev_b32 v161, 16, v161
mf v[52:55],a[136:139],a[232:235],v[52:55]
v_and_b32 v163, 2, v161
v_or_b32 v163, s17, v163
mf v[52:55],a[140:143],a[236:239],v[52:55]
ds_read_b128 a[176:179], v128 offset:12288
v_xor_b32 v160, v255, v163
mf v[20:23],a[132:135],a[236:239],v[20:23]
v_lshlrev_b32 v140, 4, v160
v_add_u32 v160, 192, v255
mf v[20:23],a[128:131],a[232:235],v[20:23]
v_mul_u32_u24 v161, 1171, v160
s_waitcnt lgkmcnt(5)
mf v[24:27],a[128:131],a[240:243],v[24:27]
ds_read_b128 a[180:183], v129 offset:12288
v_lshrrev_b32 v161, 16, v161
mf v[24:27],a[132:135],a[244:247],v[24:27]
v_and_b32 v163, 2, v161
v_or_b32 v163, s17, v163
mf v[56:59],a[140:143],a[244:247],v[56:59]
v_xor_b32 v160, v255, v163
v_lshlrev_b32 v141, 4, v160
mf v[56:59],a[136:139],a[240:243],v[56:59]
ds_read_b128 a[184:187], v128 offset:14336
v_add_u32 v160, 256, v255
mf v[88:91],a[144:147],a[240:243],v[88:91]
v_mul_u32_u24 v161, 1171, v160
v_lshrrev_b32 v161, 16, v161
mf v[88:91],a[148:151],a[244:247],v[88:91]
v_and_b32 v163, 2, v161
v_or_b32 v163, s17, v163
mf v[120:123],a[156:159],a[244:247],v[120:123]
ds_read_b128 a[188:191], v129 offset:14336
v_xor_b32 v160, v255, v163
mf v[120:123],a[152:155],a[240:243],v[120:123]
v_lshlrev_b32 v143, 4, v160
v_add_u32 v160, 320, v255
mf v[124:127],a[152:155],a[248:251],v[124:127]
v_mul_u32_u24 v161, 1171, v160
v_lshrrev_b32 v161, 16, v161
mf v[124:127],a[156:159],a[252:255],v[124:127]
v_and_b32 v163, 2, v161
v_or_b32 v163, s17, v163
mf v[92:95],a[148:151],a[252:255],v[92:95]
v_xor_b32 v160, v255, v163
v_lshlrev_b32 v144, 4, v160
mf v[92:95],a[144:147],a[248:251],v[92:95]
v_add_u32 v160, 384, v255
v_mul_u32_u24 v161, 1171, v160
v_lshrrev_b32 v161, 16, v161
v_and_b32 v163, 2, v161
v_or_b32 v163, s17, v163
v_xor_b32 v160, v255, v163
v_lshlrev_b32 v145, 4, v160
s_mul_i32 s18, s16, 7168
s_lshr_b32 s17, s16, 1
s_mul_i32 s22, s17, 448
s_mul_i32 s17, s17, 7168
s_add_u32 s21, s21, s17
v_mov_b32 v160, 0x3f803f80
v_mov_b32 v161, 0x3f803f80
v_mov_b32 v162, 0x3f803f80
v_mov_b32 v163, 0x3f803f80
v_add_u32 v164, 160768, v142
ds_write_b128 v164, v[160:163]
v_min_u32 v164, 55, v255
v_lshlrev_b32 v164, 8, v164
v_add_u32 v164, 145472, v164
ds_write_b128 v164, v[160:163]
s_bitcmp1_b32 s16, 0
s_cselect_b32 s26, 0xffefffef, -1
s_mov_b32 s27, s26
mf v[60:63],a[136:139],a[248:251],v[60:63]
mf v[60:63],a[140:143],a[252:255],v[60:63]
mf v[28:31],a[132:135],a[252:255],v[28:31]
mf v[28:31],a[128:131],a[248:251],v[28:31]
s_waitcnt lgkmcnt(0) vmcnt(1)
s_barrier
mf a[0:3],a[160:163],a[192:195],a[0:3]
ds_read_b128 a[128:131], v128 offset:32768
ds_read_b128 a[132:135], v129 offset:32768
mf a[0:3],a[164:167],a[196:199],a[0:3]
s_add_u32 m0, s21, 131072
s_add_u32 s20, s22, 0
mf a[32:35],a[172:175],a[196:199],a[32:35]
mf a[32:35],a[168:171],a[192:195],a[32:35]
s_mov_b64 exec, s[26:27]
buffer_load_dwordx4 v156, s[52:55], s20 offen lds
s_mov_b64 exec, -1
mf a[64:67],a[176:179],a[192:195],a[64:67]
ds_read_b128 a[136:139], v128 offset:34816
ds_read_b128 a[140:143], v129 offset:34816
mf a[64:67],a[180:183],a[196:199],a[64:67]
s_add_u32 m0, s21, 132096
mf a[96:99],a[188:191],a[196:199],a[96:99]
s_add_u32 s20, s22, 64
mf a[96:99],a[184:187],a[192:195],a[96:99]
mf a[100:103],a[184:187],a[200:203],a[100:103]
ds_read_b128 a[144:147], v128 offset:36864
ds_read_b128 a[148:151], v129 offset:36864
mf a[100:103],a[188:191],a[204:207],a[100:103]
s_mov_b64 exec, s[26:27]
buffer_load_dwordx4 v156, s[52:55], s20 offen lds
s_mov_b64 exec, -1
mf a[68:71],a[180:183],a[204:207],a[68:71]
s_add_u32 m0, s21, 133120
mf a[68:71],a[176:179],a[200:203],a[68:71]
s_add_u32 s20, s22, 128
mf a[36:39],a[168:171],a[200:203],a[36:39]
ds_read_b64_tr_b16 a[192:193], v130 offset:32768
ds_read_b64_tr_b16 a[194:195], v130 offset:34816
mf a[36:39],a[172:175],a[204:207],a[36:39]
s_mov_b64 exec, s[26:27]
buffer_load_dwordx4 v156, s[52:55], s20 offen lds
s_mov_b64 exec, -1
mf a[4:7],a[164:167],a[204:207],a[4:7]
mf a[4:7],a[160:163],a[200:203],a[4:7]
s_add_u32 m0, s21, 134144
mf a[8:11],a[160:163],a[208:211],a[8:11]
ds_read_b64_tr_b16 a[196:197], v130 offset:49152
ds_read_b64_tr_b16 a[198:199], v130 offset:51200
mf a[8:11],a[164:167],a[212:215],a[8:11]
s_add_u32 s20, s22, 192
mf a[40:43],a[172:175],a[212:215],a[40:43]
s_mov_b64 exec, s[26:27]
buffer_load_dwordx4 v156, s[52:55], s20 offen lds
s_mov_b64 exec, -1
mf a[40:43],a[168:171],a[208:211],a[40:43]
mf a[72:75],a[176:179],a[208:211],a[72:75]
ds_read_b128 a[152:155], v128 offset:38912
ds_read_b128 a[156:159], v129 offset:38912
mf a[72:75],a[180:183],a[212:215],a[72:75]
s_add_u32 m0, s21, 135168
s_add_u32 s20, s22, 256
mf a[104:107],a[188:191],a[212:215],a[104:107]
mf a[104:107],a[184:187],a[208:211],a[104:107]
s_mov_b64 exec, s[26:27]
buffer_load_dwordx4 v156, s[52:55], s20 offen lds
s_mov_b64 exec, -1
mf a[108:111],a[184:187],a[216:219],a[108:111]
ds_read_b64_tr_b16 a[200:201], v131 offset:32768
ds_read_b64_tr_b16 a[202:203], v131 offset:34816
mf a[108:111],a[188:191],a[220:223],a[108:111]
s_add_u32 m0, s21, 136192
mf a[76:79],a[180:183],a[220:223],a[76:79]
s_add_u32 s20, s22, 320
mf a[76:79],a[176:179],a[216:219],a[76:79]
mf a[44:47],a[168:171],a[216:219],a[44:47]
ds_read_b64_tr_b16 a[204:205], v131 offset:49152
ds_read_b64_tr_b16 a[206:207], v131 offset:51200
mf a[44:47],a[172:175],a[220:223],a[44:47]
s_mov_b64 exec, s[26:27]
buffer_load_dwordx4 v156, s[52:55], s20 offen lds
s_mov_b64 exec, -1
mf a[12:15],a[164:167],a[220:223],a[12:15]
s_add_u32 m0, s21, 137216
mf a[12:15],a[160:163],a[216:219],a[12:15]
s_add_u32 s20, s22, 384
mf a[16:19],a[160:163],a[224:227],a[16:19]
mf a[16:19],a[164:167],a[228:231],a[16:19]
s_mov_b64 exec, s[26:27]
buffer_load_dwordx4 v156, s[52:55], s20 offen lds
s_mov_b64 exec, -1
mf a[48:51],a[172:175],a[228:231],a[48:51]
mf a[48:51],a[168:171],a[224:227],a[48:51]
s_mov_b32 m0, 159744
mf a[80:83],a[176:179],a[224:227],a[80:83]
ds_read_b64_tr_b16 a[208:209], v132 offset:32768
ds_read_b64_tr_b16 a[210:211], v132 offset:34816
mf a[80:83],a[180:183],a[228:231],a[80:83]
s_nop 0
mf a[112:115],a[188:191],a[228:231],a[112:115]
buffer_load_dwordx4 v142, s[64:67], 0 offen lds
mf a[112:115],a[184:187],a[224:227],a[112:115]
mf a[116:119],a[184:187],a[232:235],a[116:119]
ds_read_b64_tr_b16 a[212:213], v132 offset:49152
ds_read_b64_tr_b16 a[214:215], v132 offset:51200
mf a[116:119],a[188:191],a[236:239],a[116:119]
s_add_u32 m0, s18, 0
s_add_u32 s20, s18, 0
mf a[84:87],a[180:183],a[236:239],a[84:87]
mf a[84:87],a[176:179],a[232:235],a[84:87]
buffer_load_dwordx4 v138, s[56:59], s20 offen offset:0 lds
mf a[52:55],a[168:171],a[232:235],a[52:55]
mf a[52:55],a[172:175],a[236:239],a[52:55]
buffer_load_dwordx4 v139, s[56:59], s20 offen offset:1024 lds
mf a[20:23],a[164:167],a[236:239],a[20:23]
buffer_load_dwordx4 v140, s[56:59], s20 offen offset:2048 lds
mf a[20:23],a[160:163],a[232:235],a[20:23]
mf a[24:27],a[160:163],a[240:243],a[24:27]
ds_read_b64_tr_b16 a[216:217], v133 offset:32768
ds_read_b64_tr_b16 a[218:219], v133 offset:34816
mf a[24:27],a[164:167],a[244:247],a[24:27]
buffer_load_dwordx4 v141, s[56:59], s20 offen offset:3072 lds
mf a[56:59],a[172:175],a[244:247],a[56:59]
s_add_u32 m0, s18, 4096
mf a[56:59],a[168:171],a[240:243],a[56:59]
s_add_u32 s20, s18, 4096
mf a[88:91],a[176:179],a[240:243],a[88:91]
ds_read_b64_tr_b16 a[220:221], v133 offset:49152
ds_read_b64_tr_b16 a[222:223], v133 offset:51200
mf a[88:91],a[180:183],a[244:247],a[88:91]
buffer_load_dwordx4 v143, s[56:59], s20 offen offset:0 lds
mf a[120:123],a[188:191],a[244:247],a[120:123]
mf a[120:123],a[184:187],a[240:243],a[120:123]
buffer_load_dwordx4 v144, s[56:59], s20 offen offset:1024 lds
mf a[124:127],a[184:187],a[248:251],a[124:127]
buffer_load_dwordx4 v145, s[56:59], s20 offen offset:2048 lds
mf a[124:127],a[188:191],a[252:255],a[124:127]
mf a[92:95],a[180:183],a[252:255],a[92:95]
buffer_load_dword v254, v157, s[60:63], s23 offen
mf a[92:95],a[176:179],a[248:251],a[92:95]
mf a[60:63],a[168:171],a[248:251],a[60:63]
mf a[60:63],a[172:175],a[252:255],a[60:63]
mf a[28:31],a[164:167],a[252:255],a[28:31]
mf a[28:31],a[160:163],a[248:251],a[28:31]
s_waitcnt lgkmcnt(0)
mf v[0:3],a[128:131],a[192:195],v[0:3]
ds_read_b64_tr_b16 a[224:225], v134 offset:32768
mf v[0:3],a[132:135],a[196:199],v[0:3]
s_add_u32 m0, s18, 65536
mf v[32:35],a[140:143],a[196:199],v[32:35]
ds_read_b64_tr_b16 a[226:227], v134 offset:34816
mf v[32:35],a[136:139],a[192:195],v[32:35]
s_add_u32 s20, s18, 28672
mf v[64:67],a[144:147],a[192:195],v[64:67]
ds_read_b64_tr_b16 a[228:229], v134 offset:49152
mf v[64:67],a[148:151],a[196:199],v[64:67]
buffer_load_dwordx4 v138, s[56:59], s20 offen offset:0 lds
mf v[96:99],a[156:159],a[196:199],v[96:99]
ds_read_b64_tr_b16 a[230:231], v134 offset:51200
mf v[96:99],a[152:155],a[192:195],v[96:99]
buffer_load_dwordx4 v139, s[56:59], s20 offen offset:1024 lds
mf v[100:103],a[152:155],a[200:203],v[100:103]
ds_read_b64_tr_b16 a[232:233], v135 offset:32768
mf v[100:103],a[156:159],a[204:207],v[100:103]
mf v[68:71],a[148:151],a[204:207],v[68:71]
ds_read_b64_tr_b16 a[234:235], v135 offset:34816
buffer_load_dwordx4 v140, s[56:59], s20 offen offset:2048 lds
mf v[68:71],a[144:147],a[200:203],v[68:71]
mf v[36:39],a[136:139],a[200:203],v[36:39]
ds_read_b64_tr_b16 a[236:237], v135 offset:49152
buffer_load_dwordx4 v141, s[56:59], s20 offen offset:3072 lds
mf v[36:39],a[140:143],a[204:207],v[36:39]
mf v[4:7],a[132:135],a[204:207],v[4:7]
ds_read_b64_tr_b16 a[238:239], v135 offset:51200
s_add_u32 m0, s18, 69632
mf v[4:7],a[128:131],a[200:203],v[4:7]
mf v[8:11],a[128:131],a[208:211],v[8:11]
ds_read_b64_tr_b16 a[240:241], v136 offset:32768
s_add_u32 s20, s18, 32768
mf v[8:11],a[132:135],a[212:215],v[8:11]
mf v[40:43],a[140:143],a[212:215],v[40:43]
ds_read_b64_tr_b16 a[242:243], v136 offset:34816
mf v[40:43],a[136:139],a[208:211],v[40:43]
buffer_load_dwordx4 v143, s[56:59], s20 offen offset:0 lds
mf v[72:75],a[144:147],a[208:211],v[72:75]
ds_read_b64_tr_b16 a[244:245], v136 offset:49152
mf v[72:75],a[148:151],a[212:215],v[72:75]
buffer_load_dwordx4 v144, s[56:59], s20 offen offset:1024 lds
mf v[104:107],a[156:159],a[212:215],v[104:107]
ds_read_b64_tr_b16 a[246:247], v136 offset:51200
mf v[104:107],a[152:155],a[208:211],v[104:107]
buffer_load_dwordx4 v145, s[56:59], s20 offen offset:2048 lds
mf v[108:111],a[152:155],a[216:219],v[108:111]
ds_read_b64_tr_b16 a[248:249], v137 offset:32768
mf v[108:111],a[156:159],a[220:223],v[108:111]
v_and_b32 v252, 3, v255
mf v[76:79],a[148:151],a[220:223],v[76:79]
ds_read_b64_tr_b16 a[250:251], v137 offset:34816
mf v[76:79],a[144:147],a[216:219],v[76:79]
mf v[44:47],a[136:139],a[216:219],v[44:47]
ds_read_b64_tr_b16 a[252:253], v137 offset:49152
v_and_b32 v158, 12, v255
mf v[44:47],a[140:143],a[220:223],v[44:47]
mf v[12:15],a[132:135],a[220:223],v[12:15]
ds_read_b64_tr_b16 a[254:255], v137 offset:51200
v_xor_b32 v158, 8, v158
mf v[12:15],a[128:131],a[216:219],v[12:15]
s_waitcnt lgkmcnt(8)
mf v[16:19],a[128:131],a[224:227],v[16:19]
v_lshl_add_u32 v252, v158, 1, v252
mf v[16:19],a[132:135],a[228:231],v[16:19]
ds_read_b128 a[160:163], v128 offset:40960
mf v[48:51],a[140:143],a[228:231],v[48:51]
mf v[48:51],a[136:139],a[224:227],v[48:51]
s_and_b32 s17, s15, 1
mf v[80:83],a[144:147],a[224:227],v[80:83]
ds_read_b128 a[164:167], v129 offset:40960
mf v[80:83],a[148:151],a[228:231],v[80:83]
s_lshl_b32 s17, s17, 5
mf v[112:115],a[156:159],a[228:231],v[112:115]
mf v[112:115],a[152:155],a[224:227],v[112:115]
ds_read_b128 a[168:171], v128 offset:43008
s_add_u32 s17, s17, s12
mf v[116:119],a[152:155],a[232:235],v[116:119]
mf v[116:119],a[156:159],a[236:239],v[116:119]
v_lshl_add_u32 v252, v252, 3, s17
mf v[84:87],a[148:151],a[236:239],v[84:87]
ds_read_b128 a[172:175], v129 offset:43008
mf v[84:87],a[144:147],a[232:235],v[84:87]
mf v[52:55],a[136:139],a[232:235],v[52:55]
v_bfe_u32 v253, v255, 3, 1
mf v[52:55],a[140:143],a[236:239],v[52:55]
ds_read_b128 a[176:179], v128 offset:45056
mf v[20:23],a[132:135],a[236:239],v[20:23]
v_add_u32 v253, 1, v253
mf v[20:23],a[128:131],a[232:235],v[20:23]
s_waitcnt lgkmcnt(5)
mf v[24:27],a[128:131],a[240:243],v[24:27]
ds_read_b128 a[180:183], v129 offset:45056
s_and_b32 s17, s2, 127
mf v[24:27],a[132:135],a[244:247],v[24:27]
mf v[56:59],a[140:143],a[244:247],v[56:59]
v_writelane_b32 v252, s17, 16
mf v[56:59],a[136:139],a[240:243],v[56:59]
ds_read_b128 a[184:187], v128 offset:47104
mf v[88:91],a[144:147],a[240:243],v[88:91]
mf v[88:91],a[148:151],a[244:247],v[88:91]
v_writelane_b32 v253, 2, 16
mf v[120:123],a[156:159],a[244:247],v[120:123]
ds_read_b128 a[188:191], v129 offset:47104
mf v[120:123],a[152:155],a[240:243],v[120:123]
v_lshlrev_b32 v252, 7, v252
mf v[124:127],a[152:155],a[248:251],v[124:127]
mf v[124:127],a[156:159],a[252:255],v[124:127]
v_add_u32 v252, 105906176, v252
mf v[92:95],a[148:151],a[252:255],v[92:95]
mf v[92:95],a[144:147],a[248:251],v[92:95]
mf v[60:63],a[136:139],a[248:251],v[60:63]
mf v[60:63],a[140:143],a[252:255],v[60:63]
mf v[28:31],a[132:135],a[252:255],v[28:31]
mf v[28:31],a[128:131],a[248:251],v[28:31]
s_waitcnt lgkmcnt(0)
s_barrier
mf a[0:3],a[160:163],a[192:195],a[0:3]
s_add_u32 m0, s18, 32768
s_add_u32 s20, s18, 57344
buffer_load_dwordx4 v138, s[56:59], s20 offen offset:0 lds
buffer_load_dwordx4 v139, s[56:59], s20 offen offset:1024 lds
mf a[0:3],a[164:167],a[196:199],a[0:3]
buffer_load_dwordx4 v140, s[56:59], s20 offen offset:2048 lds
buffer_load_dwordx4 v141, s[56:59], s20 offen offset:3072 lds
s_add_u32 m0, s18, 36864
s_add_u32 s20, s18, 61440
mf a[32:35],a[172:175],a[196:199],a[32:35]
buffer_load_dwordx4 v143, s[56:59], s20 offen offset:0 lds
buffer_load_dwordx4 v144, s[56:59], s20 offen offset:1024 lds
buffer_load_dwordx4 v145, s[56:59], s20 offen offset:2048 lds
s_add_u32 m0, s18, 98304
mf a[32:35],a[168:171],a[192:195],a[32:35]
s_add_u32 s20, s18, 86016
buffer_load_dwordx4 v138, s[56:59], s20 offen offset:0 lds
buffer_load_dwordx4 v139, s[56:59], s20 offen offset:1024 lds
buffer_load_dwordx4 v140, s[56:59], s20 offen offset:2048 lds
mf a[64:67],a[176:179],a[192:195],a[64:67]
buffer_load_dwordx4 v141, s[56:59], s20 offen offset:3072 lds
s_add_u32 m0, s18, 102400
s_add_u32 s20, s18, 90112
buffer_load_dwordx4 v143, s[56:59], s20 offen offset:0 lds
mf a[64:67],a[180:183],a[196:199],a[64:67]
buffer_load_dwordx4 v144, s[56:59], s20 offen offset:1024 lds
buffer_load_dwordx4 v145, s[56:59], s20 offen offset:2048 lds
v_cvt_pk_bf16_f32 v0, v0, v1
v_cvt_pk_bf16_f32 v1, v2, v3
mf a[96:99],a[188:191],a[196:199],a[96:99]
v_cvt_pk_bf16_f32 v2, v32, v33
v_cvt_pk_bf16_f32 v3, v34, v35
s_add_u32 s36, s39, 0
buffer_store_dwordx4 v[0:3], v142, s[28:31], s36 offen offset:0 sc1
mf a[96:99],a[184:187],a[192:195],a[96:99]
v_cvt_pk_bf16_f32 v4, v4, v5
v_cvt_pk_bf16_f32 v5, v6, v7
v_cvt_pk_bf16_f32 v6, v36, v37
v_cvt_pk_bf16_f32 v7, v38, v39
mf a[100:103],a[184:187],a[200:203],a[100:103]
s_add_u32 s36, s39, 0
buffer_store_dwordx4 v[4:7], v142, s[28:31], s36 offen offset:1024 sc1
v_cvt_pk_bf16_f32 v8, v8, v9
v_cvt_pk_bf16_f32 v9, v10, v11
mf a[100:103],a[188:191],a[204:207],a[100:103]
v_cvt_pk_bf16_f32 v10, v40, v41
v_cvt_pk_bf16_f32 v11, v42, v43
s_add_u32 s36, s39, 0
buffer_store_dwordx4 v[8:11], v142, s[28:31], s36 offen offset:2048 sc1
mf a[68:71],a[180:183],a[204:207],a[68:71]
v_cvt_pk_bf16_f32 v12, v12, v13
v_cvt_pk_bf16_f32 v13, v14, v15
v_cvt_pk_bf16_f32 v14, v44, v45
v_cvt_pk_bf16_f32 v15, v46, v47
mf a[68:71],a[176:179],a[200:203],a[68:71]
s_add_u32 s36, s39, 0
buffer_store_dwordx4 v[12:15], v142, s[28:31], s36 offen offset:3072 sc1
v_cvt_pk_bf16_f32 v16, v16, v17
v_cvt_pk_bf16_f32 v17, v18, v19
mf a[36:39],a[168:171],a[200:203],a[36:39]
v_cvt_pk_bf16_f32 v18, v48, v49
v_cvt_pk_bf16_f32 v19, v50, v51
s_add_u32 s36, s19, 0
buffer_store_dwordx4 v[16:19], v142, s[28:31], s36 offen offset:0 sc1
mf a[36:39],a[172:175],a[204:207],a[36:39]
v_cvt_pk_bf16_f32 v20, v20, v21
v_cvt_pk_bf16_f32 v21, v22, v23
v_cvt_pk_bf16_f32 v22, v52, v53
v_cvt_pk_bf16_f32 v23, v54, v55
mf a[4:7],a[164:167],a[204:207],a[4:7]
s_add_u32 s36, s19, 0
buffer_store_dwordx4 v[20:23], v142, s[28:31], s36 offen offset:1024 sc1
v_cvt_pk_bf16_f32 v24, v24, v25
v_cvt_pk_bf16_f32 v25, v26, v27
mf a[4:7],a[160:163],a[200:203],a[4:7]
v_cvt_pk_bf16_f32 v26, v56, v57
v_cvt_pk_bf16_f32 v27, v58, v59
s_add_u32 s36, s19, 0
buffer_store_dwordx4 v[24:27], v142, s[28:31], s36 offen offset:2048 sc1
mf a[8:11],a[160:163],a[208:211],a[8:11]
v_cvt_pk_bf16_f32 v28, v28, v29
v_cvt_pk_bf16_f32 v29, v30, v31
v_cvt_pk_bf16_f32 v30, v60, v61
v_cvt_pk_bf16_f32 v31, v62, v63
mf a[8:11],a[164:167],a[212:215],a[8:11]
s_add_u32 s36, s19, 0
buffer_store_dwordx4 v[28:31], v142, s[28:31], s36 offen offset:3072 sc1
v_cvt_pk_bf16_f32 v32, v64, v65
v_cvt_pk_bf16_f32 v33, v66, v67
mf a[40:43],a[172:175],a[212:215],a[40:43]
v_cvt_pk_bf16_f32 v34, v96, v97
v_cvt_pk_bf16_f32 v35, v98, v99
s_add_u32 s36, s39, 16384
buffer_store_dwordx4 v[32:35], v142, s[28:31], s36 offen offset:0 sc1
mf a[40:43],a[168:171],a[208:211],a[40:43]
v_cvt_pk_bf16_f32 v36, v68, v69
v_cvt_pk_bf16_f32 v37, v70, v71
v_cvt_pk_bf16_f32 v38, v100, v101
v_cvt_pk_bf16_f32 v39, v102, v103
mf a[72:75],a[176:179],a[208:211],a[72:75]
s_add_u32 s36, s39, 16384
buffer_store_dwordx4 v[36:39], v142, s[28:31], s36 offen offset:1024 sc1
v_cvt_pk_bf16_f32 v40, v72, v73
v_cvt_pk_bf16_f32 v41, v74, v75
mf a[72:75],a[180:183],a[212:215],a[72:75]
v_cvt_pk_bf16_f32 v42, v104, v105
v_cvt_pk_bf16_f32 v43, v106, v107
s_add_u32 s36, s39, 16384
buffer_store_dwordx4 v[40:43], v142, s[28:31], s36 offen offset:2048 sc1
mf a[104:107],a[188:191],a[212:215],a[104:107]
v_cvt_pk_bf16_f32 v44, v76, v77
v_cvt_pk_bf16_f32 v45, v78, v79
v_cvt_pk_bf16_f32 v46, v108, v109
v_cvt_pk_bf16_f32 v47, v110, v111
mf a[104:107],a[184:187],a[208:211],a[104:107]
s_add_u32 s36, s39, 16384
buffer_store_dwordx4 v[44:47], v142, s[28:31], s36 offen offset:3072 sc1
v_cvt_pk_bf16_f32 v48, v80, v81
v_cvt_pk_bf16_f32 v49, v82, v83
mf a[108:111],a[184:187],a[216:219],a[108:111]
v_cvt_pk_bf16_f32 v50, v112, v113
v_cvt_pk_bf16_f32 v51, v114, v115
s_add_u32 s36, s19, 16384
buffer_store_dwordx4 v[48:51], v142, s[28:31], s36 offen offset:0 sc1
mf a[108:111],a[188:191],a[220:223],a[108:111]
v_cvt_pk_bf16_f32 v52, v84, v85
v_cvt_pk_bf16_f32 v53, v86, v87
v_cvt_pk_bf16_f32 v54, v116, v117
v_cvt_pk_bf16_f32 v55, v118, v119
mf a[76:79],a[180:183],a[220:223],a[76:79]
s_add_u32 s36, s19, 16384
buffer_store_dwordx4 v[52:55], v142, s[28:31], s36 offen offset:1024 sc1
v_cvt_pk_bf16_f32 v56, v88, v89
v_cvt_pk_bf16_f32 v57, v90, v91
mf a[76:79],a[176:179],a[216:219],a[76:79]
v_cvt_pk_bf16_f32 v58, v120, v121
v_cvt_pk_bf16_f32 v59, v122, v123
s_add_u32 s36, s19, 16384
buffer_store_dwordx4 v[56:59], v142, s[28:31], s36 offen offset:2048 sc1
mf a[44:47],a[168:171],a[216:219],a[44:47]
v_cvt_pk_bf16_f32 v60, v92, v93
v_cvt_pk_bf16_f32 v61, v94, v95
v_cvt_pk_bf16_f32 v62, v124, v125
v_cvt_pk_bf16_f32 v63, v126, v127
mf a[44:47],a[172:175],a[220:223],a[44:47]
s_add_u32 s36, s19, 16384
buffer_store_dwordx4 v[60:63], v142, s[28:31], s36 offen offset:3072 sc1
v_accvgpr_read_b32 v148, a0
v_accvgpr_read_b32 v149, a1
mf a[12:15],a[164:167],a[220:223],a[12:15]
v_accvgpr_read_b32 v150, a2
v_accvgpr_read_b32 v151, a3
v_accvgpr_read_b32 v152, a32
v_accvgpr_read_b32 v153, a33
mf a[12:15],a[160:163],a[216:219],a[12:15]
v_accvgpr_read_b32 v154, a34
v_accvgpr_read_b32 v155, a35
v_cvt_pk_bf16_f32 v64, v148, v149
v_cvt_pk_bf16_f32 v65, v150, v151
mf a[16:19],a[160:163],a[224:227],a[16:19]
v_cvt_pk_bf16_f32 v66, v152, v153
v_cvt_pk_bf16_f32 v67, v154, v155
s_add_u32 s36, s39, 32768
buffer_store_dwordx4 v[64:67], v142, s[28:31], s36 offen offset:0 sc1
mf a[16:19],a[164:167],a[228:231],a[16:19]
v_accvgpr_read_b32 v148, a64
v_accvgpr_read_b32 v149, a65
v_accvgpr_read_b32 v150, a66
v_accvgpr_read_b32 v151, a67
mf a[48:51],a[172:175],a[228:231],a[48:51]
v_accvgpr_read_b32 v152, a96
v_accvgpr_read_b32 v153, a97
v_accvgpr_read_b32 v154, a98
v_accvgpr_read_b32 v155, a99
mf a[48:51],a[168:171],a[224:227],a[48:51]
v_cvt_pk_bf16_f32 v96, v148, v149
v_cvt_pk_bf16_f32 v97, v150, v151
v_cvt_pk_bf16_f32 v98, v152, v153
v_cvt_pk_bf16_f32 v99, v154, v155
mf a[80:83],a[176:179],a[224:227],a[80:83]
s_add_u32 s36, s39, 49152
buffer_store_dwordx4 v[96:99], v142, s[28:31], s36 offen offset:0 sc1
v_accvgpr_read_b32 v148, a68
v_accvgpr_read_b32 v149, a69
mf a[80:83],a[180:183],a[228:231],a[80:83]
v_accvgpr_read_b32 v150, a70
v_accvgpr_read_b32 v151, a71
v_accvgpr_read_b32 v152, a100
v_accvgpr_read_b32 v153, a101
mf a[112:115],a[188:191],a[228:231],a[112:115]
v_accvgpr_read_b32 v154, a102
v_accvgpr_read_b32 v155, a103
v_cvt_pk_bf16_f32 v100, v148, v149
v_cvt_pk_bf16_f32 v101, v150, v151
mf a[112:115],a[184:187],a[224:227],a[112:115]
v_cvt_pk_bf16_f32 v102, v152, v153
v_cvt_pk_bf16_f32 v103, v154, v155
s_add_u32 s36, s39, 49152
buffer_store_dwordx4 v[100:103], v142, s[28:31], s36 offen offset:1024 sc1
mf a[116:119],a[184:187],a[232:235],a[116:119]
v_accvgpr_read_b32 v148, a4
v_accvgpr_read_b32 v149, a5
v_accvgpr_read_b32 v150, a6
v_accvgpr_read_b32 v151, a7
mf a[116:119],a[188:191],a[236:239],a[116:119]
v_accvgpr_read_b32 v152, a36
v_accvgpr_read_b32 v153, a37
v_accvgpr_read_b32 v154, a38
v_accvgpr_read_b32 v155, a39
mf a[84:87],a[180:183],a[236:239],a[84:87]
v_cvt_pk_bf16_f32 v68, v148, v149
v_cvt_pk_bf16_f32 v69, v150, v151
v_cvt_pk_bf16_f32 v70, v152, v153
v_cvt_pk_bf16_f32 v71, v154, v155
mf a[84:87],a[176:179],a[232:235],a[84:87]
s_add_u32 s36, s39, 32768
buffer_store_dwordx4 v[68:71], v142, s[28:31], s36 offen offset:1024 sc1
v_accvgpr_read_b32 v148, a8
v_accvgpr_read_b32 v149, a9
mf a[52:55],a[168:171],a[232:235],a[52:55]
v_accvgpr_read_b32 v150, a10
v_accvgpr_read_b32 v151, a11
v_accvgpr_read_b32 v152, a40
v_accvgpr_read_b32 v153, a41
mf a[52:55],a[172:175],a[236:239],a[52:55]
v_accvgpr_read_b32 v154, a42
v_accvgpr_read_b32 v155, a43
v_cvt_pk_bf16_f32 v72, v148, v149
v_cvt_pk_bf16_f32 v73, v150, v151
mf a[20:23],a[164:167],a[236:239],a[20:23]
v_cvt_pk_bf16_f32 v74, v152, v153
v_cvt_pk_bf16_f32 v75, v154, v155
s_add_u32 s36, s39, 32768
buffer_store_dwordx4 v[72:75], v142, s[28:31], s36 offen offset:2048 sc1
mf a[20:23],a[160:163],a[232:235],a[20:23]
v_accvgpr_read_b32 v148, a72
v_accvgpr_read_b32 v149, a73
v_accvgpr_read_b32 v150, a74
v_accvgpr_read_b32 v151, a75
mf a[24:27],a[160:163],a[240:243],a[24:27]
v_accvgpr_read_b32 v152, a104
v_accvgpr_read_b32 v153, a105
v_accvgpr_read_b32 v154, a106
v_accvgpr_read_b32 v155, a107
mf a[24:27],a[164:167],a[244:247],a[24:27]
v_cvt_pk_bf16_f32 v104, v148, v149
v_cvt_pk_bf16_f32 v105, v150, v151
v_cvt_pk_bf16_f32 v106, v152, v153
v_cvt_pk_bf16_f32 v107, v154, v155
mf a[56:59],a[172:175],a[244:247],a[56:59]
s_add_u32 s36, s39, 49152
buffer_store_dwordx4 v[104:107], v142, s[28:31], s36 offen offset:2048 sc1
v_accvgpr_read_b32 v148, a76
v_accvgpr_read_b32 v149, a77
mf a[56:59],a[168:171],a[240:243],a[56:59]
v_accvgpr_read_b32 v150, a78
v_accvgpr_read_b32 v151, a79
v_accvgpr_read_b32 v152, a108
v_accvgpr_read_b32 v153, a109
mf a[88:91],a[176:179],a[240:243],a[88:91]
v_accvgpr_read_b32 v154, a110
v_accvgpr_read_b32 v155, a111
v_cvt_pk_bf16_f32 v108, v148, v149
v_cvt_pk_bf16_f32 v109, v150, v151
mf a[88:91],a[180:183],a[244:247],a[88:91]
v_cvt_pk_bf16_f32 v110, v152, v153
v_cvt_pk_bf16_f32 v111, v154, v155
s_add_u32 s36, s39, 49152
buffer_store_dwordx4 v[108:111], v142, s[28:31], s36 offen offset:3072 sc1
mf a[120:123],a[188:191],a[244:247],a[120:123]
v_accvgpr_read_b32 v148, a12
v_accvgpr_read_b32 v149, a13
v_accvgpr_read_b32 v150, a14
v_accvgpr_read_b32 v151, a15
mf a[120:123],a[184:187],a[240:243],a[120:123]
v_accvgpr_read_b32 v152, a44
v_accvgpr_read_b32 v153, a45
v_accvgpr_read_b32 v154, a46
v_accvgpr_read_b32 v155, a47
mf a[124:127],a[184:187],a[248:251],a[124:127]
v_cvt_pk_bf16_f32 v76, v148, v149
v_cvt_pk_bf16_f32 v77, v150, v151
v_cvt_pk_bf16_f32 v78, v152, v153
v_cvt_pk_bf16_f32 v79, v154, v155
mf a[124:127],a[188:191],a[252:255],a[124:127]
s_add_u32 s36, s39, 32768
buffer_store_dwordx4 v[76:79], v142, s[28:31], s36 offen offset:3072 sc1
mf a[92:95],a[180:183],a[252:255],a[92:95]
mf a[92:95],a[176:179],a[248:251],a[92:95]
mf a[60:63],a[168:171],a[248:251],a[60:63]
mf a[60:63],a[172:175],a[252:255],a[60:63]
mf a[28:31],a[164:167],a[252:255],a[28:31]
mf a[28:31],a[160:163],a[248:251],a[28:31]
s_nop 3
v_accvgpr_read_b32 v148, a16
v_accvgpr_read_b32 v149, a17
v_accvgpr_read_b32 v150, a18
v_accvgpr_read_b32 v151, a19
v_accvgpr_read_b32 v152, a48
v_accvgpr_read_b32 v153, a49
v_accvgpr_read_b32 v154, a50
v_accvgpr_read_b32 v155, a51
v_cvt_pk_bf16_f32 v80, v148, v149
v_cvt_pk_bf16_f32 v81, v150, v151
v_cvt_pk_bf16_f32 v82, v152, v153
v_cvt_pk_bf16_f32 v83, v154, v155
s_add_u32 s36, s19, 32768
buffer_store_dwordx4 v[80:83], v142, s[28:31], s36 offen offset:0 sc1
v_accvgpr_read_b32 v148, a80
v_accvgpr_read_b32 v149, a81
v_accvgpr_read_b32 v150, a82
v_accvgpr_read_b32 v151, a83
v_accvgpr_read_b32 v152, a112
v_accvgpr_read_b32 v153, a113
v_accvgpr_read_b32 v154, a114
v_accvgpr_read_b32 v155, a115
v_cvt_pk_bf16_f32 v112, v148, v149
v_cvt_pk_bf16_f32 v113, v150, v151
v_cvt_pk_bf16_f32 v114, v152, v153
v_cvt_pk_bf16_f32 v115, v154, v155
s_add_u32 s36, s19, 49152
buffer_store_dwordx4 v[112:115], v142, s[28:31], s36 offen offset:0 sc1
v_accvgpr_read_b32 v148, a84
v_accvgpr_read_b32 v149, a85
v_accvgpr_read_b32 v150, a86
v_accvgpr_read_b32 v151, a87
v_accvgpr_read_b32 v152, a116
v_accvgpr_read_b32 v153, a117
v_accvgpr_read_b32 v154, a118
v_accvgpr_read_b32 v155, a119
v_cvt_pk_bf16_f32 v116, v148, v149
v_cvt_pk_bf16_f32 v117, v150, v151
v_cvt_pk_bf16_f32 v118, v152, v153
v_cvt_pk_bf16_f32 v119, v154, v155
s_add_u32 s36, s19, 49152
buffer_store_dwordx4 v[116:119], v142, s[28:31], s36 offen offset:1024 sc1
v_accvgpr_read_b32 v148, a20
v_accvgpr_read_b32 v149, a21
v_accvgpr_read_b32 v150, a22
v_accvgpr_read_b32 v151, a23
v_accvgpr_read_b32 v152, a52
v_accvgpr_read_b32 v153, a53
v_accvgpr_read_b32 v154, a54
v_accvgpr_read_b32 v155, a55
v_cvt_pk_bf16_f32 v84, v148, v149
v_cvt_pk_bf16_f32 v85, v150, v151
v_cvt_pk_bf16_f32 v86, v152, v153
v_cvt_pk_bf16_f32 v87, v154, v155
s_add_u32 s36, s19, 32768
buffer_store_dwordx4 v[84:87], v142, s[28:31], s36 offen offset:1024 sc1
v_accvgpr_read_b32 v148, a24
v_accvgpr_read_b32 v149, a25
v_accvgpr_read_b32 v150, a26
v_accvgpr_read_b32 v151, a27
v_accvgpr_read_b32 v152, a56
v_accvgpr_read_b32 v153, a57
v_accvgpr_read_b32 v154, a58
v_accvgpr_read_b32 v155, a59
v_cvt_pk_bf16_f32 v88, v148, v149
v_cvt_pk_bf16_f32 v89, v150, v151
v_cvt_pk_bf16_f32 v90, v152, v153
v_cvt_pk_bf16_f32 v91, v154, v155
s_add_u32 s36, s19, 32768
buffer_store_dwordx4 v[88:91], v142, s[28:31], s36 offen offset:2048 sc1
v_accvgpr_read_b32 v148, a88
v_accvgpr_read_b32 v149, a89
v_accvgpr_read_b32 v150, a90
v_accvgpr_read_b32 v151, a91
v_accvgpr_read_b32 v152, a120
v_accvgpr_read_b32 v153, a121
v_accvgpr_read_b32 v154, a122
v_accvgpr_read_b32 v155, a123
v_cvt_pk_bf16_f32 v120, v148, v149
v_cvt_pk_bf16_f32 v121, v150, v151
v_cvt_pk_bf16_f32 v122, v152, v153
v_cvt_pk_bf16_f32 v123, v154, v155
s_add_u32 s36, s19, 49152
buffer_store_dwordx4 v[120:123], v142, s[28:31], s36 offen offset:2048 sc1
v_accvgpr_read_b32 v148, a92
v_accvgpr_read_b32 v149, a93
v_accvgpr_read_b32 v150, a94
v_accvgpr_read_b32 v151, a95
v_accvgpr_read_b32 v152, a124
v_accvgpr_read_b32 v153, a125
v_accvgpr_read_b32 v154, a126
v_accvgpr_read_b32 v155, a127
v_cvt_pk_bf16_f32 v124, v148, v149
v_cvt_pk_bf16_f32 v125, v150, v151
v_cvt_pk_bf16_f32 v126, v152, v153
v_cvt_pk_bf16_f32 v127, v154, v155
s_add_u32 s36, s19, 49152
buffer_store_dwordx4 v[124:127], v142, s[28:31], s36 offen offset:3072 sc1
v_accvgpr_read_b32 v148, a28
v_accvgpr_read_b32 v149, a29
v_accvgpr_read_b32 v150, a30
v_accvgpr_read_b32 v151, a31
v_accvgpr_read_b32 v152, a60
v_accvgpr_read_b32 v153, a61
v_accvgpr_read_b32 v154, a62
v_accvgpr_read_b32 v155, a63
v_cvt_pk_bf16_f32 v92, v148, v149
v_cvt_pk_bf16_f32 v93, v150, v151
v_cvt_pk_bf16_f32 v94, v152, v153
v_cvt_pk_bf16_f32 v95, v154, v155
s_add_u32 s36, s19, 32768
buffer_store_dwordx4 v[92:95], v142, s[28:31], s36 offen offset:3072 sc1
s_branch b12_10
qrest_9:
s_waitcnt lgkmcnt(0)
mf v[0:3],a[192:195],a[128:131],v[0:3]
ds_read_b64_tr_b16 a[224:225], v134 offset:32768
mf v[0:3],a[196:199],a[132:135],v[0:3]
mf v[32:35],a[196:199],a[140:143],v[32:35]
ds_read_b64_tr_b16 a[226:227], v134 offset:34816
mf v[32:35],a[192:195],a[136:139],v[32:35]
mf v[64:67],a[192:195],a[144:147],v[64:67]
ds_read_b64_tr_b16 a[228:229], v134 offset:49152
mf v[64:67],a[196:199],a[148:151],v[64:67]
mf v[96:99],a[196:199],a[156:159],v[96:99]
ds_read_b64_tr_b16 a[230:231], v134 offset:51200
mf v[96:99],a[192:195],a[152:155],v[96:99]
mf v[100:103],a[200:203],a[152:155],v[100:103]
ds_read_b64_tr_b16 a[232:233], v135 offset:32768
mf v[100:103],a[204:207],a[156:159],v[100:103]
mf v[68:71],a[204:207],a[148:151],v[68:71]
ds_read_b64_tr_b16 a[234:235], v135 offset:34816
mf v[68:71],a[200:203],a[144:147],v[68:71]
mf v[36:39],a[200:203],a[136:139],v[36:39]
ds_read_b64_tr_b16 a[236:237], v135 offset:49152
mf v[36:39],a[204:207],a[140:143],v[36:39]
mf v[4:7],a[204:207],a[132:135],v[4:7]
ds_read_b64_tr_b16 a[238:239], v135 offset:51200
mf v[4:7],a[200:203],a[128:131],v[4:7]
mf v[8:11],a[208:211],a[128:131],v[8:11]
ds_read_b64_tr_b16 a[240:241], v136 offset:32768
mf v[8:11],a[212:215],a[132:135],v[8:11]
mf v[40:43],a[212:215],a[140:143],v[40:43]
ds_read_b64_tr_b16 a[242:243], v136 offset:34816
mf v[40:43],a[208:211],a[136:139],v[40:43]
mf v[72:75],a[208:211],a[144:147],v[72:75]
ds_read_b64_tr_b16 a[244:245], v136 offset:49152
mf v[72:75],a[212:215],a[148:151],v[72:75]
mf v[104:107],a[212:215],a[156:159],v[104:107]
ds_read_b64_tr_b16 a[246:247], v136 offset:51200
mf v[104:107],a[208:211],a[152:155],v[104:107]
mf v[108:111],a[216:219],a[152:155],v[108:111]
ds_read_b64_tr_b16 a[248:249], v137 offset:32768
mf v[108:111],a[220:223],a[156:159],v[108:111]
mf v[76:79],a[220:223],a[148:151],v[76:79]
ds_read_b64_tr_b16 a[250:251], v137 offset:34816
mf v[76:79],a[216:219],a[144:147],v[76:79]
mf v[44:47],a[216:219],a[136:139],v[44:47]
ds_read_b64_tr_b16 a[252:253], v137 offset:49152
mf v[44:47],a[220:223],a[140:143],v[44:47]
mf v[12:15],a[220:223],a[132:135],v[12:15]
ds_read_b64_tr_b16 a[254:255], v137 offset:51200
mf v[12:15],a[216:219],a[128:131],v[12:15]
s_waitcnt lgkmcnt(8)
mf v[16:19],a[224:227],a[128:131],v[16:19]
mf v[16:19],a[228:231],a[132:135],v[16:19]
ds_read_b128 a[160:163], v128 offset:40960
mf v[48:51],a[228:231],a[140:143],v[48:51]
mf v[48:51],a[224:227],a[136:139],v[48:51]
mf v[80:83],a[224:227],a[144:147],v[80:83]
ds_read_b128 a[164:167], v129 offset:40960
mf v[80:83],a[228:231],a[148:151],v[80:83]
mf v[112:115],a[228:231],a[156:159],v[112:115]
mf v[112:115],a[224:227],a[152:155],v[112:115]
ds_read_b128 a[168:171], v128 offset:43008
mf v[116:119],a[232:235],a[152:155],v[116:119]
mf v[116:119],a[236:239],a[156:159],v[116:119]
mf v[84:87],a[236:239],a[148:151],v[84:87]
ds_read_b128 a[172:175], v129 offset:43008
mf v[84:87],a[232:235],a[144:147],v[84:87]
mf v[52:55],a[232:235],a[136:139],v[52:55]
mf v[52:55],a[236:239],a[140:143],v[52:55]
ds_read_b128 a[176:179], v128 offset:45056
mf v[20:23],a[236:239],a[132:135],v[20:23]
mf v[20:23],a[232:235],a[128:131],v[20:23]
s_waitcnt lgkmcnt(5)
mf v[24:27],a[240:243],a[128:131],v[24:27]
ds_read_b128 a[180:183], v129 offset:45056
mf v[24:27],a[244:247],a[132:135],v[24:27]
mf v[56:59],a[244:247],a[140:143],v[56:59]
mf v[56:59],a[240:243],a[136:139],v[56:59]
ds_read_b128 a[184:187], v128 offset:47104
mf v[88:91],a[240:243],a[144:147],v[88:91]
mf v[88:91],a[244:247],a[148:151],v[88:91]
mf v[120:123],a[244:247],a[156:159],v[120:123]
ds_read_b128 a[188:191], v129 offset:47104
mf v[120:123],a[240:243],a[152:155],v[120:123]
mf v[124:127],a[248:251],a[152:155],v[124:127]
mf v[124:127],a[252:255],a[156:159],v[124:127]
mf v[92:95],a[252:255],a[148:151],v[92:95]
mf v[92:95],a[248:251],a[144:147],v[92:95]
mf v[60:63],a[248:251],a[136:139],v[60:63]
mf v[60:63],a[252:255],a[140:143],v[60:63]
mf v[28:31],a[252:255],a[132:135],v[28:31]
mf v[28:31],a[248:251],a[128:131],v[28:31]
s_waitcnt lgkmcnt(0) vmcnt(0)
s_barrier
mf a[0:3],a[192:195],a[160:163],a[0:3]
ds_read_b128 a[128:131], v128 offset:0
ds_read_b128 a[132:135], v129 offset:0
mf a[0:3],a[196:199],a[164:167],a[0:3]
s_add_u32 m0, s34, 32768
mf a[32:35],a[196:199],a[172:175],a[32:35]
s_add_u32 s36, s52, 0
mf a[32:35],a[192:195],a[168:171],a[32:35]
buffer_load_dwordx4 v140, s[44:47], s36 offen lds
mf a[64:67],a[192:195],a[176:179],a[64:67]
ds_read_b128 a[136:139], v128 offset:2048
ds_read_b128 a[140:143], v129 offset:2048
mf a[64:67],a[196:199],a[180:183],a[64:67]
s_add_u32 m0, s35, 32768
mf a[96:99],a[196:199],a[188:191],a[96:99]
s_add_u32 s37, s53, 0
mf a[96:99],a[192:195],a[184:187],a[96:99]
buffer_load_dwordx4 v141, s[48:51], s37 offen lds
mf a[100:103],a[200:203],a[184:187],a[100:103]
ds_read_b128 a[144:147], v128 offset:4096
ds_read_b128 a[148:151], v129 offset:4096
mf a[100:103],a[204:207],a[188:191],a[100:103]
s_add_u32 m0, s34, 36864
mf a[68:71],a[204:207],a[180:183],a[68:71]
s_add_u32 s36, s52, 28672
mf a[68:71],a[200:203],a[176:179],a[68:71]
buffer_load_dwordx4 v140, s[44:47], s36 offen lds
mf a[36:39],a[200:203],a[168:171],a[36:39]
ds_read_b64_tr_b16 a[192:193], v130 offset:0
ds_read_b64_tr_b16 a[194:195], v130 offset:2048
mf a[36:39],a[204:207],a[172:175],a[36:39]
s_add_u32 m0, s35, 34816
mf a[4:7],a[204:207],a[164:167],a[4:7]
s_add_u32 s37, s53, 32768
mf a[4:7],a[200:203],a[160:163],a[4:7]
buffer_load_dwordx4 v141, s[48:51], s37 offen lds
mf a[8:11],a[208:211],a[160:163],a[8:11]
ds_read_b64_tr_b16 a[196:197], v130 offset:16384
ds_read_b64_tr_b16 a[198:199], v130 offset:18432
mf a[8:11],a[212:215],a[164:167],a[8:11]
s_add_u32 m0, s34, 40960
mf a[40:43],a[212:215],a[172:175],a[40:43]
s_add_u32 s36, s56, 0
mf a[40:43],a[208:211],a[168:171],a[40:43]
buffer_load_dwordx4 v140, s[44:47], s36 offen lds
mf a[72:75],a[208:211],a[176:179],a[72:75]
ds_read_b128 a[152:155], v128 offset:6144
ds_read_b128 a[156:159], v129 offset:6144
mf a[72:75],a[212:215],a[180:183],a[72:75]
s_add_u32 m0, s35, 40960
mf a[104:107],a[212:215],a[188:191],a[104:107]
s_add_u32 s37, s53, 131072
mf a[104:107],a[208:211],a[184:187],a[104:107]
buffer_load_dwordx4 v141, s[48:51], s37 offen lds
mf a[108:111],a[216:219],a[184:187],a[108:111]
ds_read_b64_tr_b16 a[200:201], v131 offset:0
ds_read_b64_tr_b16 a[202:203], v131 offset:2048
mf a[108:111],a[220:223],a[188:191],a[108:111]
s_add_u32 m0, s34, 45056
mf a[76:79],a[220:223],a[180:183],a[76:79]
s_add_u32 s36, s56, 28672
mf a[76:79],a[216:219],a[176:179],a[76:79]
buffer_load_dwordx4 v140, s[44:47], s36 offen lds
mf a[44:47],a[216:219],a[168:171],a[44:47]
ds_read_b64_tr_b16 a[204:205], v131 offset:16384
ds_read_b64_tr_b16 a[206:207], v131 offset:18432
mf a[44:47],a[220:223],a[172:175],a[44:47]
s_add_u32 m0, s35, 43008
mf a[12:15],a[220:223],a[164:167],a[12:15]
s_add_u32 s37, s53, 163840
mf a[12:15],a[216:219],a[160:163],a[12:15]
buffer_load_dwordx4 v141, s[48:51], s37 offen lds
mf a[16:19],a[224:227],a[160:163],a[16:19]
mf a[16:19],a[228:231],a[164:167],a[16:19]
s_add_u32 m0, s34, 49152
mf a[48:51],a[228:231],a[172:175],a[48:51]
s_add_u32 s36, s52, 57344
mf a[48:51],a[224:227],a[168:171],a[48:51]
buffer_load_dwordx4 v140, s[44:47], s36 offen lds
mf a[80:83],a[224:227],a[176:179],a[80:83]
ds_read_b64_tr_b16 a[208:209], v132 offset:0
ds_read_b64_tr_b16 a[210:211], v132 offset:2048
mf a[80:83],a[228:231],a[180:183],a[80:83]
s_add_u32 m0, s35, 49152
mf a[112:115],a[228:231],a[188:191],a[112:115]
s_add_u32 s37, s53, 262144
mf a[112:115],a[224:227],a[184:187],a[112:115]
buffer_load_dwordx4 v141, s[48:51], s37 offen lds
mf a[116:119],a[232:235],a[184:187],a[116:119]
ds_read_b64_tr_b16 a[212:213], v132 offset:16384
ds_read_b64_tr_b16 a[214:215], v132 offset:18432
mf a[116:119],a[236:239],a[188:191],a[116:119]
s_add_u32 m0, s34, 53248
mf a[84:87],a[236:239],a[180:183],a[84:87]
s_add_u32 s36, s52, 86016
mf a[84:87],a[232:235],a[176:179],a[84:87]
buffer_load_dwordx4 v140, s[44:47], s36 offen lds
mf a[52:55],a[232:235],a[168:171],a[52:55]
mf a[52:55],a[236:239],a[172:175],a[52:55]
s_add_u32 m0, s35, 51200
mf a[20:23],a[236:239],a[164:167],a[20:23]
s_add_u32 s37, s53, 294912
mf a[20:23],a[232:235],a[160:163],a[20:23]
buffer_load_dwordx4 v141, s[48:51], s37 offen lds
mf a[24:27],a[240:243],a[160:163],a[24:27]
ds_read_b64_tr_b16 a[216:217], v133 offset:0
ds_read_b64_tr_b16 a[218:219], v133 offset:2048
mf a[24:27],a[244:247],a[164:167],a[24:27]
s_add_u32 m0, s34, 57344
mf a[56:59],a[244:247],a[172:175],a[56:59]
s_add_u32 s36, s56, 57344
mf a[56:59],a[240:243],a[168:171],a[56:59]
buffer_load_dwordx4 v140, s[44:47], s36 offen lds
mf a[88:91],a[240:243],a[176:179],a[88:91]
ds_read_b64_tr_b16 a[220:221], v133 offset:16384
ds_read_b64_tr_b16 a[222:223], v133 offset:18432
mf a[88:91],a[244:247],a[180:183],a[88:91]
s_add_u32 m0, s35, 57344
mf a[120:123],a[244:247],a[188:191],a[120:123]
s_add_u32 s37, s53, 393216
mf a[120:123],a[240:243],a[184:187],a[120:123]
buffer_load_dwordx4 v141, s[48:51], s37 offen lds
mf a[124:127],a[248:251],a[184:187],a[124:127]
mf a[124:127],a[252:255],a[188:191],a[124:127]
s_add_u32 m0, s34, 61440
mf a[92:95],a[252:255],a[180:183],a[92:95]
s_add_u32 s36, s56, 86016
mf a[92:95],a[248:251],a[176:179],a[92:95]
buffer_load_dwordx4 v140, s[44:47], s36 offen lds
mf a[60:63],a[248:251],a[168:171],a[60:63]
mf a[60:63],a[252:255],a[172:175],a[60:63]
s_add_u32 m0, s35, 59392
mf a[28:31],a[252:255],a[164:167],a[28:31]
s_add_u32 s37, s53, 425984
mf a[28:31],a[248:251],a[160:163],a[28:31]
buffer_load_dwordx4 v141, s[48:51], s37 offen lds
s_add_u32 s52, s52, 128
s_add_u32 s53, s53, 524288
s_add_u32 s56, s56, 128
s_waitcnt lgkmcnt(0)
mf v[0:3],a[192:195],a[128:131],v[0:3]
ds_read_b64_tr_b16 a[224:225], v134 offset:0
mf v[0:3],a[196:199],a[132:135],v[0:3]
s_add_u32 s57, s39, 16384
mf v[32:35],a[196:199],a[140:143],v[32:35]
ds_read_b64_tr_b16 a[226:227], v134 offset:2048
mf v[32:35],a[192:195],a[136:139],v[32:35]
mf v[64:67],a[192:195],a[144:147],v[64:67]
ds_read_b64_tr_b16 a[228:229], v134 offset:16384
buffer_store_dwordx4 v[156:159], v142, s[28:31], s57 offen offset:0 sc1
mf v[64:67],a[196:199],a[148:151],v[64:67]
mf v[96:99],a[196:199],a[156:159],v[96:99]
ds_read_b64_tr_b16 a[230:231], v134 offset:18432
mf v[96:99],a[192:195],a[152:155],v[96:99]
mf v[100:103],a[200:203],a[152:155],v[100:103]
ds_read_b64_tr_b16 a[232:233], v135 offset:0
s_add_u32 s57, s39, 16384
mf v[100:103],a[204:207],a[156:159],v[100:103]
mf v[68:71],a[204:207],a[148:151],v[68:71]
ds_read_b64_tr_b16 a[234:235], v135 offset:2048
mf v[68:71],a[200:203],a[144:147],v[68:71]
mf v[36:39],a[200:203],a[136:139],v[36:39]
ds_read_b64_tr_b16 a[236:237], v135 offset:16384
buffer_store_dwordx4 v[160:163], v142, s[28:31], s57 offen offset:1024 sc1
mf v[36:39],a[204:207],a[140:143],v[36:39]
mf v[4:7],a[204:207],a[132:135],v[4:7]
ds_read_b64_tr_b16 a[238:239], v135 offset:18432
mf v[4:7],a[200:203],a[128:131],v[4:7]
s_add_u32 s57, s39, 16384
mf v[8:11],a[208:211],a[128:131],v[8:11]
ds_read_b64_tr_b16 a[240:241], v136 offset:0
mf v[8:11],a[212:215],a[132:135],v[8:11]
mf v[40:43],a[212:215],a[140:143],v[40:43]
ds_read_b64_tr_b16 a[242:243], v136 offset:2048
mf v[40:43],a[208:211],a[136:139],v[40:43]
buffer_store_dwordx4 v[164:167], v142, s[28:31], s57 offen offset:2048 sc1
mf v[72:75],a[208:211],a[144:147],v[72:75]
ds_read_b64_tr_b16 a[244:245], v136 offset:16384
mf v[72:75],a[212:215],a[148:151],v[72:75]
mf v[104:107],a[212:215],a[156:159],v[104:107]
ds_read_b64_tr_b16 a[246:247], v136 offset:18432
mf v[104:107],a[208:211],a[152:155],v[104:107]
s_add_u32 s57, s39, 16384
mf v[108:111],a[216:219],a[152:155],v[108:111]
ds_read_b64_tr_b16 a[248:249], v137 offset:0
mf v[108:111],a[220:223],a[156:159],v[108:111]
mf v[76:79],a[220:223],a[148:151],v[76:79]
ds_read_b64_tr_b16 a[250:251], v137 offset:2048
buffer_store_dwordx4 v[168:171], v142, s[28:31], s57 offen offset:3072 sc1
mf v[76:79],a[216:219],a[144:147],v[76:79]
mf v[44:47],a[216:219],a[136:139],v[44:47]
ds_read_b64_tr_b16 a[252:253], v137 offset:16384
mf v[44:47],a[220:223],a[140:143],v[44:47]
mf v[12:15],a[220:223],a[132:135],v[12:15]
ds_read_b64_tr_b16 a[254:255], v137 offset:18432
s_add_u32 s57, s19, 16384
mf v[12:15],a[216:219],a[128:131],v[12:15]
s_waitcnt lgkmcnt(8)
mf v[16:19],a[224:227],a[128:131],v[16:19]
mf v[16:19],a[228:231],a[132:135],v[16:19]
ds_read_b128 a[160:163], v128 offset:8192
mf v[48:51],a[228:231],a[140:143],v[48:51]
buffer_store_dwordx4 v[172:175], v142, s[28:31], s57 offen offset:0 sc1
mf v[48:51],a[224:227],a[136:139],v[48:51]
mf v[80:83],a[224:227],a[144:147],v[80:83]
ds_read_b128 a[164:167], v129 offset:8192
mf v[80:83],a[228:231],a[148:151],v[80:83]
s_add_u32 s57, s19, 16384
mf v[112:115],a[228:231],a[156:159],v[112:115]
mf v[112:115],a[224:227],a[152:155],v[112:115]
ds_read_b128 a[168:171], v128 offset:10240
mf v[116:119],a[232:235],a[152:155],v[116:119]
mf v[116:119],a[236:239],a[156:159],v[116:119]
buffer_store_dwordx4 v[176:179], v142, s[28:31], s57 offen offset:1024 sc1
mf v[84:87],a[236:239],a[148:151],v[84:87]
ds_read_b128 a[172:175], v129 offset:10240
mf v[84:87],a[232:235],a[144:147],v[84:87]
mf v[52:55],a[232:235],a[136:139],v[52:55]
mf v[52:55],a[236:239],a[140:143],v[52:55]
ds_read_b128 a[176:179], v128 offset:12288
s_add_u32 s57, s19, 16384
mf v[20:23],a[236:239],a[132:135],v[20:23]
mf v[20:23],a[232:235],a[128:131],v[20:23]
s_waitcnt lgkmcnt(5)
mf v[24:27],a[240:243],a[128:131],v[24:27]
ds_read_b128 a[180:183], v129 offset:12288
buffer_store_dwordx4 v[180:183], v142, s[28:31], s57 offen offset:2048 sc1
mf v[24:27],a[244:247],a[132:135],v[24:27]
mf v[56:59],a[244:247],a[140:143],v[56:59]
mf v[56:59],a[240:243],a[136:139],v[56:59]
ds_read_b128 a[184:187], v128 offset:14336
mf v[88:91],a[240:243],a[144:147],v[88:91]
s_add_u32 s57, s19, 16384
mf v[88:91],a[244:247],a[148:151],v[88:91]
mf v[120:123],a[244:247],a[156:159],v[120:123]
ds_read_b128 a[188:191], v129 offset:14336
mf v[120:123],a[240:243],a[152:155],v[120:123]
mf v[124:127],a[248:251],a[152:155],v[124:127]
buffer_store_dwordx4 v[184:187], v142, s[28:31], s57 offen offset:3072 sc1
mf v[124:127],a[252:255],a[156:159],v[124:127]
mf v[92:95],a[252:255],a[148:151],v[92:95]
mf v[92:95],a[248:251],a[144:147],v[92:95]
mf v[60:63],a[248:251],a[136:139],v[60:63]
mf v[60:63],a[252:255],a[140:143],v[60:63]
mf v[28:31],a[252:255],a[132:135],v[28:31]
mf v[28:31],a[248:251],a[128:131],v[28:31]
s_waitcnt lgkmcnt(0) vmcnt(8)
s_barrier
mf a[0:3],a[192:195],a[160:163],a[0:3]
ds_read_b128 a[128:131], v128 offset:32768
ds_read_b128 a[132:135], v129 offset:32768
mf a[0:3],a[196:199],a[164:167],a[0:3]
s_add_u32 m0, s34, 0
mf a[32:35],a[196:199],a[172:175],a[32:35]
s_add_u32 s36, s52, 0
mf a[32:35],a[192:195],a[168:171],a[32:35]
buffer_load_dwordx4 v140, s[44:47], s36 offen lds
mf a[64:67],a[192:195],a[176:179],a[64:67]
ds_read_b128 a[136:139], v128 offset:34816
ds_read_b128 a[140:143], v129 offset:34816
mf a[64:67],a[196:199],a[180:183],a[64:67]
s_add_u32 m0, s35, 0
mf a[96:99],a[196:199],a[188:191],a[96:99]
s_add_u32 s37, s53, 0
mf a[96:99],a[192:195],a[184:187],a[96:99]
buffer_load_dwordx4 v141, s[48:51], s37 offen lds
mf a[100:103],a[200:203],a[184:187],a[100:103]
ds_read_b128 a[144:147], v128 offset:36864
ds_read_b128 a[148:151], v129 offset:36864
mf a[100:103],a[204:207],a[188:191],a[100:103]
s_add_u32 m0, s34, 4096
mf a[68:71],a[204:207],a[180:183],a[68:71]
s_add_u32 s36, s52, 28672
mf a[68:71],a[200:203],a[176:179],a[68:71]
buffer_load_dwordx4 v140, s[44:47], s36 offen lds
mf a[36:39],a[200:203],a[168:171],a[36:39]
ds_read_b64_tr_b16 a[192:193], v130 offset:32768
ds_read_b64_tr_b16 a[194:195], v130 offset:34816
mf a[36:39],a[204:207],a[172:175],a[36:39]
s_add_u32 m0, s35, 2048
mf a[4:7],a[204:207],a[164:167],a[4:7]
s_add_u32 s37, s53, 32768
mf a[4:7],a[200:203],a[160:163],a[4:7]
buffer_load_dwordx4 v141, s[48:51], s37 offen lds
mf a[8:11],a[208:211],a[160:163],a[8:11]
ds_read_b64_tr_b16 a[196:197], v130 offset:49152
ds_read_b64_tr_b16 a[198:199], v130 offset:51200
mf a[8:11],a[212:215],a[164:167],a[8:11]
s_add_u32 m0, s34, 8192
mf a[40:43],a[212:215],a[172:175],a[40:43]
s_add_u32 s36, s56, 0
mf a[40:43],a[208:211],a[168:171],a[40:43]
buffer_load_dwordx4 v140, s[44:47], s36 offen lds
mf a[72:75],a[208:211],a[176:179],a[72:75]
ds_read_b128 a[152:155], v128 offset:38912
ds_read_b128 a[156:159], v129 offset:38912
mf a[72:75],a[212:215],a[180:183],a[72:75]
s_add_u32 m0, s35, 8192
mf a[104:107],a[212:215],a[188:191],a[104:107]
s_add_u32 s37, s53, 131072
mf a[104:107],a[208:211],a[184:187],a[104:107]
buffer_load_dwordx4 v141, s[48:51], s37 offen lds
mf a[108:111],a[216:219],a[184:187],a[108:111]
ds_read_b64_tr_b16 a[200:201], v131 offset:32768
ds_read_b64_tr_b16 a[202:203], v131 offset:34816
mf a[108:111],a[220:223],a[188:191],a[108:111]
s_add_u32 m0, s34, 12288
mf a[76:79],a[220:223],a[180:183],a[76:79]
s_add_u32 s36, s56, 28672
mf a[76:79],a[216:219],a[176:179],a[76:79]
buffer_load_dwordx4 v140, s[44:47], s36 offen lds
mf a[44:47],a[216:219],a[168:171],a[44:47]
ds_read_b64_tr_b16 a[204:205], v131 offset:49152
ds_read_b64_tr_b16 a[206:207], v131 offset:51200
mf a[44:47],a[220:223],a[172:175],a[44:47]
s_add_u32 m0, s35, 10240
mf a[12:15],a[220:223],a[164:167],a[12:15]
s_add_u32 s37, s53, 163840
mf a[12:15],a[216:219],a[160:163],a[12:15]
buffer_load_dwordx4 v141, s[48:51], s37 offen lds
mf a[16:19],a[224:227],a[160:163],a[16:19]
mf a[16:19],a[228:231],a[164:167],a[16:19]
s_add_u32 m0, s34, 16384
mf a[48:51],a[228:231],a[172:175],a[48:51]
s_add_u32 s36, s52, 57344
mf a[48:51],a[224:227],a[168:171],a[48:51]
buffer_load_dwordx4 v140, s[44:47], s36 offen lds
mf a[80:83],a[224:227],a[176:179],a[80:83]
ds_read_b64_tr_b16 a[208:209], v132 offset:32768
ds_read_b64_tr_b16 a[210:211], v132 offset:34816
mf a[80:83],a[228:231],a[180:183],a[80:83]
s_add_u32 m0, s35, 16384
mf a[112:115],a[228:231],a[188:191],a[112:115]
s_add_u32 s37, s53, 262144
mf a[112:115],a[224:227],a[184:187],a[112:115]
buffer_load_dwordx4 v141, s[48:51], s37 offen lds
mf a[116:119],a[232:235],a[184:187],a[116:119]
ds_read_b64_tr_b16 a[212:213], v132 offset:49152
ds_read_b64_tr_b16 a[214:215], v132 offset:51200
mf a[116:119],a[236:239],a[188:191],a[116:119]
s_add_u32 m0, s34, 20480
mf a[84:87],a[236:239],a[180:183],a[84:87]
s_add_u32 s36, s52, 86016
mf a[84:87],a[232:235],a[176:179],a[84:87]
buffer_load_dwordx4 v140, s[44:47], s36 offen lds
mf a[52:55],a[232:235],a[168:171],a[52:55]
mf a[52:55],a[236:239],a[172:175],a[52:55]
s_add_u32 m0, s35, 18432
mf a[20:23],a[236:239],a[164:167],a[20:23]
s_add_u32 s37, s53, 294912
mf a[20:23],a[232:235],a[160:163],a[20:23]
buffer_load_dwordx4 v141, s[48:51], s37 offen lds
mf a[24:27],a[240:243],a[160:163],a[24:27]
ds_read_b64_tr_b16 a[216:217], v133 offset:32768
ds_read_b64_tr_b16 a[218:219], v133 offset:34816
mf a[24:27],a[244:247],a[164:167],a[24:27]
s_add_u32 m0, s34, 24576
mf a[56:59],a[244:247],a[172:175],a[56:59]
s_add_u32 s36, s56, 57344
mf a[56:59],a[240:243],a[168:171],a[56:59]
buffer_load_dwordx4 v140, s[44:47], s36 offen lds
mf a[88:91],a[240:243],a[176:179],a[88:91]
ds_read_b64_tr_b16 a[220:221], v133 offset:49152
ds_read_b64_tr_b16 a[222:223], v133 offset:51200
mf a[88:91],a[244:247],a[180:183],a[88:91]
s_add_u32 m0, s35, 24576
mf a[120:123],a[244:247],a[188:191],a[120:123]
s_add_u32 s37, s53, 393216
mf a[120:123],a[240:243],a[184:187],a[120:123]
buffer_load_dwordx4 v141, s[48:51], s37 offen lds
mf a[124:127],a[248:251],a[184:187],a[124:127]
mf a[124:127],a[252:255],a[188:191],a[124:127]
s_add_u32 m0, s34, 28672
mf a[92:95],a[252:255],a[180:183],a[92:95]
s_add_u32 s36, s56, 86016
mf a[92:95],a[248:251],a[176:179],a[92:95]
buffer_load_dwordx4 v140, s[44:47], s36 offen lds
mf a[60:63],a[248:251],a[168:171],a[60:63]
mf a[60:63],a[252:255],a[172:175],a[60:63]
s_add_u32 m0, s35, 26624
mf a[28:31],a[252:255],a[164:167],a[28:31]
s_add_u32 s37, s53, 425984
mf a[28:31],a[248:251],a[160:163],a[28:31]
buffer_load_dwordx4 v141, s[48:51], s37 offen lds
s_add_u32 s52, s52, 128
s_add_u32 s53, s53, 524288
s_add_u32 s56, s56, 128
s_waitcnt lgkmcnt(0)
mf v[0:3],a[192:195],a[128:131],v[0:3]
ds_read_b64_tr_b16 a[224:225], v134 offset:32768
mf v[0:3],a[196:199],a[132:135],v[0:3]
s_add_u32 s57, s39, 32768
mf v[32:35],a[196:199],a[140:143],v[32:35]
ds_read_b64_tr_b16 a[226:227], v134 offset:34816
mf v[32:35],a[192:195],a[136:139],v[32:35]
mf v[64:67],a[192:195],a[144:147],v[64:67]
ds_read_b64_tr_b16 a[228:229], v134 offset:49152
buffer_store_dwordx4 v[188:191], v142, s[28:31], s57 offen offset:0 sc1
mf v[64:67],a[196:199],a[148:151],v[64:67]
mf v[96:99],a[196:199],a[156:159],v[96:99]
ds_read_b64_tr_b16 a[230:231], v134 offset:51200
mf v[96:99],a[192:195],a[152:155],v[96:99]
mf v[100:103],a[200:203],a[152:155],v[100:103]
ds_read_b64_tr_b16 a[232:233], v135 offset:32768
s_add_u32 s57, s39, 32768
mf v[100:103],a[204:207],a[156:159],v[100:103]
mf v[68:71],a[204:207],a[148:151],v[68:71]
ds_read_b64_tr_b16 a[234:235], v135 offset:34816
mf v[68:71],a[200:203],a[144:147],v[68:71]
mf v[36:39],a[200:203],a[136:139],v[36:39]
ds_read_b64_tr_b16 a[236:237], v135 offset:49152
buffer_store_dwordx4 v[192:195], v142, s[28:31], s57 offen offset:1024 sc1
mf v[36:39],a[204:207],a[140:143],v[36:39]
mf v[4:7],a[204:207],a[132:135],v[4:7]
ds_read_b64_tr_b16 a[238:239], v135 offset:51200
mf v[4:7],a[200:203],a[128:131],v[4:7]
s_add_u32 s57, s39, 32768
mf v[8:11],a[208:211],a[128:131],v[8:11]
ds_read_b64_tr_b16 a[240:241], v136 offset:32768
mf v[8:11],a[212:215],a[132:135],v[8:11]
mf v[40:43],a[212:215],a[140:143],v[40:43]
ds_read_b64_tr_b16 a[242:243], v136 offset:34816
mf v[40:43],a[208:211],a[136:139],v[40:43]
buffer_store_dwordx4 v[196:199], v142, s[28:31], s57 offen offset:2048 sc1
mf v[72:75],a[208:211],a[144:147],v[72:75]
ds_read_b64_tr_b16 a[244:245], v136 offset:49152
mf v[72:75],a[212:215],a[148:151],v[72:75]
mf v[104:107],a[212:215],a[156:159],v[104:107]
ds_read_b64_tr_b16 a[246:247], v136 offset:51200
mf v[104:107],a[208:211],a[152:155],v[104:107]
s_add_u32 s57, s39, 32768
mf v[108:111],a[216:219],a[152:155],v[108:111]
ds_read_b64_tr_b16 a[248:249], v137 offset:32768
mf v[108:111],a[220:223],a[156:159],v[108:111]
mf v[76:79],a[220:223],a[148:151],v[76:79]
ds_read_b64_tr_b16 a[250:251], v137 offset:34816
buffer_store_dwordx4 v[200:203], v142, s[28:31], s57 offen offset:3072 sc1
mf v[76:79],a[216:219],a[144:147],v[76:79]
mf v[44:47],a[216:219],a[136:139],v[44:47]
ds_read_b64_tr_b16 a[252:253], v137 offset:49152
mf v[44:47],a[220:223],a[140:143],v[44:47]
mf v[12:15],a[220:223],a[132:135],v[12:15]
ds_read_b64_tr_b16 a[254:255], v137 offset:51200
s_add_u32 s57, s19, 32768
mf v[12:15],a[216:219],a[128:131],v[12:15]
s_waitcnt lgkmcnt(8)
mf v[16:19],a[224:227],a[128:131],v[16:19]
mf v[16:19],a[228:231],a[132:135],v[16:19]
ds_read_b128 a[160:163], v128 offset:40960
mf v[48:51],a[228:231],a[140:143],v[48:51]
buffer_store_dwordx4 v[204:207], v142, s[28:31], s57 offen offset:0 sc1
mf v[48:51],a[224:227],a[136:139],v[48:51]
mf v[80:83],a[224:227],a[144:147],v[80:83]
ds_read_b128 a[164:167], v129 offset:40960
mf v[80:83],a[228:231],a[148:151],v[80:83]
s_add_u32 s57, s19, 32768
mf v[112:115],a[228:231],a[156:159],v[112:115]
mf v[112:115],a[224:227],a[152:155],v[112:115]
ds_read_b128 a[168:171], v128 offset:43008
mf v[116:119],a[232:235],a[152:155],v[116:119]
mf v[116:119],a[236:239],a[156:159],v[116:119]
buffer_store_dwordx4 v[208:211], v142, s[28:31], s57 offen offset:1024 sc1
mf v[84:87],a[236:239],a[148:151],v[84:87]
ds_read_b128 a[172:175], v129 offset:43008
mf v[84:87],a[232:235],a[144:147],v[84:87]
mf v[52:55],a[232:235],a[136:139],v[52:55]
mf v[52:55],a[236:239],a[140:143],v[52:55]
ds_read_b128 a[176:179], v128 offset:45056
s_add_u32 s57, s19, 32768
mf v[20:23],a[236:239],a[132:135],v[20:23]
mf v[20:23],a[232:235],a[128:131],v[20:23]
s_waitcnt lgkmcnt(5)
mf v[24:27],a[240:243],a[128:131],v[24:27]
ds_read_b128 a[180:183], v129 offset:45056
buffer_store_dwordx4 v[212:215], v142, s[28:31], s57 offen offset:2048 sc1
mf v[24:27],a[244:247],a[132:135],v[24:27]
mf v[56:59],a[244:247],a[140:143],v[56:59]
mf v[56:59],a[240:243],a[136:139],v[56:59]
ds_read_b128 a[184:187], v128 offset:47104
mf v[88:91],a[240:243],a[144:147],v[88:91]
s_add_u32 s57, s19, 32768
mf v[88:91],a[244:247],a[148:151],v[88:91]
mf v[120:123],a[244:247],a[156:159],v[120:123]
ds_read_b128 a[188:191], v129 offset:47104
mf v[120:123],a[240:243],a[152:155],v[120:123]
mf v[124:127],a[248:251],a[152:155],v[124:127]
buffer_store_dwordx4 v[216:219], v142, s[28:31], s57 offen offset:3072 sc1
mf v[124:127],a[252:255],a[156:159],v[124:127]
mf v[92:95],a[252:255],a[148:151],v[92:95]
mf v[92:95],a[248:251],a[144:147],v[92:95]
mf v[60:63],a[248:251],a[136:139],v[60:63]
mf v[60:63],a[252:255],a[140:143],v[60:63]
mf v[28:31],a[252:255],a[132:135],v[28:31]
mf v[28:31],a[248:251],a[128:131],v[28:31]
s_waitcnt lgkmcnt(0) vmcnt(8)
s_barrier
mf a[0:3],a[192:195],a[160:163],a[0:3]
ds_read_b128 a[128:131], v128 offset:0
ds_read_b128 a[132:135], v129 offset:0
mf a[0:3],a[196:199],a[164:167],a[0:3]
s_add_u32 m0, s34, 32768
mf a[32:35],a[196:199],a[172:175],a[32:35]
s_add_u32 s36, s52, 0
mf a[32:35],a[192:195],a[168:171],a[32:35]
buffer_load_dwordx4 v140, s[44:47], s36 offen lds
mf a[64:67],a[192:195],a[176:179],a[64:67]
ds_read_b128 a[136:139], v128 offset:2048
ds_read_b128 a[140:143], v129 offset:2048
mf a[64:67],a[196:199],a[180:183],a[64:67]
s_add_u32 m0, s35, 32768
mf a[96:99],a[196:199],a[188:191],a[96:99]
s_add_u32 s37, s53, 0
mf a[96:99],a[192:195],a[184:187],a[96:99]
buffer_load_dwordx4 v141, s[48:51], s37 offen lds
mf a[100:103],a[200:203],a[184:187],a[100:103]
ds_read_b128 a[144:147], v128 offset:4096
ds_read_b128 a[148:151], v129 offset:4096
mf a[100:103],a[204:207],a[188:191],a[100:103]
s_add_u32 m0, s34, 36864
mf a[68:71],a[204:207],a[180:183],a[68:71]
s_add_u32 s36, s52, 28672
mf a[68:71],a[200:203],a[176:179],a[68:71]
buffer_load_dwordx4 v140, s[44:47], s36 offen lds
mf a[36:39],a[200:203],a[168:171],a[36:39]
ds_read_b64_tr_b16 a[192:193], v130 offset:0
ds_read_b64_tr_b16 a[194:195], v130 offset:2048
mf a[36:39],a[204:207],a[172:175],a[36:39]
s_add_u32 m0, s35, 34816
mf a[4:7],a[204:207],a[164:167],a[4:7]
s_add_u32 s37, s53, 32768
mf a[4:7],a[200:203],a[160:163],a[4:7]
buffer_load_dwordx4 v141, s[48:51], s37 offen lds
mf a[8:11],a[208:211],a[160:163],a[8:11]
ds_read_b64_tr_b16 a[196:197], v130 offset:16384
ds_read_b64_tr_b16 a[198:199], v130 offset:18432
mf a[8:11],a[212:215],a[164:167],a[8:11]
s_add_u32 m0, s34, 40960
mf a[40:43],a[212:215],a[172:175],a[40:43]
s_add_u32 s36, s56, 0
mf a[40:43],a[208:211],a[168:171],a[40:43]
buffer_load_dwordx4 v140, s[44:47], s36 offen lds
mf a[72:75],a[208:211],a[176:179],a[72:75]
ds_read_b128 a[152:155], v128 offset:6144
ds_read_b128 a[156:159], v129 offset:6144
mf a[72:75],a[212:215],a[180:183],a[72:75]
s_add_u32 m0, s35, 40960
mf a[104:107],a[212:215],a[188:191],a[104:107]
s_add_u32 s37, s53, 131072
mf a[104:107],a[208:211],a[184:187],a[104:107]
buffer_load_dwordx4 v141, s[48:51], s37 offen lds
mf a[108:111],a[216:219],a[184:187],a[108:111]
ds_read_b64_tr_b16 a[200:201], v131 offset:0
ds_read_b64_tr_b16 a[202:203], v131 offset:2048
mf a[108:111],a[220:223],a[188:191],a[108:111]
s_add_u32 m0, s34, 45056
mf a[76:79],a[220:223],a[180:183],a[76:79]
s_add_u32 s36, s56, 28672
mf a[76:79],a[216:219],a[176:179],a[76:79]
buffer_load_dwordx4 v140, s[44:47], s36 offen lds
mf a[44:47],a[216:219],a[168:171],a[44:47]
ds_read_b64_tr_b16 a[204:205], v131 offset:16384
ds_read_b64_tr_b16 a[206:207], v131 offset:18432
mf a[44:47],a[220:223],a[172:175],a[44:47]
s_add_u32 m0, s35, 43008
mf a[12:15],a[220:223],a[164:167],a[12:15]
s_add_u32 s37, s53, 163840
mf a[12:15],a[216:219],a[160:163],a[12:15]
buffer_load_dwordx4 v141, s[48:51], s37 offen lds
mf a[16:19],a[224:227],a[160:163],a[16:19]
mf a[16:19],a[228:231],a[164:167],a[16:19]
s_add_u32 m0, s34, 49152
mf a[48:51],a[228:231],a[172:175],a[48:51]
s_add_u32 s36, s52, 57344
mf a[48:51],a[224:227],a[168:171],a[48:51]
buffer_load_dwordx4 v140, s[44:47], s36 offen lds
mf a[80:83],a[224:227],a[176:179],a[80:83]
ds_read_b64_tr_b16 a[208:209], v132 offset:0
ds_read_b64_tr_b16 a[210:211], v132 offset:2048
mf a[80:83],a[228:231],a[180:183],a[80:83]
s_add_u32 m0, s35, 49152
mf a[112:115],a[228:231],a[188:191],a[112:115]
s_add_u32 s37, s53, 262144
mf a[112:115],a[224:227],a[184:187],a[112:115]
buffer_load_dwordx4 v141, s[48:51], s37 offen lds
mf a[116:119],a[232:235],a[184:187],a[116:119]
ds_read_b64_tr_b16 a[212:213], v132 offset:16384
ds_read_b64_tr_b16 a[214:215], v132 offset:18432
mf a[116:119],a[236:239],a[188:191],a[116:119]
s_add_u32 m0, s34, 53248
mf a[84:87],a[236:239],a[180:183],a[84:87]
s_add_u32 s36, s52, 86016
mf a[84:87],a[232:235],a[176:179],a[84:87]
buffer_load_dwordx4 v140, s[44:47], s36 offen lds
mf a[52:55],a[232:235],a[168:171],a[52:55]
mf a[52:55],a[236:239],a[172:175],a[52:55]
s_add_u32 m0, s35, 51200
mf a[20:23],a[236:239],a[164:167],a[20:23]
s_add_u32 s37, s53, 294912
mf a[20:23],a[232:235],a[160:163],a[20:23]
buffer_load_dwordx4 v141, s[48:51], s37 offen lds
mf a[24:27],a[240:243],a[160:163],a[24:27]
ds_read_b64_tr_b16 a[216:217], v133 offset:0
ds_read_b64_tr_b16 a[218:219], v133 offset:2048
mf a[24:27],a[244:247],a[164:167],a[24:27]
s_add_u32 m0, s34, 57344
mf a[56:59],a[244:247],a[172:175],a[56:59]
s_add_u32 s36, s56, 57344
mf a[56:59],a[240:243],a[168:171],a[56:59]
buffer_load_dwordx4 v140, s[44:47], s36 offen lds
mf a[88:91],a[240:243],a[176:179],a[88:91]
ds_read_b64_tr_b16 a[220:221], v133 offset:16384
ds_read_b64_tr_b16 a[222:223], v133 offset:18432
mf a[88:91],a[244:247],a[180:183],a[88:91]
s_add_u32 m0, s35, 57344
mf a[120:123],a[244:247],a[188:191],a[120:123]
s_add_u32 s37, s53, 393216
mf a[120:123],a[240:243],a[184:187],a[120:123]
buffer_load_dwordx4 v141, s[48:51], s37 offen lds
mf a[124:127],a[248:251],a[184:187],a[124:127]
mf a[124:127],a[252:255],a[188:191],a[124:127]
s_add_u32 m0, s34, 61440
mf a[92:95],a[252:255],a[180:183],a[92:95]
s_add_u32 s36, s56, 86016
mf a[92:95],a[248:251],a[176:179],a[92:95]
buffer_load_dwordx4 v140, s[44:47], s36 offen lds
mf a[60:63],a[248:251],a[168:171],a[60:63]
mf a[60:63],a[252:255],a[172:175],a[60:63]
s_add_u32 m0, s35, 59392
mf a[28:31],a[252:255],a[164:167],a[28:31]
s_add_u32 s37, s53, 425984
mf a[28:31],a[248:251],a[160:163],a[28:31]
buffer_load_dwordx4 v141, s[48:51], s37 offen lds
s_add_u32 s52, s52, 128
s_add_u32 s53, s53, 524288
s_add_u32 s56, s56, 128
s_waitcnt lgkmcnt(0)
mf v[0:3],a[192:195],a[128:131],v[0:3]
ds_read_b64_tr_b16 a[224:225], v134 offset:0
mf v[0:3],a[196:199],a[132:135],v[0:3]
ds_read_b128 v[156:159], v147 offset:0
mf v[32:35],a[196:199],a[140:143],v[32:35]
ds_read_b64_tr_b16 a[226:227], v134 offset:2048
mf v[32:35],a[192:195],a[136:139],v[32:35]
ds_read_b128 v[160:163], v147 offset:1024
mf v[64:67],a[192:195],a[144:147],v[64:67]
ds_read_b64_tr_b16 a[228:229], v134 offset:16384
mf v[64:67],a[196:199],a[148:151],v[64:67]
ds_read_b128 v[164:167], v147 offset:2048
mf v[96:99],a[196:199],a[156:159],v[96:99]
ds_read_b64_tr_b16 a[230:231], v134 offset:18432
mf v[96:99],a[192:195],a[152:155],v[96:99]
mf v[100:103],a[200:203],a[152:155],v[100:103]
ds_read_b64_tr_b16 a[232:233], v135 offset:0
ds_read_b128 v[168:171], v147 offset:3072
mf v[100:103],a[204:207],a[156:159],v[100:103]
mf v[68:71],a[204:207],a[148:151],v[68:71]
ds_read_b64_tr_b16 a[234:235], v135 offset:2048
ds_read_b128 v[172:175], v147 offset:4096
mf v[68:71],a[200:203],a[144:147],v[68:71]
mf v[36:39],a[200:203],a[136:139],v[36:39]
ds_read_b64_tr_b16 a[236:237], v135 offset:16384
mf v[36:39],a[204:207],a[140:143],v[36:39]
ds_read_b128 v[176:179], v147 offset:5120
mf v[4:7],a[204:207],a[132:135],v[4:7]
ds_read_b64_tr_b16 a[238:239], v135 offset:18432
mf v[4:7],a[200:203],a[128:131],v[4:7]
ds_read_b128 v[180:183], v147 offset:6144
mf v[8:11],a[208:211],a[128:131],v[8:11]
ds_read_b64_tr_b16 a[240:241], v136 offset:0
mf v[8:11],a[212:215],a[132:135],v[8:11]
mf v[40:43],a[212:215],a[140:143],v[40:43]
ds_read_b64_tr_b16 a[242:243], v136 offset:2048
ds_read_b128 v[184:187], v147 offset:7168
mf v[40:43],a[208:211],a[136:139],v[40:43]
mf v[72:75],a[208:211],a[144:147],v[72:75]
ds_read_b64_tr_b16 a[244:245], v136 offset:16384
s_add_u32 s57, s39, 49152
mf v[72:75],a[212:215],a[148:151],v[72:75]
mf v[104:107],a[212:215],a[156:159],v[104:107]
ds_read_b64_tr_b16 a[246:247], v136 offset:18432
mf v[104:107],a[208:211],a[152:155],v[104:107]
buffer_store_dwordx4 v[220:223], v142, s[28:31], s57 offen offset:0 sc1
mf v[108:111],a[216:219],a[152:155],v[108:111]
ds_read_b64_tr_b16 a[248:249], v137 offset:0
mf v[108:111],a[220:223],a[156:159],v[108:111]
s_add_u32 s57, s39, 49152
mf v[76:79],a[220:223],a[148:151],v[76:79]
ds_read_b64_tr_b16 a[250:251], v137 offset:2048
mf v[76:79],a[216:219],a[144:147],v[76:79]
mf v[44:47],a[216:219],a[136:139],v[44:47]
ds_read_b64_tr_b16 a[252:253], v137 offset:16384
buffer_store_dwordx4 v[224:227], v142, s[28:31], s57 offen offset:1024 sc1
mf v[44:47],a[220:223],a[140:143],v[44:47]
mf v[12:15],a[220:223],a[132:135],v[12:15]
ds_read_b64_tr_b16 a[254:255], v137 offset:18432
s_add_u32 s57, s39, 49152
mf v[12:15],a[216:219],a[128:131],v[12:15]
s_waitcnt lgkmcnt(8)
mf v[16:19],a[224:227],a[128:131],v[16:19]
buffer_store_dwordx4 v[228:231], v142, s[28:31], s57 offen offset:2048 sc1
mf v[16:19],a[228:231],a[132:135],v[16:19]
ds_read_b128 a[160:163], v128 offset:8192
mf v[48:51],a[228:231],a[140:143],v[48:51]
mf v[48:51],a[224:227],a[136:139],v[48:51]
s_add_u32 s57, s39, 49152
mf v[80:83],a[224:227],a[144:147],v[80:83]
ds_read_b128 a[164:167], v129 offset:8192
mf v[80:83],a[228:231],a[148:151],v[80:83]
buffer_store_dwordx4 v[232:235], v142, s[28:31], s57 offen offset:3072 sc1
mf v[112:115],a[228:231],a[156:159],v[112:115]
mf v[112:115],a[224:227],a[152:155],v[112:115]
ds_read_b128 a[168:171], v128 offset:10240
mf v[116:119],a[232:235],a[152:155],v[116:119]
s_add_u32 s57, s19, 49152
mf v[116:119],a[236:239],a[156:159],v[116:119]
mf v[84:87],a[236:239],a[148:151],v[84:87]
ds_read_b128 a[172:175], v129 offset:10240
buffer_store_dwordx4 v[236:239], v142, s[28:31], s57 offen offset:0 sc1
mf v[84:87],a[232:235],a[144:147],v[84:87]
mf v[52:55],a[232:235],a[136:139],v[52:55]
mf v[52:55],a[236:239],a[140:143],v[52:55]
ds_read_b128 a[176:179], v128 offset:12288
s_add_u32 s57, s19, 49152
mf v[20:23],a[236:239],a[132:135],v[20:23]
mf v[20:23],a[232:235],a[128:131],v[20:23]
buffer_store_dwordx4 v[240:243], v142, s[28:31], s57 offen offset:1024 sc1
s_waitcnt lgkmcnt(5)
mf v[24:27],a[240:243],a[128:131],v[24:27]
ds_read_b128 a[180:183], v129 offset:12288
mf v[24:27],a[244:247],a[132:135],v[24:27]
mf v[56:59],a[244:247],a[140:143],v[56:59]
s_add_u32 s57, s19, 49152
mf v[56:59],a[240:243],a[136:139],v[56:59]
ds_read_b128 a[184:187], v128 offset:14336
mf v[88:91],a[240:243],a[144:147],v[88:91]
buffer_store_dwordx4 v[244:247], v142, s[28:31], s57 offen offset:2048 sc1
mf v[88:91],a[244:247],a[148:151],v[88:91]
mf v[120:123],a[244:247],a[156:159],v[120:123]
ds_read_b128 a[188:191], v129 offset:14336
mf v[120:123],a[240:243],a[152:155],v[120:123]
s_add_u32 s57, s19, 49152
mf v[124:127],a[248:251],a[152:155],v[124:127]
mf v[124:127],a[252:255],a[156:159],v[124:127]
buffer_store_dwordx4 v[248:251], v142, s[28:31], s57 offen offset:3072 sc1
mf v[92:95],a[252:255],a[148:151],v[92:95]
mf v[92:95],a[248:251],a[144:147],v[92:95]
mf v[60:63],a[248:251],a[136:139],v[60:63]
mf v[60:63],a[252:255],a[140:143],v[60:63]
mf v[28:31],a[252:255],a[132:135],v[28:31]
mf v[28:31],a[248:251],a[128:131],v[28:31]
s_waitcnt lgkmcnt(0) vmcnt(8)
s_barrier
mf a[0:3],a[192:195],a[160:163],a[0:3]
ds_read_b128 a[128:131], v128 offset:32768
ds_read_b128 a[132:135], v129 offset:32768
mf a[0:3],a[196:199],a[164:167],a[0:3]
s_add_u32 m0, s34, 0
mf a[32:35],a[196:199],a[172:175],a[32:35]
s_add_u32 s36, s52, 0
mf a[32:35],a[192:195],a[168:171],a[32:35]
buffer_load_dwordx4 v140, s[44:47], s36 offen lds
mf a[64:67],a[192:195],a[176:179],a[64:67]
ds_read_b128 a[136:139], v128 offset:34816
ds_read_b128 a[140:143], v129 offset:34816
mf a[64:67],a[196:199],a[180:183],a[64:67]
s_add_u32 m0, s35, 0
mf a[96:99],a[196:199],a[188:191],a[96:99]
s_add_u32 s37, s53, 0
mf a[96:99],a[192:195],a[184:187],a[96:99]
buffer_load_dwordx4 v141, s[48:51], s37 offen lds
mf a[100:103],a[200:203],a[184:187],a[100:103]
ds_read_b128 a[144:147], v128 offset:36864
ds_read_b128 a[148:151], v129 offset:36864
mf a[100:103],a[204:207],a[188:191],a[100:103]
s_add_u32 m0, s34, 4096
mf a[68:71],a[204:207],a[180:183],a[68:71]
s_add_u32 s36, s52, 28672
mf a[68:71],a[200:203],a[176:179],a[68:71]
buffer_load_dwordx4 v140, s[44:47], s36 offen lds
mf a[36:39],a[200:203],a[168:171],a[36:39]
ds_read_b64_tr_b16 a[192:193], v130 offset:32768
ds_read_b64_tr_b16 a[194:195], v130 offset:34816
mf a[36:39],a[204:207],a[172:175],a[36:39]
s_add_u32 m0, s35, 2048
mf a[4:7],a[204:207],a[164:167],a[4:7]
s_add_u32 s37, s53, 32768
mf a[4:7],a[200:203],a[160:163],a[4:7]
buffer_load_dwordx4 v141, s[48:51], s37 offen lds
mf a[8:11],a[208:211],a[160:163],a[8:11]
ds_read_b64_tr_b16 a[196:197], v130 offset:49152
ds_read_b64_tr_b16 a[198:199], v130 offset:51200
mf a[8:11],a[212:215],a[164:167],a[8:11]
s_add_u32 m0, s34, 8192
mf a[40:43],a[212:215],a[172:175],a[40:43]
s_add_u32 s36, s56, 0
mf a[40:43],a[208:211],a[168:171],a[40:43]
buffer_load_dwordx4 v140, s[44:47], s36 offen lds
mf a[72:75],a[208:211],a[176:179],a[72:75]
ds_read_b128 a[152:155], v128 offset:38912
ds_read_b128 a[156:159], v129 offset:38912
mf a[72:75],a[212:215],a[180:183],a[72:75]
s_add_u32 m0, s35, 8192
mf a[104:107],a[212:215],a[188:191],a[104:107]
s_add_u32 s37, s53, 131072
mf a[104:107],a[208:211],a[184:187],a[104:107]
buffer_load_dwordx4 v141, s[48:51], s37 offen lds
mf a[108:111],a[216:219],a[184:187],a[108:111]
ds_read_b64_tr_b16 a[200:201], v131 offset:32768
ds_read_b64_tr_b16 a[202:203], v131 offset:34816
mf a[108:111],a[220:223],a[188:191],a[108:111]
s_add_u32 m0, s34, 12288
mf a[76:79],a[220:223],a[180:183],a[76:79]
s_add_u32 s36, s56, 28672
mf a[76:79],a[216:219],a[176:179],a[76:79]
buffer_load_dwordx4 v140, s[44:47], s36 offen lds
mf a[44:47],a[216:219],a[168:171],a[44:47]
ds_read_b64_tr_b16 a[204:205], v131 offset:49152
ds_read_b64_tr_b16 a[206:207], v131 offset:51200
mf a[44:47],a[220:223],a[172:175],a[44:47]
s_add_u32 m0, s35, 10240
mf a[12:15],a[220:223],a[164:167],a[12:15]
s_add_u32 s37, s53, 163840
mf a[12:15],a[216:219],a[160:163],a[12:15]
buffer_load_dwordx4 v141, s[48:51], s37 offen lds
mf a[16:19],a[224:227],a[160:163],a[16:19]
mf a[16:19],a[228:231],a[164:167],a[16:19]
s_add_u32 m0, s34, 16384
mf a[48:51],a[228:231],a[172:175],a[48:51]
s_add_u32 s36, s52, 57344
mf a[48:51],a[224:227],a[168:171],a[48:51]
buffer_load_dwordx4 v140, s[44:47], s36 offen lds
mf a[80:83],a[224:227],a[176:179],a[80:83]
ds_read_b64_tr_b16 a[208:209], v132 offset:32768
ds_read_b64_tr_b16 a[210:211], v132 offset:34816
mf a[80:83],a[228:231],a[180:183],a[80:83]
s_add_u32 m0, s35, 16384
mf a[112:115],a[228:231],a[188:191],a[112:115]
s_add_u32 s37, s53, 262144
mf a[112:115],a[224:227],a[184:187],a[112:115]
buffer_load_dwordx4 v141, s[48:51], s37 offen lds
mf a[116:119],a[232:235],a[184:187],a[116:119]
ds_read_b64_tr_b16 a[212:213], v132 offset:49152
ds_read_b64_tr_b16 a[214:215], v132 offset:51200
mf a[116:119],a[236:239],a[188:191],a[116:119]
s_add_u32 m0, s34, 20480
mf a[84:87],a[236:239],a[180:183],a[84:87]
s_add_u32 s36, s52, 86016
mf a[84:87],a[232:235],a[176:179],a[84:87]
buffer_load_dwordx4 v140, s[44:47], s36 offen lds
mf a[52:55],a[232:235],a[168:171],a[52:55]
mf a[52:55],a[236:239],a[172:175],a[52:55]
s_add_u32 m0, s35, 18432
mf a[20:23],a[236:239],a[164:167],a[20:23]
s_add_u32 s37, s53, 294912
mf a[20:23],a[232:235],a[160:163],a[20:23]
buffer_load_dwordx4 v141, s[48:51], s37 offen lds
mf a[24:27],a[240:243],a[160:163],a[24:27]
ds_read_b64_tr_b16 a[216:217], v133 offset:32768
ds_read_b64_tr_b16 a[218:219], v133 offset:34816
mf a[24:27],a[244:247],a[164:167],a[24:27]
s_add_u32 m0, s34, 24576
mf a[56:59],a[244:247],a[172:175],a[56:59]
s_add_u32 s36, s56, 57344
mf a[56:59],a[240:243],a[168:171],a[56:59]
buffer_load_dwordx4 v140, s[44:47], s36 offen lds
mf a[88:91],a[240:243],a[176:179],a[88:91]
ds_read_b64_tr_b16 a[220:221], v133 offset:49152
ds_read_b64_tr_b16 a[222:223], v133 offset:51200
mf a[88:91],a[244:247],a[180:183],a[88:91]
s_add_u32 m0, s35, 24576
mf a[120:123],a[244:247],a[188:191],a[120:123]
s_add_u32 s37, s53, 393216
mf a[120:123],a[240:243],a[184:187],a[120:123]
buffer_load_dwordx4 v141, s[48:51], s37 offen lds
mf a[124:127],a[248:251],a[184:187],a[124:127]
mf a[124:127],a[252:255],a[188:191],a[124:127]
s_add_u32 m0, s34, 28672
mf a[92:95],a[252:255],a[180:183],a[92:95]
s_add_u32 s36, s56, 86016
mf a[92:95],a[248:251],a[176:179],a[92:95]
buffer_load_dwordx4 v140, s[44:47], s36 offen lds
mf a[60:63],a[248:251],a[168:171],a[60:63]
mf a[60:63],a[252:255],a[172:175],a[60:63]
s_add_u32 m0, s35, 26624
mf a[28:31],a[252:255],a[164:167],a[28:31]
s_add_u32 s37, s53, 425984
mf a[28:31],a[248:251],a[160:163],a[28:31]
buffer_load_dwordx4 v141, s[48:51], s37 offen lds
s_add_u32 s52, s52, 128
s_add_u32 s53, s53, 524288
s_add_u32 s56, s56, 128
s_waitcnt lgkmcnt(0)
mf v[0:3],a[192:195],a[128:131],v[0:3]
ds_read_b64_tr_b16 a[224:225], v134 offset:32768
mf v[0:3],a[196:199],a[132:135],v[0:3]
buffer_load_dword v254, v252, s[28:31], 0 offen sc1
v_lshlrev_b32 v206, 4, v255
mf v[32:35],a[196:199],a[140:143],v[32:35]
ds_read_b64_tr_b16 a[226:227], v134 offset:34816
s_load_dwordx2 s[68:69], s[0:1], 80
mf v[32:35],a[192:195],a[136:139],v[32:35]
s_lshl_b32 s5, s15, 3
mf v[64:67],a[192:195],a[144:147],v[64:67]
ds_read_b64_tr_b16 a[228:229], v134 offset:49152
s_add_u32 s5, s5, s14
mf v[64:67],a[196:199],a[148:151],v[64:67]
s_lshl_b32 s17, s14, 2
mf v[96:99],a[196:199],a[156:159],v[96:99]
ds_read_b64_tr_b16 a[230:231], v134 offset:51200
s_and_b32 s34, s42, 15
mf v[96:99],a[192:195],a[152:155],v[96:99]
s_add_u32 s57, s39, 0
buffer_store_dwordx4 v[156:159], v142, s[28:31], s57 offen offset:0 sc1
mf v[100:103],a[200:203],a[152:155],v[100:103]
ds_read_b64_tr_b16 a[232:233], v135 offset:32768
mf v[100:103],a[204:207],a[156:159],v[100:103]
s_cmp_ge_u32 s34, 14
s_cselect_b32 s34, 32, 38
mf v[68:71],a[204:207],a[148:151],v[68:71]
ds_read_b64_tr_b16 a[234:235], v135 offset:34816
s_sub_u32 s34, s34, s17
mf v[68:71],a[200:203],a[144:147],v[68:71]
s_sub_u32 s8, 15, s14
s_sub_u32 s17, 64, s17
mf v[36:39],a[200:203],a[136:139],v[36:39]
ds_read_b64_tr_b16 a[236:237], v135 offset:49152
mf v[36:39],a[204:207],a[140:143],v[36:39]
s_cmp_eq_u32 s13, 0
s_cselect_b32 s9, 0, s34
s_cselect_b32 s10, s34, s17
s_cselect_b32 s11, 0, 2
mf v[4:7],a[204:207],a[132:135],v[4:7]
ds_read_b64_tr_b16 a[238:239], v135 offset:51200
s_lshl_b32 s17, s15, 20
mf v[4:7],a[200:203],a[128:131],v[4:7]
s_add_u32 s57, s39, 0
buffer_store_dwordx4 v[160:163], v142, s[28:31], s57 offen offset:1024 sc1
mf v[8:11],a[208:211],a[128:131],v[8:11]
ds_read_b64_tr_b16 a[240:241], v136 offset:32768
mf v[8:11],a[212:215],a[132:135],v[8:11]
s_add_u32 s20, s6, s17
s_addc_u32 s21, s7, 0
mf v[40:43],a[212:215],a[140:143],v[40:43]
ds_read_b64_tr_b16 a[242:243], v136 offset:34816
s_and_b32 s21, s21, 0xffff
mf v[40:43],a[208:211],a[136:139],v[40:43]
s_mov_b32 s22, 0x100000
s_mov_b32 s23, 0x20000
mf v[72:75],a[208:211],a[144:147],v[72:75]
ds_read_b64_tr_b16 a[244:245], v136 offset:49152
mf v[72:75],a[212:215],a[148:151],v[72:75]
s_add_u32 s24, s20, 16777216
s_addc_u32 s25, s21, 0
mf v[104:107],a[212:215],a[156:159],v[104:107]
ds_read_b64_tr_b16 a[246:247], v136 offset:51200
s_add_u32 s57, s39, 0
mf v[104:107],a[208:211],a[152:155],v[104:107]
buffer_store_dwordx4 v[164:167], v142, s[28:31], s57 offen offset:2048 sc1
s_mov_b32 s26, 0x100000
mf v[108:111],a[216:219],a[152:155],v[108:111]
ds_read_b64_tr_b16 a[248:249], v137 offset:32768
s_mov_b32 s27, 0x20000
mf v[108:111],a[220:223],a[156:159],v[108:111]
s_lshl_b32 s40, s16, 12
s_lshl_b32 s32, s9, 14
mf v[76:79],a[220:223],a[148:151],v[76:79]
ds_read_b64_tr_b16 a[250:251], v137 offset:34816
s_add_u32 s32, s32, s40
mf v[76:79],a[216:219],a[144:147],v[76:79]
s_mov_b32 s33, s32
s_add_u32 s57, s39, 0
mf v[44:47],a[216:219],a[136:139],v[44:47]
ds_read_b64_tr_b16 a[252:253], v137 offset:49152
buffer_store_dwordx4 v[168:171], v142, s[28:31], s57 offen offset:3072 sc1
mf v[44:47],a[220:223],a[140:143],v[44:47]
s_lshl_b32 s4, s10, 14
s_add_u32 s4, s4, s40
mf v[12:15],a[220:223],a[132:135],v[12:15]
ds_read_b64_tr_b16 a[254:255], v137 offset:51200
mf v[12:15],a[216:219],a[128:131],v[12:15]
s_waitcnt lgkmcnt(8)
mf v[16:19],a[224:227],a[128:131],v[16:19]
s_cmp_eq_u32 s13, 0
s_cselect_b32 s34, s40, 0x70000000
mf v[16:19],a[228:231],a[132:135],v[16:19]
ds_read_b128 a[160:163], v128 offset:40960
s_add_u32 s41, s40, 98304
mf v[48:51],a[228:231],a[140:143],v[48:51]
s_lshl_b32 s38, s8, 2
s_add_u32 s38, s38, s16
mf v[48:51],a[224:227],a[136:139],v[48:51]
s_add_u32 s57, s19, 0
buffer_store_dwordx4 v[172:175], v142, s[28:31], s57 offen offset:0 sc1
mf v[80:83],a[224:227],a[144:147],v[80:83]
ds_read_b128 a[164:167], v129 offset:40960
s_lshl_b32 s38, s38, 14
mf v[80:83],a[228:231],a[148:151],v[80:83]
s_add_u32 s38, s38, s17
s_add_u32 s38, s38, 33554432
mf v[112:115],a[228:231],a[156:159],v[112:115]
s_lshr_b32 s91, s12, 2
mf v[112:115],a[224:227],a[152:155],v[112:115]
ds_read_b128 a[168:171], v128 offset:43008
s_lshl_b32 s91, s91, 3
mf v[116:119],a[232:235],a[152:155],v[116:119]
s_add_u32 s57, s19, 0
buffer_store_dwordx4 v[176:179], v142, s[28:31], s57 offen offset:1024 sc1
mf v[116:119],a[236:239],a[156:159],v[116:119]
s_and_b32 s17, s42, 7
mf v[84:87],a[236:239],a[148:151],v[84:87]
ds_read_b128 a[172:175], v129 offset:43008
s_add_u32 s91, s91, s17
mf v[84:87],a[232:235],a[144:147],v[84:87]
s_lshl_b32 s91, s91, 2
mf v[52:55],a[232:235],a[136:139],v[52:55]
s_lshr_b32 s17, s42, 3
mf v[52:55],a[236:239],a[140:143],v[52:55]
ds_read_b128 a[176:179], v128 offset:45056
s_add_u32 s91, s91, s17
mf v[20:23],a[236:239],a[132:135],v[20:23]
s_lshl_b32 s91, s91, 2
s_add_u32 s57, s19, 0
mf v[20:23],a[232:235],a[128:131],v[20:23]
buffer_store_dwordx4 v[180:183], v142, s[28:31], s57 offen offset:2048 sc1
s_waitcnt lgkmcnt(5)
mf v[24:27],a[240:243],a[128:131],v[24:27]
ds_read_b128 a[180:183], v129 offset:45056
s_and_b32 s17, s12, 3
mf v[24:27],a[244:247],a[132:135],v[24:27]
s_add_u32 s91, s91, s17
mf v[56:59],a[244:247],a[140:143],v[56:59]
s_lshl_b32 s91, s91, 15
mf v[56:59],a[240:243],a[136:139],v[56:59]
ds_read_b128 a[184:187], v128 offset:47104
s_mul_i32 s17, s16, 6144
mf v[88:91],a[240:243],a[144:147],v[88:91]
s_add_u32 s91, s91, s17
mf v[88:91],a[244:247],a[148:151],v[88:91]
s_add_u32 s91, s91, 115343360
s_add_u32 s57, s19, 0
mf v[120:123],a[244:247],a[156:159],v[120:123]
ds_read_b128 a[188:191], v129 offset:47104
buffer_store_dwordx4 v[184:187], v142, s[28:31], s57 offen offset:3072 sc1
mf v[120:123],a[240:243],a[152:155],v[120:123]
s_add_u32 s92, s6, s91
s_addc_u32 s93, s7, 0
mf v[124:127],a[248:251],a[152:155],v[124:127]
s_and_b32 s93, s93, 0xffff
mf v[124:127],a[252:255],a[156:159],v[124:127]
s_movk_i32 s94, 6144
mf v[92:95],a[252:255],a[148:151],v[92:95]
s_mov_b32 s95, 0x20000
mf v[92:95],a[248:251],a[144:147],v[92:95]
s_mov_b32 s91, 0
mf v[60:63],a[248:251],a[136:139],v[60:63]
mf v[60:63],a[252:255],a[140:143],v[60:63]
mf v[28:31],a[252:255],a[132:135],v[28:31]
mf v[28:31],a[248:251],a[128:131],v[28:31]
s_waitcnt lgkmcnt(0) vmcnt(8)
s_barrier
s_mov_b64 exec, 0xff
v_cmp_gt_u32 vcc, v253, v254
s_mov_b64 exec, -1
s_cbranch_vccz chk_23
s_mov_b32 s67, 0x80000
s_mov_b64 exec, 0xff
poll_24:
buffer_load_dword v254, v252, s[28:31], 0 offen sc1
s_waitcnt vmcnt(0)
v_cmp_gt_u32 vcc, v253, v254
s_cbranch_vccz pollok_25
s_sleep 2
s_sub_u32 s67, s67, 1
s_cmp_lg_u32 s67, 0
s_cbranch_scc1 poll_24
pollok_25:
s_mov_b64 exec, -1
chk_23:
mf a[0:3],a[192:195],a[160:163],a[0:3]
ds_read_b128 a[128:131], v128 offset:0
ds_read_b128 a[132:135], v129 offset:0
mf a[0:3],a[196:199],a[164:167],a[0:3]
s_add_u32 m0, s40, 98304
mf a[32:35],a[196:199],a[172:175],a[32:35]
mf a[32:35],a[192:195],a[168:171],a[32:35]
s_add_u32 s33, s32, 0
mf a[64:67],a[192:195],a[176:179],a[64:67]
ds_read_b128 a[136:139], v128 offset:2048
ds_read_b128 a[140:143], v129 offset:2048
mf a[64:67],a[196:199],a[180:183],a[64:67]
mf a[96:99],a[196:199],a[188:191],a[96:99]
mf a[96:99],a[192:195],a[184:187],a[96:99]
buffer_load_dwordx4 v206, s[20:23], s33 offen offset:0 sc1 lds
mf a[100:103],a[200:203],a[184:187],a[100:103]
ds_read_b128 a[144:147], v128 offset:4096
ds_read_b128 a[148:151], v129 offset:4096
mf a[100:103],a[204:207],a[188:191],a[100:103]
mf a[68:71],a[204:207],a[180:183],a[68:71]
mf a[68:71],a[200:203],a[176:179],a[68:71]
buffer_load_dwordx4 v206, s[20:23], s33 offen offset:1024 sc1 lds
mf a[36:39],a[200:203],a[168:171],a[36:39]
ds_read_b64_tr_b16 a[192:193], v130 offset:0
ds_read_b64_tr_b16 a[194:195], v130 offset:2048
mf a[36:39],a[204:207],a[172:175],a[36:39]
mf a[4:7],a[204:207],a[164:167],a[4:7]
mf a[4:7],a[200:203],a[160:163],a[4:7]
buffer_load_dwordx4 v206, s[20:23], s33 offen offset:2048 sc1 lds
mf a[8:11],a[208:211],a[160:163],a[8:11]
ds_read_b64_tr_b16 a[196:197], v130 offset:16384
ds_read_b64_tr_b16 a[198:199], v130 offset:18432
mf a[8:11],a[212:215],a[164:167],a[8:11]
mf a[40:43],a[212:215],a[172:175],a[40:43]
buffer_load_dwordx4 v206, s[20:23], s33 offen offset:3072 sc1 lds
mf a[40:43],a[208:211],a[168:171],a[40:43]
mf a[72:75],a[208:211],a[176:179],a[72:75]
ds_read_b128 a[152:155], v128 offset:6144
ds_read_b128 a[156:159], v129 offset:6144
mf a[72:75],a[212:215],a[180:183],a[72:75]
mf a[104:107],a[212:215],a[188:191],a[104:107]
s_add_u32 m0, s40, 114688
mf a[104:107],a[208:211],a[184:187],a[104:107]
mf a[108:111],a[216:219],a[184:187],a[108:111]
ds_read_b64_tr_b16 a[200:201], v131 offset:0
ds_read_b64_tr_b16 a[202:203], v131 offset:2048
mf a[108:111],a[220:223],a[188:191],a[108:111]
mf a[76:79],a[220:223],a[180:183],a[76:79]
s_add_u32 s33, s32, 16384
mf a[76:79],a[216:219],a[176:179],a[76:79]
mf a[44:47],a[216:219],a[168:171],a[44:47]
ds_read_b64_tr_b16 a[204:205], v131 offset:16384
ds_read_b64_tr_b16 a[206:207], v131 offset:18432
mf a[44:47],a[220:223],a[172:175],a[44:47]
mf a[12:15],a[220:223],a[164:167],a[12:15]
buffer_load_dwordx4 v206, s[20:23], s33 offen offset:0 sc1 lds
mf a[12:15],a[216:219],a[160:163],a[12:15]
mf a[16:19],a[224:227],a[160:163],a[16:19]
mf a[16:19],a[228:231],a[164:167],a[16:19]
buffer_load_dwordx4 v206, s[20:23], s33 offen offset:1024 sc1 lds
mf a[48:51],a[228:231],a[172:175],a[48:51]
mf a[48:51],a[224:227],a[168:171],a[48:51]
mf a[80:83],a[224:227],a[176:179],a[80:83]
ds_read_b64_tr_b16 a[208:209], v132 offset:0
ds_read_b64_tr_b16 a[210:211], v132 offset:2048
mf a[80:83],a[228:231],a[180:183],a[80:83]
buffer_load_dwordx4 v206, s[20:23], s33 offen offset:2048 sc1 lds
mf a[112:115],a[228:231],a[188:191],a[112:115]
mf a[112:115],a[224:227],a[184:187],a[112:115]
mf a[116:119],a[232:235],a[184:187],a[116:119]
ds_read_b64_tr_b16 a[212:213], v132 offset:16384
ds_read_b64_tr_b16 a[214:215], v132 offset:18432
mf a[116:119],a[236:239],a[188:191],a[116:119]
buffer_load_dwordx4 v206, s[20:23], s33 offen offset:3072 sc1 lds
mf a[84:87],a[236:239],a[180:183],a[84:87]
mf a[84:87],a[232:235],a[176:179],a[84:87]
mf a[52:55],a[232:235],a[168:171],a[52:55]
mf a[52:55],a[236:239],a[172:175],a[52:55]
s_add_u32 m0, s40, 32768
mf a[20:23],a[236:239],a[164:167],a[20:23]
mf a[20:23],a[232:235],a[160:163],a[20:23]
mf a[24:27],a[240:243],a[160:163],a[24:27]
ds_read_b64_tr_b16 a[216:217], v133 offset:0
ds_read_b64_tr_b16 a[218:219], v133 offset:2048
mf a[24:27],a[244:247],a[164:167],a[24:27]
s_add_u32 s33, s32, 0
mf a[56:59],a[244:247],a[172:175],a[56:59]
mf a[56:59],a[240:243],a[168:171],a[56:59]
mf a[88:91],a[240:243],a[176:179],a[88:91]
ds_read_b64_tr_b16 a[220:221], v133 offset:16384
ds_read_b64_tr_b16 a[222:223], v133 offset:18432
mf a[88:91],a[244:247],a[180:183],a[88:91]
buffer_load_dwordx4 v206, s[24:27], s33 offen offset:0 sc1 lds
mf a[120:123],a[244:247],a[188:191],a[120:123]
mf a[120:123],a[240:243],a[184:187],a[120:123]
mf a[124:127],a[248:251],a[184:187],a[124:127]
buffer_load_dwordx4 v206, s[24:27], s33 offen offset:1024 sc1 lds
mf a[124:127],a[252:255],a[188:191],a[124:127]
mf a[92:95],a[252:255],a[180:183],a[92:95]
mf a[92:95],a[248:251],a[176:179],a[92:95]
mf a[60:63],a[248:251],a[168:171],a[60:63]
mf a[60:63],a[252:255],a[172:175],a[60:63]
mf a[28:31],a[252:255],a[164:167],a[28:31]
mf a[28:31],a[248:251],a[160:163],a[28:31]
s_waitcnt lgkmcnt(0)
mf v[0:3],a[192:195],a[128:131],v[0:3]
ds_read_b64_tr_b16 a[224:225], v134 offset:0
mf v[0:3],a[196:199],a[132:135],v[0:3]
buffer_load_dwordx4 v206, s[24:27], s33 offen offset:2048 sc1 lds
mf v[32:35],a[196:199],a[140:143],v[32:35]
ds_read_b64_tr_b16 a[226:227], v134 offset:2048
buffer_load_dwordx4 v206, s[24:27], s33 offen offset:3072 sc1 lds
mf v[32:35],a[192:195],a[136:139],v[32:35]
mf v[64:67],a[192:195],a[144:147],v[64:67]
ds_read_b64_tr_b16 a[228:229], v134 offset:16384
s_add_u32 m0, s40, 131072
mf v[64:67],a[196:199],a[148:151],v[64:67]
mf v[96:99],a[196:199],a[156:159],v[96:99]
ds_read_b64_tr_b16 a[230:231], v134 offset:18432
s_add_u32 s33, s32, 32768
mf v[96:99],a[192:195],a[152:155],v[96:99]
mf v[100:103],a[200:203],a[152:155],v[100:103]
ds_read_b64_tr_b16 a[232:233], v135 offset:0
buffer_load_dwordx4 v206, s[20:23], s33 offen offset:0 sc1 lds
mf v[100:103],a[204:207],a[156:159],v[100:103]
buffer_load_dwordx4 v206, s[20:23], s33 offen offset:1024 sc1 lds
mf v[68:71],a[204:207],a[148:151],v[68:71]
ds_read_b64_tr_b16 a[234:235], v135 offset:2048
mf v[68:71],a[200:203],a[144:147],v[68:71]
buffer_load_dwordx4 v206, s[20:23], s33 offen offset:2048 sc1 lds
mf v[36:39],a[200:203],a[136:139],v[36:39]
ds_read_b64_tr_b16 a[236:237], v135 offset:16384
mf v[36:39],a[204:207],a[140:143],v[36:39]
buffer_load_dwordx4 v206, s[20:23], s33 offen offset:3072 sc1 lds
mf v[4:7],a[204:207],a[132:135],v[4:7]
ds_read_b64_tr_b16 a[238:239], v135 offset:18432
mf v[4:7],a[200:203],a[128:131],v[4:7]
s_add_u32 m0, s40, 49152
mf v[8:11],a[208:211],a[128:131],v[8:11]
ds_read_b64_tr_b16 a[240:241], v136 offset:0
mf v[8:11],a[212:215],a[132:135],v[8:11]
s_add_u32 s33, s32, 16384
mf v[40:43],a[212:215],a[140:143],v[40:43]
ds_read_b64_tr_b16 a[242:243], v136 offset:2048
buffer_load_dwordx4 v206, s[24:27], s33 offen offset:0 sc1 lds
mf v[40:43],a[208:211],a[136:139],v[40:43]
mf v[72:75],a[208:211],a[144:147],v[72:75]
ds_read_b64_tr_b16 a[244:245], v136 offset:16384
buffer_load_dwordx4 v206, s[24:27], s33 offen offset:1024 sc1 lds
mf v[72:75],a[212:215],a[148:151],v[72:75]
mf v[104:107],a[212:215],a[156:159],v[104:107]
ds_read_b64_tr_b16 a[246:247], v136 offset:18432
buffer_load_dwordx4 v206, s[24:27], s33 offen offset:2048 sc1 lds
mf v[104:107],a[208:211],a[152:155],v[104:107]
mf v[108:111],a[216:219],a[152:155],v[108:111]
ds_read_b64_tr_b16 a[248:249], v137 offset:0
buffer_load_dwordx4 v206, s[24:27], s33 offen offset:3072 sc1 lds
mf v[108:111],a[220:223],a[156:159],v[108:111]
mf v[76:79],a[220:223],a[148:151],v[76:79]
ds_read_b64_tr_b16 a[250:251], v137 offset:2048
s_and_b32 s17, s16, 1
mf v[76:79],a[216:219],a[144:147],v[76:79]
s_lshl_b32 s19, s17, 16
mf v[44:47],a[216:219],a[136:139],v[44:47]
ds_read_b64_tr_b16 a[252:253], v137 offset:16384
mf v[44:47],a[220:223],a[140:143],v[44:47]
s_lshr_b32 s18, s16, 1
mf v[12:15],a[220:223],a[132:135],v[12:15]
ds_read_b64_tr_b16 a[254:255], v137 offset:18432
mf v[12:15],a[216:219],a[128:131],v[12:15]
s_lshl_b32 s36, s18, 12
s_waitcnt lgkmcnt(8)
mf v[16:19],a[224:227],a[128:131],v[16:19]
mf v[16:19],a[228:231],a[132:135],v[16:19]
ds_read_b128 a[160:163], v128 offset:8192
s_add_u32 s19, s19, s36
mf v[48:51],a[228:231],a[140:143],v[48:51]
v_add_u32 v143, s19, v142
mf v[48:51],a[224:227],a[136:139],v[48:51]
mf v[80:83],a[224:227],a[144:147],v[80:83]
ds_read_b128 a[164:167], v129 offset:8192
s_lshl_b32 s19, s18, 16
mf v[80:83],a[228:231],a[148:151],v[80:83]
mf v[112:115],a[228:231],a[156:159],v[112:115]
s_lshl_b32 s37, s17, 14
mf v[112:115],a[224:227],a[152:155],v[112:115]
ds_read_b128 a[168:171], v128 offset:10240
mf v[116:119],a[232:235],a[152:155],v[116:119]
s_add_u32 s19, s19, s37
mf v[116:119],a[236:239],a[156:159],v[116:119]
mf v[84:87],a[236:239],a[148:151],v[84:87]
ds_read_b128 a[172:175], v129 offset:10240
v_add_u32 v144, s19, v142
mf v[84:87],a[232:235],a[144:147],v[84:87]
s_lshl_b32 s37, s17, 15
mf v[52:55],a[232:235],a[136:139],v[52:55]
mf v[52:55],a[236:239],a[140:143],v[52:55]
ds_read_b128 a[176:179], v128 offset:12288
s_add_u32 s36, s36, s37
mf v[20:23],a[236:239],a[132:135],v[20:23]
mf v[20:23],a[232:235],a[128:131],v[20:23]
s_lshl_b32 s37, s15, 20
s_waitcnt lgkmcnt(5)
mf v[24:27],a[240:243],a[128:131],v[24:27]
ds_read_b128 a[180:183], v129 offset:12288
mf v[24:27],a[244:247],a[132:135],v[24:27]
s_add_u32 s36, s36, s37
mf v[56:59],a[244:247],a[140:143],v[56:59]
mf v[56:59],a[240:243],a[136:139],v[56:59]
ds_read_b128 a[184:187], v128 offset:14336
s_add_u32 s36, s36, 33554432
mf v[88:91],a[240:243],a[144:147],v[88:91]
s_lshl_b32 s37, s14, 16
mf v[88:91],a[244:247],a[148:151],v[88:91]
mf v[120:123],a[244:247],a[156:159],v[120:123]
ds_read_b128 a[188:191], v129 offset:14336
s_add_u32 s39, s36, s37
mf v[120:123],a[240:243],a[152:155],v[120:123]
mf v[124:127],a[248:251],a[152:155],v[124:127]
s_lshl_b32 s37, s8, 16
mf v[124:127],a[252:255],a[156:159],v[124:127]
mf v[92:95],a[252:255],a[148:151],v[92:95]
s_add_u32 s36, s36, s37
mf v[92:95],a[248:251],a[144:147],v[92:95]
mf v[60:63],a[248:251],a[136:139],v[60:63]
mf v[60:63],a[252:255],a[140:143],v[60:63]
mf v[28:31],a[252:255],a[132:135],v[28:31]
mf v[28:31],a[248:251],a[128:131],v[28:31]
s_waitcnt lgkmcnt(0)
s_barrier
mf a[0:3],a[192:195],a[160:163],a[0:3]
s_add_u32 m0, s40, 147456
s_add_u32 s33, s32, 49152
buffer_load_dwordx4 v206, s[20:23], s33 offen offset:0 sc1 lds
buffer_load_dwordx4 v206, s[20:23], s33 offen offset:1024 sc1 lds
mf a[0:3],a[196:199],a[164:167],a[0:3]
buffer_load_dwordx4 v206, s[20:23], s33 offen offset:2048 sc1 lds
buffer_load_dwordx4 v206, s[20:23], s33 offen offset:3072 sc1 lds
s_add_u32 s32, s32, 32768
mf a[32:35],a[196:199],a[172:175],a[32:35]
mf a[32:35],a[192:195],a[168:171],a[32:35]
mf a[64:67],a[192:195],a[176:179],a[64:67]
v_mul_f32 v148, s54, v0
v_mul_f32 v149, s54, v1
v_mul_f32 v150, s54, v2
v_mul_f32 v151, s54, v3
mf a[64:67],a[196:199],a[180:183],a[64:67]
v_mul_f32 v152, s54, v4
v_mul_f32 v153, s54, v5
v_mul_f32 v154, s54, v6
v_mul_f32 v155, s54, v7
mf a[96:99],a[196:199],a[188:191],a[96:99]
v_cvt_pk_bf16_f32 v0, v148, v149
v_cvt_pk_bf16_f32 v1, v150, v151
v_cvt_pk_bf16_f32 v2, v152, v153
v_cvt_pk_bf16_f32 v3, v154, v155
mf a[96:99],a[192:195],a[184:187],a[96:99]
ds_write_b128 v143, v[0:3] offset:0
v_mul_f32 v148, s54, v8
v_mul_f32 v149, s54, v9
v_mul_f32 v150, s54, v10
mf a[100:103],a[200:203],a[184:187],a[100:103]
v_mul_f32 v151, s54, v11
v_mul_f32 v152, s54, v12
v_mul_f32 v153, s54, v13
v_mul_f32 v154, s54, v14
mf a[100:103],a[204:207],a[188:191],a[100:103]
v_mul_f32 v155, s54, v15
v_cvt_pk_bf16_f32 v4, v148, v149
v_cvt_pk_bf16_f32 v5, v150, v151
v_cvt_pk_bf16_f32 v6, v152, v153
mf a[68:71],a[204:207],a[180:183],a[68:71]
v_cvt_pk_bf16_f32 v7, v154, v155
ds_write_b128 v143, v[4:7] offset:1024
buffer_store_dwordx4 v[0:3], v142, s[28:31], s36 offen offset:0 sc1
v_mul_f32 v148, s54, v16
mf a[68:71],a[200:203],a[176:179],a[68:71]
v_mul_f32 v149, s54, v17
v_mul_f32 v150, s54, v18
v_mul_f32 v151, s54, v19
v_mul_f32 v152, s54, v20
mf a[36:39],a[200:203],a[168:171],a[36:39]
v_mul_f32 v153, s54, v21
v_mul_f32 v154, s54, v22
v_mul_f32 v155, s54, v23
v_cvt_pk_bf16_f32 v8, v148, v149
mf a[36:39],a[204:207],a[172:175],a[36:39]
v_cvt_pk_bf16_f32 v9, v150, v151
v_cvt_pk_bf16_f32 v10, v152, v153
v_cvt_pk_bf16_f32 v11, v154, v155
ds_write_b128 v143, v[8:11] offset:2048
mf a[4:7],a[204:207],a[164:167],a[4:7]
v_mul_f32 v148, s54, v24
v_mul_f32 v149, s54, v25
v_mul_f32 v150, s54, v26
v_mul_f32 v151, s54, v27
mf a[4:7],a[200:203],a[160:163],a[4:7]
v_mul_f32 v152, s54, v28
v_mul_f32 v153, s54, v29
v_mul_f32 v154, s54, v30
v_mul_f32 v155, s54, v31
mf a[8:11],a[208:211],a[160:163],a[8:11]
v_cvt_pk_bf16_f32 v12, v148, v149
v_cvt_pk_bf16_f32 v13, v150, v151
v_cvt_pk_bf16_f32 v14, v152, v153
v_cvt_pk_bf16_f32 v15, v154, v155
mf a[8:11],a[212:215],a[164:167],a[8:11]
ds_write_b128 v143, v[12:15] offset:3072
buffer_store_dwordx4 v[4:7], v142, s[28:31], s36 offen offset:1024 sc1
v_mul_f32 v148, s54, v32
v_mul_f32 v149, s54, v33
mf a[40:43],a[212:215],a[172:175],a[40:43]
v_mul_f32 v150, s54, v34
v_mul_f32 v151, s54, v35
v_mul_f32 v152, s54, v36
v_mul_f32 v153, s54, v37
mf a[40:43],a[208:211],a[168:171],a[40:43]
v_mul_f32 v154, s54, v38
v_mul_f32 v155, s54, v39
v_cvt_pk_bf16_f32 v16, v148, v149
v_cvt_pk_bf16_f32 v17, v150, v151
mf a[72:75],a[208:211],a[176:179],a[72:75]
v_cvt_pk_bf16_f32 v18, v152, v153
v_cvt_pk_bf16_f32 v19, v154, v155
ds_write_b128 v143, v[16:19] offset:8192
v_mul_f32 v148, s54, v40
mf a[72:75],a[212:215],a[180:183],a[72:75]
v_mul_f32 v149, s54, v41
v_mul_f32 v150, s54, v42
v_mul_f32 v151, s54, v43
v_mul_f32 v152, s54, v44
mf a[104:107],a[212:215],a[188:191],a[104:107]
v_mul_f32 v153, s54, v45
v_mul_f32 v154, s54, v46
v_mul_f32 v155, s54, v47
v_cvt_pk_bf16_f32 v20, v148, v149
mf a[104:107],a[208:211],a[184:187],a[104:107]
v_cvt_pk_bf16_f32 v21, v150, v151
v_cvt_pk_bf16_f32 v22, v152, v153
v_cvt_pk_bf16_f32 v23, v154, v155
ds_write_b128 v143, v[20:23] offset:9216
mf a[108:111],a[216:219],a[184:187],a[108:111]
buffer_store_dwordx4 v[8:11], v142, s[28:31], s36 offen offset:2048 sc1
v_mul_f32 v148, s54, v48
v_mul_f32 v149, s54, v49
v_mul_f32 v150, s54, v50
mf a[108:111],a[220:223],a[188:191],a[108:111]
v_mul_f32 v151, s54, v51
v_mul_f32 v152, s54, v52
v_mul_f32 v153, s54, v53
v_mul_f32 v154, s54, v54
mf a[76:79],a[220:223],a[180:183],a[76:79]
v_mul_f32 v155, s54, v55
v_cvt_pk_bf16_f32 v24, v148, v149
v_cvt_pk_bf16_f32 v25, v150, v151
v_cvt_pk_bf16_f32 v26, v152, v153
mf a[76:79],a[216:219],a[176:179],a[76:79]
v_cvt_pk_bf16_f32 v27, v154, v155
ds_write_b128 v143, v[24:27] offset:10240
v_mul_f32 v148, s54, v56
v_mul_f32 v149, s54, v57
mf a[44:47],a[216:219],a[168:171],a[44:47]
v_mul_f32 v150, s54, v58
v_mul_f32 v151, s54, v59
v_mul_f32 v152, s54, v60
v_mul_f32 v153, s54, v61
mf a[44:47],a[220:223],a[172:175],a[44:47]
v_mul_f32 v154, s54, v62
v_mul_f32 v155, s54, v63
v_cvt_pk_bf16_f32 v28, v148, v149
v_cvt_pk_bf16_f32 v29, v150, v151
mf a[12:15],a[220:223],a[164:167],a[12:15]
v_cvt_pk_bf16_f32 v30, v152, v153
v_cvt_pk_bf16_f32 v31, v154, v155
ds_write_b128 v143, v[28:31] offset:11264
buffer_store_dwordx4 v[12:15], v142, s[28:31], s36 offen offset:3072 sc1
mf a[12:15],a[216:219],a[160:163],a[12:15]
s_add_u32 s36, s36, 8192
v_mul_f32 v148, s54, v64
v_mul_f32 v149, s54, v65
v_mul_f32 v150, s54, v66
mf a[16:19],a[224:227],a[160:163],a[16:19]
v_mul_f32 v151, s54, v67
v_mul_f32 v152, s54, v68
v_mul_f32 v153, s54, v69
v_mul_f32 v154, s54, v70
mf a[16:19],a[228:231],a[164:167],a[16:19]
v_mul_f32 v155, s54, v71
v_cvt_pk_bf16_f32 v32, v148, v149
v_cvt_pk_bf16_f32 v33, v150, v151
v_cvt_pk_bf16_f32 v34, v152, v153
mf a[48:51],a[228:231],a[172:175],a[48:51]
v_cvt_pk_bf16_f32 v35, v154, v155
ds_write_b128 v143, v[32:35] offset:16384
v_mul_f32 v148, s54, v72
v_mul_f32 v149, s54, v73
mf a[48:51],a[224:227],a[168:171],a[48:51]
v_mul_f32 v150, s54, v74
v_mul_f32 v151, s54, v75
v_mul_f32 v152, s54, v76
v_mul_f32 v153, s54, v77
mf a[80:83],a[224:227],a[176:179],a[80:83]
v_mul_f32 v154, s54, v78
v_mul_f32 v155, s54, v79
v_cvt_pk_bf16_f32 v36, v148, v149
v_cvt_pk_bf16_f32 v37, v150, v151
mf a[80:83],a[228:231],a[180:183],a[80:83]
v_cvt_pk_bf16_f32 v38, v152, v153
v_cvt_pk_bf16_f32 v39, v154, v155
ds_write_b128 v143, v[36:39] offset:17408
buffer_store_dwordx4 v[16:19], v142, s[28:31], s36 offen offset:0 sc1
mf a[112:115],a[228:231],a[188:191],a[112:115]
v_mul_f32 v148, s54, v80
v_mul_f32 v149, s54, v81
v_mul_f32 v150, s54, v82
v_mul_f32 v151, s54, v83
mf a[112:115],a[224:227],a[184:187],a[112:115]
v_mul_f32 v152, s54, v84
v_mul_f32 v153, s54, v85
v_mul_f32 v154, s54, v86
v_mul_f32 v155, s54, v87
mf a[116:119],a[232:235],a[184:187],a[116:119]
v_cvt_pk_bf16_f32 v40, v148, v149
v_cvt_pk_bf16_f32 v41, v150, v151
v_cvt_pk_bf16_f32 v42, v152, v153
v_cvt_pk_bf16_f32 v43, v154, v155
mf a[116:119],a[236:239],a[188:191],a[116:119]
ds_write_b128 v143, v[40:43] offset:18432
v_mul_f32 v148, s54, v88
v_mul_f32 v149, s54, v89
v_mul_f32 v150, s54, v90
mf a[84:87],a[236:239],a[180:183],a[84:87]
v_mul_f32 v151, s54, v91
v_mul_f32 v152, s54, v92
v_mul_f32 v153, s54, v93
v_mul_f32 v154, s54, v94
mf a[84:87],a[232:235],a[176:179],a[84:87]
v_mul_f32 v155, s54, v95
v_cvt_pk_bf16_f32 v44, v148, v149
v_cvt_pk_bf16_f32 v45, v150, v151
v_cvt_pk_bf16_f32 v46, v152, v153
mf a[52:55],a[232:235],a[168:171],a[52:55]
v_cvt_pk_bf16_f32 v47, v154, v155
ds_write_b128 v143, v[44:47] offset:19456
buffer_store_dwordx4 v[20:23], v142, s[28:31], s36 offen offset:1024 sc1
v_mul_f32 v148, s54, v96
mf a[52:55],a[236:239],a[172:175],a[52:55]
v_mul_f32 v149, s54, v97
v_mul_f32 v150, s54, v98
v_mul_f32 v151, s54, v99
v_mul_f32 v152, s54, v100
mf a[20:23],a[236:239],a[164:167],a[20:23]
v_mul_f32 v153, s54, v101
v_mul_f32 v154, s54, v102
v_mul_f32 v155, s54, v103
v_cvt_pk_bf16_f32 v48, v148, v149
mf a[20:23],a[232:235],a[160:163],a[20:23]
v_cvt_pk_bf16_f32 v49, v150, v151
v_cvt_pk_bf16_f32 v50, v152, v153
v_cvt_pk_bf16_f32 v51, v154, v155
ds_write_b128 v143, v[48:51] offset:24576
mf a[24:27],a[240:243],a[160:163],a[24:27]
v_mul_f32 v148, s54, v104
v_mul_f32 v149, s54, v105
v_mul_f32 v150, s54, v106
v_mul_f32 v151, s54, v107
mf a[24:27],a[244:247],a[164:167],a[24:27]
v_mul_f32 v152, s54, v108
v_mul_f32 v153, s54, v109
v_mul_f32 v154, s54, v110
v_mul_f32 v155, s54, v111
mf a[56:59],a[244:247],a[172:175],a[56:59]
v_cvt_pk_bf16_f32 v52, v148, v149
v_cvt_pk_bf16_f32 v53, v150, v151
v_cvt_pk_bf16_f32 v54, v152, v153
v_cvt_pk_bf16_f32 v55, v154, v155
mf a[56:59],a[240:243],a[168:171],a[56:59]
ds_write_b128 v143, v[52:55] offset:25600
buffer_store_dwordx4 v[24:27], v142, s[28:31], s36 offen offset:2048 sc1
v_mul_f32 v148, s54, v112
v_mul_f32 v149, s54, v113
mf a[88:91],a[240:243],a[176:179],a[88:91]
v_mul_f32 v150, s54, v114
v_mul_f32 v151, s54, v115
v_mul_f32 v152, s54, v116
v_mul_f32 v153, s54, v117
mf a[88:91],a[244:247],a[180:183],a[88:91]
v_mul_f32 v154, s54, v118
v_mul_f32 v155, s54, v119
v_cvt_pk_bf16_f32 v56, v148, v149
v_cvt_pk_bf16_f32 v57, v150, v151
mf a[120:123],a[244:247],a[188:191],a[120:123]
v_cvt_pk_bf16_f32 v58, v152, v153
v_cvt_pk_bf16_f32 v59, v154, v155
ds_write_b128 v143, v[56:59] offset:26624
v_mul_f32 v148, s54, v120
mf a[120:123],a[240:243],a[184:187],a[120:123]
v_mul_f32 v149, s54, v121
v_mul_f32 v150, s54, v122
v_mul_f32 v151, s54, v123
v_mul_f32 v152, s54, v124
mf a[124:127],a[248:251],a[184:187],a[124:127]
v_mul_f32 v153, s54, v125
v_mul_f32 v154, s54, v126
v_mul_f32 v155, s54, v127
v_cvt_pk_bf16_f32 v60, v148, v149
mf a[124:127],a[252:255],a[188:191],a[124:127]
v_cvt_pk_bf16_f32 v61, v150, v151
v_cvt_pk_bf16_f32 v62, v152, v153
v_cvt_pk_bf16_f32 v63, v154, v155
ds_write_b128 v143, v[60:63] offset:27648
mf a[92:95],a[252:255],a[180:183],a[92:95]
buffer_store_dwordx4 v[28:31], v142, s[28:31], s36 offen offset:3072 sc1
s_add_u32 s36, s36, 8192
mf a[92:95],a[248:251],a[176:179],a[92:95]
mf a[60:63],a[248:251],a[168:171],a[60:63]
mf a[60:63],a[252:255],a[172:175],a[60:63]
mf a[28:31],a[252:255],a[164:167],a[28:31]
mf a[28:31],a[248:251],a[160:163],a[28:31]
s_nop 3
v_accvgpr_read_b32 v148, a96
v_accvgpr_read_b32 v149, a97
v_accvgpr_read_b32 v150, a98
v_accvgpr_read_b32 v151, a99
v_accvgpr_read_b32 v152, a100
v_accvgpr_read_b32 v153, a101
v_accvgpr_read_b32 v154, a102
v_accvgpr_read_b32 v155, a103
v_pk_mul_f32 v[148:149], v[148:149], s[54:55]
v_pk_mul_f32 v[150:151], v[150:151], s[54:55]
v_pk_mul_f32 v[152:153], v[152:153], s[54:55]
v_pk_mul_f32 v[154:155], v[154:155], s[54:55]
v_cvt_pk_bf16_f32 v112, v148, v149
v_cvt_pk_bf16_f32 v113, v150, v151
v_cvt_pk_bf16_f32 v114, v152, v153
v_cvt_pk_bf16_f32 v115, v154, v155
v_accvgpr_read_b32 v148, a64
v_accvgpr_read_b32 v149, a65
v_accvgpr_read_b32 v150, a66
v_accvgpr_read_b32 v151, a67
v_accvgpr_read_b32 v152, a68
v_accvgpr_read_b32 v153, a69
v_accvgpr_read_b32 v154, a70
v_accvgpr_read_b32 v155, a71
v_pk_mul_f32 v[148:149], v[148:149], s[54:55]
v_pk_mul_f32 v[150:151], v[150:151], s[54:55]
v_pk_mul_f32 v[152:153], v[152:153], s[54:55]
v_pk_mul_f32 v[154:155], v[154:155], s[54:55]
v_cvt_pk_bf16_f32 v96, v148, v149
v_cvt_pk_bf16_f32 v97, v150, v151
v_cvt_pk_bf16_f32 v98, v152, v153
v_cvt_pk_bf16_f32 v99, v154, v155
buffer_store_dwordx4 v[32:35], v142, s[28:31], s36 offen offset:0 sc1
v_accvgpr_read_b32 v148, a32
v_accvgpr_read_b32 v149, a33
v_accvgpr_read_b32 v150, a34
v_accvgpr_read_b32 v151, a35
v_accvgpr_read_b32 v152, a36
v_accvgpr_read_b32 v153, a37
v_accvgpr_read_b32 v154, a38
v_accvgpr_read_b32 v155, a39
v_pk_mul_f32 v[148:149], v[148:149], s[54:55]
v_pk_mul_f32 v[150:151], v[150:151], s[54:55]
v_pk_mul_f32 v[152:153], v[152:153], s[54:55]
v_pk_mul_f32 v[154:155], v[154:155], s[54:55]
v_cvt_pk_bf16_f32 v80, v148, v149
v_cvt_pk_bf16_f32 v81, v150, v151
v_cvt_pk_bf16_f32 v82, v152, v153
v_cvt_pk_bf16_f32 v83, v154, v155
v_accvgpr_read_b32 v148, a0
v_accvgpr_read_b32 v149, a1
v_accvgpr_read_b32 v150, a2
v_accvgpr_read_b32 v151, a3
v_accvgpr_read_b32 v152, a4
v_accvgpr_read_b32 v153, a5
v_accvgpr_read_b32 v154, a6
v_accvgpr_read_b32 v155, a7
v_pk_mul_f32 v[148:149], v[148:149], s[54:55]
v_pk_mul_f32 v[150:151], v[150:151], s[54:55]
v_pk_mul_f32 v[152:153], v[152:153], s[54:55]
v_pk_mul_f32 v[154:155], v[154:155], s[54:55]
v_cvt_pk_bf16_f32 v64, v148, v149
v_cvt_pk_bf16_f32 v65, v150, v151
v_cvt_pk_bf16_f32 v66, v152, v153
v_cvt_pk_bf16_f32 v67, v154, v155
buffer_store_dwordx4 v[36:39], v142, s[28:31], s36 offen offset:1024 sc1
v_accvgpr_read_b32 v148, a104
v_accvgpr_read_b32 v149, a105
v_accvgpr_read_b32 v150, a106
v_accvgpr_read_b32 v151, a107
v_accvgpr_read_b32 v152, a108
v_accvgpr_read_b32 v153, a109
v_accvgpr_read_b32 v154, a110
v_accvgpr_read_b32 v155, a111
v_pk_mul_f32 v[148:149], v[148:149], s[54:55]
v_pk_mul_f32 v[150:151], v[150:151], s[54:55]
v_pk_mul_f32 v[152:153], v[152:153], s[54:55]
v_pk_mul_f32 v[154:155], v[154:155], s[54:55]
v_cvt_pk_bf16_f32 v116, v148, v149
v_cvt_pk_bf16_f32 v117, v150, v151
v_cvt_pk_bf16_f32 v118, v152, v153
v_cvt_pk_bf16_f32 v119, v154, v155
v_accvgpr_read_b32 v148, a72
v_accvgpr_read_b32 v149, a73
v_accvgpr_read_b32 v150, a74
v_accvgpr_read_b32 v151, a75
v_accvgpr_read_b32 v152, a76
v_accvgpr_read_b32 v153, a77
v_accvgpr_read_b32 v154, a78
v_accvgpr_read_b32 v155, a79
v_pk_mul_f32 v[148:149], v[148:149], s[54:55]
v_pk_mul_f32 v[150:151], v[150:151], s[54:55]
v_pk_mul_f32 v[152:153], v[152:153], s[54:55]
v_pk_mul_f32 v[154:155], v[154:155], s[54:55]
v_cvt_pk_bf16_f32 v100, v148, v149
v_cvt_pk_bf16_f32 v101, v150, v151
v_cvt_pk_bf16_f32 v102, v152, v153
v_cvt_pk_bf16_f32 v103, v154, v155
buffer_store_dwordx4 v[40:43], v142, s[28:31], s36 offen offset:2048 sc1
v_accvgpr_read_b32 v148, a40
v_accvgpr_read_b32 v149, a41
v_accvgpr_read_b32 v150, a42
v_accvgpr_read_b32 v151, a43
v_accvgpr_read_b32 v152, a44
v_accvgpr_read_b32 v153, a45
v_accvgpr_read_b32 v154, a46
v_accvgpr_read_b32 v155, a47
v_pk_mul_f32 v[148:149], v[148:149], s[54:55]
v_pk_mul_f32 v[150:151], v[150:151], s[54:55]
v_pk_mul_f32 v[152:153], v[152:153], s[54:55]
v_pk_mul_f32 v[154:155], v[154:155], s[54:55]
v_cvt_pk_bf16_f32 v84, v148, v149
v_cvt_pk_bf16_f32 v85, v150, v151
v_cvt_pk_bf16_f32 v86, v152, v153
v_cvt_pk_bf16_f32 v87, v154, v155
v_accvgpr_read_b32 v148, a8
v_accvgpr_read_b32 v149, a9
v_accvgpr_read_b32 v150, a10
v_accvgpr_read_b32 v151, a11
v_accvgpr_read_b32 v152, a12
v_accvgpr_read_b32 v153, a13
v_accvgpr_read_b32 v154, a14
v_accvgpr_read_b32 v155, a15
v_pk_mul_f32 v[148:149], v[148:149], s[54:55]
v_pk_mul_f32 v[150:151], v[150:151], s[54:55]
v_pk_mul_f32 v[152:153], v[152:153], s[54:55]
v_pk_mul_f32 v[154:155], v[154:155], s[54:55]
v_cvt_pk_bf16_f32 v68, v148, v149
v_cvt_pk_bf16_f32 v69, v150, v151
v_cvt_pk_bf16_f32 v70, v152, v153
v_cvt_pk_bf16_f32 v71, v154, v155
buffer_store_dwordx4 v[44:47], v142, s[28:31], s36 offen offset:3072 sc1
s_add_u32 s36, s36, 8192
v_accvgpr_read_b32 v148, a112
v_accvgpr_read_b32 v149, a113
v_accvgpr_read_b32 v150, a114
v_accvgpr_read_b32 v151, a115
v_accvgpr_read_b32 v152, a116
v_accvgpr_read_b32 v153, a117
v_accvgpr_read_b32 v154, a118
v_accvgpr_read_b32 v155, a119
v_pk_mul_f32 v[148:149], v[148:149], s[54:55]
v_pk_mul_f32 v[150:151], v[150:151], s[54:55]
v_pk_mul_f32 v[152:153], v[152:153], s[54:55]
v_pk_mul_f32 v[154:155], v[154:155], s[54:55]
v_cvt_pk_bf16_f32 v120, v148, v149
v_cvt_pk_bf16_f32 v121, v150, v151
v_cvt_pk_bf16_f32 v122, v152, v153
v_cvt_pk_bf16_f32 v123, v154, v155
v_accvgpr_read_b32 v148, a80
v_accvgpr_read_b32 v149, a81
v_accvgpr_read_b32 v150, a82
v_accvgpr_read_b32 v151, a83
v_accvgpr_read_b32 v152, a84
v_accvgpr_read_b32 v153, a85
v_accvgpr_read_b32 v154, a86
v_accvgpr_read_b32 v155, a87
v_pk_mul_f32 v[148:149], v[148:149], s[54:55]
v_pk_mul_f32 v[150:151], v[150:151], s[54:55]
v_pk_mul_f32 v[152:153], v[152:153], s[54:55]
v_pk_mul_f32 v[154:155], v[154:155], s[54:55]
v_cvt_pk_bf16_f32 v104, v148, v149
v_cvt_pk_bf16_f32 v105, v150, v151
v_cvt_pk_bf16_f32 v106, v152, v153
v_cvt_pk_bf16_f32 v107, v154, v155
buffer_store_dwordx4 v[48:51], v142, s[28:31], s36 offen offset:0 sc1
v_accvgpr_read_b32 v148, a48
v_accvgpr_read_b32 v149, a49
v_accvgpr_read_b32 v150, a50
v_accvgpr_read_b32 v151, a51
v_accvgpr_read_b32 v152, a52
v_accvgpr_read_b32 v153, a53
v_accvgpr_read_b32 v154, a54
v_accvgpr_read_b32 v155, a55
v_pk_mul_f32 v[148:149], v[148:149], s[54:55]
v_pk_mul_f32 v[150:151], v[150:151], s[54:55]
v_pk_mul_f32 v[152:153], v[152:153], s[54:55]
v_pk_mul_f32 v[154:155], v[154:155], s[54:55]
v_cvt_pk_bf16_f32 v88, v148, v149
v_cvt_pk_bf16_f32 v89, v150, v151
v_cvt_pk_bf16_f32 v90, v152, v153
v_cvt_pk_bf16_f32 v91, v154, v155
v_accvgpr_read_b32 v148, a16
v_accvgpr_read_b32 v149, a17
v_accvgpr_read_b32 v150, a18
v_accvgpr_read_b32 v151, a19
v_accvgpr_read_b32 v152, a20
v_accvgpr_read_b32 v153, a21
v_accvgpr_read_b32 v154, a22
v_accvgpr_read_b32 v155, a23
v_pk_mul_f32 v[148:149], v[148:149], s[54:55]
v_pk_mul_f32 v[150:151], v[150:151], s[54:55]
v_pk_mul_f32 v[152:153], v[152:153], s[54:55]
v_pk_mul_f32 v[154:155], v[154:155], s[54:55]
v_cvt_pk_bf16_f32 v72, v148, v149
v_cvt_pk_bf16_f32 v73, v150, v151
v_cvt_pk_bf16_f32 v74, v152, v153
v_cvt_pk_bf16_f32 v75, v154, v155
buffer_store_dwordx4 v[52:55], v142, s[28:31], s36 offen offset:1024 sc1
v_accvgpr_read_b32 v148, a120
v_accvgpr_read_b32 v149, a121
v_accvgpr_read_b32 v150, a122
v_accvgpr_read_b32 v151, a123
v_accvgpr_read_b32 v152, a124
v_accvgpr_read_b32 v153, a125
v_accvgpr_read_b32 v154, a126
v_accvgpr_read_b32 v155, a127
v_pk_mul_f32 v[148:149], v[148:149], s[54:55]
v_pk_mul_f32 v[150:151], v[150:151], s[54:55]
v_pk_mul_f32 v[152:153], v[152:153], s[54:55]
v_pk_mul_f32 v[154:155], v[154:155], s[54:55]
v_cvt_pk_bf16_f32 v124, v148, v149
v_cvt_pk_bf16_f32 v125, v150, v151
v_cvt_pk_bf16_f32 v126, v152, v153
v_cvt_pk_bf16_f32 v127, v154, v155
v_accvgpr_read_b32 v148, a88
v_accvgpr_read_b32 v149, a89
v_accvgpr_read_b32 v150, a90
v_accvgpr_read_b32 v151, a91
v_accvgpr_read_b32 v152, a92
v_accvgpr_read_b32 v153, a93
v_accvgpr_read_b32 v154, a94
v_accvgpr_read_b32 v155, a95
v_pk_mul_f32 v[148:149], v[148:149], s[54:55]
v_pk_mul_f32 v[150:151], v[150:151], s[54:55]
v_pk_mul_f32 v[152:153], v[152:153], s[54:55]
v_pk_mul_f32 v[154:155], v[154:155], s[54:55]
v_cvt_pk_bf16_f32 v108, v148, v149
v_cvt_pk_bf16_f32 v109, v150, v151
v_cvt_pk_bf16_f32 v110, v152, v153
v_cvt_pk_bf16_f32 v111, v154, v155
buffer_store_dwordx4 v[56:59], v142, s[28:31], s36 offen offset:2048 sc1
v_accvgpr_read_b32 v148, a56
v_accvgpr_read_b32 v149, a57
v_accvgpr_read_b32 v150, a58
v_accvgpr_read_b32 v151, a59
v_accvgpr_read_b32 v152, a60
v_accvgpr_read_b32 v153, a61
v_accvgpr_read_b32 v154, a62
v_accvgpr_read_b32 v155, a63
v_pk_mul_f32 v[148:149], v[148:149], s[54:55]
v_pk_mul_f32 v[150:151], v[150:151], s[54:55]
v_pk_mul_f32 v[152:153], v[152:153], s[54:55]
v_pk_mul_f32 v[154:155], v[154:155], s[54:55]
v_cvt_pk_bf16_f32 v92, v148, v149
v_cvt_pk_bf16_f32 v93, v150, v151
v_cvt_pk_bf16_f32 v94, v152, v153
v_cvt_pk_bf16_f32 v95, v154, v155
v_accvgpr_read_b32 v148, a24
v_accvgpr_read_b32 v149, a25
v_accvgpr_read_b32 v150, a26
v_accvgpr_read_b32 v151, a27
v_accvgpr_read_b32 v152, a28
v_accvgpr_read_b32 v153, a29
v_accvgpr_read_b32 v154, a30
v_accvgpr_read_b32 v155, a31
v_pk_mul_f32 v[148:149], v[148:149], s[54:55]
v_pk_mul_f32 v[150:151], v[150:151], s[54:55]
v_pk_mul_f32 v[152:153], v[152:153], s[54:55]
v_pk_mul_f32 v[154:155], v[154:155], s[54:55]
v_cvt_pk_bf16_f32 v76, v148, v149
v_cvt_pk_bf16_f32 v77, v150, v151
v_cvt_pk_bf16_f32 v78, v152, v153
v_cvt_pk_bf16_f32 v79, v154, v155
buffer_store_dwordx4 v[60:63], v142, s[28:31], s36 offen offset:3072 sc1
s_add_u32 s36, s36, 8192
s_waitcnt vmcnt(16) lgkmcnt(0)
s_barrier
ds_read_b128 a[128:131], v144 offset:0
ds_read_b128 a[132:135], v144 offset:1024
ds_read_b128 a[136:139], v144 offset:2048
ds_read_b128 a[140:143], v144 offset:3072
ds_read_b128 a[144:147], v144 offset:4096
ds_read_b128 a[148:151], v144 offset:5120
ds_read_b128 a[152:155], v144 offset:6144
ds_read_b128 a[156:159], v144 offset:7168
ds_read_b128 a[160:163], v144 offset:8192
ds_read_b128 a[164:167], v144 offset:9216
ds_read_b128 a[168:171], v144 offset:10240
ds_read_b128 a[172:175], v144 offset:11264
ds_read_b128 a[176:179], v144 offset:12288
ds_read_b128 a[180:183], v144 offset:13312
ds_read_b128 a[184:187], v144 offset:14336
ds_read_b128 a[188:191], v144 offset:15360
v_pk_mov_b32 v[0:1], 0, 0
v_pk_mov_b32 v[2:3], 0, 0
v_pk_mov_b32 v[4:5], 0, 0
v_pk_mov_b32 v[6:7], 0, 0
v_pk_mov_b32 v[8:9], 0, 0
v_pk_mov_b32 v[10:11], 0, 0
v_pk_mov_b32 v[12:13], 0, 0
v_pk_mov_b32 v[14:15], 0, 0
v_pk_mov_b32 v[16:17], 0, 0
v_pk_mov_b32 v[18:19], 0, 0
v_pk_mov_b32 v[20:21], 0, 0
v_pk_mov_b32 v[22:23], 0, 0
v_pk_mov_b32 v[24:25], 0, 0
v_pk_mov_b32 v[26:27], 0, 0
v_pk_mov_b32 v[28:29], 0, 0
v_pk_mov_b32 v[30:31], 0, 0
v_pk_mov_b32 v[32:33], 0, 0
v_pk_mov_b32 v[34:35], 0, 0
v_pk_mov_b32 v[36:37], 0, 0
v_pk_mov_b32 v[38:39], 0, 0
v_pk_mov_b32 v[40:41], 0, 0
v_pk_mov_b32 v[42:43], 0, 0
v_pk_mov_b32 v[44:45], 0, 0
v_pk_mov_b32 v[46:47], 0, 0
v_pk_mov_b32 v[48:49], 0, 0
v_pk_mov_b32 v[50:51], 0, 0
v_pk_mov_b32 v[52:53], 0, 0
v_pk_mov_b32 v[54:55], 0, 0
v_pk_mov_b32 v[56:57], 0, 0
v_pk_mov_b32 v[58:59], 0, 0
v_pk_mov_b32 v[60:61], 0, 0
v_pk_mov_b32 v[62:63], 0, 0
s_waitcnt lgkmcnt(0)
s_barrier
ds_write_b128 v143, v[64:67] offset:0
ds_write_b128 v143, v[68:71] offset:1024
ds_write_b128 v143, v[72:75] offset:2048
ds_write_b128 v143, v[76:79] offset:3072
ds_write_b128 v143, v[80:83] offset:8192
ds_write_b128 v143, v[84:87] offset:9216
ds_write_b128 v143, v[88:91] offset:10240
ds_write_b128 v143, v[92:95] offset:11264
ds_write_b128 v143, v[96:99] offset:16384
ds_write_b128 v143, v[100:103] offset:17408
ds_write_b128 v143, v[104:107] offset:18432
ds_write_b128 v143, v[108:111] offset:19456
ds_write_b128 v143, v[112:115] offset:24576
ds_write_b128 v143, v[116:119] offset:25600
ds_write_b128 v143, v[120:123] offset:26624
ds_write_b128 v143, v[124:127] offset:27648
s_waitcnt lgkmcnt(0)
s_barrier
ds_read_b128 a[0:3], v144 offset:0
ds_read_b128 a[4:7], v144 offset:1024
ds_read_b128 a[8:11], v144 offset:2048
ds_read_b128 a[12:15], v144 offset:3072
ds_read_b128 a[16:19], v144 offset:4096
ds_read_b128 a[20:23], v144 offset:5120
ds_read_b128 a[24:27], v144 offset:6144
ds_read_b128 a[28:31], v144 offset:7168
ds_read_b128 a[32:35], v144 offset:8192
ds_read_b128 a[36:39], v144 offset:9216
ds_read_b128 a[40:43], v144 offset:10240
ds_read_b128 a[44:47], v144 offset:11264
ds_read_b128 a[48:51], v144 offset:12288
ds_read_b128 a[52:55], v144 offset:13312
ds_read_b128 a[56:59], v144 offset:14336
ds_read_b128 a[60:63], v144 offset:15360
v_pk_mov_b32 v[64:65], 0, 0
v_pk_mov_b32 v[66:67], 0, 0
v_pk_mov_b32 v[68:69], 0, 0
v_pk_mov_b32 v[70:71], 0, 0
v_pk_mov_b32 v[72:73], 0, 0
v_pk_mov_b32 v[74:75], 0, 0
v_pk_mov_b32 v[76:77], 0, 0
v_pk_mov_b32 v[78:79], 0, 0
v_pk_mov_b32 v[80:81], 0, 0
v_pk_mov_b32 v[82:83], 0, 0
v_pk_mov_b32 v[84:85], 0, 0
v_pk_mov_b32 v[86:87], 0, 0
v_pk_mov_b32 v[88:89], 0, 0
v_pk_mov_b32 v[90:91], 0, 0
v_pk_mov_b32 v[92:93], 0, 0
v_pk_mov_b32 v[94:95], 0, 0
v_pk_mov_b32 v[96:97], 0, 0
v_pk_mov_b32 v[98:99], 0, 0
v_pk_mov_b32 v[100:101], 0, 0
v_pk_mov_b32 v[102:103], 0, 0
v_pk_mov_b32 v[104:105], 0, 0
v_pk_mov_b32 v[106:107], 0, 0
v_pk_mov_b32 v[108:109], 0, 0
v_pk_mov_b32 v[110:111], 0, 0
v_pk_mov_b32 v[112:113], 0, 0
v_pk_mov_b32 v[114:115], 0, 0
v_pk_mov_b32 v[116:117], 0, 0
v_pk_mov_b32 v[118:119], 0, 0
v_pk_mov_b32 v[120:121], 0, 0
v_pk_mov_b32 v[122:123], 0, 0
v_pk_mov_b32 v[124:125], 0, 0
v_pk_mov_b32 v[126:127], 0, 0
s_branch att_8
b12_10:
s_load_dwordx2 s[68:69], s[0:1], 72
v_lshrrev_b32 v114, 4, v255
v_lshlrev_b32 v114, 3, v114
v_bfe_u32 v115, v255, 2, 2
v_add_u32 v114, v114, v115
v_mul_u32_u24 v114, 896, v114
v_and_b32 v115, 3, v255
v_lshl_add_u32 v114, v115, 3, v114
v_bfe_u32 v115, v255, 3, 2
s_mul_i32 s17, s16, 7
s_add_u32 s19, s17, 0
v_xor_b32 v116, s19, v115
v_lshl_add_u32 v100, v116, 5, v114
v_add_u32 v107, 0x10000, v100
s_add_u32 s19, s17, 1
v_xor_b32 v116, s19, v115
v_lshl_add_u32 v101, v116, 5, v114
v_add_u32 v108, 0x10000, v101
s_add_u32 s19, s17, 2
v_xor_b32 v116, s19, v115
v_lshl_add_u32 v102, v116, 5, v114
v_add_u32 v109, 0x10000, v102
s_add_u32 s19, s17, 3
v_xor_b32 v116, s19, v115
v_lshl_add_u32 v103, v116, 5, v114
v_add_u32 v110, 0x10000, v103
s_add_u32 s19, s17, 4
v_xor_b32 v116, s19, v115
v_lshl_add_u32 v104, v116, 5, v114
v_add_u32 v111, 0x10000, v104
s_add_u32 s19, s17, 5
v_xor_b32 v116, s19, v115
v_lshl_add_u32 v105, v116, 5, v114
v_add_u32 v112, 0x10000, v105
s_add_u32 s19, s17, 6
v_xor_b32 v116, s19, v115
v_lshl_add_u32 v106, v116, 5, v114
v_add_u32 v113, 0x10000, v106
v_add_u32 v114, 131072, v142
v_and_b32 v115, 1, v255
v_lshlrev_b32 v115, 10, v115
v_sub_u32 v115, v147, v115
v_add_u32 v115, 160768, v115
v_mov_b32 v116, 160768
s_waitcnt vmcnt(53)
s_barrier
ds_read_b64_tr_b16 a[168:169], v100 offset:0
ds_read_b64_tr_b16 a[170:171], v100 offset:3584
ds_read_b64_tr_b16 a[172:173], v101 offset:0
ds_read_b64_tr_b16 a[174:175], v101 offset:3584
ds_read_b64_tr_b16 a[176:177], v102 offset:0
ds_read_b64_tr_b16 a[178:179], v102 offset:3584
ds_read_b64_tr_b16 a[180:181], v103 offset:0
ds_read_b64_tr_b16 a[182:183], v103 offset:3584
ds_read_b64_tr_b16 a[184:185], v104 offset:0
ds_read_b64_tr_b16 a[186:187], v104 offset:3584
ds_read_b64_tr_b16 a[188:189], v105 offset:0
ds_read_b64_tr_b16 a[190:191], v105 offset:3584
ds_read_b64_tr_b16 a[192:193], v106 offset:0
ds_read_b64_tr_b16 a[194:195], v106 offset:3584
ds_read_b128 a[0:3], v114 offset:0
ds_read_b128 a[4:7], v114 offset:14336
ds_read_b128 a[112:115], v115 offset:0
v_and_b32 v117, 15, v255
v_lshlrev_b32 v117, 4, v117
v_lshrrev_b32 v118, 5, v255
v_lshl_add_u32 v117, v118, 8, v117
v_bfe_u32 v118, v255, 4, 1
v_lshl_add_u32 v117, v118, 3, v117
s_mul_i32 s17, s16, 3584
s_add_u32 s17, s17, 131072
v_add_u32 v117, s17, v117
ds_read_b64 v[156:157], v117 offset:0
ds_read_b64 v[158:159], v117 offset:512
ds_read_b64 v[160:161], v117 offset:1024
ds_read_b64 v[162:163], v117 offset:1536
ds_read_b64 v[164:165], v117 offset:2048
ds_read_b64 v[166:167], v117 offset:2560
ds_read_b64 v[168:169], v117 offset:3072
s_add_u32 m0, s18, 0
s_add_u32 s20, s18, 114688
s_waitcnt vmcnt(46) lgkmcnt(0)
s_barrier
buffer_load_dwordx4 v138, s[56:59], s20 offen offset:0 lds
mf v[0:3],a[168:171],a[0:3],0
ds_read_b64_tr_b16 a[196:197], v107 offset:0
ds_read_b64_tr_b16 a[198:199], v107 offset:3584
mf v[28:31],a[168:171],a[4:7],0
ds_read_b64_tr_b16 a[200:201], v108 offset:0
mf v[4:7],a[172:175],a[0:3],0
ds_read_b64_tr_b16 a[202:203], v108 offset:3584
ds_read_b64_tr_b16 a[204:205], v109 offset:0
buffer_load_dwordx4 v139, s[56:59], s20 offen offset:1024 lds
mf v[32:35],a[172:175],a[4:7],0
ds_read_b64_tr_b16 a[206:207], v109 offset:3584
mf v[8:11],a[176:179],a[0:3],0
ds_read_b64_tr_b16 a[208:209], v110 offset:0
ds_read_b64_tr_b16 a[210:211], v110 offset:3584
mf v[36:39],a[176:179],a[4:7],0
ds_read_b64_tr_b16 a[212:213], v111 offset:0
buffer_load_dwordx4 v140, s[56:59], s20 offen offset:2048 lds
mf v[12:15],a[180:183],a[0:3],0
ds_read_b64_tr_b16 a[214:215], v111 offset:3584
mf v[40:43],a[180:183],a[4:7],0
ds_read_b64_tr_b16 a[216:217], v112 offset:0
ds_read_b64_tr_b16 a[218:219], v112 offset:3584
buffer_load_dwordx4 v141, s[56:59], s20 offen offset:3072 lds
mf v[16:19],a[184:187],a[0:3],0
ds_read_b64_tr_b16 a[220:221], v113 offset:0
mf v[44:47],a[184:187],a[4:7],0
ds_read_b64_tr_b16 a[222:223], v113 offset:3584
ds_read_b128 a[8:11], v114 offset:1024
mf v[20:23],a[188:191],a[0:3],0
ds_read_b128 a[12:15], v114 offset:15360
s_add_u32 m0, s18, 4096
s_add_u32 s20, s18, 118784
buffer_load_dwordx4 v143, s[56:59], s20 offen offset:0 lds
mf v[48:51],a[188:191],a[4:7],0
ds_read_b128 a[116:119], v115 offset:64
mf v[24:27],a[192:195],a[0:3],0
buffer_load_dwordx4 v144, s[56:59], s20 offen offset:1024 lds
mf v[52:55],a[192:195],a[4:7],0
mf v[84:87],a[112:115],a[0:3],0
mf v[92:95],a[0:3],a[0:3],0
buffer_load_dwordx4 v145, s[56:59], s20 offen offset:2048 lds
mf v[88:91],a[112:115],a[4:7],0
mf v[96:99],a[4:7],a[4:7],0
s_add_u32 m0, s18, 65536
s_add_u32 s20, s18, 143360
s_waitcnt vmcnt(46) lgkmcnt(0)
s_barrier
buffer_load_dwordx4 v138, s[56:59], s20 offen offset:0 lds
mf v[0:3],a[196:199],a[8:11],v[0:3]
ds_read_b64_tr_b16 a[168:169], v100 offset:32768
ds_read_b64_tr_b16 a[170:171], v100 offset:36352
mf v[28:31],a[196:199],a[12:15],v[28:31]
ds_read_b64_tr_b16 a[172:173], v101 offset:32768
mf v[4:7],a[200:203],a[8:11],v[4:7]
ds_read_b64_tr_b16 a[174:175], v101 offset:36352
ds_read_b64_tr_b16 a[176:177], v102 offset:32768
buffer_load_dwordx4 v139, s[56:59], s20 offen offset:1024 lds
mf v[32:35],a[200:203],a[12:15],v[32:35]
ds_read_b64_tr_b16 a[178:179], v102 offset:36352
mf v[8:11],a[204:207],a[8:11],v[8:11]
ds_read_b64_tr_b16 a[180:181], v103 offset:32768
ds_read_b64_tr_b16 a[182:183], v103 offset:36352
mf v[36:39],a[204:207],a[12:15],v[36:39]
ds_read_b64_tr_b16 a[184:185], v104 offset:32768
buffer_load_dwordx4 v140, s[56:59], s20 offen offset:2048 lds
mf v[12:15],a[208:211],a[8:11],v[12:15]
ds_read_b64_tr_b16 a[186:187], v104 offset:36352
mf v[40:43],a[208:211],a[12:15],v[40:43]
ds_read_b64_tr_b16 a[188:189], v105 offset:32768
ds_read_b64_tr_b16 a[190:191], v105 offset:36352
buffer_load_dwordx4 v141, s[56:59], s20 offen offset:3072 lds
mf v[16:19],a[212:215],a[8:11],v[16:19]
ds_read_b64_tr_b16 a[192:193], v106 offset:32768
mf v[44:47],a[212:215],a[12:15],v[44:47]
ds_read_b64_tr_b16 a[194:195], v106 offset:36352
ds_read_b128 a[16:19], v114 offset:2048
mf v[20:23],a[216:219],a[8:11],v[20:23]
ds_read_b128 a[20:23], v114 offset:16384
s_add_u32 m0, s18, 69632
s_add_u32 s20, s18, 147456
buffer_load_dwordx4 v143, s[56:59], s20 offen offset:0 lds
mf v[48:51],a[216:219],a[12:15],v[48:51]
ds_read_b128 a[120:123], v115 offset:128
mf v[24:27],a[220:223],a[8:11],v[24:27]
buffer_load_dwordx4 v144, s[56:59], s20 offen offset:1024 lds
mf v[52:55],a[220:223],a[12:15],v[52:55]
mf v[84:87],a[116:119],a[8:11],v[84:87]
mf v[92:95],a[8:11],a[8:11],v[92:95]
buffer_load_dwordx4 v145, s[56:59], s20 offen offset:2048 lds
mf v[88:91],a[116:119],a[12:15],v[88:91]
mf v[96:99],a[12:15],a[12:15],v[96:99]
s_add_u32 m0, s18, 32768
s_add_u32 s20, s18, 172032
s_waitcnt vmcnt(46) lgkmcnt(0)
s_barrier
buffer_load_dwordx4 v138, s[56:59], s20 offen offset:0 lds
mf v[0:3],a[168:171],a[16:19],v[0:3]
ds_read_b64_tr_b16 a[196:197], v107 offset:32768
ds_read_b64_tr_b16 a[198:199], v107 offset:36352
mf v[28:31],a[168:171],a[20:23],v[28:31]
ds_read_b64_tr_b16 a[200:201], v108 offset:32768
mf v[4:7],a[172:175],a[16:19],v[4:7]
ds_read_b64_tr_b16 a[202:203], v108 offset:36352
ds_read_b64_tr_b16 a[204:205], v109 offset:32768
buffer_load_dwordx4 v139, s[56:59], s20 offen offset:1024 lds
mf v[32:35],a[172:175],a[20:23],v[32:35]
ds_read_b64_tr_b16 a[206:207], v109 offset:36352
mf v[8:11],a[176:179],a[16:19],v[8:11]
ds_read_b64_tr_b16 a[208:209], v110 offset:32768
ds_read_b64_tr_b16 a[210:211], v110 offset:36352
mf v[36:39],a[176:179],a[20:23],v[36:39]
ds_read_b64_tr_b16 a[212:213], v111 offset:32768
buffer_load_dwordx4 v140, s[56:59], s20 offen offset:2048 lds
mf v[12:15],a[180:183],a[16:19],v[12:15]
ds_read_b64_tr_b16 a[214:215], v111 offset:36352
mf v[40:43],a[180:183],a[20:23],v[40:43]
ds_read_b64_tr_b16 a[216:217], v112 offset:32768
ds_read_b64_tr_b16 a[218:219], v112 offset:36352
buffer_load_dwordx4 v141, s[56:59], s20 offen offset:3072 lds
mf v[16:19],a[184:187],a[16:19],v[16:19]
ds_read_b64_tr_b16 a[220:221], v113 offset:32768
mf v[44:47],a[184:187],a[20:23],v[44:47]
ds_read_b64_tr_b16 a[222:223], v113 offset:36352
ds_read_b128 a[24:27], v114 offset:3072
mf v[20:23],a[188:191],a[16:19],v[20:23]
ds_read_b128 a[28:31], v114 offset:17408
s_add_u32 m0, s18, 36864
s_add_u32 s20, s18, 176128
buffer_load_dwordx4 v143, s[56:59], s20 offen offset:0 lds
mf v[48:51],a[188:191],a[20:23],v[48:51]
ds_read_b128 a[124:127], v115 offset:192
mf v[24:27],a[192:195],a[16:19],v[24:27]
buffer_load_dwordx4 v144, s[56:59], s20 offen offset:1024 lds
mf v[52:55],a[192:195],a[20:23],v[52:55]
mf v[84:87],a[120:123],a[16:19],v[84:87]
mf v[92:95],a[16:19],a[16:19],v[92:95]
buffer_load_dwordx4 v145, s[56:59], s20 offen offset:2048 lds
mf v[88:91],a[120:123],a[20:23],v[88:91]
mf v[96:99],a[20:23],a[20:23],v[96:99]
s_add_u32 m0, s18, 98304
s_add_u32 s20, s18, 200704
s_waitcnt vmcnt(14) lgkmcnt(0)
s_barrier
buffer_load_dwordx4 v138, s[56:59], s20 offen offset:0 lds
s_cmp_lg_u32 s16, 0
s_cbranch_scc1 nofl_26
v_mov_b32 v134, 1
v_mov_b32 v135, 0
s_mov_b64 exec, 1
buffer_store_dword v134, v135, s[28:31], s3 offen sc1
s_mov_b64 exec, -1
nofl_26:
mf v[0:3],a[196:199],a[24:27],v[0:3]
ds_read_b64_tr_b16 a[168:169], v100 offset:0
ds_read_b64_tr_b16 a[170:171], v100 offset:3584
mf v[28:31],a[196:199],a[28:31],v[28:31]
ds_read_b64_tr_b16 a[172:173], v101 offset:0
mf v[4:7],a[200:203],a[24:27],v[4:7]
ds_read_b64_tr_b16 a[174:175], v101 offset:3584
ds_read_b64_tr_b16 a[176:177], v102 offset:0
buffer_load_dwordx4 v139, s[56:59], s20 offen offset:1024 lds
mf v[32:35],a[200:203],a[28:31],v[32:35]
ds_read_b64_tr_b16 a[178:179], v102 offset:3584
mf v[8:11],a[204:207],a[24:27],v[8:11]
ds_read_b64_tr_b16 a[180:181], v103 offset:0
ds_read_b64_tr_b16 a[182:183], v103 offset:3584
mf v[36:39],a[204:207],a[28:31],v[36:39]
ds_read_b64_tr_b16 a[184:185], v104 offset:0
buffer_load_dwordx4 v140, s[56:59], s20 offen offset:2048 lds
mf v[12:15],a[208:211],a[24:27],v[12:15]
ds_read_b64_tr_b16 a[186:187], v104 offset:3584
mf v[40:43],a[208:211],a[28:31],v[40:43]
ds_read_b64_tr_b16 a[188:189], v105 offset:0
ds_read_b64_tr_b16 a[190:191], v105 offset:3584
buffer_load_dwordx4 v141, s[56:59], s20 offen offset:3072 lds
mf v[16:19],a[212:215],a[24:27],v[16:19]
ds_read_b64_tr_b16 a[192:193], v106 offset:0
mf v[44:47],a[212:215],a[28:31],v[44:47]
ds_read_b64_tr_b16 a[194:195], v106 offset:3584
ds_read_b128 a[32:35], v114 offset:4096
mf v[20:23],a[216:219],a[24:27],v[20:23]
ds_read_b128 a[36:39], v114 offset:18432
s_add_u32 m0, s18, 102400
s_add_u32 s20, s18, 204800
buffer_load_dwordx4 v143, s[56:59], s20 offen offset:0 lds
mf v[48:51],a[216:219],a[28:31],v[48:51]
ds_read_b128 a[128:131], v115 offset:256
mf v[24:27],a[220:223],a[24:27],v[24:27]
buffer_load_dwordx4 v144, s[56:59], s20 offen offset:1024 lds
mf v[52:55],a[220:223],a[28:31],v[52:55]
mf v[84:87],a[124:127],a[24:27],v[84:87]
mf v[92:95],a[24:27],a[24:27],v[92:95]
buffer_load_dwordx4 v145, s[56:59], s20 offen offset:2048 lds
mf v[88:91],a[124:127],a[28:31],v[88:91]
mf v[96:99],a[28:31],a[28:31],v[96:99]
s_add_u32 m0, s18, 0
s_add_u32 s20, s18, 229376
s_waitcnt vmcnt(14) lgkmcnt(0)
s_barrier
buffer_load_dwordx4 v138, s[56:59], s20 offen offset:0 lds
mf v[0:3],a[168:171],a[32:35],v[0:3]
ds_read_b64_tr_b16 a[196:197], v107 offset:0
ds_read_b64_tr_b16 a[198:199], v107 offset:3584
mf v[28:31],a[168:171],a[36:39],v[28:31]
ds_read_b64_tr_b16 a[200:201], v108 offset:0
mf v[4:7],a[172:175],a[32:35],v[4:7]
ds_read_b64_tr_b16 a[202:203], v108 offset:3584
ds_read_b64_tr_b16 a[204:205], v109 offset:0
buffer_load_dwordx4 v139, s[56:59], s20 offen offset:1024 lds
mf v[32:35],a[172:175],a[36:39],v[32:35]
ds_read_b64_tr_b16 a[206:207], v109 offset:3584
mf v[8:11],a[176:179],a[32:35],v[8:11]
ds_read_b64_tr_b16 a[208:209], v110 offset:0
ds_read_b64_tr_b16 a[210:211], v110 offset:3584
mf v[36:39],a[176:179],a[36:39],v[36:39]
ds_read_b64_tr_b16 a[212:213], v111 offset:0
buffer_load_dwordx4 v140, s[56:59], s20 offen offset:2048 lds
mf v[12:15],a[180:183],a[32:35],v[12:15]
ds_read_b64_tr_b16 a[214:215], v111 offset:3584
mf v[40:43],a[180:183],a[36:39],v[40:43]
ds_read_b64_tr_b16 a[216:217], v112 offset:0
ds_read_b64_tr_b16 a[218:219], v112 offset:3584
buffer_load_dwordx4 v141, s[56:59], s20 offen offset:3072 lds
mf v[16:19],a[184:187],a[32:35],v[16:19]
ds_read_b64_tr_b16 a[220:221], v113 offset:0
mf v[44:47],a[184:187],a[36:39],v[44:47]
ds_read_b64_tr_b16 a[222:223], v113 offset:3584
ds_read_b128 a[40:43], v114 offset:5120
mf v[20:23],a[188:191],a[32:35],v[20:23]
ds_read_b128 a[44:47], v114 offset:19456
s_add_u32 m0, s18, 4096
s_add_u32 s20, s18, 233472
buffer_load_dwordx4 v143, s[56:59], s20 offen offset:0 lds
mf v[48:51],a[188:191],a[36:39],v[48:51]
ds_read_b128 a[132:135], v115 offset:320
mf v[24:27],a[192:195],a[32:35],v[24:27]
buffer_load_dwordx4 v144, s[56:59], s20 offen offset:1024 lds
mf v[52:55],a[192:195],a[36:39],v[52:55]
mf v[84:87],a[128:131],a[32:35],v[84:87]
mf v[92:95],a[32:35],a[32:35],v[92:95]
buffer_load_dwordx4 v145, s[56:59], s20 offen offset:2048 lds
mf v[88:91],a[128:131],a[36:39],v[88:91]
mf v[96:99],a[36:39],a[36:39],v[96:99]
s_add_u32 m0, s18, 65536
s_add_u32 s20, s18, 258048
s_waitcnt vmcnt(14) lgkmcnt(0)
s_barrier
buffer_load_dwordx4 v138, s[56:59], s20 offen offset:0 lds
mf v[0:3],a[196:199],a[40:43],v[0:3]
ds_read_b64_tr_b16 a[168:169], v100 offset:32768
ds_read_b64_tr_b16 a[170:171], v100 offset:36352
mf v[28:31],a[196:199],a[44:47],v[28:31]
ds_read_b64_tr_b16 a[172:173], v101 offset:32768
mf v[4:7],a[200:203],a[40:43],v[4:7]
ds_read_b64_tr_b16 a[174:175], v101 offset:36352
ds_read_b64_tr_b16 a[176:177], v102 offset:32768
buffer_load_dwordx4 v139, s[56:59], s20 offen offset:1024 lds
mf v[32:35],a[200:203],a[44:47],v[32:35]
ds_read_b64_tr_b16 a[178:179], v102 offset:36352
mf v[8:11],a[204:207],a[40:43],v[8:11]
ds_read_b64_tr_b16 a[180:181], v103 offset:32768
ds_read_b64_tr_b16 a[182:183], v103 offset:36352
mf v[36:39],a[204:207],a[44:47],v[36:39]
ds_read_b64_tr_b16 a[184:185], v104 offset:32768
buffer_load_dwordx4 v140, s[56:59], s20 offen offset:2048 lds
mf v[12:15],a[208:211],a[40:43],v[12:15]
ds_read_b64_tr_b16 a[186:187], v104 offset:36352
mf v[40:43],a[208:211],a[44:47],v[40:43]
ds_read_b64_tr_b16 a[188:189], v105 offset:32768
ds_read_b64_tr_b16 a[190:191], v105 offset:36352
buffer_load_dwordx4 v141, s[56:59], s20 offen offset:3072 lds
mf v[16:19],a[212:215],a[40:43],v[16:19]
ds_read_b64_tr_b16 a[192:193], v106 offset:32768
mf v[44:47],a[212:215],a[44:47],v[44:47]
ds_read_b64_tr_b16 a[194:195], v106 offset:36352
ds_read_b128 a[48:51], v114 offset:6144
mf v[20:23],a[216:219],a[40:43],v[20:23]
ds_read_b128 a[52:55], v114 offset:20480
s_add_u32 m0, s18, 69632
s_add_u32 s20, s18, 262144
buffer_load_dwordx4 v143, s[56:59], s20 offen offset:0 lds
mf v[48:51],a[216:219],a[44:47],v[48:51]
ds_read_b128 a[136:139], v115 offset:384
mf v[24:27],a[220:223],a[40:43],v[24:27]
buffer_load_dwordx4 v144, s[56:59], s20 offen offset:1024 lds
mf v[52:55],a[220:223],a[44:47],v[52:55]
mf v[84:87],a[132:135],a[40:43],v[84:87]
mf v[92:95],a[40:43],a[40:43],v[92:95]
buffer_load_dwordx4 v145, s[56:59], s20 offen offset:2048 lds
mf v[88:91],a[132:135],a[44:47],v[88:91]
mf v[96:99],a[44:47],a[44:47],v[96:99]
s_add_u32 m0, s18, 32768
s_add_u32 s20, s18, 286720
s_waitcnt vmcnt(14) lgkmcnt(0)
s_barrier
buffer_load_dwordx4 v138, s[56:59], s20 offen offset:0 lds
mf v[0:3],a[168:171],a[48:51],v[0:3]
ds_read_b64_tr_b16 a[196:197], v107 offset:32768
ds_read_b64_tr_b16 a[198:199], v107 offset:36352
mf v[28:31],a[168:171],a[52:55],v[28:31]
ds_read_b64_tr_b16 a[200:201], v108 offset:32768
mf v[4:7],a[172:175],a[48:51],v[4:7]
ds_read_b64_tr_b16 a[202:203], v108 offset:36352
ds_read_b64_tr_b16 a[204:205], v109 offset:32768
buffer_load_dwordx4 v139, s[56:59], s20 offen offset:1024 lds
mf v[32:35],a[172:175],a[52:55],v[32:35]
ds_read_b64_tr_b16 a[206:207], v109 offset:36352
mf v[8:11],a[176:179],a[48:51],v[8:11]
ds_read_b64_tr_b16 a[208:209], v110 offset:32768
ds_read_b64_tr_b16 a[210:211], v110 offset:36352
mf v[36:39],a[176:179],a[52:55],v[36:39]
ds_read_b64_tr_b16 a[212:213], v111 offset:32768
buffer_load_dwordx4 v140, s[56:59], s20 offen offset:2048 lds
mf v[12:15],a[180:183],a[48:51],v[12:15]
ds_read_b64_tr_b16 a[214:215], v111 offset:36352
mf v[40:43],a[180:183],a[52:55],v[40:43]
ds_read_b64_tr_b16 a[216:217], v112 offset:32768
ds_read_b64_tr_b16 a[218:219], v112 offset:36352
buffer_load_dwordx4 v141, s[56:59], s20 offen offset:3072 lds
mf v[16:19],a[184:187],a[48:51],v[16:19]
ds_read_b64_tr_b16 a[220:221], v113 offset:32768
mf v[44:47],a[184:187],a[52:55],v[44:47]
ds_read_b64_tr_b16 a[222:223], v113 offset:36352
ds_read_b128 a[56:59], v114 offset:7168
mf v[20:23],a[188:191],a[48:51],v[20:23]
ds_read_b128 a[60:63], v114 offset:21504
s_add_u32 m0, s18, 36864
s_add_u32 s20, s18, 290816
buffer_load_dwordx4 v143, s[56:59], s20 offen offset:0 lds
mf v[48:51],a[188:191],a[52:55],v[48:51]
ds_read_b128 a[140:143], v115 offset:448
mf v[24:27],a[192:195],a[48:51],v[24:27]
buffer_load_dwordx4 v144, s[56:59], s20 offen offset:1024 lds
mf v[52:55],a[192:195],a[52:55],v[52:55]
mf v[84:87],a[136:139],a[48:51],v[84:87]
mf v[92:95],a[48:51],a[48:51],v[92:95]
buffer_load_dwordx4 v145, s[56:59], s20 offen offset:2048 lds
mf v[88:91],a[136:139],a[52:55],v[88:91]
mf v[96:99],a[52:55],a[52:55],v[96:99]
s_add_u32 m0, s18, 98304
s_add_u32 s20, s18, 315392
s_waitcnt vmcnt(14) lgkmcnt(0)
s_barrier
buffer_load_dwordx4 v138, s[56:59], s20 offen offset:0 lds
mf v[0:3],a[196:199],a[56:59],v[0:3]
ds_read_b64_tr_b16 a[168:169], v100 offset:0
ds_read_b64_tr_b16 a[170:171], v100 offset:3584
mf v[28:31],a[196:199],a[60:63],v[28:31]
ds_read_b64_tr_b16 a[172:173], v101 offset:0
mf v[4:7],a[200:203],a[56:59],v[4:7]
ds_read_b64_tr_b16 a[174:175], v101 offset:3584
ds_read_b64_tr_b16 a[176:177], v102 offset:0
buffer_load_dwordx4 v139, s[56:59], s20 offen offset:1024 lds
mf v[32:35],a[200:203],a[60:63],v[32:35]
ds_read_b64_tr_b16 a[178:179], v102 offset:3584
mf v[8:11],a[204:207],a[56:59],v[8:11]
ds_read_b64_tr_b16 a[180:181], v103 offset:0
ds_read_b64_tr_b16 a[182:183], v103 offset:3584
mf v[36:39],a[204:207],a[60:63],v[36:39]
ds_read_b64_tr_b16 a[184:185], v104 offset:0
buffer_load_dwordx4 v140, s[56:59], s20 offen offset:2048 lds
mf v[12:15],a[208:211],a[56:59],v[12:15]
ds_read_b64_tr_b16 a[186:187], v104 offset:3584
mf v[40:43],a[208:211],a[60:63],v[40:43]
ds_read_b64_tr_b16 a[188:189], v105 offset:0
ds_read_b64_tr_b16 a[190:191], v105 offset:3584
buffer_load_dwordx4 v141, s[56:59], s20 offen offset:3072 lds
mf v[16:19],a[212:215],a[56:59],v[16:19]
ds_read_b64_tr_b16 a[192:193], v106 offset:0
mf v[44:47],a[212:215],a[60:63],v[44:47]
ds_read_b64_tr_b16 a[194:195], v106 offset:3584
ds_read_b128 a[64:67], v114 offset:8192
mf v[20:23],a[216:219],a[56:59],v[20:23]
ds_read_b128 a[68:71], v114 offset:22528
s_add_u32 m0, s18, 102400
s_add_u32 s20, s18, 319488
buffer_load_dwordx4 v143, s[56:59], s20 offen offset:0 lds
mf v[48:51],a[216:219],a[60:63],v[48:51]
ds_read_b128 a[144:147], v115 offset:512
mf v[24:27],a[220:223],a[56:59],v[24:27]
buffer_load_dwordx4 v144, s[56:59], s20 offen offset:1024 lds
mf v[52:55],a[220:223],a[60:63],v[52:55]
mf v[84:87],a[140:143],a[56:59],v[84:87]
mf v[92:95],a[56:59],a[56:59],v[92:95]
buffer_load_dwordx4 v145, s[56:59], s20 offen offset:2048 lds
mf v[88:91],a[140:143],a[60:63],v[88:91]
mf v[96:99],a[60:63],a[60:63],v[96:99]
s_add_u32 m0, s18, 0
s_add_u32 s20, s18, 344064
s_waitcnt vmcnt(14) lgkmcnt(0)
s_barrier
buffer_load_dwordx4 v138, s[56:59], s20 offen offset:0 lds
mf v[0:3],a[168:171],a[64:67],v[0:3]
ds_read_b64_tr_b16 a[196:197], v107 offset:0
ds_read_b64_tr_b16 a[198:199], v107 offset:3584
mf v[28:31],a[168:171],a[68:71],v[28:31]
ds_read_b64_tr_b16 a[200:201], v108 offset:0
mf v[4:7],a[172:175],a[64:67],v[4:7]
ds_read_b64_tr_b16 a[202:203], v108 offset:3584
ds_read_b64_tr_b16 a[204:205], v109 offset:0
buffer_load_dwordx4 v139, s[56:59], s20 offen offset:1024 lds
mf v[32:35],a[172:175],a[68:71],v[32:35]
ds_read_b64_tr_b16 a[206:207], v109 offset:3584
mf v[8:11],a[176:179],a[64:67],v[8:11]
ds_read_b64_tr_b16 a[208:209], v110 offset:0
ds_read_b64_tr_b16 a[210:211], v110 offset:3584
mf v[36:39],a[176:179],a[68:71],v[36:39]
ds_read_b64_tr_b16 a[212:213], v111 offset:0
buffer_load_dwordx4 v140, s[56:59], s20 offen offset:2048 lds
mf v[12:15],a[180:183],a[64:67],v[12:15]
ds_read_b64_tr_b16 a[214:215], v111 offset:3584
mf v[40:43],a[180:183],a[68:71],v[40:43]
ds_read_b64_tr_b16 a[216:217], v112 offset:0
ds_read_b64_tr_b16 a[218:219], v112 offset:3584
buffer_load_dwordx4 v141, s[56:59], s20 offen offset:3072 lds
mf v[16:19],a[184:187],a[64:67],v[16:19]
ds_read_b64_tr_b16 a[220:221], v113 offset:0
mf v[44:47],a[184:187],a[68:71],v[44:47]
ds_read_b64_tr_b16 a[222:223], v113 offset:3584
ds_read_b128 a[72:75], v114 offset:9216
mf v[20:23],a[188:191],a[64:67],v[20:23]
ds_read_b128 a[76:79], v114 offset:23552
s_add_u32 m0, s18, 4096
s_add_u32 s20, s18, 348160
buffer_load_dwordx4 v143, s[56:59], s20 offen offset:0 lds
mf v[48:51],a[188:191],a[68:71],v[48:51]
ds_read_b128 a[148:151], v115 offset:576
mf v[24:27],a[192:195],a[64:67],v[24:27]
buffer_load_dwordx4 v144, s[56:59], s20 offen offset:1024 lds
mf v[52:55],a[192:195],a[68:71],v[52:55]
mf v[84:87],a[144:147],a[64:67],v[84:87]
mf v[92:95],a[64:67],a[64:67],v[92:95]
buffer_load_dwordx4 v145, s[56:59], s20 offen offset:2048 lds
mf v[88:91],a[144:147],a[68:71],v[88:91]
mf v[96:99],a[68:71],a[68:71],v[96:99]
s_add_u32 m0, s18, 65536
s_add_u32 s20, s18, 372736
s_waitcnt vmcnt(14) lgkmcnt(0)
s_barrier
buffer_load_dwordx4 v138, s[56:59], s20 offen offset:0 lds
mf v[0:3],a[196:199],a[72:75],v[0:3]
ds_read_b64_tr_b16 a[168:169], v100 offset:32768
ds_read_b64_tr_b16 a[170:171], v100 offset:36352
mf v[28:31],a[196:199],a[76:79],v[28:31]
ds_read_b64_tr_b16 a[172:173], v101 offset:32768
mf v[4:7],a[200:203],a[72:75],v[4:7]
ds_read_b64_tr_b16 a[174:175], v101 offset:36352
ds_read_b64_tr_b16 a[176:177], v102 offset:32768
buffer_load_dwordx4 v139, s[56:59], s20 offen offset:1024 lds
mf v[32:35],a[200:203],a[76:79],v[32:35]
ds_read_b64_tr_b16 a[178:179], v102 offset:36352
mf v[8:11],a[204:207],a[72:75],v[8:11]
ds_read_b64_tr_b16 a[180:181], v103 offset:32768
ds_read_b64_tr_b16 a[182:183], v103 offset:36352
mf v[36:39],a[204:207],a[76:79],v[36:39]
ds_read_b64_tr_b16 a[184:185], v104 offset:32768
buffer_load_dwordx4 v140, s[56:59], s20 offen offset:2048 lds
mf v[12:15],a[208:211],a[72:75],v[12:15]
ds_read_b64_tr_b16 a[186:187], v104 offset:36352
mf v[40:43],a[208:211],a[76:79],v[40:43]
ds_read_b64_tr_b16 a[188:189], v105 offset:32768
ds_read_b64_tr_b16 a[190:191], v105 offset:36352
buffer_load_dwordx4 v141, s[56:59], s20 offen offset:3072 lds
mf v[16:19],a[212:215],a[72:75],v[16:19]
ds_read_b64_tr_b16 a[192:193], v106 offset:32768
mf v[44:47],a[212:215],a[76:79],v[44:47]
ds_read_b64_tr_b16 a[194:195], v106 offset:36352
ds_read_b128 a[80:83], v114 offset:10240
mf v[20:23],a[216:219],a[72:75],v[20:23]
ds_read_b128 a[84:87], v114 offset:24576
s_add_u32 m0, s18, 69632
s_add_u32 s20, s18, 376832
buffer_load_dwordx4 v143, s[56:59], s20 offen offset:0 lds
mf v[48:51],a[216:219],a[76:79],v[48:51]
ds_read_b128 a[152:155], v115 offset:640
mf v[24:27],a[220:223],a[72:75],v[24:27]
buffer_load_dwordx4 v144, s[56:59], s20 offen offset:1024 lds
mf v[52:55],a[220:223],a[76:79],v[52:55]
mf v[84:87],a[148:151],a[72:75],v[84:87]
mf v[92:95],a[72:75],a[72:75],v[92:95]
buffer_load_dwordx4 v145, s[56:59], s20 offen offset:2048 lds
mf v[88:91],a[148:151],a[76:79],v[88:91]
mf v[96:99],a[76:79],a[76:79],v[96:99]
s_add_u32 m0, s18, 32768
s_add_u32 s20, s18, 0
s_waitcnt vmcnt(14) lgkmcnt(0)
s_barrier
buffer_load_dwordx4 v138, s[60:63], s20 offen offset:0 lds
mf v[0:3],a[168:171],a[80:83],v[0:3]
ds_read_b64_tr_b16 a[196:197], v107 offset:32768
ds_read_b64_tr_b16 a[198:199], v107 offset:36352
mf v[28:31],a[168:171],a[84:87],v[28:31]
ds_read_b64_tr_b16 a[200:201], v108 offset:32768
mf v[4:7],a[172:175],a[80:83],v[4:7]
ds_read_b64_tr_b16 a[202:203], v108 offset:36352
ds_read_b64_tr_b16 a[204:205], v109 offset:32768
buffer_load_dwordx4 v139, s[60:63], s20 offen offset:1024 lds
mf v[32:35],a[172:175],a[84:87],v[32:35]
ds_read_b64_tr_b16 a[206:207], v109 offset:36352
mf v[8:11],a[176:179],a[80:83],v[8:11]
ds_read_b64_tr_b16 a[208:209], v110 offset:32768
ds_read_b64_tr_b16 a[210:211], v110 offset:36352
mf v[36:39],a[176:179],a[84:87],v[36:39]
ds_read_b64_tr_b16 a[212:213], v111 offset:32768
buffer_load_dwordx4 v140, s[60:63], s20 offen offset:2048 lds
mf v[12:15],a[180:183],a[80:83],v[12:15]
ds_read_b64_tr_b16 a[214:215], v111 offset:36352
mf v[40:43],a[180:183],a[84:87],v[40:43]
ds_read_b64_tr_b16 a[216:217], v112 offset:32768
ds_read_b64_tr_b16 a[218:219], v112 offset:36352
buffer_load_dwordx4 v141, s[60:63], s20 offen offset:3072 lds
mf v[16:19],a[184:187],a[80:83],v[16:19]
ds_read_b64_tr_b16 a[220:221], v113 offset:32768
mf v[44:47],a[184:187],a[84:87],v[44:47]
ds_read_b64_tr_b16 a[222:223], v113 offset:36352
ds_read_b128 a[88:91], v114 offset:11264
mf v[20:23],a[188:191],a[80:83],v[20:23]
ds_read_b128 a[92:95], v114 offset:25600
s_add_u32 m0, s18, 36864
s_add_u32 s20, s18, 4096
buffer_load_dwordx4 v143, s[60:63], s20 offen offset:0 lds
mf v[48:51],a[188:191],a[84:87],v[48:51]
ds_read_b128 a[156:159], v115 offset:704
mf v[24:27],a[192:195],a[80:83],v[24:27]
buffer_load_dwordx4 v144, s[60:63], s20 offen offset:1024 lds
mf v[52:55],a[192:195],a[84:87],v[52:55]
mf v[84:87],a[152:155],a[80:83],v[84:87]
mf v[92:95],a[80:83],a[80:83],v[92:95]
buffer_load_dwordx4 v145, s[60:63], s20 offen offset:2048 lds
mf v[88:91],a[152:155],a[84:87],v[88:91]
mf v[96:99],a[84:87],a[84:87],v[96:99]
s_add_u32 m0, s18, 98304
s_add_u32 s20, s18, 28672
s_waitcnt vmcnt(14) lgkmcnt(0)
s_barrier
buffer_load_dwordx4 v138, s[60:63], s20 offen offset:0 lds
mf v[0:3],a[196:199],a[88:91],v[0:3]
ds_read_b64_tr_b16 a[168:169], v100 offset:0
ds_read_b64_tr_b16 a[170:171], v100 offset:3584
mf v[28:31],a[196:199],a[92:95],v[28:31]
ds_read_b64_tr_b16 a[172:173], v101 offset:0
mf v[4:7],a[200:203],a[88:91],v[4:7]
ds_read_b64_tr_b16 a[174:175], v101 offset:3584
ds_read_b64_tr_b16 a[176:177], v102 offset:0
buffer_load_dwordx4 v139, s[60:63], s20 offen offset:1024 lds
mf v[32:35],a[200:203],a[92:95],v[32:35]
ds_read_b64_tr_b16 a[178:179], v102 offset:3584
mf v[8:11],a[204:207],a[88:91],v[8:11]
ds_read_b64_tr_b16 a[180:181], v103 offset:0
ds_read_b64_tr_b16 a[182:183], v103 offset:3584
mf v[36:39],a[204:207],a[92:95],v[36:39]
ds_read_b64_tr_b16 a[184:185], v104 offset:0
buffer_load_dwordx4 v140, s[60:63], s20 offen offset:2048 lds
mf v[12:15],a[208:211],a[88:91],v[12:15]
ds_read_b64_tr_b16 a[186:187], v104 offset:3584
mf v[40:43],a[208:211],a[92:95],v[40:43]
ds_read_b64_tr_b16 a[188:189], v105 offset:0
ds_read_b64_tr_b16 a[190:191], v105 offset:3584
buffer_load_dwordx4 v141, s[60:63], s20 offen offset:3072 lds
mf v[16:19],a[212:215],a[88:91],v[16:19]
ds_read_b64_tr_b16 a[192:193], v106 offset:0
mf v[44:47],a[212:215],a[92:95],v[44:47]
ds_read_b64_tr_b16 a[194:195], v106 offset:3584
ds_read_b128 a[96:99], v114 offset:12288
mf v[20:23],a[216:219],a[88:91],v[20:23]
ds_read_b128 a[100:103], v114 offset:26624
s_add_u32 m0, s18, 102400
s_add_u32 s20, s18, 32768
buffer_load_dwordx4 v143, s[60:63], s20 offen offset:0 lds
mf v[48:51],a[216:219],a[92:95],v[48:51]
ds_read_b128 a[160:163], v115 offset:768
mf v[24:27],a[220:223],a[88:91],v[24:27]
buffer_load_dwordx4 v144, s[60:63], s20 offen offset:1024 lds
mf v[52:55],a[220:223],a[92:95],v[52:55]
mf v[84:87],a[156:159],a[88:91],v[84:87]
mf v[92:95],a[88:91],a[88:91],v[92:95]
buffer_load_dwordx4 v145, s[60:63], s20 offen offset:2048 lds
mf v[88:91],a[156:159],a[92:95],v[88:91]
mf v[96:99],a[92:95],a[92:95],v[96:99]
s_add_u32 m0, s18, 0
s_add_u32 s20, s18, 57344
s_waitcnt vmcnt(14) lgkmcnt(0)
s_barrier
buffer_load_dwordx4 v138, s[60:63], s20 offen offset:0 lds
mf v[0:3],a[168:171],a[96:99],v[0:3]
ds_read_b64_tr_b16 a[196:197], v107 offset:0
ds_read_b64_tr_b16 a[198:199], v107 offset:3584
mf v[28:31],a[168:171],a[100:103],v[28:31]
ds_read_b64_tr_b16 a[200:201], v108 offset:0
mf v[4:7],a[172:175],a[96:99],v[4:7]
ds_read_b64_tr_b16 a[202:203], v108 offset:3584
ds_read_b64_tr_b16 a[204:205], v109 offset:0
buffer_load_dwordx4 v139, s[60:63], s20 offen offset:1024 lds
mf v[32:35],a[172:175],a[100:103],v[32:35]
ds_read_b64_tr_b16 a[206:207], v109 offset:3584
mf v[8:11],a[176:179],a[96:99],v[8:11]
ds_read_b64_tr_b16 a[208:209], v110 offset:0
ds_read_b64_tr_b16 a[210:211], v110 offset:3584
mf v[36:39],a[176:179],a[100:103],v[36:39]
ds_read_b64_tr_b16 a[212:213], v111 offset:0
buffer_load_dwordx4 v140, s[60:63], s20 offen offset:2048 lds
mf v[12:15],a[180:183],a[96:99],v[12:15]
ds_read_b64_tr_b16 a[214:215], v111 offset:3584
mf v[40:43],a[180:183],a[100:103],v[40:43]
ds_read_b64_tr_b16 a[216:217], v112 offset:0
ds_read_b64_tr_b16 a[218:219], v112 offset:3584
buffer_load_dwordx4 v141, s[60:63], s20 offen offset:3072 lds
mf v[16:19],a[184:187],a[96:99],v[16:19]
ds_read_b64_tr_b16 a[220:221], v113 offset:0
mf v[44:47],a[184:187],a[100:103],v[44:47]
ds_read_b64_tr_b16 a[222:223], v113 offset:3584
ds_read_b128 a[104:107], v114 offset:13312
mf v[20:23],a[188:191],a[96:99],v[20:23]
ds_read_b128 a[108:111], v114 offset:27648
s_add_u32 m0, s18, 4096
s_add_u32 s20, s18, 61440
buffer_load_dwordx4 v143, s[60:63], s20 offen offset:0 lds
mf v[48:51],a[188:191],a[100:103],v[48:51]
ds_read_b128 a[164:167], v115 offset:832
mf v[24:27],a[192:195],a[96:99],v[24:27]
buffer_load_dwordx4 v144, s[60:63], s20 offen offset:1024 lds
mf v[52:55],a[192:195],a[100:103],v[52:55]
mf v[84:87],a[160:163],a[96:99],v[84:87]
mf v[92:95],a[96:99],a[96:99],v[92:95]
buffer_load_dwordx4 v145, s[60:63], s20 offen offset:2048 lds
mf v[88:91],a[160:163],a[100:103],v[88:91]
mf v[96:99],a[100:103],a[100:103],v[96:99]
s_add_u32 m0, s18, 65536
s_add_u32 s20, s18, 86016
s_waitcnt vmcnt(14) lgkmcnt(0)
s_barrier
buffer_load_dwordx4 v138, s[60:63], s20 offen offset:0 lds
mf v[0:3],a[196:199],a[104:107],v[0:3]
ds_read_b64_tr_b16 a[168:169], v100 offset:32768
ds_read_b64_tr_b16 a[170:171], v100 offset:36352
mf v[28:31],a[196:199],a[108:111],v[28:31]
ds_read_b64_tr_b16 a[172:173], v101 offset:32768
mf v[4:7],a[200:203],a[104:107],v[4:7]
ds_read_b64_tr_b16 a[174:175], v101 offset:36352
buffer_load_dwordx4 v139, s[60:63], s20 offen offset:1024 lds
mf v[32:35],a[200:203],a[108:111],v[32:35]
ds_read_b64_tr_b16 a[176:177], v102 offset:32768
mf v[8:11],a[204:207],a[104:107],v[8:11]
ds_read_b64_tr_b16 a[178:179], v102 offset:36352
mf v[36:39],a[204:207],a[108:111],v[36:39]
ds_read_b64_tr_b16 a[180:181], v103 offset:32768
buffer_load_dwordx4 v140, s[60:63], s20 offen offset:2048 lds
mf v[12:15],a[208:211],a[104:107],v[12:15]
ds_read_b64_tr_b16 a[182:183], v103 offset:36352
ds_read_b64_tr_b16 a[184:185], v104 offset:32768
mf v[40:43],a[208:211],a[108:111],v[40:43]
ds_read_b64_tr_b16 a[186:187], v104 offset:36352
buffer_load_dwordx4 v141, s[60:63], s20 offen offset:3072 lds
mf v[16:19],a[212:215],a[104:107],v[16:19]
ds_read_b64_tr_b16 a[188:189], v105 offset:32768
mf v[44:47],a[212:215],a[108:111],v[44:47]
ds_read_b64_tr_b16 a[190:191], v105 offset:36352
mf v[20:23],a[216:219],a[104:107],v[20:23]
ds_read_b64_tr_b16 a[192:193], v106 offset:32768
s_add_u32 m0, s18, 69632
s_add_u32 s20, s18, 90112
buffer_load_dwordx4 v143, s[60:63], s20 offen offset:0 lds
mf v[48:51],a[216:219],a[108:111],v[48:51]
ds_read_b64_tr_b16 a[194:195], v106 offset:36352
mf v[24:27],a[220:223],a[104:107],v[24:27]
buffer_load_dwordx4 v144, s[60:63], s20 offen offset:1024 lds
mf v[52:55],a[220:223],a[108:111],v[52:55]
mf v[84:87],a[164:167],a[104:107],v[84:87]
mf v[92:95],a[104:107],a[104:107],v[92:95]
buffer_load_dwordx4 v145, s[60:63], s20 offen offset:2048 lds
mf v[88:91],a[164:167],a[108:111],v[88:91]
mf v[96:99],a[108:111],a[108:111],v[96:99]
v_and_b32 v114, 15, v255
v_lshrrev_b32 v116, 2, v147
v_sub_u32 v116, v114, v116
v_cmp_eq_u32 s[44:45], 0, v116
v_cmp_eq_u32 s[46:47], 1, v116
v_cmp_eq_u32 s[48:49], 2, v116
v_cmp_eq_u32 s[50:51], 3, v116
s_lshr_b32 s17, s16, 1
s_add_u32 s17, s17, 1
s_sub_u32 s19, 0, s17
s_bitcmp1_b32 s16, 0
s_cselect_b32 s17, s19, s17
v_add_u32 v123, s17, v114
v_add_u32 v124, s17, v146
s_mul_i32 s17, s16, 224
s_add_u32 s17, s17, 131072
v_lshrrev_b32 v117, 1, v147
v_add_u32 v117, s17, v117
v_mov_b32 v119, 928
v_cndmask_b32 v130, 0, v92, s[44:45]
v_cndmask_b32 v130, v130, v93, s[46:47]
v_cndmask_b32 v130, v130, v94, s[48:49]
v_cndmask_b32 v130, v130, v95, s[50:51]
v_cndmask_b32 v131, 0, v96, s[44:45]
v_cndmask_b32 v131, v131, v97, s[46:47]
v_cndmask_b32 v131, v131, v98, s[48:49]
v_cndmask_b32 v131, v131, v99, s[50:51]
v_mov_b32_dpp v56, v28 row_newbcast:4 row_mask:0xf bank_mask:0xf
v_mov_b32_dpp v57, v29 row_newbcast:4 row_mask:0xf bank_mask:0xf
v_mov_b32_dpp v58, v30 row_newbcast:4 row_mask:0xf bank_mask:0xf
v_mov_b32_dpp v59, v31 row_newbcast:4 row_mask:0xf bank_mask:0xf
v_mov_b32_dpp v60, v32 row_newbcast:4 row_mask:0xf bank_mask:0xf
v_mov_b32_dpp v61, v33 row_newbcast:4 row_mask:0xf bank_mask:0xf
v_mov_b32_dpp v62, v34 row_newbcast:4 row_mask:0xf bank_mask:0xf
v_mov_b32_dpp v63, v35 row_newbcast:4 row_mask:0xf bank_mask:0xf
v_mov_b32_dpp v64, v36 row_newbcast:4 row_mask:0xf bank_mask:0xf
v_mov_b32_dpp v65, v37 row_newbcast:4 row_mask:0xf bank_mask:0xf
v_mov_b32_dpp v66, v38 row_newbcast:4 row_mask:0xf bank_mask:0xf
v_mov_b32_dpp v67, v39 row_newbcast:4 row_mask:0xf bank_mask:0xf
v_mov_b32_dpp v68, v40 row_newbcast:4 row_mask:0xf bank_mask:0xf
v_mov_b32_dpp v69, v41 row_newbcast:4 row_mask:0xf bank_mask:0xf
v_mov_b32_dpp v70, v42 row_newbcast:4 row_mask:0xf bank_mask:0xf
v_mov_b32_dpp v71, v43 row_newbcast:4 row_mask:0xf bank_mask:0xf
v_mov_b32_dpp v72, v44 row_newbcast:4 row_mask:0xf bank_mask:0xf
v_mov_b32_dpp v73, v45 row_newbcast:4 row_mask:0xf bank_mask:0xf
v_mov_b32_dpp v74, v46 row_newbcast:4 row_mask:0xf bank_mask:0xf
v_mov_b32_dpp v75, v47 row_newbcast:4 row_mask:0xf bank_mask:0xf
v_mov_b32_dpp v76, v48 row_newbcast:4 row_mask:0xf bank_mask:0xf
v_mov_b32_dpp v77, v49 row_newbcast:4 row_mask:0xf bank_mask:0xf
v_mov_b32_dpp v78, v50 row_newbcast:4 row_mask:0xf bank_mask:0xf
v_mov_b32_dpp v79, v51 row_newbcast:4 row_mask:0xf bank_mask:0xf
v_mov_b32_dpp v80, v52 row_newbcast:4 row_mask:0xf bank_mask:0xf
v_mov_b32_dpp v81, v53 row_newbcast:4 row_mask:0xf bank_mask:0xf
v_mov_b32_dpp v82, v54 row_newbcast:4 row_mask:0xf bank_mask:0xf
v_mov_b32_dpp v83, v55 row_newbcast:4 row_mask:0xf bank_mask:0xf
v_mov_b32 v132, v130
v_mov_b32 v133, v131
s_nop 1
v_permlane16_swap_b32 v132, v130
v_permlane16_swap_b32 v133, v131
s_nop 1
v_add_f32 v130, v130, v132
v_add_f32 v131, v131, v133
v_mov_b32 v132, v130
v_mov_b32 v133, v131
s_nop 1
v_permlane32_swap_b32 v132, v130
v_permlane32_swap_b32 v133, v131
s_nop 1
v_add_f32 v130, v130, v132
v_add_f32 v131, v131, v133
v_mul_f32 v148, 0xbb124925, v84
v_mov_b32 v152, 0x3727c5ac
v_fmac_f32 v152, 0x3b124925, v130
v_fma_f32 v152, -v148, v148, v152
v_max_f32 v152, 0x3727c5ac, v152
v_mul_f32 v150, 0xbb124925, v88
v_mov_b32 v154, 0x3727c5ac
v_fmac_f32 v154, 0x3b124925, v131
v_fma_f32 v154, -v150, v150, v154
v_max_f32 v154, 0x3727c5ac, v154
v_rsq_f32 v152, v152
v_rsq_f32 v154, v154
v_mul_f32 v120, 0xbfb8aa3b, v85
v_exp_f32 v120, v120
s_mov_b32 s24, 0xc0135761
s_mov_b32 s25, s24
v_mov_b32 v130, 0xbdd2d3e8
v_mov_b32 v132, 1.0
v_add_f32 v120, 1.0, v120
v_rcp_f32 v120, v120
s_add_u32 m0, s18, 32768
s_add_u32 s20, s18, 114688
s_waitcnt vmcnt(14) lgkmcnt(0)
s_barrier
buffer_load_dwordx4 v138, s[60:63], s20 offen offset:0 lds
v_pk_fma_f32 v[0:1], v[56:57], v[148:149], v[0:1] op_sel_hi:[1,0,1]
v_pk_fma_f32 v[2:3], v[58:59], v[148:149], v[2:3] op_sel_hi:[1,0,1]
v_pk_fma_f32 v[4:5], v[60:61], v[148:149], v[4:5] op_sel_hi:[1,0,1]
ds_read_b64_tr_b16 a[196:197], v107 offset:32768
v_pk_fma_f32 v[6:7], v[62:63], v[148:149], v[6:7] op_sel_hi:[1,0,1]
v_pk_fma_f32 v[8:9], v[64:65], v[148:149], v[8:9] op_sel_hi:[1,0,1]
v_pk_fma_f32 v[10:11], v[66:67], v[148:149], v[10:11] op_sel_hi:[1,0,1]
ds_read_b64_tr_b16 a[198:199], v107 offset:36352
v_pk_fma_f32 v[12:13], v[68:69], v[148:149], v[12:13] op_sel_hi:[1,0,1]
v_pk_fma_f32 v[14:15], v[70:71], v[148:149], v[14:15] op_sel_hi:[1,0,1]
v_pk_fma_f32 v[16:17], v[72:73], v[148:149], v[16:17] op_sel_hi:[1,0,1]
ds_read_b64_tr_b16 a[200:201], v108 offset:32768
v_pk_fma_f32 v[18:19], v[74:75], v[148:149], v[18:19] op_sel_hi:[1,0,1]
v_pk_fma_f32 v[20:21], v[76:77], v[148:149], v[20:21] op_sel_hi:[1,0,1]
v_pk_fma_f32 v[22:23], v[78:79], v[148:149], v[22:23] op_sel_hi:[1,0,1]
buffer_load_dwordx4 v139, s[60:63], s20 offen offset:1024 lds
ds_read_b64_tr_b16 a[202:203], v108 offset:36352
v_pk_fma_f32 v[24:25], v[80:81], v[148:149], v[24:25] op_sel_hi:[1,0,1]
v_pk_fma_f32 v[26:27], v[82:83], v[148:149], v[26:27] op_sel_hi:[1,0,1]
v_pk_fma_f32 v[28:29], v[56:57], v[150:151], v[28:29] op_sel_hi:[1,0,1]
ds_read_b64_tr_b16 a[204:205], v109 offset:32768
v_pk_fma_f32 v[30:31], v[58:59], v[150:151], v[30:31] op_sel_hi:[1,0,1]
v_pk_fma_f32 v[32:33], v[60:61], v[150:151], v[32:33] op_sel_hi:[1,0,1]
v_pk_fma_f32 v[34:35], v[62:63], v[150:151], v[34:35] op_sel_hi:[1,0,1]
ds_read_b64_tr_b16 a[206:207], v109 offset:36352
v_pk_fma_f32 v[36:37], v[64:65], v[150:151], v[36:37] op_sel_hi:[1,0,1]
v_pk_fma_f32 v[38:39], v[66:67], v[150:151], v[38:39] op_sel_hi:[1,0,1]
v_pk_fma_f32 v[40:41], v[68:69], v[150:151], v[40:41] op_sel_hi:[1,0,1]
ds_read_b64_tr_b16 a[208:209], v110 offset:32768
v_pk_fma_f32 v[42:43], v[70:71], v[150:151], v[42:43] op_sel_hi:[1,0,1]
buffer_load_dwordx4 v140, s[60:63], s20 offen offset:2048 lds
v_pk_fma_f32 v[44:45], v[72:73], v[150:151], v[44:45] op_sel_hi:[1,0,1]
ds_read_b64_tr_b16 a[210:211], v110 offset:36352
v_pk_fma_f32 v[46:47], v[74:75], v[150:151], v[46:47] op_sel_hi:[1,0,1]
v_pk_fma_f32 v[48:49], v[76:77], v[150:151], v[48:49] op_sel_hi:[1,0,1]
v_pk_fma_f32 v[50:51], v[78:79], v[150:151], v[50:51] op_sel_hi:[1,0,1]
ds_read_b64_tr_b16 a[212:213], v111 offset:32768
v_pk_fma_f32 v[52:53], v[80:81], v[150:151], v[52:53] op_sel_hi:[1,0,1]
v_pk_fma_f32 v[54:55], v[82:83], v[150:151], v[54:55] op_sel_hi:[1,0,1]
v_pk_mul_f32 v[0:1], v[0:1], v[152:153] op_sel_hi:[1,0]
ds_read_b64_tr_b16 a[214:215], v111 offset:36352
v_pk_mul_f32 v[2:3], v[2:3], v[152:153] op_sel_hi:[1,0]
v_pk_mul_f32 v[4:5], v[4:5], v[152:153] op_sel_hi:[1,0]
v_pk_mul_f32 v[6:7], v[6:7], v[152:153] op_sel_hi:[1,0]
ds_read_b64_tr_b16 a[216:217], v112 offset:32768
buffer_load_dwordx4 v141, s[60:63], s20 offen offset:3072 lds
v_pk_mul_f32 v[8:9], v[8:9], v[152:153] op_sel_hi:[1,0]
v_pk_mul_f32 v[10:11], v[10:11], v[152:153] op_sel_hi:[1,0]
v_pk_mul_f32 v[12:13], v[12:13], v[152:153] op_sel_hi:[1,0]
ds_read_b64_tr_b16 a[218:219], v112 offset:36352
v_pk_mul_f32 v[14:15], v[14:15], v[152:153] op_sel_hi:[1,0]
v_pk_mul_f32 v[16:17], v[16:17], v[152:153] op_sel_hi:[1,0]
v_pk_mul_f32 v[18:19], v[18:19], v[152:153] op_sel_hi:[1,0]
ds_read_b64_tr_b16 a[220:221], v113 offset:32768
v_pk_mul_f32 v[20:21], v[20:21], v[152:153] op_sel_hi:[1,0]
v_pk_mul_f32 v[22:23], v[22:23], v[152:153] op_sel_hi:[1,0]
v_pk_mul_f32 v[24:25], v[24:25], v[152:153] op_sel_hi:[1,0]
ds_read_b64_tr_b16 a[222:223], v113 offset:36352
v_pk_mul_f32 v[26:27], v[26:27], v[152:153] op_sel_hi:[1,0]
v_pk_mul_f32 v[56:57], v[0:1], v[0:1]
v_pk_mul_f32 v[58:59], v[2:3], v[2:3]
s_add_u32 m0, s18, 36864
s_add_u32 s20, s18, 118784
buffer_load_dwordx4 v143, s[60:63], s20 offen offset:0 lds
v_pk_mul_f32 v[60:61], v[4:5], v[4:5]
v_pk_mul_f32 v[62:63], v[6:7], v[6:7]
v_pk_mul_f32 v[64:65], v[8:9], v[8:9]
v_pk_mul_f32 v[66:67], v[10:11], v[10:11]
v_pk_mul_f32 v[68:69], v[12:13], v[12:13]
v_pk_mul_f32 v[70:71], v[14:15], v[14:15]
v_pk_mul_f32 v[72:73], v[16:17], v[16:17]
v_pk_mul_f32 v[74:75], v[18:19], v[18:19]
v_pk_mul_f32 v[76:77], v[20:21], v[20:21]
v_pk_mul_f32 v[78:79], v[22:23], v[22:23]
v_pk_mul_f32 v[80:81], v[24:25], v[24:25]
v_pk_mul_f32 v[82:83], v[26:27], v[26:27]
v_pk_fma_f32 v[56:57], v[56:57], v[130:131], s[24:25] op_sel_hi:[1,0,1]
v_pk_fma_f32 v[58:59], v[58:59], v[130:131], s[24:25] op_sel_hi:[1,0,1]
buffer_load_dwordx4 v144, s[60:63], s20 offen offset:1024 lds
v_pk_fma_f32 v[60:61], v[60:61], v[130:131], s[24:25] op_sel_hi:[1,0,1]
v_pk_fma_f32 v[62:63], v[62:63], v[130:131], s[24:25] op_sel_hi:[1,0,1]
v_pk_fma_f32 v[64:65], v[64:65], v[130:131], s[24:25] op_sel_hi:[1,0,1]
v_pk_fma_f32 v[66:67], v[66:67], v[130:131], s[24:25] op_sel_hi:[1,0,1]
v_pk_fma_f32 v[68:69], v[68:69], v[130:131], s[24:25] op_sel_hi:[1,0,1]
v_pk_fma_f32 v[70:71], v[70:71], v[130:131], s[24:25] op_sel_hi:[1,0,1]
v_pk_fma_f32 v[72:73], v[72:73], v[130:131], s[24:25] op_sel_hi:[1,0,1]
v_pk_fma_f32 v[74:75], v[74:75], v[130:131], s[24:25] op_sel_hi:[1,0,1]
v_pk_fma_f32 v[76:77], v[76:77], v[130:131], s[24:25] op_sel_hi:[1,0,1]
v_pk_fma_f32 v[78:79], v[78:79], v[130:131], s[24:25] op_sel_hi:[1,0,1]
v_pk_fma_f32 v[80:81], v[80:81], v[130:131], s[24:25] op_sel_hi:[1,0,1]
v_pk_fma_f32 v[82:83], v[82:83], v[130:131], s[24:25] op_sel_hi:[1,0,1]
v_pk_mul_f32 v[56:57], v[56:57], v[0:1]
v_pk_mul_f32 v[58:59], v[58:59], v[2:3]
buffer_load_dwordx4 v145, s[60:63], s20 offen offset:2048 lds
v_pk_mul_f32 v[60:61], v[60:61], v[4:5]
v_pk_mul_f32 v[62:63], v[62:63], v[6:7]
v_pk_mul_f32 v[64:65], v[64:65], v[8:9]
v_pk_mul_f32 v[66:67], v[66:67], v[10:11]
v_pk_mul_f32 v[68:69], v[68:69], v[12:13]
v_pk_mul_f32 v[70:71], v[70:71], v[14:15]
v_pk_mul_f32 v[72:73], v[72:73], v[16:17]
v_pk_mul_f32 v[74:75], v[74:75], v[18:19]
v_pk_mul_f32 v[76:77], v[76:77], v[20:21]
v_pk_mul_f32 v[78:79], v[78:79], v[22:23]
v_pk_mul_f32 v[80:81], v[80:81], v[24:25]
v_pk_mul_f32 v[82:83], v[82:83], v[26:27]
v_exp_f32 v56, v56
v_exp_f32 v57, v57
s_add_u32 m0, s18, 98304
s_add_u32 s20, s18, 143360
s_waitcnt vmcnt(14) lgkmcnt(0)
s_barrier
buffer_load_dwordx4 v138, s[60:63], s20 offen offset:0 lds
v_exp_f32 v58, v58
v_exp_f32 v59, v59
v_exp_f32 v60, v60
ds_read_b64_tr_b16 a[56:57], v100 offset:0
v_exp_f32 v61, v61
v_exp_f32 v62, v62
v_exp_f32 v63, v63
ds_read_b64_tr_b16 a[58:59], v100 offset:3584
v_exp_f32 v64, v64
v_exp_f32 v65, v65
v_exp_f32 v66, v66
ds_read_b64_tr_b16 a[60:61], v101 offset:0
v_exp_f32 v67, v67
v_exp_f32 v68, v68
v_exp_f32 v69, v69
buffer_load_dwordx4 v139, s[60:63], s20 offen offset:1024 lds
ds_read_b64_tr_b16 a[62:63], v101 offset:3584
v_exp_f32 v70, v70
v_exp_f32 v71, v71
v_exp_f32 v72, v72
ds_read_b64_tr_b16 a[64:65], v102 offset:0
v_exp_f32 v73, v73
v_exp_f32 v74, v74
v_exp_f32 v75, v75
ds_read_b64_tr_b16 a[66:67], v102 offset:3584
v_exp_f32 v76, v76
v_exp_f32 v77, v77
v_exp_f32 v78, v78
ds_read_b64_tr_b16 a[68:69], v103 offset:0
v_exp_f32 v79, v79
buffer_load_dwordx4 v140, s[60:63], s20 offen offset:2048 lds
v_exp_f32 v80, v80
ds_read_b64_tr_b16 a[70:71], v103 offset:3584
v_exp_f32 v81, v81
v_exp_f32 v82, v82
v_exp_f32 v83, v83
ds_read_b64_tr_b16 a[72:73], v104 offset:0
s_nop 0
v_pk_add_f32 v[56:57], v[56:57], v[132:133] op_sel_hi:[1,0]
v_pk_add_f32 v[58:59], v[58:59], v[132:133] op_sel_hi:[1,0]
ds_read_b64_tr_b16 a[74:75], v104 offset:3584
v_pk_add_f32 v[60:61], v[60:61], v[132:133] op_sel_hi:[1,0]
v_pk_add_f32 v[62:63], v[62:63], v[132:133] op_sel_hi:[1,0]
v_pk_add_f32 v[64:65], v[64:65], v[132:133] op_sel_hi:[1,0]
ds_read_b64_tr_b16 a[76:77], v105 offset:0
buffer_load_dwordx4 v141, s[60:63], s20 offen offset:3072 lds
v_pk_add_f32 v[66:67], v[66:67], v[132:133] op_sel_hi:[1,0]
v_pk_add_f32 v[68:69], v[68:69], v[132:133] op_sel_hi:[1,0]
v_pk_add_f32 v[70:71], v[70:71], v[132:133] op_sel_hi:[1,0]
ds_read_b64_tr_b16 a[78:79], v105 offset:3584
v_pk_add_f32 v[72:73], v[72:73], v[132:133] op_sel_hi:[1,0]
v_pk_add_f32 v[74:75], v[74:75], v[132:133] op_sel_hi:[1,0]
v_pk_add_f32 v[76:77], v[76:77], v[132:133] op_sel_hi:[1,0]
ds_read_b64_tr_b16 a[80:81], v106 offset:0
v_pk_add_f32 v[78:79], v[78:79], v[132:133] op_sel_hi:[1,0]
v_pk_add_f32 v[80:81], v[80:81], v[132:133] op_sel_hi:[1,0]
v_pk_add_f32 v[82:83], v[82:83], v[132:133] op_sel_hi:[1,0]
ds_read_b64_tr_b16 a[82:83], v106 offset:3584
v_rcp_f32 v56, v56
v_rcp_f32 v57, v57
v_rcp_f32 v58, v58
s_add_u32 m0, s18, 102400
s_add_u32 s20, s18, 147456
buffer_load_dwordx4 v143, s[60:63], s20 offen offset:0 lds
v_rcp_f32 v59, v59
v_rcp_f32 v60, v60
v_rcp_f32 v61, v61
v_rcp_f32 v62, v62
v_rcp_f32 v63, v63
v_rcp_f32 v64, v64
v_rcp_f32 v65, v65
v_rcp_f32 v66, v66
v_rcp_f32 v67, v67
v_rcp_f32 v68, v68
v_rcp_f32 v69, v69
v_rcp_f32 v70, v70
v_rcp_f32 v71, v71
v_rcp_f32 v72, v72
buffer_load_dwordx4 v144, s[60:63], s20 offen offset:1024 lds
v_rcp_f32 v73, v73
v_rcp_f32 v74, v74
v_rcp_f32 v75, v75
v_rcp_f32 v76, v76
v_rcp_f32 v77, v77
v_rcp_f32 v78, v78
v_rcp_f32 v79, v79
v_rcp_f32 v80, v80
v_rcp_f32 v81, v81
v_rcp_f32 v82, v82
v_rcp_f32 v83, v83
s_nop 0
v_pk_mul_f32 v[0:1], v[0:1], v[56:57]
v_pk_mul_f32 v[2:3], v[2:3], v[58:59]
buffer_load_dwordx4 v145, s[60:63], s20 offen offset:2048 lds
v_pk_mul_f32 v[4:5], v[4:5], v[60:61]
v_pk_mul_f32 v[6:7], v[6:7], v[62:63]
v_pk_mul_f32 v[8:9], v[8:9], v[64:65]
v_pk_mul_f32 v[10:11], v[10:11], v[66:67]
v_pk_mul_f32 v[12:13], v[12:13], v[68:69]
v_pk_mul_f32 v[14:15], v[14:15], v[70:71]
v_pk_mul_f32 v[16:17], v[16:17], v[72:73]
v_pk_mul_f32 v[18:19], v[18:19], v[74:75]
v_pk_mul_f32 v[20:21], v[20:21], v[76:77]
v_pk_mul_f32 v[22:23], v[22:23], v[78:79]
v_pk_mul_f32 v[24:25], v[24:25], v[80:81]
v_pk_mul_f32 v[26:27], v[26:27], v[82:83]
v_cvt_pk_bf16_f32 v56, v0, v1
v_cvt_pk_bf16_f32 v57, v2, v3
s_add_u32 m0, s18, 0
s_add_u32 s20, s18, 172032
s_waitcnt vmcnt(14) lgkmcnt(0)
s_barrier
buffer_load_dwordx4 v138, s[60:63], s20 offen offset:0 lds
v_cvt_pk_bf16_f32 v58, v4, v5
v_cvt_pk_bf16_f32 v59, v6, v7
v_cvt_pk_bf16_f32 v60, v8, v9
ds_read_b64_tr_b16 a[84:85], v107 offset:0
v_cvt_pk_bf16_f32 v61, v10, v11
v_cvt_pk_bf16_f32 v62, v12, v13
v_cvt_pk_bf16_f32 v63, v14, v15
ds_read_b64_tr_b16 a[86:87], v107 offset:3584
v_cvt_pk_bf16_f32 v64, v16, v17
v_cvt_pk_bf16_f32 v65, v18, v19
v_cvt_pk_bf16_f32 v66, v20, v21
ds_read_b64_tr_b16 a[88:89], v108 offset:0
v_cvt_pk_bf16_f32 v67, v22, v23
v_cvt_pk_bf16_f32 v68, v24, v25
v_cvt_pk_bf16_f32 v69, v26, v27
buffer_load_dwordx4 v139, s[60:63], s20 offen offset:1024 lds
ds_read_b64_tr_b16 a[90:91], v108 offset:3584
v_cmp_gt_u32 vcc, 16, v123
v_mad_u32_u24 v118, v123, v119, v117
s_and_saveexec_b64 s[26:27], vcc
ds_write_b64 v118, v[56:57] offset:0
ds_write_b64 v118, v[58:59] offset:32
ds_write_b64 v118, v[60:61] offset:64
ds_write_b64 v118, v[62:63] offset:96
ds_write_b64 v118, v[64:65] offset:128
ds_write_b64 v118, v[66:67] offset:160
ds_write_b64 v118, v[68:69] offset:192
s_mov_b64 exec, s[26:27]
v_pk_mul_f32 v[28:29], v[28:29], v[154:155] op_sel_hi:[1,0]
v_pk_mul_f32 v[30:31], v[30:31], v[154:155] op_sel_hi:[1,0]
ds_read_b64_tr_b16 a[92:93], v109 offset:0
v_pk_mul_f32 v[32:33], v[32:33], v[154:155] op_sel_hi:[1,0]
v_pk_mul_f32 v[34:35], v[34:35], v[154:155] op_sel_hi:[1,0]
v_pk_mul_f32 v[36:37], v[36:37], v[154:155] op_sel_hi:[1,0]
ds_read_b64_tr_b16 a[94:95], v109 offset:3584
v_pk_mul_f32 v[38:39], v[38:39], v[154:155] op_sel_hi:[1,0]
v_pk_mul_f32 v[40:41], v[40:41], v[154:155] op_sel_hi:[1,0]
v_pk_mul_f32 v[42:43], v[42:43], v[154:155] op_sel_hi:[1,0]
ds_read_b64_tr_b16 a[96:97], v110 offset:0
v_pk_mul_f32 v[44:45], v[44:45], v[154:155] op_sel_hi:[1,0]
buffer_load_dwordx4 v140, s[60:63], s20 offen offset:2048 lds
v_pk_mul_f32 v[46:47], v[46:47], v[154:155] op_sel_hi:[1,0]
ds_read_b64_tr_b16 a[98:99], v110 offset:3584
v_pk_mul_f32 v[48:49], v[48:49], v[154:155] op_sel_hi:[1,0]
v_pk_mul_f32 v[50:51], v[50:51], v[154:155] op_sel_hi:[1,0]
v_pk_mul_f32 v[52:53], v[52:53], v[154:155] op_sel_hi:[1,0]
ds_read_b64_tr_b16 a[100:101], v111 offset:0
v_pk_mul_f32 v[54:55], v[54:55], v[154:155] op_sel_hi:[1,0]
v_pk_mul_f32 v[56:57], v[28:29], v[28:29]
v_pk_mul_f32 v[58:59], v[30:31], v[30:31]
ds_read_b64_tr_b16 a[102:103], v111 offset:3584
v_pk_mul_f32 v[60:61], v[32:33], v[32:33]
v_pk_mul_f32 v[62:63], v[34:35], v[34:35]
v_pk_mul_f32 v[64:65], v[36:37], v[36:37]
ds_read_b64_tr_b16 a[104:105], v112 offset:0
buffer_load_dwordx4 v141, s[60:63], s20 offen offset:3072 lds
v_pk_mul_f32 v[66:67], v[38:39], v[38:39]
v_pk_mul_f32 v[68:69], v[40:41], v[40:41]
v_pk_mul_f32 v[70:71], v[42:43], v[42:43]
ds_read_b64_tr_b16 a[106:107], v112 offset:3584
v_pk_mul_f32 v[72:73], v[44:45], v[44:45]
v_pk_mul_f32 v[74:75], v[46:47], v[46:47]
v_pk_mul_f32 v[76:77], v[48:49], v[48:49]
ds_read_b64_tr_b16 a[108:109], v113 offset:0
v_pk_mul_f32 v[78:79], v[50:51], v[50:51]
v_pk_mul_f32 v[80:81], v[52:53], v[52:53]
v_pk_mul_f32 v[82:83], v[54:55], v[54:55]
ds_read_b64_tr_b16 a[110:111], v113 offset:3584
v_pk_fma_f32 v[56:57], v[56:57], v[130:131], s[24:25] op_sel_hi:[1,0,1]
v_pk_fma_f32 v[58:59], v[58:59], v[130:131], s[24:25] op_sel_hi:[1,0,1]
v_pk_fma_f32 v[60:61], v[60:61], v[130:131], s[24:25] op_sel_hi:[1,0,1]
s_add_u32 m0, s18, 4096
s_add_u32 s20, s18, 176128
buffer_load_dwordx4 v143, s[60:63], s20 offen offset:0 lds
v_pk_fma_f32 v[62:63], v[62:63], v[130:131], s[24:25] op_sel_hi:[1,0,1]
v_pk_fma_f32 v[64:65], v[64:65], v[130:131], s[24:25] op_sel_hi:[1,0,1]
v_pk_fma_f32 v[66:67], v[66:67], v[130:131], s[24:25] op_sel_hi:[1,0,1]
v_pk_fma_f32 v[68:69], v[68:69], v[130:131], s[24:25] op_sel_hi:[1,0,1]
v_pk_fma_f32 v[70:71], v[70:71], v[130:131], s[24:25] op_sel_hi:[1,0,1]
v_pk_fma_f32 v[72:73], v[72:73], v[130:131], s[24:25] op_sel_hi:[1,0,1]
v_pk_fma_f32 v[74:75], v[74:75], v[130:131], s[24:25] op_sel_hi:[1,0,1]
v_pk_fma_f32 v[76:77], v[76:77], v[130:131], s[24:25] op_sel_hi:[1,0,1]
v_pk_fma_f32 v[78:79], v[78:79], v[130:131], s[24:25] op_sel_hi:[1,0,1]
v_pk_fma_f32 v[80:81], v[80:81], v[130:131], s[24:25] op_sel_hi:[1,0,1]
v_pk_fma_f32 v[82:83], v[82:83], v[130:131], s[24:25] op_sel_hi:[1,0,1]
v_pk_mul_f32 v[56:57], v[56:57], v[28:29]
v_pk_mul_f32 v[58:59], v[58:59], v[30:31]
v_pk_mul_f32 v[60:61], v[60:61], v[32:33]
buffer_load_dwordx4 v144, s[60:63], s20 offen offset:1024 lds
v_pk_mul_f32 v[62:63], v[62:63], v[34:35]
v_pk_mul_f32 v[64:65], v[64:65], v[36:37]
v_pk_mul_f32 v[66:67], v[66:67], v[38:39]
v_pk_mul_f32 v[68:69], v[68:69], v[40:41]
v_pk_mul_f32 v[70:71], v[70:71], v[42:43]
v_pk_mul_f32 v[72:73], v[72:73], v[44:45]
v_pk_mul_f32 v[74:75], v[74:75], v[46:47]
v_pk_mul_f32 v[76:77], v[76:77], v[48:49]
v_pk_mul_f32 v[78:79], v[78:79], v[50:51]
v_pk_mul_f32 v[80:81], v[80:81], v[52:53]
v_pk_mul_f32 v[82:83], v[82:83], v[54:55]
v_exp_f32 v56, v56
v_exp_f32 v57, v57
v_exp_f32 v58, v58
buffer_load_dwordx4 v145, s[60:63], s20 offen offset:2048 lds
v_exp_f32 v59, v59
v_exp_f32 v60, v60
v_exp_f32 v61, v61
v_exp_f32 v62, v62
v_exp_f32 v63, v63
v_exp_f32 v64, v64
v_exp_f32 v65, v65
v_exp_f32 v66, v66
v_exp_f32 v67, v67
v_exp_f32 v68, v68
v_exp_f32 v69, v69
v_exp_f32 v70, v70
v_exp_f32 v71, v71
v_exp_f32 v72, v72
s_add_u32 m0, s18, 65536
s_add_u32 s20, s18, 200704
s_waitcnt vmcnt(14) lgkmcnt(0)
s_barrier
buffer_load_dwordx4 v138, s[60:63], s20 offen offset:0 lds
v_exp_f32 v73, v73
v_exp_f32 v74, v74
v_exp_f32 v75, v75
ds_read_b64_tr_b16 a[112:113], v100 offset:32768
v_exp_f32 v76, v76
v_exp_f32 v77, v77
v_exp_f32 v78, v78
ds_read_b64_tr_b16 a[114:115], v100 offset:36352
v_exp_f32 v79, v79
v_exp_f32 v80, v80
v_exp_f32 v81, v81
ds_read_b64_tr_b16 a[116:117], v101 offset:32768
v_exp_f32 v82, v82
v_exp_f32 v83, v83
buffer_load_dwordx4 v139, s[60:63], s20 offen offset:1024 lds
s_nop 0
ds_read_b64_tr_b16 a[118:119], v101 offset:36352
v_pk_add_f32 v[56:57], v[56:57], v[132:133] op_sel_hi:[1,0]
v_pk_add_f32 v[58:59], v[58:59], v[132:133] op_sel_hi:[1,0]
ds_read_b64_tr_b16 a[120:121], v102 offset:32768
v_pk_add_f32 v[60:61], v[60:61], v[132:133] op_sel_hi:[1,0]
v_pk_add_f32 v[62:63], v[62:63], v[132:133] op_sel_hi:[1,0]
v_pk_add_f32 v[64:65], v[64:65], v[132:133] op_sel_hi:[1,0]
ds_read_b64_tr_b16 a[122:123], v102 offset:36352
v_pk_add_f32 v[66:67], v[66:67], v[132:133] op_sel_hi:[1,0]
v_pk_add_f32 v[68:69], v[68:69], v[132:133] op_sel_hi:[1,0]
v_pk_add_f32 v[70:71], v[70:71], v[132:133] op_sel_hi:[1,0]
ds_read_b64_tr_b16 a[124:125], v103 offset:32768
v_pk_add_f32 v[72:73], v[72:73], v[132:133] op_sel_hi:[1,0]
buffer_load_dwordx4 v140, s[60:63], s20 offen offset:2048 lds
v_pk_add_f32 v[74:75], v[74:75], v[132:133] op_sel_hi:[1,0]
v_pk_add_f32 v[76:77], v[76:77], v[132:133] op_sel_hi:[1,0]
ds_read_b64_tr_b16 a[126:127], v103 offset:36352
v_pk_add_f32 v[78:79], v[78:79], v[132:133] op_sel_hi:[1,0]
v_pk_add_f32 v[80:81], v[80:81], v[132:133] op_sel_hi:[1,0]
v_pk_add_f32 v[82:83], v[82:83], v[132:133] op_sel_hi:[1,0]
ds_read_b64_tr_b16 a[128:129], v104 offset:32768
v_rcp_f32 v56, v56
v_rcp_f32 v57, v57
ds_read_b64_tr_b16 a[130:131], v104 offset:36352
v_rcp_f32 v58, v58
v_rcp_f32 v59, v59
v_rcp_f32 v60, v60
ds_read_b64_tr_b16 a[132:133], v105 offset:32768
buffer_load_dwordx4 v141, s[60:63], s20 offen offset:3072 lds
v_rcp_f32 v61, v61
v_rcp_f32 v62, v62
v_rcp_f32 v63, v63
ds_read_b64_tr_b16 a[134:135], v105 offset:36352
v_rcp_f32 v64, v64
v_rcp_f32 v65, v65
v_rcp_f32 v66, v66
ds_read_b64_tr_b16 a[136:137], v106 offset:32768
v_rcp_f32 v67, v67
v_rcp_f32 v68, v68
v_rcp_f32 v69, v69
ds_read_b64_tr_b16 a[138:139], v106 offset:36352
v_rcp_f32 v70, v70
v_rcp_f32 v71, v71
s_add_u32 m0, s18, 69632
s_add_u32 s20, s18, 204800
buffer_load_dwordx4 v143, s[60:63], s20 offen offset:0 lds
v_rcp_f32 v72, v72
v_rcp_f32 v73, v73
v_rcp_f32 v74, v74
v_rcp_f32 v75, v75
v_rcp_f32 v76, v76
v_rcp_f32 v77, v77
v_rcp_f32 v78, v78
v_rcp_f32 v79, v79
v_rcp_f32 v80, v80
v_rcp_f32 v81, v81
v_rcp_f32 v82, v82
v_rcp_f32 v83, v83
s_nop 0
v_pk_mul_f32 v[28:29], v[28:29], v[56:57]
buffer_load_dwordx4 v144, s[60:63], s20 offen offset:1024 lds
v_pk_mul_f32 v[30:31], v[30:31], v[58:59]
v_pk_mul_f32 v[32:33], v[32:33], v[60:61]
v_pk_mul_f32 v[34:35], v[34:35], v[62:63]
v_pk_mul_f32 v[36:37], v[36:37], v[64:65]
v_pk_mul_f32 v[38:39], v[38:39], v[66:67]
v_pk_mul_f32 v[40:41], v[40:41], v[68:69]
v_pk_mul_f32 v[42:43], v[42:43], v[70:71]
v_pk_mul_f32 v[44:45], v[44:45], v[72:73]
v_pk_mul_f32 v[46:47], v[46:47], v[74:75]
v_pk_mul_f32 v[48:49], v[48:49], v[76:77]
v_pk_mul_f32 v[50:51], v[50:51], v[78:79]
v_pk_mul_f32 v[52:53], v[52:53], v[80:81]
v_pk_mul_f32 v[54:55], v[54:55], v[82:83]
v_cvt_pk_bf16_f32 v56, v28, v29
buffer_load_dwordx4 v145, s[60:63], s20 offen offset:2048 lds
v_cvt_pk_bf16_f32 v57, v30, v31
v_cvt_pk_bf16_f32 v58, v32, v33
v_cvt_pk_bf16_f32 v59, v34, v35
v_cvt_pk_bf16_f32 v60, v36, v37
v_cvt_pk_bf16_f32 v61, v38, v39
v_cvt_pk_bf16_f32 v62, v40, v41
v_cvt_pk_bf16_f32 v63, v42, v43
v_cvt_pk_bf16_f32 v64, v44, v45
v_cvt_pk_bf16_f32 v65, v46, v47
v_cvt_pk_bf16_f32 v66, v48, v49
v_cvt_pk_bf16_f32 v67, v50, v51
v_cvt_pk_bf16_f32 v68, v52, v53
v_cvt_pk_bf16_f32 v69, v54, v55
v_cmp_gt_u32 vcc, 16, v124
v_mad_u32_u24 v118, v124, v119, v117
s_and_saveexec_b64 s[26:27], vcc
ds_write_b64 v118, v[56:57] offset:0
ds_write_b64 v118, v[58:59] offset:32
ds_write_b64 v118, v[60:61] offset:64
ds_write_b64 v118, v[62:63] offset:96
ds_write_b64 v118, v[64:65] offset:128
ds_write_b64 v118, v[66:67] offset:160
ds_write_b64 v118, v[68:69] offset:192
s_mov_b64 exec, s[26:27]
v_mul_u32_u24 v121, 928, v114
v_add_u32 v122, v121, v147
v_add_u32 v122, 131072, v122
s_waitcnt lgkmcnt(0)
s_barrier
ds_read_b128 a[0:3], v122 offset:0
ds_read_b128 a[4:7], v122 offset:64
ds_read_b128 a[8:11], v122 offset:128
ds_read_b128 a[12:15], v122 offset:192
ds_read_b128 a[16:19], v122 offset:256
ds_read_b128 a[20:23], v122 offset:320
ds_read_b128 a[24:27], v122 offset:384
ds_read_b128 a[28:31], v122 offset:448
ds_read_b128 a[32:35], v122 offset:512
ds_read_b128 a[36:39], v122 offset:576
ds_read_b128 a[40:43], v122 offset:640
ds_read_b128 a[44:47], v122 offset:704
ds_read_b128 a[48:51], v122 offset:768
ds_read_b128 a[52:55], v122 offset:832
s_add_u32 m0, s18, 32768
s_add_u32 s20, s18, 229376
s_waitcnt vmcnt(14) lgkmcnt(0)
s_barrier
buffer_load_dwordx4 v138, s[60:63], s20 offen offset:0 lds
mf v[0:3],a[168:171],a[0:3],0
ds_read_b64_tr_b16 a[140:141], v107 offset:32768
ds_read_b64_tr_b16 a[142:143], v107 offset:36352
ds_read_b64_tr_b16 a[144:145], v108 offset:32768
ds_read_b64_tr_b16 a[146:147], v108 offset:36352
mf v[4:7],a[172:175],a[0:3],0
ds_read_b64_tr_b16 a[148:149], v109 offset:32768
ds_read_b64_tr_b16 a[150:151], v109 offset:36352
ds_read_b64_tr_b16 a[152:153], v110 offset:32768
buffer_load_dwordx4 v139, s[60:63], s20 offen offset:1024 lds
mf v[8:11],a[176:179],a[0:3],0
ds_read_b64_tr_b16 a[154:155], v110 offset:36352
ds_read_b64_tr_b16 a[156:157], v111 offset:32768
ds_read_b64_tr_b16 a[158:159], v111 offset:36352
ds_read_b64_tr_b16 a[160:161], v112 offset:32768
buffer_load_dwordx4 v140, s[60:63], s20 offen offset:2048 lds
mf v[12:15],a[180:183],a[0:3],0
ds_read_b64_tr_b16 a[162:163], v112 offset:36352
ds_read_b64_tr_b16 a[164:165], v113 offset:32768
ds_read_b64_tr_b16 a[166:167], v113 offset:36352
buffer_load_dwordx4 v141, s[60:63], s20 offen offset:3072 lds
mf v[16:19],a[184:187],a[0:3],0
s_add_u32 m0, s18, 36864
s_add_u32 s20, s18, 233472
buffer_load_dwordx4 v143, s[60:63], s20 offen offset:0 lds
mf v[20:23],a[188:191],a[0:3],0
buffer_load_dwordx4 v144, s[60:63], s20 offen offset:1024 lds
mf v[24:27],a[192:195],a[0:3],0
buffer_load_dwordx4 v145, s[60:63], s20 offen offset:2048 lds
s_add_u32 m0, s18, 98304
s_add_u32 s20, s18, 258048
s_waitcnt vmcnt(14) lgkmcnt(0)
s_barrier
buffer_load_dwordx4 v138, s[60:63], s20 offen offset:0 lds
mf v[0:3],a[196:199],a[4:7],v[0:3]
ds_read_b64_tr_b16 a[168:169], v100 offset:0
ds_read_b64_tr_b16 a[170:171], v100 offset:3584
ds_read_b64_tr_b16 a[172:173], v101 offset:0
ds_read_b64_tr_b16 a[174:175], v101 offset:3584
mf v[4:7],a[200:203],a[4:7],v[4:7]
ds_read_b64_tr_b16 a[176:177], v102 offset:0
ds_read_b64_tr_b16 a[178:179], v102 offset:3584
ds_read_b64_tr_b16 a[180:181], v103 offset:0
buffer_load_dwordx4 v139, s[60:63], s20 offen offset:1024 lds
mf v[8:11],a[204:207],a[4:7],v[8:11]
ds_read_b64_tr_b16 a[182:183], v103 offset:3584
ds_read_b64_tr_b16 a[184:185], v104 offset:0
ds_read_b64_tr_b16 a[186:187], v104 offset:3584
ds_read_b64_tr_b16 a[188:189], v105 offset:0
buffer_load_dwordx4 v140, s[60:63], s20 offen offset:2048 lds
mf v[12:15],a[208:211],a[4:7],v[12:15]
ds_read_b64_tr_b16 a[190:191], v105 offset:3584
ds_read_b64_tr_b16 a[192:193], v106 offset:0
ds_read_b64_tr_b16 a[194:195], v106 offset:3584
buffer_load_dwordx4 v141, s[60:63], s20 offen offset:3072 lds
mf v[16:19],a[212:215],a[4:7],v[16:19]
s_add_u32 m0, s18, 102400
s_add_u32 s20, s18, 262144
buffer_load_dwordx4 v143, s[60:63], s20 offen offset:0 lds
mf v[20:23],a[216:219],a[4:7],v[20:23]
buffer_load_dwordx4 v144, s[60:63], s20 offen offset:1024 lds
mf v[24:27],a[220:223],a[4:7],v[24:27]
buffer_load_dwordx4 v145, s[60:63], s20 offen offset:2048 lds
s_add_u32 m0, s18, 0
s_add_u32 s20, s18, 286720
s_waitcnt vmcnt(14) lgkmcnt(0)
s_barrier
buffer_load_dwordx4 v138, s[60:63], s20 offen offset:0 lds
mf v[0:3],a[56:59],a[8:11],v[0:3]
ds_read_b64_tr_b16 a[196:197], v107 offset:0
ds_read_b64_tr_b16 a[198:199], v107 offset:3584
ds_read_b64_tr_b16 a[200:201], v108 offset:0
ds_read_b64_tr_b16 a[202:203], v108 offset:3584
mf v[4:7],a[60:63],a[8:11],v[4:7]
ds_read_b64_tr_b16 a[204:205], v109 offset:0
ds_read_b64_tr_b16 a[206:207], v109 offset:3584
ds_read_b64_tr_b16 a[208:209], v110 offset:0
buffer_load_dwordx4 v139, s[60:63], s20 offen offset:1024 lds
mf v[8:11],a[64:67],a[8:11],v[8:11]
ds_read_b64_tr_b16 a[210:211], v110 offset:3584
ds_read_b64_tr_b16 a[212:213], v111 offset:0
ds_read_b64_tr_b16 a[214:215], v111 offset:3584
ds_read_b64_tr_b16 a[216:217], v112 offset:0
buffer_load_dwordx4 v140, s[60:63], s20 offen offset:2048 lds
mf v[12:15],a[68:71],a[8:11],v[12:15]
ds_read_b64_tr_b16 a[218:219], v112 offset:3584
ds_read_b64_tr_b16 a[220:221], v113 offset:0
ds_read_b64_tr_b16 a[222:223], v113 offset:3584
buffer_load_dwordx4 v141, s[60:63], s20 offen offset:3072 lds
mf v[16:19],a[72:75],a[8:11],v[16:19]
s_add_u32 m0, s18, 4096
s_add_u32 s20, s18, 290816
buffer_load_dwordx4 v143, s[60:63], s20 offen offset:0 lds
mf v[20:23],a[76:79],a[8:11],v[20:23]
buffer_load_dwordx4 v144, s[60:63], s20 offen offset:1024 lds
mf v[24:27],a[80:83],a[8:11],v[24:27]
buffer_load_dwordx4 v145, s[60:63], s20 offen offset:2048 lds
s_add_u32 m0, s18, 65536
s_add_u32 s20, s18, 315392
s_waitcnt vmcnt(14) lgkmcnt(0)
s_barrier
buffer_load_dwordx4 v138, s[60:63], s20 offen offset:0 lds
mf v[0:3],a[84:87],a[12:15],v[0:3]
ds_read_b64_tr_b16 a[56:57], v100 offset:32768
ds_read_b64_tr_b16 a[58:59], v100 offset:36352
ds_read_b64_tr_b16 a[60:61], v101 offset:32768
ds_read_b64_tr_b16 a[62:63], v101 offset:36352
mf v[4:7],a[88:91],a[12:15],v[4:7]
ds_read_b64_tr_b16 a[64:65], v102 offset:32768
ds_read_b64_tr_b16 a[66:67], v102 offset:36352
ds_read_b64_tr_b16 a[68:69], v103 offset:32768
buffer_load_dwordx4 v139, s[60:63], s20 offen offset:1024 lds
mf v[8:11],a[92:95],a[12:15],v[8:11]
ds_read_b64_tr_b16 a[70:71], v103 offset:36352
ds_read_b64_tr_b16 a[72:73], v104 offset:32768
ds_read_b64_tr_b16 a[74:75], v104 offset:36352
ds_read_b64_tr_b16 a[76:77], v105 offset:32768
buffer_load_dwordx4 v140, s[60:63], s20 offen offset:2048 lds
mf v[12:15],a[96:99],a[12:15],v[12:15]
ds_read_b64_tr_b16 a[78:79], v105 offset:36352
ds_read_b64_tr_b16 a[80:81], v106 offset:32768
ds_read_b64_tr_b16 a[82:83], v106 offset:36352
buffer_load_dwordx4 v141, s[60:63], s20 offen offset:3072 lds
mf v[16:19],a[100:103],a[12:15],v[16:19]
s_add_u32 m0, s18, 69632
s_add_u32 s20, s18, 319488
buffer_load_dwordx4 v143, s[60:63], s20 offen offset:0 lds
mf v[20:23],a[104:107],a[12:15],v[20:23]
buffer_load_dwordx4 v144, s[60:63], s20 offen offset:1024 lds
mf v[24:27],a[108:111],a[12:15],v[24:27]
buffer_load_dwordx4 v145, s[60:63], s20 offen offset:2048 lds
s_add_u32 m0, s18, 32768
s_add_u32 s20, s18, 344064
s_waitcnt vmcnt(14) lgkmcnt(0)
s_barrier
buffer_load_dwordx4 v138, s[60:63], s20 offen offset:0 lds
mf v[0:3],a[112:115],a[16:19],v[0:3]
ds_read_b64_tr_b16 a[84:85], v107 offset:32768
ds_read_b64_tr_b16 a[86:87], v107 offset:36352
ds_read_b64_tr_b16 a[88:89], v108 offset:32768
ds_read_b64_tr_b16 a[90:91], v108 offset:36352
mf v[4:7],a[116:119],a[16:19],v[4:7]
ds_read_b64_tr_b16 a[92:93], v109 offset:32768
ds_read_b64_tr_b16 a[94:95], v109 offset:36352
ds_read_b64_tr_b16 a[96:97], v110 offset:32768
buffer_load_dwordx4 v139, s[60:63], s20 offen offset:1024 lds
mf v[8:11],a[120:123],a[16:19],v[8:11]
ds_read_b64_tr_b16 a[98:99], v110 offset:36352
ds_read_b64_tr_b16 a[100:101], v111 offset:32768
ds_read_b64_tr_b16 a[102:103], v111 offset:36352
ds_read_b64_tr_b16 a[104:105], v112 offset:32768
buffer_load_dwordx4 v140, s[60:63], s20 offen offset:2048 lds
mf v[12:15],a[124:127],a[16:19],v[12:15]
ds_read_b64_tr_b16 a[106:107], v112 offset:36352
ds_read_b64_tr_b16 a[108:109], v113 offset:32768
ds_read_b64_tr_b16 a[110:111], v113 offset:36352
buffer_load_dwordx4 v141, s[60:63], s20 offen offset:3072 lds
mf v[16:19],a[128:131],a[16:19],v[16:19]
s_add_u32 m0, s18, 36864
s_add_u32 s20, s18, 348160
buffer_load_dwordx4 v143, s[60:63], s20 offen offset:0 lds
mf v[20:23],a[132:135],a[16:19],v[20:23]
buffer_load_dwordx4 v144, s[60:63], s20 offen offset:1024 lds
mf v[24:27],a[136:139],a[16:19],v[24:27]
buffer_load_dwordx4 v145, s[60:63], s20 offen offset:2048 lds
s_add_u32 m0, s18, 98304
s_add_u32 s20, s18, 372736
s_waitcnt vmcnt(14) lgkmcnt(0)
s_barrier
buffer_load_dwordx4 v138, s[60:63], s20 offen offset:0 lds
mf v[0:3],a[140:143],a[20:23],v[0:3]
ds_read_b64_tr_b16 a[112:113], v100 offset:0
ds_read_b64_tr_b16 a[114:115], v100 offset:3584
ds_read_b64_tr_b16 a[116:117], v101 offset:0
ds_read_b64_tr_b16 a[118:119], v101 offset:3584
mf v[4:7],a[144:147],a[20:23],v[4:7]
ds_read_b64_tr_b16 a[120:121], v102 offset:0
ds_read_b64_tr_b16 a[122:123], v102 offset:3584
ds_read_b64_tr_b16 a[124:125], v103 offset:0
buffer_load_dwordx4 v139, s[60:63], s20 offen offset:1024 lds
mf v[8:11],a[148:151],a[20:23],v[8:11]
ds_read_b64_tr_b16 a[126:127], v103 offset:3584
ds_read_b64_tr_b16 a[128:129], v104 offset:0
ds_read_b64_tr_b16 a[130:131], v104 offset:3584
ds_read_b64_tr_b16 a[132:133], v105 offset:0
buffer_load_dwordx4 v140, s[60:63], s20 offen offset:2048 lds
mf v[12:15],a[152:155],a[20:23],v[12:15]
ds_read_b64_tr_b16 a[134:135], v105 offset:3584
ds_read_b64_tr_b16 a[136:137], v106 offset:0
ds_read_b64_tr_b16 a[138:139], v106 offset:3584
buffer_load_dwordx4 v141, s[60:63], s20 offen offset:3072 lds
mf v[16:19],a[156:159],a[20:23],v[16:19]
s_add_u32 m0, s18, 102400
s_add_u32 s20, s18, 376832
buffer_load_dwordx4 v143, s[60:63], s20 offen offset:0 lds
mf v[20:23],a[160:163],a[20:23],v[20:23]
buffer_load_dwordx4 v144, s[60:63], s20 offen offset:1024 lds
mf v[24:27],a[164:167],a[20:23],v[24:27]
buffer_load_dwordx4 v145, s[60:63], s20 offen offset:2048 lds
v_lshlrev_b32 v206, 4, v255
s_and_b32 s4, s42, 1
s_lshl_b32 s17, s12, 1
s_add_u32 s4, s4, s17
s_bfe_u32 s5, s42, 0x30001
v_lshrrev_b32 v242, 4, v255
s_lshl_b32 s17, s16, 2
v_add_u32 v242, s17, v242
v_and_b32 v243, 7, v242
v_lshlrev_b32 v243, 1, v243
v_and_b32 v244, 15, v255
v_xor_b32 v243, v243, v244
v_lshlrev_b32 v243, 4, v243
v_mul_u32_u24 v244, 3584, v242
v_add_u32 v240, v244, v243
v_add_u32 v241, 56320, v240
v_add_u32 v222, 16384, v206
s_mov_b32 s20, s68
s_and_b32 s21, s69, 0xffff
s_mov_b32 s22, 1605632
s_mov_b32 s23, 0x20000
s_lshl_b32 s34, s16, 11
s_lshl_b32 s32, s5, 9
s_waitcnt vmcnt(14) lgkmcnt(0)
s_barrier
mf v[0:3],a[168:171],a[24:27],v[0:3]
ds_read_b64_tr_b16 a[140:141], v107 offset:0
ds_read_b64_tr_b16 a[142:143], v107 offset:3584
ds_read_b64_tr_b16 a[144:145], v108 offset:0
ds_read_b64_tr_b16 a[146:147], v108 offset:3584
mf v[4:7],a[172:175],a[24:27],v[4:7]
ds_read_b64_tr_b16 a[148:149], v109 offset:0
ds_read_b64_tr_b16 a[150:151], v109 offset:3584
ds_read_b64_tr_b16 a[152:153], v110 offset:0
s_add_u32 m0, s34, 0
s_add_u32 s37, s32, 0
buffer_load_dwordx4 v240, s[20:23], s37 offen lds
mf v[8:11],a[176:179],a[24:27],v[8:11]
ds_read_b64_tr_b16 a[154:155], v110 offset:3584
ds_read_b64_tr_b16 a[156:157], v111 offset:0
ds_read_b64_tr_b16 a[158:159], v111 offset:3584
ds_read_b64_tr_b16 a[160:161], v112 offset:0
buffer_load_dwordx4 v241, s[20:23], s37 offen offset:1024 lds
mf v[12:15],a[180:183],a[24:27],v[12:15]
ds_read_b64_tr_b16 a[162:163], v112 offset:3584
ds_read_b64_tr_b16 a[164:165], v113 offset:0
ds_read_b64_tr_b16 a[166:167], v113 offset:3584
mf v[16:19],a[184:187],a[24:27],v[16:19]
s_add_u32 m0, s34, 8192
s_add_u32 s37, s32, 114688
buffer_load_dwordx4 v240, s[20:23], s37 offen lds
mf v[20:23],a[188:191],a[24:27],v[20:23]
buffer_load_dwordx4 v241, s[20:23], s37 offen offset:1024 lds
mf v[24:27],a[192:195],a[24:27],v[24:27]
s_waitcnt vmcnt(11) lgkmcnt(0)
s_barrier
mf v[0:3],a[196:199],a[28:31],v[0:3]
ds_read_b64_tr_b16 a[168:169], v100 offset:32768
ds_read_b64_tr_b16 a[170:171], v100 offset:36352
ds_read_b64_tr_b16 a[172:173], v101 offset:32768
ds_read_b64_tr_b16 a[174:175], v101 offset:36352
mf v[4:7],a[200:203],a[28:31],v[4:7]
ds_read_b64_tr_b16 a[176:177], v102 offset:32768
ds_read_b64_tr_b16 a[178:179], v102 offset:36352
ds_read_b64_tr_b16 a[180:181], v103 offset:32768
s_add_u32 m0, s34, 16384
s_add_u32 s37, s32, 229376
buffer_load_dwordx4 v240, s[20:23], s37 offen lds
mf v[8:11],a[204:207],a[28:31],v[8:11]
ds_read_b64_tr_b16 a[182:183], v103 offset:36352
ds_read_b64_tr_b16 a[184:185], v104 offset:32768
ds_read_b64_tr_b16 a[186:187], v104 offset:36352
ds_read_b64_tr_b16 a[188:189], v105 offset:32768
buffer_load_dwordx4 v241, s[20:23], s37 offen offset:1024 lds
mf v[12:15],a[208:211],a[28:31],v[12:15]
ds_read_b64_tr_b16 a[190:191], v105 offset:36352
ds_read_b64_tr_b16 a[192:193], v106 offset:32768
ds_read_b64_tr_b16 a[194:195], v106 offset:36352
mf v[16:19],a[212:215],a[28:31],v[16:19]
s_add_u32 m0, s34, 24576
s_add_u32 s37, s32, 344064
buffer_load_dwordx4 v240, s[20:23], s37 offen lds
mf v[20:23],a[216:219],a[28:31],v[20:23]
buffer_load_dwordx4 v241, s[20:23], s37 offen offset:1024 lds
mf v[24:27],a[220:223],a[28:31],v[24:27]
s_waitcnt vmcnt(8) lgkmcnt(0)
s_barrier
mf v[0:3],a[56:59],a[32:35],v[0:3]
ds_read_b64_tr_b16 a[196:197], v107 offset:32768
ds_read_b64_tr_b16 a[198:199], v107 offset:36352
ds_read_b64_tr_b16 a[200:201], v108 offset:32768
ds_read_b64_tr_b16 a[202:203], v108 offset:36352
mf v[4:7],a[60:63],a[32:35],v[4:7]
ds_read_b64_tr_b16 a[204:205], v109 offset:32768
ds_read_b64_tr_b16 a[206:207], v109 offset:36352
ds_read_b64_tr_b16 a[208:209], v110 offset:32768
s_add_u32 m0, s34, 65536
s_add_u32 s37, s32, 458752
buffer_load_dwordx4 v240, s[20:23], s37 offen lds
mf v[8:11],a[64:67],a[32:35],v[8:11]
ds_read_b64_tr_b16 a[210:211], v110 offset:36352
ds_read_b64_tr_b16 a[212:213], v111 offset:32768
ds_read_b64_tr_b16 a[214:215], v111 offset:36352
ds_read_b64_tr_b16 a[216:217], v112 offset:32768
buffer_load_dwordx4 v241, s[20:23], s37 offen offset:1024 lds
mf v[12:15],a[68:71],a[32:35],v[12:15]
ds_read_b64_tr_b16 a[218:219], v112 offset:36352
ds_read_b64_tr_b16 a[220:221], v113 offset:32768
ds_read_b64_tr_b16 a[222:223], v113 offset:36352
mf v[16:19],a[72:75],a[32:35],v[16:19]
s_add_u32 m0, s34, 73728
s_add_u32 s37, s32, 573440
buffer_load_dwordx4 v240, s[20:23], s37 offen lds
mf v[20:23],a[76:79],a[32:35],v[20:23]
buffer_load_dwordx4 v241, s[20:23], s37 offen offset:1024 lds
mf v[24:27],a[80:83],a[32:35],v[24:27]
s_waitcnt lgkmcnt(0)
s_barrier
mf v[0:3],a[84:87],a[36:39],v[0:3]
mf v[4:7],a[88:91],a[36:39],v[4:7]
s_add_u32 m0, s34, 81920
s_add_u32 s37, s32, 688128
buffer_load_dwordx4 v240, s[20:23], s37 offen lds
mf v[8:11],a[92:95],a[36:39],v[8:11]
buffer_load_dwordx4 v241, s[20:23], s37 offen offset:1024 lds
mf v[12:15],a[96:99],a[36:39],v[12:15]
mf v[16:19],a[100:103],a[36:39],v[16:19]
s_add_u32 m0, s34, 90112
s_add_u32 s37, s32, 802816
buffer_load_dwordx4 v240, s[20:23], s37 offen lds
mf v[20:23],a[104:107],a[36:39],v[20:23]
buffer_load_dwordx4 v241, s[20:23], s37 offen offset:1024 lds
mf v[24:27],a[108:111],a[36:39],v[24:27]
mf v[0:3],a[112:115],a[40:43],v[0:3]
mf v[4:7],a[116:119],a[40:43],v[4:7]
mf v[8:11],a[120:123],a[40:43],v[8:11]
mf v[12:15],a[124:127],a[40:43],v[12:15]
mf v[16:19],a[128:131],a[40:43],v[16:19]
mf v[20:23],a[132:135],a[40:43],v[20:23]
mf v[24:27],a[136:139],a[40:43],v[24:27]
mf v[0:3],a[140:143],a[44:47],v[0:3]
mf v[4:7],a[144:147],a[44:47],v[4:7]
mf v[8:11],a[148:151],a[44:47],v[8:11]
mf v[12:15],a[152:155],a[44:47],v[12:15]
mf v[16:19],a[156:159],a[44:47],v[16:19]
mf v[20:23],a[160:163],a[44:47],v[20:23]
mf v[24:27],a[164:167],a[44:47],v[24:27]
mf v[0:3],a[168:171],a[48:51],v[0:3]
mf v[4:7],a[172:175],a[48:51],v[4:7]
mf v[8:11],a[176:179],a[48:51],v[8:11]
mf v[12:15],a[180:183],a[48:51],v[12:15]
mf v[16:19],a[184:187],a[48:51],v[16:19]
mf v[20:23],a[188:191],a[48:51],v[20:23]
mf v[24:27],a[192:195],a[48:51],v[24:27]
mf v[0:3],a[196:199],a[52:55],v[0:3]
mf v[4:7],a[200:203],a[52:55],v[4:7]
mf v[8:11],a[204:207],a[52:55],v[8:11]
mf v[12:15],a[208:211],a[52:55],v[12:15]
mf v[16:19],a[212:215],a[52:55],v[16:19]
mf v[20:23],a[216:219],a[52:55],v[20:23]
mf v[24:27],a[220:223],a[52:55],v[24:27]
v_lshlrev_b32 v28, 16, v156
v_and_b32 v29, 0xffff0000, v156
v_lshlrev_b32 v30, 16, v157
v_and_b32 v31, 0xffff0000, v157
v_lshlrev_b32 v32, 16, v158
v_and_b32 v33, 0xffff0000, v158
v_lshlrev_b32 v34, 16, v159
v_and_b32 v35, 0xffff0000, v159
v_lshlrev_b32 v36, 16, v160
v_and_b32 v37, 0xffff0000, v160
v_lshlrev_b32 v38, 16, v161
v_and_b32 v39, 0xffff0000, v161
v_lshlrev_b32 v40, 16, v162
v_and_b32 v41, 0xffff0000, v162
v_lshlrev_b32 v42, 16, v163
v_and_b32 v43, 0xffff0000, v163
v_lshlrev_b32 v44, 16, v164
v_and_b32 v45, 0xffff0000, v164
v_lshlrev_b32 v46, 16, v165
v_and_b32 v47, 0xffff0000, v165
v_lshlrev_b32 v48, 16, v166
v_and_b32 v49, 0xffff0000, v166
v_lshlrev_b32 v50, 16, v167
v_and_b32 v51, 0xffff0000, v167
v_lshlrev_b32 v52, 16, v168
v_and_b32 v53, 0xffff0000, v168
v_lshlrev_b32 v54, 16, v169
v_and_b32 v55, 0xffff0000, v169
v_pk_add_f32 v[0:1], v[0:1], v[28:29]
v_pk_add_f32 v[2:3], v[2:3], v[30:31]
v_pk_add_f32 v[4:5], v[4:5], v[32:33]
v_pk_add_f32 v[6:7], v[6:7], v[34:35]
v_pk_add_f32 v[8:9], v[8:9], v[36:37]
v_pk_add_f32 v[10:11], v[10:11], v[38:39]
v_pk_add_f32 v[12:13], v[12:13], v[40:41]
v_pk_add_f32 v[14:15], v[14:15], v[42:43]
v_pk_add_f32 v[16:17], v[16:17], v[44:45]
v_pk_add_f32 v[18:19], v[18:19], v[46:47]
v_pk_add_f32 v[20:21], v[20:21], v[48:49]
v_pk_add_f32 v[22:23], v[22:23], v[50:51]
v_pk_add_f32 v[24:25], v[24:25], v[52:53]
v_pk_add_f32 v[26:27], v[26:27], v[54:55]
v_pk_mul_f32 v[58:59], v[0:1], v[0:1]
v_pk_fma_f32 v[58:59], v[2:3], v[2:3], v[58:59]
v_pk_add_f32 v[56:57], v[0:1], v[2:3]
v_pk_fma_f32 v[58:59], v[4:5], v[4:5], v[58:59]
v_pk_add_f32 v[56:57], v[56:57], v[4:5]
v_pk_fma_f32 v[58:59], v[6:7], v[6:7], v[58:59]
v_pk_add_f32 v[56:57], v[56:57], v[6:7]
v_pk_fma_f32 v[58:59], v[8:9], v[8:9], v[58:59]
v_pk_add_f32 v[56:57], v[56:57], v[8:9]
v_pk_fma_f32 v[58:59], v[10:11], v[10:11], v[58:59]
v_pk_add_f32 v[56:57], v[56:57], v[10:11]
v_pk_fma_f32 v[58:59], v[12:13], v[12:13], v[58:59]
v_pk_add_f32 v[56:57], v[56:57], v[12:13]
v_pk_fma_f32 v[58:59], v[14:15], v[14:15], v[58:59]
v_pk_add_f32 v[56:57], v[56:57], v[14:15]
v_pk_fma_f32 v[58:59], v[16:17], v[16:17], v[58:59]
v_pk_add_f32 v[56:57], v[56:57], v[16:17]
v_pk_fma_f32 v[58:59], v[18:19], v[18:19], v[58:59]
v_pk_add_f32 v[56:57], v[56:57], v[18:19]
v_pk_fma_f32 v[58:59], v[20:21], v[20:21], v[58:59]
v_pk_add_f32 v[56:57], v[56:57], v[20:21]
v_pk_fma_f32 v[58:59], v[22:23], v[22:23], v[58:59]
v_pk_add_f32 v[56:57], v[56:57], v[22:23]
v_pk_fma_f32 v[58:59], v[24:25], v[24:25], v[58:59]
v_pk_add_f32 v[56:57], v[56:57], v[24:25]
v_pk_fma_f32 v[58:59], v[26:27], v[26:27], v[58:59]
v_pk_add_f32 v[56:57], v[56:57], v[26:27]
v_add_f32 v60, v56, v57
v_add_f32 v61, v58, v59
v_mov_b32 v56, v60
v_mov_b32 v57, v61
s_nop 1
v_permlane16_swap_b32 v56, v60
v_permlane16_swap_b32 v57, v61
s_nop 1
v_add_f32 v60, v60, v56
v_add_f32 v61, v61, v57
v_mov_b32 v56, v60
v_mov_b32 v57, v61
s_nop 1
v_permlane32_swap_b32 v56, v60
v_permlane32_swap_b32 v57, v61
s_nop 1
v_add_f32 v60, v60, v56
v_add_f32 v61, v61, v57
v_lshlrev_b32 v116, 3, v114
v_add_u32 v116, 147456, v116
s_lshl_b32 s17, s16, 7
v_add_u32 v118, s17, v116
ds_write_b64 v118, v[60:61]
v_sub_f32 v62, 1.0, v120
v_pk_mul_f32 v[28:29], v[0:1], v[62:63] op_sel_hi:[1,0]
v_pk_mul_f32 v[30:31], v[2:3], v[62:63] op_sel_hi:[1,0]
v_pk_mul_f32 v[32:33], v[4:5], v[62:63] op_sel_hi:[1,0]
v_pk_mul_f32 v[34:35], v[6:7], v[62:63] op_sel_hi:[1,0]
v_pk_mul_f32 v[36:37], v[8:9], v[62:63] op_sel_hi:[1,0]
v_pk_mul_f32 v[38:39], v[10:11], v[62:63] op_sel_hi:[1,0]
v_pk_mul_f32 v[40:41], v[12:13], v[62:63] op_sel_hi:[1,0]
v_pk_mul_f32 v[42:43], v[14:15], v[62:63] op_sel_hi:[1,0]
v_pk_mul_f32 v[44:45], v[16:17], v[62:63] op_sel_hi:[1,0]
v_pk_mul_f32 v[46:47], v[18:19], v[62:63] op_sel_hi:[1,0]
v_pk_mul_f32 v[48:49], v[20:21], v[62:63] op_sel_hi:[1,0]
v_pk_mul_f32 v[50:51], v[22:23], v[62:63] op_sel_hi:[1,0]
v_pk_mul_f32 v[52:53], v[24:25], v[62:63] op_sel_hi:[1,0]
v_pk_mul_f32 v[54:55], v[26:27], v[62:63] op_sel_hi:[1,0]
s_waitcnt lgkmcnt(0)
s_barrier
ds_read_b64 v[64:65], v116 offset:0
ds_read_b64 v[66:67], v116 offset:128
ds_read_b64 v[68:69], v116 offset:256
ds_read_b64 v[70:71], v116 offset:384
s_mul_i32 s26, s43, 28672
s_mul_i32 s17, s16, 7168
s_add_u32 s26, s26, s17
s_add_u32 s26, s26, 106954752
s_add_u32 s27, s26, 4096
s_waitcnt lgkmcnt(0)
v_pk_add_f32 v[64:65], v[64:65], v[66:67]
v_pk_add_f32 v[68:69], v[68:69], v[70:71]
v_pk_add_f32 v[64:65], v[64:65], v[68:69]
v_mul_f32 v56, 0xbb124925, v64
v_mov_b32 v58, 0x3727c5ac
v_fmac_f32 v58, 0x3b124925, v65
v_fma_f32 v58, -v56, v56, v58
v_max_f32 v58, 0x3727c5ac, v58
v_rsq_f32 v58, v58
v_pk_add_f32 v[0:1], v[0:1], v[56:57] op_sel_hi:[1,0]
v_pk_add_f32 v[2:3], v[2:3], v[56:57] op_sel_hi:[1,0]
v_pk_add_f32 v[4:5], v[4:5], v[56:57] op_sel_hi:[1,0]
v_pk_add_f32 v[6:7], v[6:7], v[56:57] op_sel_hi:[1,0]
v_pk_add_f32 v[8:9], v[8:9], v[56:57] op_sel_hi:[1,0]
v_pk_add_f32 v[10:11], v[10:11], v[56:57] op_sel_hi:[1,0]
v_pk_add_f32 v[12:13], v[12:13], v[56:57] op_sel_hi:[1,0]
v_pk_add_f32 v[14:15], v[14:15], v[56:57] op_sel_hi:[1,0]
v_pk_add_f32 v[16:17], v[16:17], v[56:57] op_sel_hi:[1,0]
v_pk_add_f32 v[18:19], v[18:19], v[56:57] op_sel_hi:[1,0]
v_pk_add_f32 v[20:21], v[20:21], v[56:57] op_sel_hi:[1,0]
v_pk_add_f32 v[22:23], v[22:23], v[56:57] op_sel_hi:[1,0]
v_pk_add_f32 v[24:25], v[24:25], v[56:57] op_sel_hi:[1,0]
v_pk_add_f32 v[26:27], v[26:27], v[56:57] op_sel_hi:[1,0]
v_pk_mul_f32 v[0:1], v[0:1], v[58:59] op_sel_hi:[1,0]
v_pk_mul_f32 v[2:3], v[2:3], v[58:59] op_sel_hi:[1,0]
v_pk_mul_f32 v[4:5], v[4:5], v[58:59] op_sel_hi:[1,0]
v_pk_mul_f32 v[6:7], v[6:7], v[58:59] op_sel_hi:[1,0]
v_pk_mul_f32 v[8:9], v[8:9], v[58:59] op_sel_hi:[1,0]
v_pk_mul_f32 v[10:11], v[10:11], v[58:59] op_sel_hi:[1,0]
v_pk_mul_f32 v[12:13], v[12:13], v[58:59] op_sel_hi:[1,0]
v_pk_mul_f32 v[14:15], v[14:15], v[58:59] op_sel_hi:[1,0]
v_pk_mul_f32 v[16:17], v[16:17], v[58:59] op_sel_hi:[1,0]
v_pk_mul_f32 v[18:19], v[18:19], v[58:59] op_sel_hi:[1,0]
v_pk_mul_f32 v[20:21], v[20:21], v[58:59] op_sel_hi:[1,0]
v_pk_mul_f32 v[22:23], v[22:23], v[58:59] op_sel_hi:[1,0]
v_pk_mul_f32 v[24:25], v[24:25], v[58:59] op_sel_hi:[1,0]
v_pk_mul_f32 v[26:27], v[26:27], v[58:59] op_sel_hi:[1,0]
v_cvt_pk_bf16_f32 v156, v0, v1
v_cvt_pk_bf16_f32 v157, v2, v3
v_cvt_pk_bf16_f32 v158, v4, v5
v_cvt_pk_bf16_f32 v159, v6, v7
v_cvt_pk_bf16_f32 v160, v8, v9
v_cvt_pk_bf16_f32 v161, v10, v11
v_cvt_pk_bf16_f32 v162, v12, v13
v_cvt_pk_bf16_f32 v163, v14, v15
v_cvt_pk_bf16_f32 v164, v16, v17
v_cvt_pk_bf16_f32 v165, v18, v19
v_cvt_pk_bf16_f32 v166, v20, v21
v_cvt_pk_bf16_f32 v167, v22, v23
v_cvt_pk_bf16_f32 v168, v24, v25
v_cvt_pk_bf16_f32 v169, v26, v27
s_mul_i32 s17, s16, 7
s_lshr_b32 s17, s17, 1
s_lshl_b32 s17, s17, 10
s_lshl_b32 s19, s43, 14
s_add_u32 s19, s19, s17
s_add_u32 s19, s19, 111149056
v_lshlrev_b32 v116, 2, v114
s_lshl_b32 s17, s43, 6
s_add_u32 s17, s17, 104857600
s_bitcmp1_b32 s16, 0
s_cbranch_scc1 xodd_27
buffer_store_dwordx4 v[156:159], v142, s[28:31], s19 offen offset:0 sc1
buffer_store_dwordx4 v[160:163], v142, s[28:31], s19 offen offset:1024 sc1
buffer_store_dwordx4 v[164:167], v142, s[28:31], s19 offen offset:2048 sc1
buffer_store_dwordx2 v[168:169], v142, s[28:31], s19 offen offset:3072 sc1
s_branch xjoin_28
xodd_27:
buffer_store_dwordx2 v[156:157], v142, s[28:31], s19 offen offset:8 sc1
buffer_store_dwordx4 v[158:161], v142, s[28:31], s19 offen offset:1024 sc1
buffer_store_dwordx4 v[162:165], v142, s[28:31], s19 offen offset:2048 sc1
buffer_store_dwordx4 v[166:169], v142, s[28:31], s19 offen offset:3072 sc1
xjoin_28:
buffer_store_dword v120, v116, s[28:31], s17 offen sc1
buffer_store_dwordx4 v[28:31], v142, s[28:31], s26 offen offset:0 sc1
buffer_store_dwordx4 v[32:35], v142, s[28:31], s26 offen offset:1024 sc1
buffer_store_dwordx4 v[36:39], v142, s[28:31], s26 offen offset:2048 sc1
buffer_store_dwordx4 v[40:43], v142, s[28:31], s26 offen offset:3072 sc1
buffer_store_dwordx4 v[44:47], v142, s[28:31], s27 offen offset:0 sc1
buffer_store_dwordx4 v[48:51], v142, s[28:31], s27 offen offset:1024 sc1
buffer_store_dwordx4 v[52:55], v142, s[28:31], s27 offen offset:2048 sc1
s_waitcnt vmcnt(7)
s_barrier
s_cmp_lg_u32 s16, 0
s_cbranch_scc1 nofl_29
v_mov_b32 v134, 2
v_mov_b32 v135, 0
s_mov_b64 exec, 1
buffer_store_dword v134, v135, s[28:31], s3 offen sc1
s_mov_b64 exec, -1
nofl_29:
s_add_u32 m0, s34, 32768
s_add_u32 s37, s32, 917504
buffer_load_dwordx4 v240, s[20:23], s37 offen lds
buffer_load_dwordx4 v241, s[20:23], s37 offen offset:1024 lds
s_add_u32 m0, s34, 40960
s_add_u32 s37, s32, 1032192
buffer_load_dwordx4 v240, s[20:23], s37 offen lds
buffer_load_dwordx4 v241, s[20:23], s37 offen offset:1024 lds
s_add_u32 m0, s34, 49152
s_add_u32 s37, s32, 1146880
buffer_load_dwordx4 v240, s[20:23], s37 offen lds
buffer_load_dwordx4 v241, s[20:23], s37 offen offset:1024 lds
s_cmp_ge_u32 s42, 30
s_cbranch_scc1 notile_30
s_and_b32 s17, s4, 1
s_lshl_b32 s17, s17, 6
s_add_u32 s17, s17, s12
s_add_u32 s17, s17, 128
v_and_b32 v221, 7, v255
v_lshl_add_u32 v221, v221, 3, s17
v_lshlrev_b32 v221, 7, v221
v_add_u32 v221, 105906176, v221
v_lshrrev_b32 v242, 4, v255
v_lshlrev_b32 v242, 11, v242
v_bfe_u32 v243, v255, 2, 2
v_lshl_add_u32 v242, v243, 8, v242
v_and_b32 v244, 3, v255
v_lshl_add_u32 v242, v244, 3, v242
v_bfe_u32 v243, v255, 2, 3
v_xor_b32 v244, 0, v243
v_lshl_add_u32 v224, v244, 5, v242
v_add_u32 v232, 0x10000, v224
v_xor_b32 v244, 1, v243
v_lshl_add_u32 v225, v244, 5, v242
v_add_u32 v233, 0x10000, v225
v_xor_b32 v244, 2, v243
v_lshl_add_u32 v226, v244, 5, v242
v_add_u32 v234, 0x10000, v226
v_xor_b32 v244, 3, v243
v_lshl_add_u32 v227, v244, 5, v242
v_add_u32 v235, 0x10000, v227
v_xor_b32 v244, 4, v243
v_lshl_add_u32 v228, v244, 5, v242
v_add_u32 v236, 0x10000, v228
v_xor_b32 v244, 5, v243
v_lshl_add_u32 v229, v244, 5, v242
v_add_u32 v237, 0x10000, v229
v_xor_b32 v244, 6, v243
v_lshl_add_u32 v230, v244, 5, v242
v_add_u32 v238, 0x10000, v230
v_xor_b32 v244, 7, v243
v_lshl_add_u32 v231, v244, 5, v242
v_add_u32 v239, 0x10000, v231
s_lshl_b32 s36, s4, 2
s_add_u32 s36, s36, s16
s_lshl_b32 s33, s36, 15
s_add_u32 s33, s33, 111149056
s_mul_i32 s35, s36, 376832
s_lshl_b32 s18, s5, 13
s_add_u32 s35, s35, s18
s_add_u32 s35, s35, 50462720
s_add_u32 s39, s35, 188416
s_lshl_b32 s36, s36, 7
s_add_u32 s36, s36, 104857600
v_and_b32 v242, 15, v255
v_lshlrev_b32 v242, 2, v242
s_mov_b32 s67, 0x80000
s_mov_b64 exec, 0xff
poll_32:
buffer_load_dword v220, v221, s[28:31], 0 offen sc1
s_waitcnt vmcnt(0)
v_cmp_gt_u32 vcc, 2, v220
s_cbranch_vccz pollok_33
s_sleep 2
s_sub_u32 s67, s67, 1
s_cmp_lg_u32 s67, 0
s_cbranch_scc1 poll_32
pollok_33:
s_mov_b64 exec, -1
s_add_u32 s38, s33, 0
buffer_load_dwordx4 a[0:3], v206, s[28:31], s38 offen sc1
buffer_load_dwordx4 a[4:7], v222, s[28:31], s38 offen sc1
s_add_u32 s38, s33, 1024
buffer_load_dwordx4 a[8:11], v206, s[28:31], s38 offen sc1
buffer_load_dwordx4 a[12:15], v222, s[28:31], s38 offen sc1
s_add_u32 s38, s33, 2048
buffer_load_dwordx4 a[16:19], v206, s[28:31], s38 offen sc1
buffer_load_dwordx4 a[20:23], v222, s[28:31], s38 offen sc1
s_add_u32 s38, s33, 3072
buffer_load_dwordx4 a[24:27], v206, s[28:31], s38 offen sc1
buffer_load_dwordx4 a[28:31], v222, s[28:31], s38 offen sc1
buffer_load_dword v250, v242, s[28:31], s36 offen sc1
buffer_load_dword v251, v242, s[28:31], s36 offen offset:64 sc1
s_barrier
ds_read_b64_tr_b16 v[64:65], v224 offset:0
ds_read_b64_tr_b16 v[66:67], v224 offset:1024
ds_read_b64_tr_b16 v[68:69], v225 offset:0
ds_read_b64_tr_b16 v[70:71], v225 offset:1024
ds_read_b64_tr_b16 v[72:73], v226 offset:0
ds_read_b64_tr_b16 v[74:75], v226 offset:1024
ds_read_b64_tr_b16 v[76:77], v227 offset:0
ds_read_b64_tr_b16 v[78:79], v227 offset:1024
ds_read_b64_tr_b16 v[80:81], v228 offset:0
ds_read_b64_tr_b16 v[82:83], v228 offset:1024
ds_read_b64_tr_b16 v[84:85], v229 offset:0
ds_read_b64_tr_b16 v[86:87], v229 offset:1024
ds_read_b64_tr_b16 v[88:89], v230 offset:0
ds_read_b64_tr_b16 v[90:91], v230 offset:1024
ds_read_b64_tr_b16 v[92:93], v231 offset:0
ds_read_b64_tr_b16 v[94:95], v231 offset:1024
s_waitcnt vmcnt(6) lgkmcnt(8)
s_barrier
mf v[0:3],v[64:67],a[0:3],0
ds_read_b64_tr_b16 v[96:97], v224 offset:8192
s_add_u32 s38, s33, 4096
mf v[32:35],v[64:67],a[4:7],0
ds_read_b64_tr_b16 v[98:99], v224 offset:9216
mf v[36:39],v[68:71],a[4:7],0
ds_read_b64_tr_b16 v[100:101], v225 offset:8192
buffer_load_dwordx4 a[32:35], v206, s[28:31], s38 offen sc1
mf v[4:7],v[68:71],a[0:3],0
ds_read_b64_tr_b16 v[102:103], v225 offset:9216
mf v[8:11],v[72:75],a[0:3],0
ds_read_b64_tr_b16 v[104:105], v226 offset:8192
mf v[40:43],v[72:75],a[4:7],0
ds_read_b64_tr_b16 v[106:107], v226 offset:9216
buffer_load_dwordx4 a[36:39], v222, s[28:31], s38 offen sc1
mf v[44:47],v[76:79],a[4:7],0
ds_read_b64_tr_b16 v[108:109], v227 offset:8192
mf v[12:15],v[76:79],a[0:3],0
ds_read_b64_tr_b16 v[110:111], v227 offset:9216
s_waitcnt lgkmcnt(8)
mf v[16:19],v[80:83],a[0:3],0
ds_read_b64_tr_b16 v[112:113], v228 offset:8192
s_add_u32 s38, s33, 5120
mf v[48:51],v[80:83],a[4:7],0
ds_read_b64_tr_b16 v[114:115], v228 offset:9216
mf v[52:55],v[84:87],a[4:7],0
ds_read_b64_tr_b16 v[116:117], v229 offset:8192
buffer_load_dwordx4 a[40:43], v206, s[28:31], s38 offen sc1
mf v[20:23],v[84:87],a[0:3],0
ds_read_b64_tr_b16 v[118:119], v229 offset:9216
mf v[24:27],v[88:91],a[0:3],0
ds_read_b64_tr_b16 v[120:121], v230 offset:8192
mf v[56:59],v[88:91],a[4:7],0
ds_read_b64_tr_b16 v[122:123], v230 offset:9216
buffer_load_dwordx4 a[44:47], v222, s[28:31], s38 offen sc1
mf v[60:63],v[92:95],a[4:7],0
ds_read_b64_tr_b16 v[124:125], v231 offset:8192
mf v[28:31],v[92:95],a[0:3],0
ds_read_b64_tr_b16 v[126:127], v231 offset:9216
s_waitcnt lgkmcnt(8)
mf v[0:3],v[96:99],a[8:11],v[0:3]
ds_read_b64_tr_b16 v[64:65], v224 offset:16384
s_add_u32 s38, s33, 6144
mf v[32:35],v[96:99],a[12:15],v[32:35]
ds_read_b64_tr_b16 v[66:67], v224 offset:17408
mf v[36:39],v[100:103],a[12:15],v[36:39]
ds_read_b64_tr_b16 v[68:69], v225 offset:16384
buffer_load_dwordx4 a[48:51], v206, s[28:31], s38 offen sc1
mf v[4:7],v[100:103],a[8:11],v[4:7]
ds_read_b64_tr_b16 v[70:71], v225 offset:17408
mf v[8:11],v[104:107],a[8:11],v[8:11]
ds_read_b64_tr_b16 v[72:73], v226 offset:16384
mf v[40:43],v[104:107],a[12:15],v[40:43]
ds_read_b64_tr_b16 v[74:75], v226 offset:17408
buffer_load_dwordx4 a[52:55], v222, s[28:31], s38 offen sc1
mf v[44:47],v[108:111],a[12:15],v[44:47]
ds_read_b64_tr_b16 v[76:77], v227 offset:16384
mf v[12:15],v[108:111],a[8:11],v[12:15]
ds_read_b64_tr_b16 v[78:79], v227 offset:17408
s_waitcnt lgkmcnt(8)
mf v[16:19],v[112:115],a[8:11],v[16:19]
ds_read_b64_tr_b16 v[80:81], v228 offset:16384
s_add_u32 s38, s33, 7168
mf v[48:51],v[112:115],a[12:15],v[48:51]
ds_read_b64_tr_b16 v[82:83], v228 offset:17408
mf v[52:55],v[116:119],a[12:15],v[52:55]
ds_read_b64_tr_b16 v[84:85], v229 offset:16384
buffer_load_dwordx4 a[56:59], v206, s[28:31], s38 offen sc1
mf v[20:23],v[116:119],a[8:11],v[20:23]
ds_read_b64_tr_b16 v[86:87], v229 offset:17408
mf v[24:27],v[120:123],a[8:11],v[24:27]
ds_read_b64_tr_b16 v[88:89], v230 offset:16384
mf v[56:59],v[120:123],a[12:15],v[56:59]
ds_read_b64_tr_b16 v[90:91], v230 offset:17408
buffer_load_dwordx4 a[60:63], v222, s[28:31], s38 offen sc1
mf v[60:63],v[124:127],a[12:15],v[60:63]
ds_read_b64_tr_b16 v[92:93], v231 offset:16384
mf v[28:31],v[124:127],a[8:11],v[28:31]
ds_read_b64_tr_b16 v[94:95], v231 offset:17408
s_waitcnt vmcnt(10) lgkmcnt(8)
s_barrier
mf v[0:3],v[64:67],a[16:19],v[0:3]
ds_read_b64_tr_b16 v[96:97], v224 offset:24576
s_add_u32 s38, s33, 8192
mf v[32:35],v[64:67],a[20:23],v[32:35]
ds_read_b64_tr_b16 v[98:99], v224 offset:25600
mf v[36:39],v[68:71],a[20:23],v[36:39]
ds_read_b64_tr_b16 v[100:101], v225 offset:24576
buffer_load_dwordx4 a[64:67], v206, s[28:31], s38 offen sc1
mf v[4:7],v[68:71],a[16:19],v[4:7]
ds_read_b64_tr_b16 v[102:103], v225 offset:25600
mf v[8:11],v[72:75],a[16:19],v[8:11]
ds_read_b64_tr_b16 v[104:105], v226 offset:24576
mf v[40:43],v[72:75],a[20:23],v[40:43]
ds_read_b64_tr_b16 v[106:107], v226 offset:25600
buffer_load_dwordx4 a[68:71], v222, s[28:31], s38 offen sc1
mf v[44:47],v[76:79],a[20:23],v[44:47]
ds_read_b64_tr_b16 v[108:109], v227 offset:24576
mf v[12:15],v[76:79],a[16:19],v[12:15]
ds_read_b64_tr_b16 v[110:111], v227 offset:25600
s_waitcnt lgkmcnt(8)
mf v[16:19],v[80:83],a[16:19],v[16:19]
ds_read_b64_tr_b16 v[112:113], v228 offset:24576
s_add_u32 s38, s33, 9216
mf v[48:51],v[80:83],a[20:23],v[48:51]
ds_read_b64_tr_b16 v[114:115], v228 offset:25600
mf v[52:55],v[84:87],a[20:23],v[52:55]
ds_read_b64_tr_b16 v[116:117], v229 offset:24576
buffer_load_dwordx4 a[72:75], v206, s[28:31], s38 offen sc1
mf v[20:23],v[84:87],a[16:19],v[20:23]
ds_read_b64_tr_b16 v[118:119], v229 offset:25600
mf v[24:27],v[88:91],a[16:19],v[24:27]
ds_read_b64_tr_b16 v[120:121], v230 offset:24576
mf v[56:59],v[88:91],a[20:23],v[56:59]
ds_read_b64_tr_b16 v[122:123], v230 offset:25600
buffer_load_dwordx4 a[76:79], v222, s[28:31], s38 offen sc1
mf v[60:63],v[92:95],a[20:23],v[60:63]
ds_read_b64_tr_b16 v[124:125], v231 offset:24576
mf v[28:31],v[92:95],a[16:19],v[28:31]
ds_read_b64_tr_b16 v[126:127], v231 offset:25600
s_waitcnt lgkmcnt(8)
mf v[0:3],v[96:99],a[24:27],v[0:3]
ds_read_b64_tr_b16 v[64:65], v232 offset:0
s_add_u32 m0, s34, 57344
mf v[32:35],v[96:99],a[28:31],v[32:35]
ds_read_b64_tr_b16 v[66:67], v232 offset:1024
mf v[36:39],v[100:103],a[28:31],v[36:39]
ds_read_b64_tr_b16 v[68:69], v233 offset:0
s_add_u32 s37, s32, 1261568
mf v[4:7],v[100:103],a[24:27],v[4:7]
ds_read_b64_tr_b16 v[70:71], v233 offset:1024
mf v[8:11],v[104:107],a[24:27],v[8:11]
ds_read_b64_tr_b16 v[72:73], v234 offset:0
buffer_load_dwordx4 v240, s[20:23], s37 offen lds
mf v[40:43],v[104:107],a[28:31],v[40:43]
ds_read_b64_tr_b16 v[74:75], v234 offset:1024
mf v[44:47],v[108:111],a[28:31],v[44:47]
ds_read_b64_tr_b16 v[76:77], v235 offset:0
buffer_load_dwordx4 v241, s[20:23], s37 offen offset:1024 lds
mf v[12:15],v[108:111],a[24:27],v[12:15]
ds_read_b64_tr_b16 v[78:79], v235 offset:1024
s_waitcnt lgkmcnt(8)
mf v[16:19],v[112:115],a[24:27],v[16:19]
ds_read_b64_tr_b16 v[80:81], v236 offset:0
mf v[48:51],v[112:115],a[28:31],v[48:51]
ds_read_b64_tr_b16 v[82:83], v236 offset:1024
s_add_u32 s38, s33, 10240
mf v[52:55],v[116:119],a[28:31],v[52:55]
ds_read_b64_tr_b16 v[84:85], v237 offset:0
mf v[20:23],v[116:119],a[24:27],v[20:23]
ds_read_b64_tr_b16 v[86:87], v237 offset:1024
buffer_load_dwordx4 a[80:83], v206, s[28:31], s38 offen sc1
mf v[24:27],v[120:123],a[24:27],v[24:27]
ds_read_b64_tr_b16 v[88:89], v238 offset:0
mf v[56:59],v[120:123],a[28:31],v[56:59]
ds_read_b64_tr_b16 v[90:91], v238 offset:1024
buffer_load_dwordx4 a[84:87], v222, s[28:31], s38 offen sc1
mf v[60:63],v[124:127],a[28:31],v[60:63]
ds_read_b64_tr_b16 v[92:93], v239 offset:0
mf v[28:31],v[124:127],a[24:27],v[28:31]
ds_read_b64_tr_b16 v[94:95], v239 offset:1024
s_waitcnt vmcnt(12) lgkmcnt(8)
s_barrier
mf v[0:3],v[64:67],a[32:35],v[0:3]
ds_read_b64_tr_b16 v[96:97], v232 offset:8192
s_add_u32 m0, s34, 98304
mf v[32:35],v[64:67],a[36:39],v[32:35]
ds_read_b64_tr_b16 v[98:99], v232 offset:9216
mf v[36:39],v[68:71],a[36:39],v[36:39]
ds_read_b64_tr_b16 v[100:101], v233 offset:8192
s_add_u32 s37, s32, 1376256
mf v[4:7],v[68:71],a[32:35],v[4:7]
ds_read_b64_tr_b16 v[102:103], v233 offset:9216
mf v[8:11],v[72:75],a[32:35],v[8:11]
ds_read_b64_tr_b16 v[104:105], v234 offset:8192
buffer_load_dwordx4 v240, s[20:23], s37 offen lds
mf v[40:43],v[72:75],a[36:39],v[40:43]
ds_read_b64_tr_b16 v[106:107], v234 offset:9216
mf v[44:47],v[76:79],a[36:39],v[44:47]
ds_read_b64_tr_b16 v[108:109], v235 offset:8192
buffer_load_dwordx4 v241, s[20:23], s37 offen offset:1024 lds
mf v[12:15],v[76:79],a[32:35],v[12:15]
ds_read_b64_tr_b16 v[110:111], v235 offset:9216
s_waitcnt lgkmcnt(8)
mf v[16:19],v[80:83],a[32:35],v[16:19]
ds_read_b64_tr_b16 v[112:113], v236 offset:8192
mf v[48:51],v[80:83],a[36:39],v[48:51]
ds_read_b64_tr_b16 v[114:115], v236 offset:9216
s_add_u32 s38, s33, 11264
mf v[52:55],v[84:87],a[36:39],v[52:55]
ds_read_b64_tr_b16 v[116:117], v237 offset:8192
mf v[20:23],v[84:87],a[32:35],v[20:23]
ds_read_b64_tr_b16 v[118:119], v237 offset:9216
buffer_load_dwordx4 a[88:91], v206, s[28:31], s38 offen sc1
mf v[24:27],v[88:91],a[32:35],v[24:27]
ds_read_b64_tr_b16 v[120:121], v238 offset:8192
mf v[56:59],v[88:91],a[36:39],v[56:59]
ds_read_b64_tr_b16 v[122:123], v238 offset:9216
buffer_load_dwordx4 a[92:95], v222, s[28:31], s38 offen sc1
mf v[60:63],v[92:95],a[36:39],v[60:63]
ds_read_b64_tr_b16 v[124:125], v239 offset:8192
mf v[28:31],v[92:95],a[32:35],v[28:31]
ds_read_b64_tr_b16 v[126:127], v239 offset:9216
s_waitcnt lgkmcnt(8)
mf v[0:3],v[96:99],a[40:43],v[0:3]
ds_read_b64_tr_b16 v[64:65], v232 offset:16384
s_add_u32 m0, s34, 106496
mf v[32:35],v[96:99],a[44:47],v[32:35]
ds_read_b64_tr_b16 v[66:67], v232 offset:17408
mf v[36:39],v[100:103],a[44:47],v[36:39]
ds_read_b64_tr_b16 v[68:69], v233 offset:16384
s_add_u32 s37, s32, 1490944
mf v[4:7],v[100:103],a[40:43],v[4:7]
ds_read_b64_tr_b16 v[70:71], v233 offset:17408
mf v[8:11],v[104:107],a[40:43],v[8:11]
ds_read_b64_tr_b16 v[72:73], v234 offset:16384
buffer_load_dwordx4 v240, s[20:23], s37 offen lds
mf v[40:43],v[104:107],a[44:47],v[40:43]
ds_read_b64_tr_b16 v[74:75], v234 offset:17408
mf v[44:47],v[108:111],a[44:47],v[44:47]
ds_read_b64_tr_b16 v[76:77], v235 offset:16384
buffer_load_dwordx4 v241, s[20:23], s37 offen offset:1024 lds
mf v[12:15],v[108:111],a[40:43],v[12:15]
ds_read_b64_tr_b16 v[78:79], v235 offset:17408
s_waitcnt lgkmcnt(8)
mf v[16:19],v[112:115],a[40:43],v[16:19]
ds_read_b64_tr_b16 v[80:81], v236 offset:16384
mf v[48:51],v[112:115],a[44:47],v[48:51]
ds_read_b64_tr_b16 v[82:83], v236 offset:17408
s_add_u32 s38, s33, 12288
mf v[52:55],v[116:119],a[44:47],v[52:55]
ds_read_b64_tr_b16 v[84:85], v237 offset:16384
mf v[20:23],v[116:119],a[40:43],v[20:23]
ds_read_b64_tr_b16 v[86:87], v237 offset:17408
buffer_load_dwordx4 a[96:99], v206, s[28:31], s38 offen sc1
mf v[24:27],v[120:123],a[40:43],v[24:27]
ds_read_b64_tr_b16 v[88:89], v238 offset:16384
mf v[56:59],v[120:123],a[44:47],v[56:59]
ds_read_b64_tr_b16 v[90:91], v238 offset:17408
buffer_load_dwordx4 a[100:103], v222, s[28:31], s38 offen sc1
mf v[60:63],v[124:127],a[44:47],v[60:63]
ds_read_b64_tr_b16 v[92:93], v239 offset:16384
mf v[28:31],v[124:127],a[40:43],v[28:31]
ds_read_b64_tr_b16 v[94:95], v239 offset:17408
s_waitcnt vmcnt(16) lgkmcnt(8)
s_barrier
mf v[0:3],v[64:67],a[48:51],v[0:3]
ds_read_b64_tr_b16 v[96:97], v232 offset:24576
s_add_u32 m0, s34, 114688
mf v[32:35],v[64:67],a[52:55],v[32:35]
ds_read_b64_tr_b16 v[98:99], v232 offset:25600
mf v[36:39],v[68:71],a[52:55],v[36:39]
ds_read_b64_tr_b16 v[100:101], v233 offset:24576
s_add_u32 s37, s32, 256
mf v[4:7],v[68:71],a[48:51],v[4:7]
ds_read_b64_tr_b16 v[102:103], v233 offset:25600
mf v[8:11],v[72:75],a[48:51],v[8:11]
ds_read_b64_tr_b16 v[104:105], v234 offset:24576
buffer_load_dwordx4 v240, s[20:23], s37 offen lds
mf v[40:43],v[72:75],a[52:55],v[40:43]
ds_read_b64_tr_b16 v[106:107], v234 offset:25600
mf v[44:47],v[76:79],a[52:55],v[44:47]
ds_read_b64_tr_b16 v[108:109], v235 offset:24576
buffer_load_dwordx4 v241, s[20:23], s37 offen offset:1024 lds
mf v[12:15],v[76:79],a[48:51],v[12:15]
ds_read_b64_tr_b16 v[110:111], v235 offset:25600
s_waitcnt lgkmcnt(8)
mf v[16:19],v[80:83],a[48:51],v[16:19]
ds_read_b64_tr_b16 v[112:113], v236 offset:24576
mf v[48:51],v[80:83],a[52:55],v[48:51]
ds_read_b64_tr_b16 v[114:115], v236 offset:25600
s_add_u32 s38, s33, 13312
mf v[52:55],v[84:87],a[52:55],v[52:55]
ds_read_b64_tr_b16 v[116:117], v237 offset:24576
mf v[20:23],v[84:87],a[48:51],v[20:23]
ds_read_b64_tr_b16 v[118:119], v237 offset:25600
buffer_load_dwordx4 a[104:107], v206, s[28:31], s38 offen sc1
mf v[24:27],v[88:91],a[48:51],v[24:27]
ds_read_b64_tr_b16 v[120:121], v238 offset:24576
mf v[56:59],v[88:91],a[52:55],v[56:59]
ds_read_b64_tr_b16 v[122:123], v238 offset:25600
buffer_load_dwordx4 a[108:111], v222, s[28:31], s38 offen sc1
mf v[60:63],v[92:95],a[52:55],v[60:63]
ds_read_b64_tr_b16 v[124:125], v239 offset:24576
mf v[28:31],v[92:95],a[48:51],v[28:31]
ds_read_b64_tr_b16 v[126:127], v239 offset:25600
s_waitcnt lgkmcnt(8)
mf v[0:3],v[96:99],a[56:59],v[0:3]
ds_read_b64_tr_b16 v[64:65], v224 offset:32768
s_add_u32 m0, s34, 122880
mf v[32:35],v[96:99],a[60:63],v[32:35]
ds_read_b64_tr_b16 v[66:67], v224 offset:33792
mf v[36:39],v[100:103],a[60:63],v[36:39]
ds_read_b64_tr_b16 v[68:69], v225 offset:32768
s_add_u32 s37, s32, 114944
mf v[4:7],v[100:103],a[56:59],v[4:7]
ds_read_b64_tr_b16 v[70:71], v225 offset:33792
mf v[8:11],v[104:107],a[56:59],v[8:11]
ds_read_b64_tr_b16 v[72:73], v226 offset:32768
buffer_load_dwordx4 v240, s[20:23], s37 offen lds
mf v[40:43],v[104:107],a[60:63],v[40:43]
ds_read_b64_tr_b16 v[74:75], v226 offset:33792
mf v[44:47],v[108:111],a[60:63],v[44:47]
ds_read_b64_tr_b16 v[76:77], v227 offset:32768
buffer_load_dwordx4 v241, s[20:23], s37 offen offset:1024 lds
mf v[12:15],v[108:111],a[56:59],v[12:15]
ds_read_b64_tr_b16 v[78:79], v227 offset:33792
s_waitcnt lgkmcnt(8)
mf v[16:19],v[112:115],a[56:59],v[16:19]
ds_read_b64_tr_b16 v[80:81], v228 offset:32768
s_add_u32 m0, s34, 0
mf v[48:51],v[112:115],a[60:63],v[48:51]
ds_read_b64_tr_b16 v[82:83], v228 offset:33792
mf v[52:55],v[116:119],a[60:63],v[52:55]
ds_read_b64_tr_b16 v[84:85], v229 offset:32768
s_add_u32 s37, s32, 229632
mf v[20:23],v[116:119],a[56:59],v[20:23]
ds_read_b64_tr_b16 v[86:87], v229 offset:33792
mf v[24:27],v[120:123],a[56:59],v[24:27]
ds_read_b64_tr_b16 v[88:89], v230 offset:32768
buffer_load_dwordx4 v240, s[20:23], s37 offen lds
mf v[56:59],v[120:123],a[60:63],v[56:59]
ds_read_b64_tr_b16 v[90:91], v230 offset:33792
mf v[60:63],v[124:127],a[60:63],v[60:63]
ds_read_b64_tr_b16 v[92:93], v231 offset:32768
buffer_load_dwordx4 v241, s[20:23], s37 offen offset:1024 lds
mf v[28:31],v[124:127],a[56:59],v[28:31]
ds_read_b64_tr_b16 v[94:95], v231 offset:33792
s_waitcnt vmcnt(20) lgkmcnt(8)
s_barrier
mf v[0:3],v[64:67],a[64:67],v[0:3]
ds_read_b64_tr_b16 v[96:97], v224 offset:40960
s_add_u32 m0, s34, 8192
mf v[32:35],v[64:67],a[68:71],v[32:35]
ds_read_b64_tr_b16 v[98:99], v224 offset:41984
mf v[36:39],v[68:71],a[68:71],v[36:39]
ds_read_b64_tr_b16 v[100:101], v225 offset:40960
s_add_u32 s37, s32, 344320
mf v[4:7],v[68:71],a[64:67],v[4:7]
ds_read_b64_tr_b16 v[102:103], v225 offset:41984
mf v[8:11],v[72:75],a[64:67],v[8:11]
ds_read_b64_tr_b16 v[104:105], v226 offset:40960
buffer_load_dwordx4 v240, s[20:23], s37 offen lds
mf v[40:43],v[72:75],a[68:71],v[40:43]
ds_read_b64_tr_b16 v[106:107], v226 offset:41984
mf v[44:47],v[76:79],a[68:71],v[44:47]
ds_read_b64_tr_b16 v[108:109], v227 offset:40960
buffer_load_dwordx4 v241, s[20:23], s37 offen offset:1024 lds
mf v[12:15],v[76:79],a[64:67],v[12:15]
ds_read_b64_tr_b16 v[110:111], v227 offset:41984
s_waitcnt lgkmcnt(8)
mf v[16:19],v[80:83],a[64:67],v[16:19]
ds_read_b64_tr_b16 v[112:113], v228 offset:40960
s_add_u32 m0, s34, 16384
mf v[48:51],v[80:83],a[68:71],v[48:51]
ds_read_b64_tr_b16 v[114:115], v228 offset:41984
mf v[52:55],v[84:87],a[68:71],v[52:55]
ds_read_b64_tr_b16 v[116:117], v229 offset:40960
s_add_u32 s37, s32, 459008
mf v[20:23],v[84:87],a[64:67],v[20:23]
ds_read_b64_tr_b16 v[118:119], v229 offset:41984
mf v[24:27],v[88:91],a[64:67],v[24:27]
ds_read_b64_tr_b16 v[120:121], v230 offset:40960
buffer_load_dwordx4 v240, s[20:23], s37 offen lds
mf v[56:59],v[88:91],a[68:71],v[56:59]
ds_read_b64_tr_b16 v[122:123], v230 offset:41984
mf v[60:63],v[92:95],a[68:71],v[60:63]
ds_read_b64_tr_b16 v[124:125], v231 offset:40960
buffer_load_dwordx4 v241, s[20:23], s37 offen offset:1024 lds
mf v[28:31],v[92:95],a[64:67],v[28:31]
ds_read_b64_tr_b16 v[126:127], v231 offset:41984
s_waitcnt lgkmcnt(8)
mf v[0:3],v[96:99],a[72:75],v[0:3]
ds_read_b64_tr_b16 v[64:65], v224 offset:49152
s_add_u32 m0, s34, 24576
mf v[32:35],v[96:99],a[76:79],v[32:35]
ds_read_b64_tr_b16 v[66:67], v224 offset:50176
mf v[36:39],v[100:103],a[76:79],v[36:39]
ds_read_b64_tr_b16 v[68:69], v225 offset:49152
s_add_u32 s37, s32, 573696
mf v[4:7],v[100:103],a[72:75],v[4:7]
ds_read_b64_tr_b16 v[70:71], v225 offset:50176
mf v[8:11],v[104:107],a[72:75],v[8:11]
ds_read_b64_tr_b16 v[72:73], v226 offset:49152
buffer_load_dwordx4 v240, s[20:23], s37 offen lds
mf v[40:43],v[104:107],a[76:79],v[40:43]
ds_read_b64_tr_b16 v[74:75], v226 offset:50176
mf v[44:47],v[108:111],a[76:79],v[44:47]
ds_read_b64_tr_b16 v[76:77], v227 offset:49152
buffer_load_dwordx4 v241, s[20:23], s37 offen offset:1024 lds
mf v[12:15],v[108:111],a[72:75],v[12:15]
ds_read_b64_tr_b16 v[78:79], v227 offset:50176
s_waitcnt lgkmcnt(8)
mf v[16:19],v[112:115],a[72:75],v[16:19]
ds_read_b64_tr_b16 v[80:81], v228 offset:49152
s_add_u32 m0, s34, 65536
mf v[48:51],v[112:115],a[76:79],v[48:51]
ds_read_b64_tr_b16 v[82:83], v228 offset:50176
mf v[52:55],v[116:119],a[76:79],v[52:55]
ds_read_b64_tr_b16 v[84:85], v229 offset:49152
s_add_u32 s37, s32, 688384
mf v[20:23],v[116:119],a[72:75],v[20:23]
ds_read_b64_tr_b16 v[86:87], v229 offset:50176
mf v[24:27],v[120:123],a[72:75],v[24:27]
ds_read_b64_tr_b16 v[88:89], v230 offset:49152
buffer_load_dwordx4 v240, s[20:23], s37 offen lds
mf v[56:59],v[120:123],a[76:79],v[56:59]
ds_read_b64_tr_b16 v[90:91], v230 offset:50176
mf v[60:63],v[124:127],a[76:79],v[60:63]
ds_read_b64_tr_b16 v[92:93], v231 offset:49152
buffer_load_dwordx4 v241, s[20:23], s37 offen offset:1024 lds
mf v[28:31],v[124:127],a[72:75],v[28:31]
ds_read_b64_tr_b16 v[94:95], v231 offset:50176
s_waitcnt vmcnt(20) lgkmcnt(8)
s_barrier
mf v[0:3],v[64:67],a[80:83],v[0:3]
ds_read_b64_tr_b16 v[96:97], v224 offset:57344
s_add_u32 m0, s34, 73728
mf v[32:35],v[64:67],a[84:87],v[32:35]
ds_read_b64_tr_b16 v[98:99], v224 offset:58368
mf v[36:39],v[68:71],a[84:87],v[36:39]
ds_read_b64_tr_b16 v[100:101], v225 offset:57344
s_add_u32 s37, s32, 803072
mf v[4:7],v[68:71],a[80:83],v[4:7]
ds_read_b64_tr_b16 v[102:103], v225 offset:58368
mf v[8:11],v[72:75],a[80:83],v[8:11]
ds_read_b64_tr_b16 v[104:105], v226 offset:57344
buffer_load_dwordx4 v240, s[20:23], s37 offen lds
mf v[40:43],v[72:75],a[84:87],v[40:43]
ds_read_b64_tr_b16 v[106:107], v226 offset:58368
mf v[44:47],v[76:79],a[84:87],v[44:47]
ds_read_b64_tr_b16 v[108:109], v227 offset:57344
buffer_load_dwordx4 v241, s[20:23], s37 offen offset:1024 lds
mf v[12:15],v[76:79],a[80:83],v[12:15]
ds_read_b64_tr_b16 v[110:111], v227 offset:58368
s_waitcnt lgkmcnt(8)
mf v[16:19],v[80:83],a[80:83],v[16:19]
ds_read_b64_tr_b16 v[112:113], v228 offset:57344
s_add_u32 m0, s34, 81920
mf v[48:51],v[80:83],a[84:87],v[48:51]
ds_read_b64_tr_b16 v[114:115], v228 offset:58368
mf v[52:55],v[84:87],a[84:87],v[52:55]
ds_read_b64_tr_b16 v[116:117], v229 offset:57344
s_add_u32 s37, s32, 917760
mf v[20:23],v[84:87],a[80:83],v[20:23]
ds_read_b64_tr_b16 v[118:119], v229 offset:58368
mf v[24:27],v[88:91],a[80:83],v[24:27]
ds_read_b64_tr_b16 v[120:121], v230 offset:57344
buffer_load_dwordx4 v240, s[20:23], s37 offen lds
mf v[56:59],v[88:91],a[84:87],v[56:59]
ds_read_b64_tr_b16 v[122:123], v230 offset:58368
mf v[60:63],v[92:95],a[84:87],v[60:63]
ds_read_b64_tr_b16 v[124:125], v231 offset:57344
buffer_load_dwordx4 v241, s[20:23], s37 offen offset:1024 lds
mf v[28:31],v[92:95],a[80:83],v[28:31]
ds_read_b64_tr_b16 v[126:127], v231 offset:58368
s_waitcnt lgkmcnt(8)
mf v[0:3],v[96:99],a[88:91],v[0:3]
ds_read_b64_tr_b16 v[64:65], v232 offset:32768
s_add_u32 m0, s34, 90112
mf v[32:35],v[96:99],a[92:95],v[32:35]
ds_read_b64_tr_b16 v[66:67], v232 offset:33792
s_add_u32 s37, s32, 1032448
mf v[36:39],v[100:103],a[92:95],v[36:39]
ds_read_b64_tr_b16 v[68:69], v233 offset:32768
mf v[4:7],v[100:103],a[88:91],v[4:7]
ds_read_b64_tr_b16 v[70:71], v233 offset:33792
buffer_load_dwordx4 v240, s[20:23], s37 offen lds
mf v[8:11],v[104:107],a[88:91],v[8:11]
ds_read_b64_tr_b16 v[72:73], v234 offset:32768
mf v[40:43],v[104:107],a[92:95],v[40:43]
ds_read_b64_tr_b16 v[74:75], v234 offset:33792
buffer_load_dwordx4 v241, s[20:23], s37 offen offset:1024 lds
mf v[44:47],v[108:111],a[92:95],v[44:47]
ds_read_b64_tr_b16 v[76:77], v235 offset:32768
mf v[12:15],v[108:111],a[88:91],v[12:15]
ds_read_b64_tr_b16 v[78:79], v235 offset:33792
s_waitcnt lgkmcnt(8)
mf v[16:19],v[112:115],a[88:91],v[16:19]
ds_read_b64_tr_b16 v[80:81], v236 offset:32768
s_add_u32 m0, s34, 32768
mf v[48:51],v[112:115],a[92:95],v[48:51]
ds_read_b64_tr_b16 v[82:83], v236 offset:33792
s_add_u32 s37, s32, 1147136
mf v[52:55],v[116:119],a[92:95],v[52:55]
ds_read_b64_tr_b16 v[84:85], v237 offset:32768
buffer_load_dwordx4 v240, s[20:23], s37 offen lds
mf v[20:23],v[116:119],a[88:91],v[20:23]
ds_read_b64_tr_b16 v[86:87], v237 offset:33792
mf v[24:27],v[120:123],a[88:91],v[24:27]
ds_read_b64_tr_b16 v[88:89], v238 offset:32768
buffer_load_dwordx4 v241, s[20:23], s37 offen offset:1024 lds
mf v[56:59],v[120:123],a[92:95],v[56:59]
ds_read_b64_tr_b16 v[90:91], v238 offset:33792
mf v[60:63],v[124:127],a[92:95],v[60:63]
ds_read_b64_tr_b16 v[92:93], v239 offset:32768
buffer_load_dword v254, v252, s[28:31], 0 offen sc1
mf v[28:31],v[124:127],a[88:91],v[28:31]
ds_read_b64_tr_b16 v[94:95], v239 offset:33792
s_waitcnt vmcnt(21) lgkmcnt(8)
s_barrier
mf v[0:3],v[64:67],a[96:99],v[0:3]
ds_read_b64_tr_b16 v[96:97], v232 offset:40960
s_add_u32 m0, s34, 40960
mf v[32:35],v[64:67],a[100:103],v[32:35]
ds_read_b64_tr_b16 v[98:99], v232 offset:41984
mf v[36:39],v[68:71],a[100:103],v[36:39]
ds_read_b64_tr_b16 v[100:101], v233 offset:40960
s_add_u32 s37, s32, 1261824
mf v[4:7],v[68:71],a[96:99],v[4:7]
ds_read_b64_tr_b16 v[102:103], v233 offset:41984
mf v[8:11],v[72:75],a[96:99],v[8:11]
ds_read_b64_tr_b16 v[104:105], v234 offset:40960
buffer_load_dwordx4 v240, s[20:23], s37 offen lds
mf v[40:43],v[72:75],a[100:103],v[40:43]
ds_read_b64_tr_b16 v[106:107], v234 offset:41984
mf v[44:47],v[76:79],a[100:103],v[44:47]
ds_read_b64_tr_b16 v[108:109], v235 offset:40960
buffer_load_dwordx4 v241, s[20:23], s37 offen offset:1024 lds
mf v[12:15],v[76:79],a[96:99],v[12:15]
ds_read_b64_tr_b16 v[110:111], v235 offset:41984
s_waitcnt lgkmcnt(8)
mf v[16:19],v[80:83],a[96:99],v[16:19]
ds_read_b64_tr_b16 v[112:113], v236 offset:40960
s_add_u32 m0, s34, 49152
mf v[48:51],v[80:83],a[100:103],v[48:51]
ds_read_b64_tr_b16 v[114:115], v236 offset:41984
mf v[52:55],v[84:87],a[100:103],v[52:55]
ds_read_b64_tr_b16 v[116:117], v237 offset:40960
s_add_u32 s37, s32, 1376512
mf v[20:23],v[84:87],a[96:99],v[20:23]
ds_read_b64_tr_b16 v[118:119], v237 offset:41984
mf v[24:27],v[88:91],a[96:99],v[24:27]
ds_read_b64_tr_b16 v[120:121], v238 offset:40960
buffer_load_dwordx4 v240, s[20:23], s37 offen lds
mf v[56:59],v[88:91],a[100:103],v[56:59]
ds_read_b64_tr_b16 v[122:123], v238 offset:41984
mf v[60:63],v[92:95],a[100:103],v[60:63]
ds_read_b64_tr_b16 v[124:125], v239 offset:40960
buffer_load_dwordx4 v241, s[20:23], s37 offen offset:1024 lds
mf v[28:31],v[92:95],a[96:99],v[28:31]
ds_read_b64_tr_b16 v[126:127], v239 offset:41984
s_waitcnt lgkmcnt(8)
mf v[0:3],v[96:99],a[104:107],v[0:3]
s_add_u32 m0, s34, 57344
mf v[32:35],v[96:99],a[108:111],v[32:35]
mf v[36:39],v[100:103],a[108:111],v[36:39]
mf v[4:7],v[100:103],a[104:107],v[4:7]
mf v[8:11],v[104:107],a[104:107],v[8:11]
s_add_u32 s37, s32, 1491200
mf v[40:43],v[104:107],a[108:111],v[40:43]
mf v[44:47],v[108:111],a[108:111],v[44:47]
mf v[12:15],v[108:111],a[104:107],v[12:15]
s_waitcnt lgkmcnt(0)
mf v[16:19],v[112:115],a[104:107],v[16:19]
buffer_load_dwordx4 v240, s[20:23], s37 offen lds
mf v[48:51],v[112:115],a[108:111],v[48:51]
mf v[52:55],v[116:119],a[108:111],v[52:55]
mf v[20:23],v[116:119],a[104:107],v[20:23]
mf v[24:27],v[120:123],a[104:107],v[24:27]
buffer_load_dwordx4 v241, s[20:23], s37 offen offset:1024 lds
mf v[56:59],v[120:123],a[108:111],v[56:59]
mf v[60:63],v[124:127],a[108:111],v[60:63]
mf v[28:31],v[124:127],a[104:107],v[28:31]
s_mov_b32 s64, 0xc0135761
s_mov_b32 s65, s64
v_mov_b32 v242, 0xbdd2d3e8
v_mov_b32 v244, 1.0
v_sub_f32 v246, 1.0, v250
v_sub_f32 v248, 1.0, v251
v_pk_mul_f32 v[128:129], v[0:1], v[0:1]
v_pk_mul_f32 v[130:131], v[2:3], v[2:3]
v_pk_mul_f32 v[132:133], v[4:5], v[4:5]
v_pk_mul_f32 v[134:135], v[6:7], v[6:7]
v_pk_mul_f32 v[136:137], v[8:9], v[8:9]
v_pk_mul_f32 v[138:139], v[10:11], v[10:11]
v_pk_mul_f32 v[140:141], v[12:13], v[12:13]
v_pk_mul_f32 v[142:143], v[14:15], v[14:15]
v_pk_fma_f32 v[128:129], v[128:129], v[242:243], s[64:65] op_sel_hi:[1,0,1]
v_pk_fma_f32 v[130:131], v[130:131], v[242:243], s[64:65] op_sel_hi:[1,0,1]
v_pk_fma_f32 v[132:133], v[132:133], v[242:243], s[64:65] op_sel_hi:[1,0,1]
v_pk_fma_f32 v[134:135], v[134:135], v[242:243], s[64:65] op_sel_hi:[1,0,1]
v_pk_fma_f32 v[136:137], v[136:137], v[242:243], s[64:65] op_sel_hi:[1,0,1]
v_pk_fma_f32 v[138:139], v[138:139], v[242:243], s[64:65] op_sel_hi:[1,0,1]
v_pk_fma_f32 v[140:141], v[140:141], v[242:243], s[64:65] op_sel_hi:[1,0,1]
v_pk_fma_f32 v[142:143], v[142:143], v[242:243], s[64:65] op_sel_hi:[1,0,1]
v_pk_mul_f32 v[128:129], v[128:129], v[0:1]
v_pk_mul_f32 v[130:131], v[130:131], v[2:3]
v_pk_mul_f32 v[132:133], v[132:133], v[4:5]
v_pk_mul_f32 v[134:135], v[134:135], v[6:7]
v_pk_mul_f32 v[136:137], v[136:137], v[8:9]
ds_read_b64_tr_b16 v[64:65], v232 offset:49152
v_pk_mul_f32 v[138:139], v[138:139], v[10:11]
v_pk_mul_f32 v[140:141], v[140:141], v[12:13]
v_pk_mul_f32 v[142:143], v[142:143], v[14:15]
v_exp_f32 v128, v128
v_exp_f32 v129, v129
v_exp_f32 v130, v130
v_exp_f32 v131, v131
v_exp_f32 v132, v132
v_exp_f32 v133, v133
v_exp_f32 v134, v134
v_exp_f32 v135, v135
v_exp_f32 v136, v136
v_exp_f32 v137, v137
v_exp_f32 v138, v138
v_exp_f32 v139, v139
v_exp_f32 v140, v140
v_exp_f32 v141, v141
v_exp_f32 v142, v142
v_exp_f32 v143, v143
v_pk_mul_f32 v[0:1], v[0:1], v[246:247] op_sel_hi:[1,0]
v_pk_mul_f32 v[2:3], v[2:3], v[246:247] op_sel_hi:[1,0]
ds_read_b64_tr_b16 v[66:67], v232 offset:50176
v_pk_mul_f32 v[4:5], v[4:5], v[246:247] op_sel_hi:[1,0]
v_pk_mul_f32 v[6:7], v[6:7], v[246:247] op_sel_hi:[1,0]
v_pk_mul_f32 v[8:9], v[8:9], v[246:247] op_sel_hi:[1,0]
v_pk_mul_f32 v[10:11], v[10:11], v[246:247] op_sel_hi:[1,0]
v_pk_mul_f32 v[12:13], v[12:13], v[246:247] op_sel_hi:[1,0]
v_pk_mul_f32 v[14:15], v[14:15], v[246:247] op_sel_hi:[1,0]
v_pk_add_f32 v[128:129], v[128:129], v[244:245] op_sel_hi:[1,0]
v_pk_add_f32 v[130:131], v[130:131], v[244:245] op_sel_hi:[1,0]
v_pk_add_f32 v[132:133], v[132:133], v[244:245] op_sel_hi:[1,0]
v_pk_add_f32 v[134:135], v[134:135], v[244:245] op_sel_hi:[1,0]
v_pk_add_f32 v[136:137], v[136:137], v[244:245] op_sel_hi:[1,0]
v_pk_add_f32 v[138:139], v[138:139], v[244:245] op_sel_hi:[1,0]
v_pk_add_f32 v[140:141], v[140:141], v[244:245] op_sel_hi:[1,0]
v_pk_add_f32 v[142:143], v[142:143], v[244:245] op_sel_hi:[1,0]
v_rcp_f32 v128, v128
v_rcp_f32 v129, v129
v_rcp_f32 v130, v130
v_rcp_f32 v131, v131
v_rcp_f32 v132, v132
v_rcp_f32 v133, v133
v_rcp_f32 v134, v134
ds_read_b64_tr_b16 v[68:69], v233 offset:49152
v_rcp_f32 v135, v135
v_rcp_f32 v136, v136
v_rcp_f32 v137, v137
v_rcp_f32 v138, v138
v_rcp_f32 v139, v139
v_rcp_f32 v140, v140
v_rcp_f32 v141, v141
v_rcp_f32 v142, v142
v_rcp_f32 v143, v143
s_nop 0
v_pk_mul_f32 v[0:1], v[0:1], v[128:129]
v_pk_mul_f32 v[2:3], v[2:3], v[130:131]
v_pk_mul_f32 v[4:5], v[4:5], v[132:133]
v_pk_mul_f32 v[6:7], v[6:7], v[134:135]
v_pk_mul_f32 v[8:9], v[8:9], v[136:137]
v_pk_mul_f32 v[10:11], v[10:11], v[138:139]
v_pk_mul_f32 v[12:13], v[12:13], v[140:141]
v_pk_mul_f32 v[14:15], v[14:15], v[142:143]
v_cvt_pk_bf16_f32 v144, v0, v1
v_cvt_pk_bf16_f32 v145, v2, v3
v_cvt_pk_bf16_f32 v146, v4, v5
ds_read_b64_tr_b16 v[70:71], v233 offset:50176
v_cvt_pk_bf16_f32 v147, v6, v7
v_cvt_pk_bf16_f32 v148, v8, v9
v_cvt_pk_bf16_f32 v149, v10, v11
v_cvt_pk_bf16_f32 v150, v12, v13
v_cvt_pk_bf16_f32 v151, v14, v15
v_pk_mul_f32 v[128:129], v[16:17], v[16:17]
v_pk_mul_f32 v[130:131], v[18:19], v[18:19]
v_pk_mul_f32 v[132:133], v[20:21], v[20:21]
v_pk_mul_f32 v[134:135], v[22:23], v[22:23]
v_pk_mul_f32 v[136:137], v[24:25], v[24:25]
v_pk_mul_f32 v[138:139], v[26:27], v[26:27]
v_pk_mul_f32 v[140:141], v[28:29], v[28:29]
v_pk_mul_f32 v[142:143], v[30:31], v[30:31]
v_pk_fma_f32 v[128:129], v[128:129], v[242:243], s[64:65] op_sel_hi:[1,0,1]
v_pk_fma_f32 v[130:131], v[130:131], v[242:243], s[64:65] op_sel_hi:[1,0,1]
v_pk_fma_f32 v[132:133], v[132:133], v[242:243], s[64:65] op_sel_hi:[1,0,1]
v_pk_fma_f32 v[134:135], v[134:135], v[242:243], s[64:65] op_sel_hi:[1,0,1]
v_pk_fma_f32 v[136:137], v[136:137], v[242:243], s[64:65] op_sel_hi:[1,0,1]
v_pk_fma_f32 v[138:139], v[138:139], v[242:243], s[64:65] op_sel_hi:[1,0,1]
v_pk_fma_f32 v[140:141], v[140:141], v[242:243], s[64:65] op_sel_hi:[1,0,1]
v_pk_fma_f32 v[142:143], v[142:143], v[242:243], s[64:65] op_sel_hi:[1,0,1]
ds_read_b64_tr_b16 v[72:73], v234 offset:49152
v_pk_mul_f32 v[128:129], v[128:129], v[16:17]
v_pk_mul_f32 v[130:131], v[130:131], v[18:19]
v_pk_mul_f32 v[132:133], v[132:133], v[20:21]
v_pk_mul_f32 v[134:135], v[134:135], v[22:23]
v_pk_mul_f32 v[136:137], v[136:137], v[24:25]
v_pk_mul_f32 v[138:139], v[138:139], v[26:27]
v_pk_mul_f32 v[140:141], v[140:141], v[28:29]
v_pk_mul_f32 v[142:143], v[142:143], v[30:31]
v_exp_f32 v128, v128
v_exp_f32 v129, v129
v_exp_f32 v130, v130
v_exp_f32 v131, v131
v_exp_f32 v132, v132
v_exp_f32 v133, v133
v_exp_f32 v134, v134
v_exp_f32 v135, v135
v_exp_f32 v136, v136
v_exp_f32 v137, v137
v_exp_f32 v138, v138
v_exp_f32 v139, v139
v_exp_f32 v140, v140
ds_read_b64_tr_b16 v[74:75], v234 offset:50176
v_exp_f32 v141, v141
v_exp_f32 v142, v142
v_exp_f32 v143, v143
v_pk_mul_f32 v[16:17], v[16:17], v[246:247] op_sel_hi:[1,0]
v_pk_mul_f32 v[18:19], v[18:19], v[246:247] op_sel_hi:[1,0]
v_pk_mul_f32 v[20:21], v[20:21], v[246:247] op_sel_hi:[1,0]
v_pk_mul_f32 v[22:23], v[22:23], v[246:247] op_sel_hi:[1,0]
v_pk_mul_f32 v[24:25], v[24:25], v[246:247] op_sel_hi:[1,0]
v_pk_mul_f32 v[26:27], v[26:27], v[246:247] op_sel_hi:[1,0]
v_pk_mul_f32 v[28:29], v[28:29], v[246:247] op_sel_hi:[1,0]
v_pk_mul_f32 v[30:31], v[30:31], v[246:247] op_sel_hi:[1,0]
v_pk_add_f32 v[128:129], v[128:129], v[244:245] op_sel_hi:[1,0]
v_pk_add_f32 v[130:131], v[130:131], v[244:245] op_sel_hi:[1,0]
v_pk_add_f32 v[132:133], v[132:133], v[244:245] op_sel_hi:[1,0]
v_pk_add_f32 v[134:135], v[134:135], v[244:245] op_sel_hi:[1,0]
v_pk_add_f32 v[136:137], v[136:137], v[244:245] op_sel_hi:[1,0]
v_pk_add_f32 v[138:139], v[138:139], v[244:245] op_sel_hi:[1,0]
v_pk_add_f32 v[140:141], v[140:141], v[244:245] op_sel_hi:[1,0]
v_pk_add_f32 v[142:143], v[142:143], v[244:245] op_sel_hi:[1,0]
v_rcp_f32 v128, v128
v_rcp_f32 v129, v129
ds_read_b64_tr_b16 v[76:77], v235 offset:49152
v_rcp_f32 v130, v130
v_rcp_f32 v131, v131
v_rcp_f32 v132, v132
v_rcp_f32 v133, v133
v_rcp_f32 v134, v134
v_rcp_f32 v135, v135
v_rcp_f32 v136, v136
v_rcp_f32 v137, v137
v_rcp_f32 v138, v138
v_rcp_f32 v139, v139
v_rcp_f32 v140, v140
v_rcp_f32 v141, v141
v_rcp_f32 v142, v142
v_rcp_f32 v143, v143
s_nop 0
v_pk_mul_f32 v[16:17], v[16:17], v[128:129]
v_pk_mul_f32 v[18:19], v[18:19], v[130:131]
v_pk_mul_f32 v[20:21], v[20:21], v[132:133]
v_pk_mul_f32 v[22:23], v[22:23], v[134:135]
v_pk_mul_f32 v[24:25], v[24:25], v[136:137]
v_pk_mul_f32 v[26:27], v[26:27], v[138:139]
ds_read_b64_tr_b16 v[78:79], v235 offset:50176
v_pk_mul_f32 v[28:29], v[28:29], v[140:141]
v_pk_mul_f32 v[30:31], v[30:31], v[142:143]
v_cvt_pk_bf16_f32 v152, v16, v17
v_cvt_pk_bf16_f32 v153, v18, v19
v_cvt_pk_bf16_f32 v154, v20, v21
v_cvt_pk_bf16_f32 v155, v22, v23
v_cvt_pk_bf16_f32 v156, v24, v25
v_cvt_pk_bf16_f32 v157, v26, v27
v_cvt_pk_bf16_f32 v158, v28, v29
v_cvt_pk_bf16_f32 v159, v30, v31
v_pk_mul_f32 v[128:129], v[32:33], v[32:33]
v_pk_mul_f32 v[130:131], v[34:35], v[34:35]
v_pk_mul_f32 v[132:133], v[36:37], v[36:37]
v_pk_mul_f32 v[134:135], v[38:39], v[38:39]
v_pk_mul_f32 v[136:137], v[40:41], v[40:41]
v_pk_mul_f32 v[138:139], v[42:43], v[42:43]
v_pk_mul_f32 v[140:141], v[44:45], v[44:45]
v_pk_mul_f32 v[142:143], v[46:47], v[46:47]
v_pk_fma_f32 v[128:129], v[128:129], v[242:243], s[64:65] op_sel_hi:[1,0,1]
v_pk_fma_f32 v[130:131], v[130:131], v[242:243], s[64:65] op_sel_hi:[1,0,1]
v_pk_fma_f32 v[132:133], v[132:133], v[242:243], s[64:65] op_sel_hi:[1,0,1]
ds_read_b64_tr_b16 v[80:81], v236 offset:49152
v_pk_fma_f32 v[134:135], v[134:135], v[242:243], s[64:65] op_sel_hi:[1,0,1]
v_pk_fma_f32 v[136:137], v[136:137], v[242:243], s[64:65] op_sel_hi:[1,0,1]
v_pk_fma_f32 v[138:139], v[138:139], v[242:243], s[64:65] op_sel_hi:[1,0,1]
v_pk_fma_f32 v[140:141], v[140:141], v[242:243], s[64:65] op_sel_hi:[1,0,1]
v_pk_fma_f32 v[142:143], v[142:143], v[242:243], s[64:65] op_sel_hi:[1,0,1]
v_pk_mul_f32 v[128:129], v[128:129], v[32:33]
v_pk_mul_f32 v[130:131], v[130:131], v[34:35]
v_pk_mul_f32 v[132:133], v[132:133], v[36:37]
v_pk_mul_f32 v[134:135], v[134:135], v[38:39]
v_pk_mul_f32 v[136:137], v[136:137], v[40:41]
v_pk_mul_f32 v[138:139], v[138:139], v[42:43]
v_pk_mul_f32 v[140:141], v[140:141], v[44:45]
v_pk_mul_f32 v[142:143], v[142:143], v[46:47]
v_exp_f32 v128, v128
v_exp_f32 v129, v129
v_exp_f32 v130, v130
v_exp_f32 v131, v131
v_exp_f32 v132, v132
v_exp_f32 v133, v133
v_exp_f32 v134, v134
v_exp_f32 v135, v135
ds_read_b64_tr_b16 v[82:83], v236 offset:50176
v_exp_f32 v136, v136
v_exp_f32 v137, v137
v_exp_f32 v138, v138
v_exp_f32 v139, v139
v_exp_f32 v140, v140
v_exp_f32 v141, v141
v_exp_f32 v142, v142
v_exp_f32 v143, v143
v_pk_mul_f32 v[32:33], v[32:33], v[248:249] op_sel_hi:[1,0]
v_pk_mul_f32 v[34:35], v[34:35], v[248:249] op_sel_hi:[1,0]
v_pk_mul_f32 v[36:37], v[36:37], v[248:249] op_sel_hi:[1,0]
v_pk_mul_f32 v[38:39], v[38:39], v[248:249] op_sel_hi:[1,0]
v_pk_mul_f32 v[40:41], v[40:41], v[248:249] op_sel_hi:[1,0]
v_pk_mul_f32 v[42:43], v[42:43], v[248:249] op_sel_hi:[1,0]
v_pk_mul_f32 v[44:45], v[44:45], v[248:249] op_sel_hi:[1,0]
v_pk_mul_f32 v[46:47], v[46:47], v[248:249] op_sel_hi:[1,0]
v_pk_add_f32 v[128:129], v[128:129], v[244:245] op_sel_hi:[1,0]
v_pk_add_f32 v[130:131], v[130:131], v[244:245] op_sel_hi:[1,0]
v_pk_add_f32 v[132:133], v[132:133], v[244:245] op_sel_hi:[1,0]
v_pk_add_f32 v[134:135], v[134:135], v[244:245] op_sel_hi:[1,0]
v_pk_add_f32 v[136:137], v[136:137], v[244:245] op_sel_hi:[1,0]
ds_read_b64_tr_b16 v[84:85], v237 offset:49152
v_pk_add_f32 v[138:139], v[138:139], v[244:245] op_sel_hi:[1,0]
v_pk_add_f32 v[140:141], v[140:141], v[244:245] op_sel_hi:[1,0]
v_pk_add_f32 v[142:143], v[142:143], v[244:245] op_sel_hi:[1,0]
v_rcp_f32 v128, v128
v_rcp_f32 v129, v129
v_rcp_f32 v130, v130
v_rcp_f32 v131, v131
v_rcp_f32 v132, v132
v_rcp_f32 v133, v133
v_rcp_f32 v134, v134
v_rcp_f32 v135, v135
v_rcp_f32 v136, v136
v_rcp_f32 v137, v137
v_rcp_f32 v138, v138
v_rcp_f32 v139, v139
v_rcp_f32 v140, v140
v_rcp_f32 v141, v141
v_rcp_f32 v142, v142
v_rcp_f32 v143, v143
s_nop 0
v_pk_mul_f32 v[32:33], v[32:33], v[128:129]
ds_read_b64_tr_b16 v[86:87], v237 offset:50176
v_pk_mul_f32 v[34:35], v[34:35], v[130:131]
v_pk_mul_f32 v[36:37], v[36:37], v[132:133]
v_pk_mul_f32 v[38:39], v[38:39], v[134:135]
v_pk_mul_f32 v[40:41], v[40:41], v[136:137]
v_pk_mul_f32 v[42:43], v[42:43], v[138:139]
v_pk_mul_f32 v[44:45], v[44:45], v[140:141]
v_pk_mul_f32 v[46:47], v[46:47], v[142:143]
v_cvt_pk_bf16_f32 v160, v32, v33
v_cvt_pk_bf16_f32 v161, v34, v35
v_cvt_pk_bf16_f32 v162, v36, v37
v_cvt_pk_bf16_f32 v163, v38, v39
v_cvt_pk_bf16_f32 v164, v40, v41
v_cvt_pk_bf16_f32 v165, v42, v43
v_cvt_pk_bf16_f32 v166, v44, v45
v_cvt_pk_bf16_f32 v167, v46, v47
v_pk_mul_f32 v[128:129], v[48:49], v[48:49]
v_pk_mul_f32 v[130:131], v[50:51], v[50:51]
v_pk_mul_f32 v[132:133], v[52:53], v[52:53]
v_pk_mul_f32 v[134:135], v[54:55], v[54:55]
v_pk_mul_f32 v[136:137], v[56:57], v[56:57]
v_pk_mul_f32 v[138:139], v[58:59], v[58:59]
ds_read_b64_tr_b16 v[88:89], v238 offset:49152
v_pk_mul_f32 v[140:141], v[60:61], v[60:61]
v_pk_mul_f32 v[142:143], v[62:63], v[62:63]
v_pk_fma_f32 v[128:129], v[128:129], v[242:243], s[64:65] op_sel_hi:[1,0,1]
v_pk_fma_f32 v[130:131], v[130:131], v[242:243], s[64:65] op_sel_hi:[1,0,1]
v_pk_fma_f32 v[132:133], v[132:133], v[242:243], s[64:65] op_sel_hi:[1,0,1]
v_pk_fma_f32 v[134:135], v[134:135], v[242:243], s[64:65] op_sel_hi:[1,0,1]
v_pk_fma_f32 v[136:137], v[136:137], v[242:243], s[64:65] op_sel_hi:[1,0,1]
v_pk_fma_f32 v[138:139], v[138:139], v[242:243], s[64:65] op_sel_hi:[1,0,1]
v_pk_fma_f32 v[140:141], v[140:141], v[242:243], s[64:65] op_sel_hi:[1,0,1]
v_pk_fma_f32 v[142:143], v[142:143], v[242:243], s[64:65] op_sel_hi:[1,0,1]
v_pk_mul_f32 v[128:129], v[128:129], v[48:49]
v_pk_mul_f32 v[130:131], v[130:131], v[50:51]
v_pk_mul_f32 v[132:133], v[132:133], v[52:53]
v_pk_mul_f32 v[134:135], v[134:135], v[54:55]
v_pk_mul_f32 v[136:137], v[136:137], v[56:57]
v_pk_mul_f32 v[138:139], v[138:139], v[58:59]
v_pk_mul_f32 v[140:141], v[140:141], v[60:61]
v_pk_mul_f32 v[142:143], v[142:143], v[62:63]
v_exp_f32 v128, v128
v_exp_f32 v129, v129
v_exp_f32 v130, v130
ds_read_b64_tr_b16 v[90:91], v238 offset:50176
v_exp_f32 v131, v131
v_exp_f32 v132, v132
v_exp_f32 v133, v133
v_exp_f32 v134, v134
v_exp_f32 v135, v135
v_exp_f32 v136, v136
v_exp_f32 v137, v137
v_exp_f32 v138, v138
v_exp_f32 v139, v139
v_exp_f32 v140, v140
v_exp_f32 v141, v141
v_exp_f32 v142, v142
v_exp_f32 v143, v143
v_pk_mul_f32 v[48:49], v[48:49], v[248:249] op_sel_hi:[1,0]
v_pk_mul_f32 v[50:51], v[50:51], v[248:249] op_sel_hi:[1,0]
v_pk_mul_f32 v[52:53], v[52:53], v[248:249] op_sel_hi:[1,0]
v_pk_mul_f32 v[54:55], v[54:55], v[248:249] op_sel_hi:[1,0]
v_pk_mul_f32 v[56:57], v[56:57], v[248:249] op_sel_hi:[1,0]
v_pk_mul_f32 v[58:59], v[58:59], v[248:249] op_sel_hi:[1,0]
v_pk_mul_f32 v[60:61], v[60:61], v[248:249] op_sel_hi:[1,0]
v_pk_mul_f32 v[62:63], v[62:63], v[248:249] op_sel_hi:[1,0]
ds_read_b64_tr_b16 v[92:93], v239 offset:49152
v_pk_add_f32 v[128:129], v[128:129], v[244:245] op_sel_hi:[1,0]
v_pk_add_f32 v[130:131], v[130:131], v[244:245] op_sel_hi:[1,0]
v_pk_add_f32 v[132:133], v[132:133], v[244:245] op_sel_hi:[1,0]
v_pk_add_f32 v[134:135], v[134:135], v[244:245] op_sel_hi:[1,0]
v_pk_add_f32 v[136:137], v[136:137], v[244:245] op_sel_hi:[1,0]
v_pk_add_f32 v[138:139], v[138:139], v[244:245] op_sel_hi:[1,0]
v_pk_add_f32 v[140:141], v[140:141], v[244:245] op_sel_hi:[1,0]
v_pk_add_f32 v[142:143], v[142:143], v[244:245] op_sel_hi:[1,0]
v_rcp_f32 v128, v128
v_rcp_f32 v129, v129
v_rcp_f32 v130, v130
v_rcp_f32 v131, v131
v_rcp_f32 v132, v132
v_rcp_f32 v133, v133
v_rcp_f32 v134, v134
v_rcp_f32 v135, v135
v_rcp_f32 v136, v136
v_rcp_f32 v137, v137
v_rcp_f32 v138, v138
v_rcp_f32 v139, v139
v_rcp_f32 v140, v140
ds_read_b64_tr_b16 v[94:95], v239 offset:50176
v_rcp_f32 v141, v141
v_rcp_f32 v142, v142
v_rcp_f32 v143, v143
s_nop 0
v_pk_mul_f32 v[48:49], v[48:49], v[128:129]
v_pk_mul_f32 v[50:51], v[50:51], v[130:131]
v_pk_mul_f32 v[52:53], v[52:53], v[132:133]
v_pk_mul_f32 v[54:55], v[54:55], v[134:135]
v_pk_mul_f32 v[56:57], v[56:57], v[136:137]
v_pk_mul_f32 v[58:59], v[58:59], v[138:139]
v_pk_mul_f32 v[60:61], v[60:61], v[140:141]
v_pk_mul_f32 v[62:63], v[62:63], v[142:143]
v_cvt_pk_bf16_f32 v168, v48, v49
v_cvt_pk_bf16_f32 v169, v50, v51
v_cvt_pk_bf16_f32 v170, v52, v53
v_cvt_pk_bf16_f32 v171, v54, v55
v_cvt_pk_bf16_f32 v172, v56, v57
v_cvt_pk_bf16_f32 v173, v58, v59
v_cvt_pk_bf16_f32 v174, v60, v61
v_cvt_pk_bf16_f32 v175, v62, v63
s_waitcnt vmcnt(6)
s_mov_b64 exec, 0x1ffff
v_cmp_gt_u32 vcc, v253, v254
s_mov_b64 exec, -1
s_cbranch_vccz chk_34
s_mov_b32 s36, 0x80000
s_mov_b64 exec, 0x1ffff
poll_35:
buffer_load_dword v254, v252, s[28:31], 0 offen sc1
s_waitcnt vmcnt(0)
v_cmp_gt_u32 vcc, v253, v254
s_cbranch_vccz pollok_36
s_sleep 2
s_sub_u32 s36, s36, 1
s_cmp_lg_u32 s36, 0
s_cbranch_scc1 poll_35
pollok_36:
s_mov_b64 exec, -1
chk_34:
s_waitcnt vmcnt(23) lgkmcnt(8)
s_barrier
mf v[0:3],v[64:67],a[0:3],0
ds_read_b64_tr_b16 v[96:97], v232 offset:57344
v_lshlrev_b32 v206, 4, v255
mf v[32:35],v[64:67],a[4:7],0
ds_read_b64_tr_b16 v[98:99], v232 offset:58368
s_load_dwordx2 s[68:69], s[0:1], 80
mf v[36:39],v[68:71],a[4:7],0
ds_read_b64_tr_b16 v[100:101], v233 offset:57344
s_lshl_b32 s5, s15, 3
mf v[4:7],v[68:71],a[0:3],0
ds_read_b64_tr_b16 v[102:103], v233 offset:58368
s_add_u32 s5, s5, s14
mf v[8:11],v[72:75],a[0:3],0
ds_read_b64_tr_b16 v[104:105], v234 offset:57344
s_lshl_b32 s17, s14, 2
mf v[40:43],v[72:75],a[4:7],0
ds_read_b64_tr_b16 v[106:107], v234 offset:58368
s_and_b32 s34, s42, 15
mf v[44:47],v[76:79],a[4:7],0
ds_read_b64_tr_b16 v[108:109], v235 offset:57344
s_cmp_ge_u32 s34, 14
mf v[12:15],v[76:79],a[0:3],0
ds_read_b64_tr_b16 v[110:111], v235 offset:58368
s_waitcnt lgkmcnt(8)
mf v[16:19],v[80:83],a[0:3],0
ds_read_b64_tr_b16 v[112:113], v236 offset:57344
s_cselect_b32 s34, 32, 38
mf v[48:51],v[80:83],a[4:7],0
ds_read_b64_tr_b16 v[114:115], v236 offset:58368
s_sub_u32 s34, s34, s17
mf v[52:55],v[84:87],a[4:7],0
ds_read_b64_tr_b16 v[116:117], v237 offset:57344
s_sub_u32 s8, 15, s14
mf v[20:23],v[84:87],a[0:3],0
ds_read_b64_tr_b16 v[118:119], v237 offset:58368
s_sub_u32 s17, 64, s17
mf v[24:27],v[88:91],a[0:3],0
ds_read_b64_tr_b16 v[120:121], v238 offset:57344
s_cmp_eq_u32 s13, 0
mf v[56:59],v[88:91],a[4:7],0
ds_read_b64_tr_b16 v[122:123], v238 offset:58368
s_cselect_b32 s9, 0, s34
mf v[60:63],v[92:95],a[4:7],0
ds_read_b64_tr_b16 v[124:125], v239 offset:57344
s_cselect_b32 s10, s34, s17
mf v[28:31],v[92:95],a[0:3],0
ds_read_b64_tr_b16 v[126:127], v239 offset:58368
s_cselect_b32 s11, 0, 2
s_lshl_b32 s17, s15, 20
s_add_u32 s20, s6, s17
s_addc_u32 s21, s7, 0
s_and_b32 s21, s21, 0xffff
s_mov_b32 s22, 0x100000
s_mov_b32 s23, 0x20000
s_add_u32 s24, s20, 16777216
s_addc_u32 s25, s21, 0
s_mov_b32 s26, 0x100000
s_mov_b32 s27, 0x20000
s_lshl_b32 s40, s16, 12
s_lshl_b32 s32, s9, 14
s_add_u32 s32, s32, s40
s_mov_b32 s33, s32
s_lshl_b32 s4, s10, 14
buffer_store_dwordx4 v[144:147], v206, s[28:31], s35 offen offset:0 sc1
s_waitcnt lgkmcnt(8)
mf v[0:3],v[96:99],a[8:11],v[0:3]
ds_read_b64_tr_b16 v[64:65], v224 offset:0
s_add_u32 s4, s4, s40
mf v[32:35],v[96:99],a[12:15],v[32:35]
ds_read_b64_tr_b16 v[66:67], v224 offset:1024
s_cmp_eq_u32 s13, 0
mf v[36:39],v[100:103],a[12:15],v[36:39]
ds_read_b64_tr_b16 v[68:69], v225 offset:0
s_cselect_b32 s34, s40, 0x70000000
mf v[4:7],v[100:103],a[8:11],v[4:7]
ds_read_b64_tr_b16 v[70:71], v225 offset:1024
s_add_u32 s41, s40, 98304
mf v[8:11],v[104:107],a[8:11],v[8:11]
ds_read_b64_tr_b16 v[72:73], v226 offset:0
s_lshl_b32 s38, s8, 2
mf v[40:43],v[104:107],a[12:15],v[40:43]
ds_read_b64_tr_b16 v[74:75], v226 offset:1024
s_add_u32 s38, s38, s16
mf v[44:47],v[108:111],a[12:15],v[44:47]
ds_read_b64_tr_b16 v[76:77], v227 offset:0
s_lshl_b32 s38, s38, 14
mf v[12:15],v[108:111],a[8:11],v[12:15]
ds_read_b64_tr_b16 v[78:79], v227 offset:1024
s_waitcnt lgkmcnt(8)
mf v[16:19],v[112:115],a[8:11],v[16:19]
ds_read_b64_tr_b16 v[80:81], v228 offset:0
s_add_u32 s38, s38, s17
mf v[48:51],v[112:115],a[12:15],v[48:51]
ds_read_b64_tr_b16 v[82:83], v228 offset:1024
s_add_u32 s38, s38, 33554432
mf v[52:55],v[116:119],a[12:15],v[52:55]
ds_read_b64_tr_b16 v[84:85], v229 offset:0
s_lshr_b32 s91, s12, 2
mf v[20:23],v[116:119],a[8:11],v[20:23]
ds_read_b64_tr_b16 v[86:87], v229 offset:1024
s_lshl_b32 s91, s91, 3
mf v[24:27],v[120:123],a[8:11],v[24:27]
ds_read_b64_tr_b16 v[88:89], v230 offset:0
s_and_b32 s17, s42, 7
mf v[56:59],v[120:123],a[12:15],v[56:59]
ds_read_b64_tr_b16 v[90:91], v230 offset:1024
s_add_u32 s91, s91, s17
mf v[60:63],v[124:127],a[12:15],v[60:63]
ds_read_b64_tr_b16 v[92:93], v231 offset:0
s_lshl_b32 s91, s91, 2
mf v[28:31],v[124:127],a[8:11],v[28:31]
ds_read_b64_tr_b16 v[94:95], v231 offset:1024
s_lshr_b32 s17, s42, 3
s_add_u32 s91, s91, s17
s_lshl_b32 s91, s91, 2
s_and_b32 s17, s12, 3
s_add_u32 s91, s91, s17
s_lshl_b32 s91, s91, 15
s_mul_i32 s17, s16, 6144
s_add_u32 s91, s91, s17
s_add_u32 s91, s91, 115343360
s_add_u32 s92, s6, s91
s_addc_u32 s93, s7, 0
s_and_b32 s93, s93, 0xffff
s_movk_i32 s94, 6144
s_mov_b32 s95, 0x20000
s_mov_b32 s91, 0
buffer_store_dwordx4 v[148:151], v206, s[28:31], s35 offen offset:1024 sc1
s_waitcnt vmcnt(21) lgkmcnt(8)
s_barrier
mf v[0:3],v[64:67],a[16:19],v[0:3]
ds_read_b64_tr_b16 v[96:97], v224 offset:8192
buffer_load_dwordx4 a[128:131], v206, s[28:31], s38 offen offset:0 sc1
mf v[32:35],v[64:67],a[20:23],v[32:35]
ds_read_b64_tr_b16 v[98:99], v224 offset:9216
mf v[36:39],v[68:71],a[20:23],v[36:39]
ds_read_b64_tr_b16 v[100:101], v225 offset:8192
mf v[4:7],v[68:71],a[16:19],v[4:7]
ds_read_b64_tr_b16 v[102:103], v225 offset:9216
mf v[8:11],v[72:75],a[16:19],v[8:11]
ds_read_b64_tr_b16 v[104:105], v226 offset:8192
buffer_load_dwordx4 a[132:135], v206, s[28:31], s38 offen offset:1024 sc1
mf v[40:43],v[72:75],a[20:23],v[40:43]
ds_read_b64_tr_b16 v[106:107], v226 offset:9216
mf v[44:47],v[76:79],a[20:23],v[44:47]
ds_read_b64_tr_b16 v[108:109], v227 offset:8192
mf v[12:15],v[76:79],a[16:19],v[12:15]
ds_read_b64_tr_b16 v[110:111], v227 offset:9216
s_waitcnt lgkmcnt(8)
mf v[16:19],v[80:83],a[16:19],v[16:19]
ds_read_b64_tr_b16 v[112:113], v228 offset:8192
buffer_load_dwordx4 a[136:139], v206, s[28:31], s38 offen offset:2048 sc1
mf v[48:51],v[80:83],a[20:23],v[48:51]
ds_read_b64_tr_b16 v[114:115], v228 offset:9216
mf v[52:55],v[84:87],a[20:23],v[52:55]
ds_read_b64_tr_b16 v[116:117], v229 offset:8192
mf v[20:23],v[84:87],a[16:19],v[20:23]
ds_read_b64_tr_b16 v[118:119], v229 offset:9216
mf v[24:27],v[88:91],a[16:19],v[24:27]
ds_read_b64_tr_b16 v[120:121], v230 offset:8192
buffer_store_dwordx4 v[152:155], v206, s[28:31], s35 offen offset:2048 sc1
mf v[56:59],v[88:91],a[20:23],v[56:59]
ds_read_b64_tr_b16 v[122:123], v230 offset:9216
mf v[60:63],v[92:95],a[20:23],v[60:63]
ds_read_b64_tr_b16 v[124:125], v231 offset:8192
mf v[28:31],v[92:95],a[16:19],v[28:31]
ds_read_b64_tr_b16 v[126:127], v231 offset:9216
s_waitcnt lgkmcnt(8)
mf v[0:3],v[96:99],a[24:27],v[0:3]
ds_read_b64_tr_b16 v[64:65], v224 offset:16384
buffer_load_dwordx4 a[140:143], v206, s[28:31], s38 offen offset:3072 sc1
mf v[32:35],v[96:99],a[28:31],v[32:35]
ds_read_b64_tr_b16 v[66:67], v224 offset:17408
mf v[36:39],v[100:103],a[28:31],v[36:39]
ds_read_b64_tr_b16 v[68:69], v225 offset:16384
mf v[4:7],v[100:103],a[24:27],v[4:7]
ds_read_b64_tr_b16 v[70:71], v225 offset:17408
s_add_u32 s38, s38, 4096
mf v[8:11],v[104:107],a[24:27],v[8:11]
ds_read_b64_tr_b16 v[72:73], v226 offset:16384
mf v[40:43],v[104:107],a[28:31],v[40:43]
ds_read_b64_tr_b16 v[74:75], v226 offset:17408
mf v[44:47],v[108:111],a[28:31],v[44:47]
ds_read_b64_tr_b16 v[76:77], v227 offset:16384
buffer_load_dwordx4 a[144:147], v206, s[28:31], s38 offen offset:0 sc1
mf v[12:15],v[108:111],a[24:27],v[12:15]
ds_read_b64_tr_b16 v[78:79], v227 offset:17408
s_waitcnt lgkmcnt(8)
mf v[16:19],v[112:115],a[24:27],v[16:19]
ds_read_b64_tr_b16 v[80:81], v228 offset:16384
mf v[48:51],v[112:115],a[28:31],v[48:51]
ds_read_b64_tr_b16 v[82:83], v228 offset:17408
buffer_load_dwordx4 a[148:151], v206, s[28:31], s38 offen offset:1024 sc1
mf v[52:55],v[116:119],a[28:31],v[52:55]
ds_read_b64_tr_b16 v[84:85], v229 offset:16384
mf v[20:23],v[116:119],a[24:27],v[20:23]
ds_read_b64_tr_b16 v[86:87], v229 offset:17408
mf v[24:27],v[120:123],a[24:27],v[24:27]
ds_read_b64_tr_b16 v[88:89], v230 offset:16384
buffer_store_dwordx4 v[156:159], v206, s[28:31], s35 offen offset:3072 sc1
mf v[56:59],v[120:123],a[28:31],v[56:59]
ds_read_b64_tr_b16 v[90:91], v230 offset:17408
mf v[60:63],v[124:127],a[28:31],v[60:63]
ds_read_b64_tr_b16 v[92:93], v231 offset:16384
mf v[28:31],v[124:127],a[24:27],v[28:31]
ds_read_b64_tr_b16 v[94:95], v231 offset:17408
s_waitcnt vmcnt(25) lgkmcnt(8)
s_barrier
mf v[0:3],v[64:67],a[32:35],v[0:3]
ds_read_b64_tr_b16 v[96:97], v224 offset:24576
buffer_load_dwordx4 a[152:155], v206, s[28:31], s38 offen offset:2048 sc1
mf v[32:35],v[64:67],a[36:39],v[32:35]
ds_read_b64_tr_b16 v[98:99], v224 offset:25600
mf v[36:39],v[68:71],a[36:39],v[36:39]
ds_read_b64_tr_b16 v[100:101], v225 offset:24576
mf v[4:7],v[68:71],a[32:35],v[4:7]
ds_read_b64_tr_b16 v[102:103], v225 offset:25600
buffer_load_dwordx4 a[156:159], v206, s[28:31], s38 offen offset:3072 sc1
mf v[8:11],v[72:75],a[32:35],v[8:11]
ds_read_b64_tr_b16 v[104:105], v226 offset:24576
mf v[40:43],v[72:75],a[36:39],v[40:43]
ds_read_b64_tr_b16 v[106:107], v226 offset:25600
mf v[44:47],v[76:79],a[36:39],v[44:47]
ds_read_b64_tr_b16 v[108:109], v227 offset:24576
s_add_u32 s38, s38, 4096
mf v[12:15],v[76:79],a[32:35],v[12:15]
ds_read_b64_tr_b16 v[110:111], v227 offset:25600
s_waitcnt lgkmcnt(8)
mf v[16:19],v[80:83],a[32:35],v[16:19]
ds_read_b64_tr_b16 v[112:113], v228 offset:24576
mf v[48:51],v[80:83],a[36:39],v[48:51]
ds_read_b64_tr_b16 v[114:115], v228 offset:25600
buffer_load_dwordx4 a[160:163], v206, s[28:31], s38 offen offset:0 sc1
mf v[52:55],v[84:87],a[36:39],v[52:55]
ds_read_b64_tr_b16 v[116:117], v229 offset:24576
mf v[20:23],v[84:87],a[32:35],v[20:23]
ds_read_b64_tr_b16 v[118:119], v229 offset:25600
mf v[24:27],v[88:91],a[32:35],v[24:27]
ds_read_b64_tr_b16 v[120:121], v230 offset:24576
buffer_store_dwordx4 v[160:163], v206, s[28:31], s39 offen offset:0 sc1
mf v[56:59],v[88:91],a[36:39],v[56:59]
ds_read_b64_tr_b16 v[122:123], v230 offset:25600
mf v[60:63],v[92:95],a[36:39],v[60:63]
ds_read_b64_tr_b16 v[124:125], v231 offset:24576
mf v[28:31],v[92:95],a[32:35],v[28:31]
ds_read_b64_tr_b16 v[126:127], v231 offset:25600
s_waitcnt lgkmcnt(8)
mf v[0:3],v[96:99],a[40:43],v[0:3]
ds_read_b64_tr_b16 v[64:65], v232 offset:0
buffer_load_dwordx4 a[164:167], v206, s[28:31], s38 offen offset:1024 sc1
mf v[32:35],v[96:99],a[44:47],v[32:35]
ds_read_b64_tr_b16 v[66:67], v232 offset:1024
mf v[36:39],v[100:103],a[44:47],v[36:39]
ds_read_b64_tr_b16 v[68:69], v233 offset:0
mf v[4:7],v[100:103],a[40:43],v[4:7]
ds_read_b64_tr_b16 v[70:71], v233 offset:1024
mf v[8:11],v[104:107],a[40:43],v[8:11]
ds_read_b64_tr_b16 v[72:73], v234 offset:0
buffer_load_dwordx4 a[168:171], v206, s[28:31], s38 offen offset:2048 sc1
mf v[40:43],v[104:107],a[44:47],v[40:43]
ds_read_b64_tr_b16 v[74:75], v234 offset:1024
mf v[44:47],v[108:111],a[44:47],v[44:47]
ds_read_b64_tr_b16 v[76:77], v235 offset:0
mf v[12:15],v[108:111],a[40:43],v[12:15]
ds_read_b64_tr_b16 v[78:79], v235 offset:1024
s_waitcnt lgkmcnt(8)
mf v[16:19],v[112:115],a[40:43],v[16:19]
ds_read_b64_tr_b16 v[80:81], v236 offset:0
buffer_load_dwordx4 a[172:175], v206, s[28:31], s38 offen offset:3072 sc1
mf v[48:51],v[112:115],a[44:47],v[48:51]
ds_read_b64_tr_b16 v[82:83], v236 offset:1024
mf v[52:55],v[116:119],a[44:47],v[52:55]
ds_read_b64_tr_b16 v[84:85], v237 offset:0
mf v[20:23],v[116:119],a[40:43],v[20:23]
ds_read_b64_tr_b16 v[86:87], v237 offset:1024
mf v[24:27],v[120:123],a[40:43],v[24:27]
ds_read_b64_tr_b16 v[88:89], v238 offset:0
s_add_u32 s38, s38, 4096
mf v[56:59],v[120:123],a[44:47],v[56:59]
ds_read_b64_tr_b16 v[90:91], v238 offset:1024
mf v[60:63],v[124:127],a[44:47],v[60:63]
ds_read_b64_tr_b16 v[92:93], v239 offset:0
mf v[28:31],v[124:127],a[40:43],v[28:31]
ds_read_b64_tr_b16 v[94:95], v239 offset:1024
s_waitcnt vmcnt(28) lgkmcnt(8)
s_barrier
mf v[0:3],v[64:67],a[48:51],v[0:3]
ds_read_b64_tr_b16 v[96:97], v232 offset:8192
buffer_load_dwordx4 a[176:179], v206, s[28:31], s38 offen offset:0 sc1
mf v[32:35],v[64:67],a[52:55],v[32:35]
ds_read_b64_tr_b16 v[98:99], v232 offset:9216
mf v[36:39],v[68:71],a[52:55],v[36:39]
ds_read_b64_tr_b16 v[100:101], v233 offset:8192
mf v[4:7],v[68:71],a[48:51],v[4:7]
ds_read_b64_tr_b16 v[102:103], v233 offset:9216
mf v[8:11],v[72:75],a[48:51],v[8:11]
ds_read_b64_tr_b16 v[104:105], v234 offset:8192
buffer_load_dwordx4 a[180:183], v206, s[28:31], s38 offen offset:1024 sc1
mf v[40:43],v[72:75],a[52:55],v[40:43]
ds_read_b64_tr_b16 v[106:107], v234 offset:9216
mf v[44:47],v[76:79],a[52:55],v[44:47]
ds_read_b64_tr_b16 v[108:109], v235 offset:8192
mf v[12:15],v[76:79],a[48:51],v[12:15]
ds_read_b64_tr_b16 v[110:111], v235 offset:9216
s_waitcnt lgkmcnt(8)
mf v[16:19],v[80:83],a[48:51],v[16:19]
ds_read_b64_tr_b16 v[112:113], v236 offset:8192
buffer_load_dwordx4 a[184:187], v206, s[28:31], s38 offen offset:2048 sc1
mf v[48:51],v[80:83],a[52:55],v[48:51]
ds_read_b64_tr_b16 v[114:115], v236 offset:9216
mf v[52:55],v[84:87],a[52:55],v[52:55]
ds_read_b64_tr_b16 v[116:117], v237 offset:8192
mf v[20:23],v[84:87],a[48:51],v[20:23]
ds_read_b64_tr_b16 v[118:119], v237 offset:9216
mf v[24:27],v[88:91],a[48:51],v[24:27]
ds_read_b64_tr_b16 v[120:121], v238 offset:8192
buffer_store_dwordx4 v[164:167], v206, s[28:31], s39 offen offset:1024 sc1
mf v[56:59],v[88:91],a[52:55],v[56:59]
ds_read_b64_tr_b16 v[122:123], v238 offset:9216
mf v[60:63],v[92:95],a[52:55],v[60:63]
ds_read_b64_tr_b16 v[124:125], v239 offset:8192
mf v[28:31],v[92:95],a[48:51],v[28:31]
ds_read_b64_tr_b16 v[126:127], v239 offset:9216
s_waitcnt lgkmcnt(8)
mf v[0:3],v[96:99],a[56:59],v[0:3]
ds_read_b64_tr_b16 v[64:65], v232 offset:16384
buffer_load_dwordx4 a[188:191], v206, s[28:31], s38 offen offset:3072 sc1
mf v[32:35],v[96:99],a[60:63],v[32:35]
ds_read_b64_tr_b16 v[66:67], v232 offset:17408
mf v[36:39],v[100:103],a[60:63],v[36:39]
ds_read_b64_tr_b16 v[68:69], v233 offset:16384
mf v[4:7],v[100:103],a[56:59],v[4:7]
ds_read_b64_tr_b16 v[70:71], v233 offset:17408
s_add_u32 m0, s40, 98304
mf v[8:11],v[104:107],a[56:59],v[8:11]
ds_read_b64_tr_b16 v[72:73], v234 offset:16384
mf v[40:43],v[104:107],a[60:63],v[40:43]
ds_read_b64_tr_b16 v[74:75], v234 offset:17408
mf v[44:47],v[108:111],a[60:63],v[44:47]
ds_read_b64_tr_b16 v[76:77], v235 offset:16384
s_add_u32 s33, s32, 0
mf v[12:15],v[108:111],a[56:59],v[12:15]
ds_read_b64_tr_b16 v[78:79], v235 offset:17408
s_waitcnt lgkmcnt(8)
mf v[16:19],v[112:115],a[56:59],v[16:19]
ds_read_b64_tr_b16 v[80:81], v236 offset:16384
mf v[48:51],v[112:115],a[60:63],v[48:51]
ds_read_b64_tr_b16 v[82:83], v236 offset:17408
buffer_load_dwordx4 v206, s[20:23], s33 offen offset:0 sc1 lds
mf v[52:55],v[116:119],a[60:63],v[52:55]
ds_read_b64_tr_b16 v[84:85], v237 offset:16384
mf v[20:23],v[116:119],a[56:59],v[20:23]
ds_read_b64_tr_b16 v[86:87], v237 offset:17408
mf v[24:27],v[120:123],a[56:59],v[24:27]
ds_read_b64_tr_b16 v[88:89], v238 offset:16384
buffer_load_dwordx4 v206, s[20:23], s33 offen offset:1024 sc1 lds
mf v[56:59],v[120:123],a[60:63],v[56:59]
ds_read_b64_tr_b16 v[90:91], v238 offset:17408
mf v[60:63],v[124:127],a[60:63],v[60:63]
ds_read_b64_tr_b16 v[92:93], v239 offset:16384
mf v[28:31],v[124:127],a[56:59],v[28:31]
ds_read_b64_tr_b16 v[94:95], v239 offset:17408
s_waitcnt vmcnt(31) lgkmcnt(8)
s_barrier
mf v[0:3],v[64:67],a[64:67],v[0:3]
ds_read_b64_tr_b16 v[96:97], v232 offset:24576
buffer_load_dwordx4 v206, s[20:23], s33 offen offset:2048 sc1 lds
mf v[32:35],v[64:67],a[68:71],v[32:35]
ds_read_b64_tr_b16 v[98:99], v232 offset:25600
mf v[36:39],v[68:71],a[68:71],v[36:39]
ds_read_b64_tr_b16 v[100:101], v233 offset:24576
buffer_load_dwordx4 v206, s[20:23], s33 offen offset:3072 sc1 lds
mf v[4:7],v[68:71],a[64:67],v[4:7]
ds_read_b64_tr_b16 v[102:103], v233 offset:25600
mf v[8:11],v[72:75],a[64:67],v[8:11]
ds_read_b64_tr_b16 v[104:105], v234 offset:24576
mf v[40:43],v[72:75],a[68:71],v[40:43]
ds_read_b64_tr_b16 v[106:107], v234 offset:25600
s_add_u32 m0, s40, 114688
mf v[44:47],v[76:79],a[68:71],v[44:47]
ds_read_b64_tr_b16 v[108:109], v235 offset:24576
mf v[12:15],v[76:79],a[64:67],v[12:15]
ds_read_b64_tr_b16 v[110:111], v235 offset:25600
s_waitcnt lgkmcnt(8)
mf v[16:19],v[80:83],a[64:67],v[16:19]
ds_read_b64_tr_b16 v[112:113], v236 offset:24576
s_add_u32 s33, s32, 16384
mf v[48:51],v[80:83],a[68:71],v[48:51]
ds_read_b64_tr_b16 v[114:115], v236 offset:25600
mf v[52:55],v[84:87],a[68:71],v[52:55]
ds_read_b64_tr_b16 v[116:117], v237 offset:24576
buffer_load_dwordx4 v206, s[20:23], s33 offen offset:0 sc1 lds
mf v[20:23],v[84:87],a[64:67],v[20:23]
ds_read_b64_tr_b16 v[118:119], v237 offset:25600
mf v[24:27],v[88:91],a[64:67],v[24:27]
ds_read_b64_tr_b16 v[120:121], v238 offset:24576
mf v[56:59],v[88:91],a[68:71],v[56:59]
ds_read_b64_tr_b16 v[122:123], v238 offset:25600
buffer_store_dwordx4 v[168:171], v206, s[28:31], s39 offen offset:2048 sc1
mf v[60:63],v[92:95],a[68:71],v[60:63]
ds_read_b64_tr_b16 v[124:125], v239 offset:24576
mf v[28:31],v[92:95],a[64:67],v[28:31]
ds_read_b64_tr_b16 v[126:127], v239 offset:25600
s_waitcnt lgkmcnt(8)
mf v[0:3],v[96:99],a[72:75],v[0:3]
ds_read_b64_tr_b16 v[64:65], v224 offset:32768
buffer_load_dwordx4 v206, s[20:23], s33 offen offset:1024 sc1 lds
mf v[32:35],v[96:99],a[76:79],v[32:35]
ds_read_b64_tr_b16 v[66:67], v224 offset:33792
mf v[36:39],v[100:103],a[76:79],v[36:39]
ds_read_b64_tr_b16 v[68:69], v225 offset:32768
mf v[4:7],v[100:103],a[72:75],v[4:7]
ds_read_b64_tr_b16 v[70:71], v225 offset:33792
mf v[8:11],v[104:107],a[72:75],v[8:11]
ds_read_b64_tr_b16 v[72:73], v226 offset:32768
mf v[40:43],v[104:107],a[76:79],v[40:43]
ds_read_b64_tr_b16 v[74:75], v226 offset:33792
buffer_load_dwordx4 v206, s[20:23], s33 offen offset:2048 sc1 lds
mf v[44:47],v[108:111],a[76:79],v[44:47]
ds_read_b64_tr_b16 v[76:77], v227 offset:32768
mf v[12:15],v[108:111],a[72:75],v[12:15]
ds_read_b64_tr_b16 v[78:79], v227 offset:33792
s_waitcnt lgkmcnt(8)
mf v[16:19],v[112:115],a[72:75],v[16:19]
ds_read_b64_tr_b16 v[80:81], v228 offset:32768
mf v[48:51],v[112:115],a[76:79],v[48:51]
ds_read_b64_tr_b16 v[82:83], v228 offset:33792
mf v[52:55],v[116:119],a[76:79],v[52:55]
ds_read_b64_tr_b16 v[84:85], v229 offset:32768
buffer_load_dwordx4 v206, s[20:23], s33 offen offset:3072 sc1 lds
mf v[20:23],v[116:119],a[72:75],v[20:23]
ds_read_b64_tr_b16 v[86:87], v229 offset:33792
mf v[24:27],v[120:123],a[72:75],v[24:27]
ds_read_b64_tr_b16 v[88:89], v230 offset:32768
mf v[56:59],v[120:123],a[76:79],v[56:59]
ds_read_b64_tr_b16 v[90:91], v230 offset:33792
mf v[60:63],v[124:127],a[76:79],v[60:63]
ds_read_b64_tr_b16 v[92:93], v231 offset:32768
mf v[28:31],v[124:127],a[72:75],v[28:31]
ds_read_b64_tr_b16 v[94:95], v231 offset:33792
s_waitcnt vmcnt(33) lgkmcnt(8)
s_barrier
mf v[0:3],v[64:67],a[80:83],v[0:3]
ds_read_b64_tr_b16 v[96:97], v224 offset:40960
s_add_u32 m0, s40, 131072
mf v[32:35],v[64:67],a[84:87],v[32:35]
ds_read_b64_tr_b16 v[98:99], v224 offset:41984
mf v[36:39],v[68:71],a[84:87],v[36:39]
ds_read_b64_tr_b16 v[100:101], v225 offset:40960
s_add_u32 s33, s32, 32768
mf v[4:7],v[68:71],a[80:83],v[4:7]
ds_read_b64_tr_b16 v[102:103], v225 offset:41984
mf v[8:11],v[72:75],a[80:83],v[8:11]
ds_read_b64_tr_b16 v[104:105], v226 offset:40960
mf v[40:43],v[72:75],a[84:87],v[40:43]
ds_read_b64_tr_b16 v[106:107], v226 offset:41984
buffer_load_dwordx4 v206, s[20:23], s33 offen offset:0 sc1 lds
mf v[44:47],v[76:79],a[84:87],v[44:47]
ds_read_b64_tr_b16 v[108:109], v227 offset:40960
mf v[12:15],v[76:79],a[80:83],v[12:15]
ds_read_b64_tr_b16 v[110:111], v227 offset:41984
s_waitcnt lgkmcnt(8)
mf v[16:19],v[80:83],a[80:83],v[16:19]
ds_read_b64_tr_b16 v[112:113], v228 offset:40960
buffer_load_dwordx4 v206, s[20:23], s33 offen offset:1024 sc1 lds
mf v[48:51],v[80:83],a[84:87],v[48:51]
ds_read_b64_tr_b16 v[114:115], v228 offset:41984
mf v[52:55],v[84:87],a[84:87],v[52:55]
ds_read_b64_tr_b16 v[116:117], v229 offset:40960
buffer_load_dwordx4 v206, s[20:23], s33 offen offset:2048 sc1 lds
mf v[20:23],v[84:87],a[80:83],v[20:23]
ds_read_b64_tr_b16 v[118:119], v229 offset:41984
mf v[24:27],v[88:91],a[80:83],v[24:27]
ds_read_b64_tr_b16 v[120:121], v230 offset:40960
mf v[56:59],v[88:91],a[84:87],v[56:59]
ds_read_b64_tr_b16 v[122:123], v230 offset:41984
buffer_store_dwordx4 v[172:175], v206, s[28:31], s39 offen offset:3072 sc1
mf v[60:63],v[92:95],a[84:87],v[60:63]
ds_read_b64_tr_b16 v[124:125], v231 offset:40960
mf v[28:31],v[92:95],a[80:83],v[28:31]
ds_read_b64_tr_b16 v[126:127], v231 offset:41984
s_waitcnt lgkmcnt(8)
mf v[0:3],v[96:99],a[88:91],v[0:3]
ds_read_b64_tr_b16 v[64:65], v224 offset:49152
buffer_load_dwordx4 v206, s[20:23], s33 offen offset:3072 sc1 lds
mf v[32:35],v[96:99],a[92:95],v[32:35]
ds_read_b64_tr_b16 v[66:67], v224 offset:50176
mf v[36:39],v[100:103],a[92:95],v[36:39]
ds_read_b64_tr_b16 v[68:69], v225 offset:49152
mf v[4:7],v[100:103],a[88:91],v[4:7]
ds_read_b64_tr_b16 v[70:71], v225 offset:50176
s_add_u32 m0, s40, 147456
mf v[8:11],v[104:107],a[88:91],v[8:11]
ds_read_b64_tr_b16 v[72:73], v226 offset:49152
mf v[40:43],v[104:107],a[92:95],v[40:43]
ds_read_b64_tr_b16 v[74:75], v226 offset:50176
mf v[44:47],v[108:111],a[92:95],v[44:47]
ds_read_b64_tr_b16 v[76:77], v227 offset:49152
s_add_u32 s33, s32, 49152
mf v[12:15],v[108:111],a[88:91],v[12:15]
ds_read_b64_tr_b16 v[78:79], v227 offset:50176
s_waitcnt lgkmcnt(8)
mf v[16:19],v[112:115],a[88:91],v[16:19]
ds_read_b64_tr_b16 v[80:81], v228 offset:49152
mf v[48:51],v[112:115],a[92:95],v[48:51]
ds_read_b64_tr_b16 v[82:83], v228 offset:50176
buffer_load_dwordx4 v206, s[20:23], s33 offen offset:0 sc1 lds
mf v[52:55],v[116:119],a[92:95],v[52:55]
ds_read_b64_tr_b16 v[84:85], v229 offset:49152
mf v[20:23],v[116:119],a[88:91],v[20:23]
ds_read_b64_tr_b16 v[86:87], v229 offset:50176
mf v[24:27],v[120:123],a[88:91],v[24:27]
ds_read_b64_tr_b16 v[88:89], v230 offset:49152
buffer_load_dwordx4 v206, s[20:23], s33 offen offset:1024 sc1 lds
mf v[56:59],v[120:123],a[92:95],v[56:59]
ds_read_b64_tr_b16 v[90:91], v230 offset:50176
mf v[60:63],v[124:127],a[92:95],v[60:63]
ds_read_b64_tr_b16 v[92:93], v231 offset:49152
mf v[28:31],v[124:127],a[88:91],v[28:31]
ds_read_b64_tr_b16 v[94:95], v231 offset:50176
s_waitcnt vmcnt(38) lgkmcnt(8)
s_barrier
mf v[0:3],v[64:67],a[96:99],v[0:3]
ds_read_b64_tr_b16 v[96:97], v224 offset:57344
buffer_load_dwordx4 v206, s[20:23], s33 offen offset:2048 sc1 lds
mf v[32:35],v[64:67],a[100:103],v[32:35]
ds_read_b64_tr_b16 v[98:99], v224 offset:58368
mf v[36:39],v[68:71],a[100:103],v[36:39]
ds_read_b64_tr_b16 v[100:101], v225 offset:57344
mf v[4:7],v[68:71],a[96:99],v[4:7]
ds_read_b64_tr_b16 v[102:103], v225 offset:58368
mf v[8:11],v[72:75],a[96:99],v[8:11]
ds_read_b64_tr_b16 v[104:105], v226 offset:57344
mf v[40:43],v[72:75],a[100:103],v[40:43]
ds_read_b64_tr_b16 v[106:107], v226 offset:58368
mf v[44:47],v[76:79],a[100:103],v[44:47]
ds_read_b64_tr_b16 v[108:109], v227 offset:57344
mf v[12:15],v[76:79],a[96:99],v[12:15]
ds_read_b64_tr_b16 v[110:111], v227 offset:58368
s_waitcnt lgkmcnt(8)
mf v[16:19],v[80:83],a[96:99],v[16:19]
ds_read_b64_tr_b16 v[112:113], v228 offset:57344
buffer_load_dwordx4 v206, s[20:23], s33 offen offset:3072 sc1 lds
mf v[48:51],v[80:83],a[100:103],v[48:51]
ds_read_b64_tr_b16 v[114:115], v228 offset:58368
mf v[52:55],v[84:87],a[100:103],v[52:55]
ds_read_b64_tr_b16 v[116:117], v229 offset:57344
mf v[20:23],v[84:87],a[96:99],v[20:23]
ds_read_b64_tr_b16 v[118:119], v229 offset:58368
mf v[24:27],v[88:91],a[96:99],v[24:27]
ds_read_b64_tr_b16 v[120:121], v230 offset:57344
mf v[56:59],v[88:91],a[100:103],v[56:59]
ds_read_b64_tr_b16 v[122:123], v230 offset:58368
mf v[60:63],v[92:95],a[100:103],v[60:63]
ds_read_b64_tr_b16 v[124:125], v231 offset:57344
mf v[28:31],v[92:95],a[96:99],v[28:31]
ds_read_b64_tr_b16 v[126:127], v231 offset:58368
s_waitcnt lgkmcnt(8)
mf v[0:3],v[96:99],a[104:107],v[0:3]
mf v[32:35],v[96:99],a[108:111],v[32:35]
mf v[36:39],v[100:103],a[108:111],v[36:39]
mf v[4:7],v[100:103],a[104:107],v[4:7]
mf v[8:11],v[104:107],a[104:107],v[8:11]
mf v[40:43],v[104:107],a[108:111],v[40:43]
mf v[44:47],v[108:111],a[108:111],v[44:47]
mf v[12:15],v[108:111],a[104:107],v[12:15]
s_waitcnt lgkmcnt(0)
mf v[16:19],v[112:115],a[104:107],v[16:19]
mf v[48:51],v[112:115],a[108:111],v[48:51]
mf v[52:55],v[116:119],a[108:111],v[52:55]
mf v[20:23],v[116:119],a[104:107],v[20:23]
mf v[24:27],v[120:123],a[104:107],v[24:27]
mf v[56:59],v[120:123],a[108:111],v[56:59]
mf v[60:63],v[124:127],a[108:111],v[60:63]
mf v[28:31],v[124:127],a[104:107],v[28:31]
s_barrier
v_pk_mul_f32 v[128:129], v[0:1], v[0:1]
v_pk_mul_f32 v[130:131], v[2:3], v[2:3]
v_pk_mul_f32 v[132:133], v[4:5], v[4:5]
v_pk_mul_f32 v[134:135], v[6:7], v[6:7]
v_pk_mul_f32 v[136:137], v[8:9], v[8:9]
v_pk_mul_f32 v[138:139], v[10:11], v[10:11]
v_pk_mul_f32 v[140:141], v[12:13], v[12:13]
v_pk_mul_f32 v[142:143], v[14:15], v[14:15]
v_pk_fma_f32 v[128:129], v[128:129], v[242:243], s[64:65] op_sel_hi:[1,0,1]
v_pk_fma_f32 v[130:131], v[130:131], v[242:243], s[64:65] op_sel_hi:[1,0,1]
v_pk_fma_f32 v[132:133], v[132:133], v[242:243], s[64:65] op_sel_hi:[1,0,1]
v_pk_fma_f32 v[134:135], v[134:135], v[242:243], s[64:65] op_sel_hi:[1,0,1]
v_pk_fma_f32 v[136:137], v[136:137], v[242:243], s[64:65] op_sel_hi:[1,0,1]
v_pk_fma_f32 v[138:139], v[138:139], v[242:243], s[64:65] op_sel_hi:[1,0,1]
v_pk_fma_f32 v[140:141], v[140:141], v[242:243], s[64:65] op_sel_hi:[1,0,1]
v_pk_fma_f32 v[142:143], v[142:143], v[242:243], s[64:65] op_sel_hi:[1,0,1]
v_pk_mul_f32 v[128:129], v[128:129], v[0:1]
v_pk_mul_f32 v[130:131], v[130:131], v[2:3]
v_pk_mul_f32 v[132:133], v[132:133], v[4:5]
v_pk_mul_f32 v[134:135], v[134:135], v[6:7]
v_pk_mul_f32 v[136:137], v[136:137], v[8:9]
v_pk_mul_f32 v[138:139], v[138:139], v[10:11]
v_pk_mul_f32 v[140:141], v[140:141], v[12:13]
v_pk_mul_f32 v[142:143], v[142:143], v[14:15]
v_exp_f32 v128, v128
v_exp_f32 v129, v129
v_exp_f32 v130, v130
v_exp_f32 v131, v131
v_exp_f32 v132, v132
v_exp_f32 v133, v133
v_exp_f32 v134, v134
v_exp_f32 v135, v135
v_exp_f32 v136, v136
v_exp_f32 v137, v137
v_exp_f32 v138, v138
v_exp_f32 v139, v139
s_add_u32 m0, s40, 32768
s_add_u32 s33, s32, 0
buffer_load_dwordx4 v206, s[24:27], s33 offen offset:0 sc1 lds
v_exp_f32 v140, v140
v_exp_f32 v141, v141
v_exp_f32 v142, v142
v_exp_f32 v143, v143
v_pk_mul_f32 v[0:1], v[0:1], v[246:247] op_sel_hi:[1,0]
v_pk_mul_f32 v[2:3], v[2:3], v[246:247] op_sel_hi:[1,0]
v_pk_mul_f32 v[4:5], v[4:5], v[246:247] op_sel_hi:[1,0]
v_pk_mul_f32 v[6:7], v[6:7], v[246:247] op_sel_hi:[1,0]
v_pk_mul_f32 v[8:9], v[8:9], v[246:247] op_sel_hi:[1,0]
v_pk_mul_f32 v[10:11], v[10:11], v[246:247] op_sel_hi:[1,0]
v_pk_mul_f32 v[12:13], v[12:13], v[246:247] op_sel_hi:[1,0]
v_pk_mul_f32 v[14:15], v[14:15], v[246:247] op_sel_hi:[1,0]
v_pk_add_f32 v[128:129], v[128:129], v[244:245] op_sel_hi:[1,0]
v_pk_add_f32 v[130:131], v[130:131], v[244:245] op_sel_hi:[1,0]
v_pk_add_f32 v[132:133], v[132:133], v[244:245] op_sel_hi:[1,0]
v_pk_add_f32 v[134:135], v[134:135], v[244:245] op_sel_hi:[1,0]
v_pk_add_f32 v[136:137], v[136:137], v[244:245] op_sel_hi:[1,0]
v_pk_add_f32 v[138:139], v[138:139], v[244:245] op_sel_hi:[1,0]
v_pk_add_f32 v[140:141], v[140:141], v[244:245] op_sel_hi:[1,0]
v_pk_add_f32 v[142:143], v[142:143], v[244:245] op_sel_hi:[1,0]
v_rcp_f32 v128, v128
v_rcp_f32 v129, v129
v_rcp_f32 v130, v130
v_rcp_f32 v131, v131
v_rcp_f32 v132, v132
v_rcp_f32 v133, v133
v_rcp_f32 v134, v134
v_rcp_f32 v135, v135
v_rcp_f32 v136, v136
v_rcp_f32 v137, v137
v_rcp_f32 v138, v138
v_rcp_f32 v139, v139
v_rcp_f32 v140, v140
v_rcp_f32 v141, v141
v_rcp_f32 v142, v142
v_rcp_f32 v143, v143
buffer_load_dwordx4 v206, s[24:27], s33 offen offset:1024 sc1 lds
s_nop 0
v_pk_mul_f32 v[0:1], v[0:1], v[128:129]
v_pk_mul_f32 v[2:3], v[2:3], v[130:131]
v_pk_mul_f32 v[4:5], v[4:5], v[132:133]
v_pk_mul_f32 v[6:7], v[6:7], v[134:135]
v_pk_mul_f32 v[8:9], v[8:9], v[136:137]
v_pk_mul_f32 v[10:11], v[10:11], v[138:139]
v_pk_mul_f32 v[12:13], v[12:13], v[140:141]
v_pk_mul_f32 v[14:15], v[14:15], v[142:143]
v_cvt_pk_bf16_f32 v144, v0, v1
v_cvt_pk_bf16_f32 v145, v2, v3
v_cvt_pk_bf16_f32 v146, v4, v5
v_cvt_pk_bf16_f32 v147, v6, v7
v_cvt_pk_bf16_f32 v148, v8, v9
v_cvt_pk_bf16_f32 v149, v10, v11
v_cvt_pk_bf16_f32 v150, v12, v13
v_cvt_pk_bf16_f32 v151, v14, v15
v_pk_mul_f32 v[128:129], v[16:17], v[16:17]
v_pk_mul_f32 v[130:131], v[18:19], v[18:19]
v_pk_mul_f32 v[132:133], v[20:21], v[20:21]
v_pk_mul_f32 v[134:135], v[22:23], v[22:23]
v_pk_mul_f32 v[136:137], v[24:25], v[24:25]
v_pk_mul_f32 v[138:139], v[26:27], v[26:27]
v_pk_mul_f32 v[140:141], v[28:29], v[28:29]
v_pk_mul_f32 v[142:143], v[30:31], v[30:31]
v_pk_fma_f32 v[128:129], v[128:129], v[242:243], s[64:65] op_sel_hi:[1,0,1]
v_pk_fma_f32 v[130:131], v[130:131], v[242:243], s[64:65] op_sel_hi:[1,0,1]
v_pk_fma_f32 v[132:133], v[132:133], v[242:243], s[64:65] op_sel_hi:[1,0,1]
v_pk_fma_f32 v[134:135], v[134:135], v[242:243], s[64:65] op_sel_hi:[1,0,1]
v_pk_fma_f32 v[136:137], v[136:137], v[242:243], s[64:65] op_sel_hi:[1,0,1]
v_pk_fma_f32 v[138:139], v[138:139], v[242:243], s[64:65] op_sel_hi:[1,0,1]
v_pk_fma_f32 v[140:141], v[140:141], v[242:243], s[64:65] op_sel_hi:[1,0,1]
v_pk_fma_f32 v[142:143], v[142:143], v[242:243], s[64:65] op_sel_hi:[1,0,1]
v_pk_mul_f32 v[128:129], v[128:129], v[16:17]
v_pk_mul_f32 v[130:131], v[130:131], v[18:19]
buffer_load_dwordx4 v206, s[24:27], s33 offen offset:2048 sc1 lds
v_pk_mul_f32 v[132:133], v[132:133], v[20:21]
v_pk_mul_f32 v[134:135], v[134:135], v[22:23]
v_pk_mul_f32 v[136:137], v[136:137], v[24:25]
v_pk_mul_f32 v[138:139], v[138:139], v[26:27]
v_pk_mul_f32 v[140:141], v[140:141], v[28:29]
v_pk_mul_f32 v[142:143], v[142:143], v[30:31]
v_exp_f32 v128, v128
v_exp_f32 v129, v129
v_exp_f32 v130, v130
v_exp_f32 v131, v131
v_exp_f32 v132, v132
v_exp_f32 v133, v133
v_exp_f32 v134, v134
v_exp_f32 v135, v135
v_exp_f32 v136, v136
v_exp_f32 v137, v137
v_exp_f32 v138, v138
v_exp_f32 v139, v139
v_exp_f32 v140, v140
v_exp_f32 v141, v141
v_exp_f32 v142, v142
v_exp_f32 v143, v143
v_pk_mul_f32 v[16:17], v[16:17], v[246:247] op_sel_hi:[1,0]
v_pk_mul_f32 v[18:19], v[18:19], v[246:247] op_sel_hi:[1,0]
v_pk_mul_f32 v[20:21], v[20:21], v[246:247] op_sel_hi:[1,0]
v_pk_mul_f32 v[22:23], v[22:23], v[246:247] op_sel_hi:[1,0]
v_pk_mul_f32 v[24:25], v[24:25], v[246:247] op_sel_hi:[1,0]
v_pk_mul_f32 v[26:27], v[26:27], v[246:247] op_sel_hi:[1,0]
v_pk_mul_f32 v[28:29], v[28:29], v[246:247] op_sel_hi:[1,0]
v_pk_mul_f32 v[30:31], v[30:31], v[246:247] op_sel_hi:[1,0]
v_pk_add_f32 v[128:129], v[128:129], v[244:245] op_sel_hi:[1,0]
v_pk_add_f32 v[130:131], v[130:131], v[244:245] op_sel_hi:[1,0]
v_pk_add_f32 v[132:133], v[132:133], v[244:245] op_sel_hi:[1,0]
v_pk_add_f32 v[134:135], v[134:135], v[244:245] op_sel_hi:[1,0]
v_pk_add_f32 v[136:137], v[136:137], v[244:245] op_sel_hi:[1,0]
v_pk_add_f32 v[138:139], v[138:139], v[244:245] op_sel_hi:[1,0]
buffer_load_dwordx4 v206, s[24:27], s33 offen offset:3072 sc1 lds
v_pk_add_f32 v[140:141], v[140:141], v[244:245] op_sel_hi:[1,0]
v_pk_add_f32 v[142:143], v[142:143], v[244:245] op_sel_hi:[1,0]
v_rcp_f32 v128, v128
v_rcp_f32 v129, v129
v_rcp_f32 v130, v130
v_rcp_f32 v131, v131
v_rcp_f32 v132, v132
v_rcp_f32 v133, v133
v_rcp_f32 v134, v134
v_rcp_f32 v135, v135
v_rcp_f32 v136, v136
v_rcp_f32 v137, v137
v_rcp_f32 v138, v138
v_rcp_f32 v139, v139
v_rcp_f32 v140, v140
v_rcp_f32 v141, v141
v_rcp_f32 v142, v142
v_rcp_f32 v143, v143
s_nop 0
v_pk_mul_f32 v[16:17], v[16:17], v[128:129]
v_pk_mul_f32 v[18:19], v[18:19], v[130:131]
v_pk_mul_f32 v[20:21], v[20:21], v[132:133]
v_pk_mul_f32 v[22:23], v[22:23], v[134:135]
v_pk_mul_f32 v[24:25], v[24:25], v[136:137]
v_pk_mul_f32 v[26:27], v[26:27], v[138:139]
v_pk_mul_f32 v[28:29], v[28:29], v[140:141]
v_pk_mul_f32 v[30:31], v[30:31], v[142:143]
v_cvt_pk_bf16_f32 v152, v16, v17
v_cvt_pk_bf16_f32 v153, v18, v19
v_cvt_pk_bf16_f32 v154, v20, v21
v_cvt_pk_bf16_f32 v155, v22, v23
v_cvt_pk_bf16_f32 v156, v24, v25
v_cvt_pk_bf16_f32 v157, v26, v27
v_cvt_pk_bf16_f32 v158, v28, v29
v_cvt_pk_bf16_f32 v159, v30, v31
s_add_u32 m0, s40, 49152
s_add_u32 s33, s32, 16384
buffer_load_dwordx4 v206, s[24:27], s33 offen offset:0 sc1 lds
v_pk_mul_f32 v[128:129], v[32:33], v[32:33]
v_pk_mul_f32 v[130:131], v[34:35], v[34:35]
v_pk_mul_f32 v[132:133], v[36:37], v[36:37]
v_pk_mul_f32 v[134:135], v[38:39], v[38:39]
v_pk_mul_f32 v[136:137], v[40:41], v[40:41]
v_pk_mul_f32 v[138:139], v[42:43], v[42:43]
v_pk_mul_f32 v[140:141], v[44:45], v[44:45]
v_pk_mul_f32 v[142:143], v[46:47], v[46:47]
v_pk_fma_f32 v[128:129], v[128:129], v[242:243], s[64:65] op_sel_hi:[1,0,1]
v_pk_fma_f32 v[130:131], v[130:131], v[242:243], s[64:65] op_sel_hi:[1,0,1]
v_pk_fma_f32 v[132:133], v[132:133], v[242:243], s[64:65] op_sel_hi:[1,0,1]
v_pk_fma_f32 v[134:135], v[134:135], v[242:243], s[64:65] op_sel_hi:[1,0,1]
v_pk_fma_f32 v[136:137], v[136:137], v[242:243], s[64:65] op_sel_hi:[1,0,1]
v_pk_fma_f32 v[138:139], v[138:139], v[242:243], s[64:65] op_sel_hi:[1,0,1]
v_pk_fma_f32 v[140:141], v[140:141], v[242:243], s[64:65] op_sel_hi:[1,0,1]
v_pk_fma_f32 v[142:143], v[142:143], v[242:243], s[64:65] op_sel_hi:[1,0,1]
v_pk_mul_f32 v[128:129], v[128:129], v[32:33]
v_pk_mul_f32 v[130:131], v[130:131], v[34:35]
v_pk_mul_f32 v[132:133], v[132:133], v[36:37]
v_pk_mul_f32 v[134:135], v[134:135], v[38:39]
v_pk_mul_f32 v[136:137], v[136:137], v[40:41]
v_pk_mul_f32 v[138:139], v[138:139], v[42:43]
v_pk_mul_f32 v[140:141], v[140:141], v[44:45]
v_pk_mul_f32 v[142:143], v[142:143], v[46:47]
v_exp_f32 v128, v128
v_exp_f32 v129, v129
v_exp_f32 v130, v130
v_exp_f32 v131, v131
v_exp_f32 v132, v132
v_exp_f32 v133, v133
v_exp_f32 v134, v134
v_exp_f32 v135, v135
v_exp_f32 v136, v136
v_exp_f32 v137, v137
v_exp_f32 v138, v138
v_exp_f32 v139, v139
buffer_load_dwordx4 v206, s[24:27], s33 offen offset:1024 sc1 lds
v_exp_f32 v140, v140
v_exp_f32 v141, v141
v_exp_f32 v142, v142
v_exp_f32 v143, v143
v_pk_mul_f32 v[32:33], v[32:33], v[248:249] op_sel_hi:[1,0]
v_pk_mul_f32 v[34:35], v[34:35], v[248:249] op_sel_hi:[1,0]
v_pk_mul_f32 v[36:37], v[36:37], v[248:249] op_sel_hi:[1,0]
v_pk_mul_f32 v[38:39], v[38:39], v[248:249] op_sel_hi:[1,0]
v_pk_mul_f32 v[40:41], v[40:41], v[248:249] op_sel_hi:[1,0]
v_pk_mul_f32 v[42:43], v[42:43], v[248:249] op_sel_hi:[1,0]
v_pk_mul_f32 v[44:45], v[44:45], v[248:249] op_sel_hi:[1,0]
v_pk_mul_f32 v[46:47], v[46:47], v[248:249] op_sel_hi:[1,0]
v_pk_add_f32 v[128:129], v[128:129], v[244:245] op_sel_hi:[1,0]
v_pk_add_f32 v[130:131], v[130:131], v[244:245] op_sel_hi:[1,0]
v_pk_add_f32 v[132:133], v[132:133], v[244:245] op_sel_hi:[1,0]
v_pk_add_f32 v[134:135], v[134:135], v[244:245] op_sel_hi:[1,0]
v_pk_add_f32 v[136:137], v[136:137], v[244:245] op_sel_hi:[1,0]
v_pk_add_f32 v[138:139], v[138:139], v[244:245] op_sel_hi:[1,0]
v_pk_add_f32 v[140:141], v[140:141], v[244:245] op_sel_hi:[1,0]
v_pk_add_f32 v[142:143], v[142:143], v[244:245] op_sel_hi:[1,0]
v_rcp_f32 v128, v128
v_rcp_f32 v129, v129
v_rcp_f32 v130, v130
v_rcp_f32 v131, v131
v_rcp_f32 v132, v132
v_rcp_f32 v133, v133
v_rcp_f32 v134, v134
v_rcp_f32 v135, v135
v_rcp_f32 v136, v136
v_rcp_f32 v137, v137
v_rcp_f32 v138, v138
v_rcp_f32 v139, v139
v_rcp_f32 v140, v140
v_rcp_f32 v141, v141
v_rcp_f32 v142, v142
v_rcp_f32 v143, v143
buffer_load_dwordx4 v206, s[24:27], s33 offen offset:2048 sc1 lds
s_nop 0
v_pk_mul_f32 v[32:33], v[32:33], v[128:129]
v_pk_mul_f32 v[34:35], v[34:35], v[130:131]
v_pk_mul_f32 v[36:37], v[36:37], v[132:133]
v_pk_mul_f32 v[38:39], v[38:39], v[134:135]
v_pk_mul_f32 v[40:41], v[40:41], v[136:137]
v_pk_mul_f32 v[42:43], v[42:43], v[138:139]
v_pk_mul_f32 v[44:45], v[44:45], v[140:141]
v_pk_mul_f32 v[46:47], v[46:47], v[142:143]
v_cvt_pk_bf16_f32 v160, v32, v33
v_cvt_pk_bf16_f32 v161, v34, v35
v_cvt_pk_bf16_f32 v162, v36, v37
v_cvt_pk_bf16_f32 v163, v38, v39
v_cvt_pk_bf16_f32 v164, v40, v41
v_cvt_pk_bf16_f32 v165, v42, v43
v_cvt_pk_bf16_f32 v166, v44, v45
v_cvt_pk_bf16_f32 v167, v46, v47
v_pk_mul_f32 v[128:129], v[48:49], v[48:49]
v_pk_mul_f32 v[130:131], v[50:51], v[50:51]
v_pk_mul_f32 v[132:133], v[52:53], v[52:53]
v_pk_mul_f32 v[134:135], v[54:55], v[54:55]
v_pk_mul_f32 v[136:137], v[56:57], v[56:57]
v_pk_mul_f32 v[138:139], v[58:59], v[58:59]
v_pk_mul_f32 v[140:141], v[60:61], v[60:61]
v_pk_mul_f32 v[142:143], v[62:63], v[62:63]
v_pk_fma_f32 v[128:129], v[128:129], v[242:243], s[64:65] op_sel_hi:[1,0,1]
v_pk_fma_f32 v[130:131], v[130:131], v[242:243], s[64:65] op_sel_hi:[1,0,1]
v_pk_fma_f32 v[132:133], v[132:133], v[242:243], s[64:65] op_sel_hi:[1,0,1]
v_pk_fma_f32 v[134:135], v[134:135], v[242:243], s[64:65] op_sel_hi:[1,0,1]
v_pk_fma_f32 v[136:137], v[136:137], v[242:243], s[64:65] op_sel_hi:[1,0,1]
v_pk_fma_f32 v[138:139], v[138:139], v[242:243], s[64:65] op_sel_hi:[1,0,1]
v_pk_fma_f32 v[140:141], v[140:141], v[242:243], s[64:65] op_sel_hi:[1,0,1]
v_pk_fma_f32 v[142:143], v[142:143], v[242:243], s[64:65] op_sel_hi:[1,0,1]
v_pk_mul_f32 v[128:129], v[128:129], v[48:49]
v_pk_mul_f32 v[130:131], v[130:131], v[50:51]
buffer_load_dwordx4 v206, s[24:27], s33 offen offset:3072 sc1 lds
v_pk_mul_f32 v[132:133], v[132:133], v[52:53]
v_pk_mul_f32 v[134:135], v[134:135], v[54:55]
v_pk_mul_f32 v[136:137], v[136:137], v[56:57]
v_pk_mul_f32 v[138:139], v[138:139], v[58:59]
v_pk_mul_f32 v[140:141], v[140:141], v[60:61]
v_pk_mul_f32 v[142:143], v[142:143], v[62:63]
v_exp_f32 v128, v128
v_exp_f32 v129, v129
v_exp_f32 v130, v130
v_exp_f32 v131, v131
v_exp_f32 v132, v132
v_exp_f32 v133, v133
v_exp_f32 v134, v134
v_exp_f32 v135, v135
v_exp_f32 v136, v136
v_exp_f32 v137, v137
v_exp_f32 v138, v138
v_exp_f32 v139, v139
v_exp_f32 v140, v140
v_exp_f32 v141, v141
v_exp_f32 v142, v142
v_exp_f32 v143, v143
v_pk_mul_f32 v[48:49], v[48:49], v[248:249] op_sel_hi:[1,0]
v_pk_mul_f32 v[50:51], v[50:51], v[248:249] op_sel_hi:[1,0]
v_pk_mul_f32 v[52:53], v[52:53], v[248:249] op_sel_hi:[1,0]
v_pk_mul_f32 v[54:55], v[54:55], v[248:249] op_sel_hi:[1,0]
v_pk_mul_f32 v[56:57], v[56:57], v[248:249] op_sel_hi:[1,0]
v_pk_mul_f32 v[58:59], v[58:59], v[248:249] op_sel_hi:[1,0]
v_pk_mul_f32 v[60:61], v[60:61], v[248:249] op_sel_hi:[1,0]
v_pk_mul_f32 v[62:63], v[62:63], v[248:249] op_sel_hi:[1,0]
v_pk_add_f32 v[128:129], v[128:129], v[244:245] op_sel_hi:[1,0]
v_pk_add_f32 v[130:131], v[130:131], v[244:245] op_sel_hi:[1,0]
v_pk_add_f32 v[132:133], v[132:133], v[244:245] op_sel_hi:[1,0]
v_pk_add_f32 v[134:135], v[134:135], v[244:245] op_sel_hi:[1,0]
v_pk_add_f32 v[136:137], v[136:137], v[244:245] op_sel_hi:[1,0]
v_pk_add_f32 v[138:139], v[138:139], v[244:245] op_sel_hi:[1,0]
s_add_u32 s32, s32, 32768
v_pk_add_f32 v[140:141], v[140:141], v[244:245] op_sel_hi:[1,0]
v_pk_add_f32 v[142:143], v[142:143], v[244:245] op_sel_hi:[1,0]
v_rcp_f32 v128, v128
v_rcp_f32 v129, v129
v_rcp_f32 v130, v130
v_rcp_f32 v131, v131
v_rcp_f32 v132, v132
v_rcp_f32 v133, v133
v_rcp_f32 v134, v134
v_rcp_f32 v135, v135
v_rcp_f32 v136, v136
v_rcp_f32 v137, v137
v_rcp_f32 v138, v138
v_rcp_f32 v139, v139
v_rcp_f32 v140, v140
v_rcp_f32 v141, v141
v_rcp_f32 v142, v142
v_rcp_f32 v143, v143
s_nop 0
v_pk_mul_f32 v[48:49], v[48:49], v[128:129]
v_pk_mul_f32 v[50:51], v[50:51], v[130:131]
v_pk_mul_f32 v[52:53], v[52:53], v[132:133]
v_pk_mul_f32 v[54:55], v[54:55], v[134:135]
v_pk_mul_f32 v[56:57], v[56:57], v[136:137]
v_pk_mul_f32 v[58:59], v[58:59], v[138:139]
v_pk_mul_f32 v[60:61], v[60:61], v[140:141]
v_pk_mul_f32 v[62:63], v[62:63], v[142:143]
v_cvt_pk_bf16_f32 v168, v48, v49
v_cvt_pk_bf16_f32 v169, v50, v51
v_cvt_pk_bf16_f32 v170, v52, v53
v_cvt_pk_bf16_f32 v171, v54, v55
v_cvt_pk_bf16_f32 v172, v56, v57
v_cvt_pk_bf16_f32 v173, v58, v59
v_cvt_pk_bf16_f32 v174, v60, v61
v_cvt_pk_bf16_f32 v175, v62, v63
s_add_u32 s35, s35, 4096
s_add_u32 s39, s39, 4096
v_pk_mov_b32 v[0:1], 0, 0
v_pk_mov_b32 v[2:3], 0, 0
v_pk_mov_b32 v[4:5], 0, 0
v_pk_mov_b32 v[6:7], 0, 0
v_pk_mov_b32 v[8:9], 0, 0
v_pk_mov_b32 v[10:11], 0, 0
v_pk_mov_b32 v[12:13], 0, 0
v_pk_mov_b32 v[14:15], 0, 0
buffer_store_dwordx4 v[144:147], v206, s[28:31], s35 offen offset:0 sc1
v_pk_mov_b32 v[16:17], 0, 0
v_pk_mov_b32 v[18:19], 0, 0
v_pk_mov_b32 v[20:21], 0, 0
v_pk_mov_b32 v[22:23], 0, 0
v_pk_mov_b32 v[24:25], 0, 0
v_pk_mov_b32 v[26:27], 0, 0
v_pk_mov_b32 v[28:29], 0, 0
buffer_store_dwordx4 v[148:151], v206, s[28:31], s35 offen offset:1024 sc1
v_pk_mov_b32 v[30:31], 0, 0
v_pk_mov_b32 v[32:33], 0, 0
v_pk_mov_b32 v[34:35], 0, 0
v_pk_mov_b32 v[36:37], 0, 0
v_pk_mov_b32 v[38:39], 0, 0
v_pk_mov_b32 v[40:41], 0, 0
v_pk_mov_b32 v[42:43], 0, 0
buffer_store_dwordx4 v[152:155], v206, s[28:31], s35 offen offset:2048 sc1
v_pk_mov_b32 v[44:45], 0, 0
v_pk_mov_b32 v[46:47], 0, 0
v_pk_mov_b32 v[48:49], 0, 0
v_pk_mov_b32 v[50:51], 0, 0
v_pk_mov_b32 v[52:53], 0, 0
v_pk_mov_b32 v[54:55], 0, 0
v_pk_mov_b32 v[56:57], 0, 0
buffer_store_dwordx4 v[156:159], v206, s[28:31], s35 offen offset:3072 sc1
v_pk_mov_b32 v[58:59], 0, 0
v_pk_mov_b32 v[60:61], 0, 0
v_pk_mov_b32 v[62:63], 0, 0
v_pk_mov_b32 v[64:65], 0, 0
v_pk_mov_b32 v[66:67], 0, 0
v_pk_mov_b32 v[68:69], 0, 0
v_pk_mov_b32 v[70:71], 0, 0
buffer_store_dwordx4 v[160:163], v206, s[28:31], s39 offen offset:0 sc1
v_pk_mov_b32 v[72:73], 0, 0
v_pk_mov_b32 v[74:75], 0, 0
v_pk_mov_b32 v[76:77], 0, 0
v_pk_mov_b32 v[78:79], 0, 0
v_pk_mov_b32 v[80:81], 0, 0
v_pk_mov_b32 v[82:83], 0, 0
v_pk_mov_b32 v[84:85], 0, 0
buffer_store_dwordx4 v[164:167], v206, s[28:31], s39 offen offset:1024 sc1
v_pk_mov_b32 v[86:87], 0, 0
v_pk_mov_b32 v[88:89], 0, 0
v_pk_mov_b32 v[90:91], 0, 0
v_pk_mov_b32 v[92:93], 0, 0
v_pk_mov_b32 v[94:95], 0, 0
v_pk_mov_b32 v[96:97], 0, 0
v_pk_mov_b32 v[98:99], 0, 0
buffer_store_dwordx4 v[168:171], v206, s[28:31], s39 offen offset:2048 sc1
v_pk_mov_b32 v[100:101], 0, 0
v_pk_mov_b32 v[102:103], 0, 0
v_pk_mov_b32 v[104:105], 0, 0
v_pk_mov_b32 v[106:107], 0, 0
v_pk_mov_b32 v[108:109], 0, 0
v_pk_mov_b32 v[110:111], 0, 0
v_pk_mov_b32 v[112:113], 0, 0
buffer_store_dwordx4 v[172:175], v206, s[28:31], s39 offen offset:3072 sc1
v_pk_mov_b32 v[114:115], 0, 0
v_pk_mov_b32 v[116:117], 0, 0
v_pk_mov_b32 v[118:119], 0, 0
v_pk_mov_b32 v[120:121], 0, 0
v_pk_mov_b32 v[122:123], 0, 0
v_pk_mov_b32 v[124:125], 0, 0
v_pk_mov_b32 v[126:127], 0, 0
s_waitcnt vmcnt(8)
s_branch ajoin_31
notile_30:
buffer_load_dword v254, v252, s[28:31], 0 offen sc1
s_waitcnt vmcnt(0)
s_barrier
s_mov_b64 exec, 0x1ffff
v_cmp_gt_u32 vcc, v253, v254
s_mov_b64 exec, -1
s_cbranch_vccz chk_37
s_mov_b32 s36, 0x80000
s_mov_b64 exec, 0x1ffff
poll_38:
buffer_load_dword v254, v252, s[28:31], 0 offen sc1
s_waitcnt vmcnt(0)
v_cmp_gt_u32 vcc, v253, v254
s_cbranch_vccz pollok_39
s_sleep 2
s_sub_u32 s36, s36, 1
s_cmp_lg_u32 s36, 0
s_cbranch_scc1 poll_38
pollok_39:
s_mov_b64 exec, -1
chk_37:
v_lshlrev_b32 v206, 4, v255
s_load_dwordx2 s[68:69], s[0:1], 80
s_lshl_b32 s5, s15, 3
s_add_u32 s5, s5, s14
s_lshl_b32 s17, s14, 2
s_and_b32 s34, s42, 15
s_cmp_ge_u32 s34, 14
s_cselect_b32 s34, 32, 38
s_sub_u32 s34, s34, s17
s_sub_u32 s8, 15, s14
s_sub_u32 s17, 64, s17
s_cmp_eq_u32 s13, 0
s_cselect_b32 s9, 0, s34
s_cselect_b32 s10, s34, s17
s_cselect_b32 s11, 0, 2
s_lshl_b32 s17, s15, 20
s_add_u32 s20, s6, s17
s_addc_u32 s21, s7, 0
s_and_b32 s21, s21, 0xffff
s_mov_b32 s22, 0x100000
s_mov_b32 s23, 0x20000
s_add_u32 s24, s20, 16777216
s_addc_u32 s25, s21, 0
s_mov_b32 s26, 0x100000
s_mov_b32 s27, 0x20000
s_lshl_b32 s40, s16, 12
s_lshl_b32 s32, s9, 14
s_add_u32 s32, s32, s40
s_mov_b32 s33, s32
s_lshl_b32 s4, s10, 14
s_add_u32 s4, s4, s40
s_cmp_eq_u32 s13, 0
s_cselect_b32 s34, s40, 0x70000000
s_add_u32 s41, s40, 98304
s_lshl_b32 s38, s8, 2
s_add_u32 s38, s38, s16
s_lshl_b32 s38, s38, 14
s_add_u32 s38, s38, s17
s_add_u32 s38, s38, 33554432
s_lshr_b32 s91, s12, 2
s_lshl_b32 s91, s91, 3
s_and_b32 s17, s42, 7
s_add_u32 s91, s91, s17
s_lshl_b32 s91, s91, 2
s_lshr_b32 s17, s42, 3
s_add_u32 s91, s91, s17
s_lshl_b32 s91, s91, 2
s_and_b32 s17, s12, 3
s_add_u32 s91, s91, s17
s_lshl_b32 s91, s91, 15
s_mul_i32 s17, s16, 6144
s_add_u32 s91, s91, s17
s_add_u32 s91, s91, 115343360
s_add_u32 s92, s6, s91
s_addc_u32 s93, s7, 0
s_and_b32 s93, s93, 0xffff
s_movk_i32 s94, 6144
s_mov_b32 s95, 0x20000
s_mov_b32 s91, 0
buffer_load_dwordx4 a[128:131], v206, s[28:31], s38 offen offset:0 sc1
buffer_load_dwordx4 a[132:135], v206, s[28:31], s38 offen offset:1024 sc1
buffer_load_dwordx4 a[136:139], v206, s[28:31], s38 offen offset:2048 sc1
buffer_load_dwordx4 a[140:143], v206, s[28:31], s38 offen offset:3072 sc1
s_add_u32 s38, s38, 4096
buffer_load_dwordx4 a[144:147], v206, s[28:31], s38 offen offset:0 sc1
buffer_load_dwordx4 a[148:151], v206, s[28:31], s38 offen offset:1024 sc1
buffer_load_dwordx4 a[152:155], v206, s[28:31], s38 offen offset:2048 sc1
buffer_load_dwordx4 a[156:159], v206, s[28:31], s38 offen offset:3072 sc1
s_add_u32 s38, s38, 4096
buffer_load_dwordx4 a[160:163], v206, s[28:31], s38 offen offset:0 sc1
buffer_load_dwordx4 a[164:167], v206, s[28:31], s38 offen offset:1024 sc1
buffer_load_dwordx4 a[168:171], v206, s[28:31], s38 offen offset:2048 sc1
buffer_load_dwordx4 a[172:175], v206, s[28:31], s38 offen offset:3072 sc1
s_add_u32 s38, s38, 4096
buffer_load_dwordx4 a[176:179], v206, s[28:31], s38 offen offset:0 sc1
buffer_load_dwordx4 a[180:183], v206, s[28:31], s38 offen offset:1024 sc1
buffer_load_dwordx4 a[184:187], v206, s[28:31], s38 offen offset:2048 sc1
buffer_load_dwordx4 a[188:191], v206, s[28:31], s38 offen offset:3072 sc1
s_add_u32 m0, s40, 98304
s_add_u32 s33, s32, 0
buffer_load_dwordx4 v206, s[20:23], s33 offen offset:0 sc1 lds
buffer_load_dwordx4 v206, s[20:23], s33 offen offset:1024 sc1 lds
buffer_load_dwordx4 v206, s[20:23], s33 offen offset:2048 sc1 lds
buffer_load_dwordx4 v206, s[20:23], s33 offen offset:3072 sc1 lds
s_add_u32 m0, s40, 114688
s_add_u32 s33, s32, 16384
buffer_load_dwordx4 v206, s[20:23], s33 offen offset:0 sc1 lds
buffer_load_dwordx4 v206, s[20:23], s33 offen offset:1024 sc1 lds
buffer_load_dwordx4 v206, s[20:23], s33 offen offset:2048 sc1 lds
buffer_load_dwordx4 v206, s[20:23], s33 offen offset:3072 sc1 lds
s_add_u32 m0, s40, 131072
s_add_u32 s33, s32, 32768
buffer_load_dwordx4 v206, s[20:23], s33 offen offset:0 sc1 lds
buffer_load_dwordx4 v206, s[20:23], s33 offen offset:1024 sc1 lds
buffer_load_dwordx4 v206, s[20:23], s33 offen offset:2048 sc1 lds
buffer_load_dwordx4 v206, s[20:23], s33 offen offset:3072 sc1 lds
s_add_u32 m0, s40, 147456
s_add_u32 s33, s32, 49152
buffer_load_dwordx4 v206, s[20:23], s33 offen offset:0 sc1 lds
buffer_load_dwordx4 v206, s[20:23], s33 offen offset:1024 sc1 lds
buffer_load_dwordx4 v206, s[20:23], s33 offen offset:2048 sc1 lds
buffer_load_dwordx4 v206, s[20:23], s33 offen offset:3072 sc1 lds
s_add_u32 m0, s40, 32768
s_add_u32 s33, s32, 0
buffer_load_dwordx4 v206, s[24:27], s33 offen offset:0 sc1 lds
buffer_load_dwordx4 v206, s[24:27], s33 offen offset:1024 sc1 lds
buffer_load_dwordx4 v206, s[24:27], s33 offen offset:2048 sc1 lds
buffer_load_dwordx4 v206, s[24:27], s33 offen offset:3072 sc1 lds
s_add_u32 m0, s40, 49152
s_add_u32 s33, s32, 16384
buffer_load_dwordx4 v206, s[24:27], s33 offen offset:0 sc1 lds
buffer_load_dwordx4 v206, s[24:27], s33 offen offset:1024 sc1 lds
buffer_load_dwordx4 v206, s[24:27], s33 offen offset:2048 sc1 lds
buffer_load_dwordx4 v206, s[24:27], s33 offen offset:3072 sc1 lds
s_add_u32 s32, s32, 32768
v_pk_mov_b32 v[0:1], 0, 0
v_pk_mov_b32 v[2:3], 0, 0
v_pk_mov_b32 v[4:5], 0, 0
v_pk_mov_b32 v[6:7], 0, 0
v_pk_mov_b32 v[8:9], 0, 0
v_pk_mov_b32 v[10:11], 0, 0
v_pk_mov_b32 v[12:13], 0, 0
v_pk_mov_b32 v[14:15], 0, 0
v_pk_mov_b32 v[16:17], 0, 0
v_pk_mov_b32 v[18:19], 0, 0
v_pk_mov_b32 v[20:21], 0, 0
v_pk_mov_b32 v[22:23], 0, 0
v_pk_mov_b32 v[24:25], 0, 0
v_pk_mov_b32 v[26:27], 0, 0
v_pk_mov_b32 v[28:29], 0, 0
v_pk_mov_b32 v[30:31], 0, 0
v_pk_mov_b32 v[32:33], 0, 0
v_pk_mov_b32 v[34:35], 0, 0
v_pk_mov_b32 v[36:37], 0, 0
v_pk_mov_b32 v[38:39], 0, 0
v_pk_mov_b32 v[40:41], 0, 0
v_pk_mov_b32 v[42:43], 0, 0
v_pk_mov_b32 v[44:45], 0, 0
v_pk_mov_b32 v[46:47], 0, 0
v_pk_mov_b32 v[48:49], 0, 0
v_pk_mov_b32 v[50:51], 0, 0
v_pk_mov_b32 v[52:53], 0, 0
v_pk_mov_b32 v[54:55], 0, 0
v_pk_mov_b32 v[56:57], 0, 0
v_pk_mov_b32 v[58:59], 0, 0
v_pk_mov_b32 v[60:61], 0, 0
v_pk_mov_b32 v[62:63], 0, 0
v_pk_mov_b32 v[64:65], 0, 0
v_pk_mov_b32 v[66:67], 0, 0
v_pk_mov_b32 v[68:69], 0, 0
v_pk_mov_b32 v[70:71], 0, 0
v_pk_mov_b32 v[72:73], 0, 0
v_pk_mov_b32 v[74:75], 0, 0
v_pk_mov_b32 v[76:77], 0, 0
v_pk_mov_b32 v[78:79], 0, 0
v_pk_mov_b32 v[80:81], 0, 0
v_pk_mov_b32 v[82:83], 0, 0
v_pk_mov_b32 v[84:85], 0, 0
v_pk_mov_b32 v[86:87], 0, 0
v_pk_mov_b32 v[88:89], 0, 0
v_pk_mov_b32 v[90:91], 0, 0
v_pk_mov_b32 v[92:93], 0, 0
v_pk_mov_b32 v[94:95], 0, 0
v_pk_mov_b32 v[96:97], 0, 0
v_pk_mov_b32 v[98:99], 0, 0
v_pk_mov_b32 v[100:101], 0, 0
v_pk_mov_b32 v[102:103], 0, 0
v_pk_mov_b32 v[104:105], 0, 0
v_pk_mov_b32 v[106:107], 0, 0
v_pk_mov_b32 v[108:109], 0, 0
v_pk_mov_b32 v[110:111], 0, 0
v_pk_mov_b32 v[112:113], 0, 0
v_pk_mov_b32 v[114:115], 0, 0
v_pk_mov_b32 v[116:117], 0, 0
v_pk_mov_b32 v[118:119], 0, 0
v_pk_mov_b32 v[120:121], 0, 0
v_pk_mov_b32 v[122:123], 0, 0
v_pk_mov_b32 v[124:125], 0, 0
v_pk_mov_b32 v[126:127], 0, 0
s_waitcnt vmcnt(0) lgkmcnt(0)
ajoin_31:
s_barrier
att_8:
v_add_u32 v204, 0x18000, v206
v_and_b32 v219, 15, v255
v_lshrrev_b32 v212, 4, v255
v_lshlrev_b32 v212, 2, v212
v_sub_u32 v218, v219, v212
v_mov_b32 v208, 0xff800000
s_mov_b32 s39, 1317011456
v_add_u32 v205, 0x8000, v206
s_add_u32 s35, s13, 2
v_mov_b32 v221, 105906176
v_mov_b32 v246, -1
v_mov_b32 v247, -1
v_mov_b32 v248, -1
v_mov_b32 v249, -1
seg_40:
s_lshl_b32 s18, s8, 2
s_add_u32 s18, s18, s16
s_sub_u32 s17, s10, s9
s_lshr_b32 s17, s17, 1
s_sub_u32 s17, s17, 1
s_min_u32 s37, s17, 2
s_cmp_eq_u32 s11, 0
s_cselect_b32 s37, 0, s37
s_sub_u32 s19, s17, s37
s_min_u32 s36, s19, 1
s_sub_u32 s19, s19, s36
s_mov_b32 s38, 0
s_lshl_b32 s17, s16, 5
v_add_u32 v207, s17, v218
s_cmp_eq_u32 s37, 1
s_cbranch_scc1 st2_43
ds_read_b128 a[192:195], v204 offset:0
ds_read_b128 a[196:199], v204 offset:1024
ds_read_b128 a[200:203], v204 offset:2048
ds_read_b128 a[204:207], v204 offset:3072
ds_read_b128 a[208:211], v204 offset:4096
ds_read_b128 a[212:215], v204 offset:5120
ds_read_b128 a[216:219], v204 offset:6144
ds_read_b128 a[220:223], v204 offset:7168
v_mov_b32 v202, 0
v_mov_b32 v203, 0
s_waitcnt lgkmcnt(4)
mf v[128:131],a[192:195],a[128:131],0
ds_read_b128 a[224:227], v204 offset:8192
mf v[128:131],a[196:199],a[132:135],v[128:131]
mf v[128:131],a[200:203],a[136:139],v[128:131]
ds_read_b128 a[228:231], v204 offset:9216
mf v[128:131],a[204:207],a[140:143],v[128:131]
mf v[132:135],a[204:207],a[172:175],0
ds_read_b128 a[232:235], v204 offset:10240
mf v[132:135],a[200:203],a[168:171],v[132:135]
mf v[132:135],a[196:199],a[164:167],v[132:135]
ds_read_b128 a[236:239], v204 offset:11264
s_waitcnt lgkmcnt(4)
mf v[132:135],a[192:195],a[160:163],v[132:135]
mf v[132:135],a[208:211],a[176:179],v[132:135]
ds_read_b128 a[240:243], v204 offset:12288
mf v[132:135],a[212:215],a[180:183],v[132:135]
mf v[132:135],a[216:219],a[184:187],v[132:135]
ds_read_b128 a[244:247], v204 offset:13312
mf v[132:135],a[220:223],a[188:191],v[132:135]
mf v[128:131],a[220:223],a[156:159],v[128:131]
ds_read_b128 a[248:251], v204 offset:14336
mf v[128:131],a[216:219],a[152:155],v[128:131]
mf v[128:131],a[212:215],a[148:151],v[128:131]
ds_read_b128 a[252:255], v204 offset:15360
s_waitcnt lgkmcnt(4)
mf v[128:131],a[208:211],a[144:147],v[128:131]
mf v[136:139],a[224:227],a[128:131],0
ds_read_b128 a[192:195], v204 offset:16384
mf v[136:139],a[228:231],a[132:135],v[136:139]
mf v[136:139],a[232:235],a[136:139],v[136:139]
ds_read_b128 a[196:199], v204 offset:17408
mf v[136:139],a[236:239],a[140:143],v[136:139]
mf v[140:143],a[236:239],a[172:175],0
ds_read_b128 a[200:203], v204 offset:18432
mf v[140:143],a[232:235],a[168:171],v[140:143]
mf v[140:143],a[228:231],a[164:167],v[140:143]
ds_read_b128 a[204:207], v204 offset:19456
s_waitcnt lgkmcnt(4)
mf v[140:143],a[224:227],a[160:163],v[140:143]
v_max3_f32 v210, v128, v129, v130
v_max_f32 v210, v210, v131
mf v[140:143],a[240:243],a[176:179],v[140:143]
ds_read_b128 a[208:211], v204 offset:20480
v_max3_f32 v211, v132, v133, v134
mf v[140:143],a[244:247],a[180:183],v[140:143]
v_max_f32 v211, v211, v135
v_mov_b32 v212, v210
mf v[140:143],a[248:251],a[184:187],v[140:143]
ds_read_b128 a[212:215], v204 offset:21504
v_mov_b32 v213, v211
mf v[140:143],a[252:255],a[188:191],v[140:143]
s_nop 1
v_permlane16_swap_b32 v212, v210
mf v[136:139],a[252:255],a[156:159],v[136:139]
ds_read_b128 a[216:219], v204 offset:22528
v_permlane16_swap_b32 v213, v211
mf v[136:139],a[248:251],a[152:155],v[136:139]
s_nop 1
v_max_f32 v210, v210, v212
mf v[136:139],a[244:247],a[148:151],v[136:139]
ds_read_b128 a[220:223], v204 offset:23552
s_waitcnt lgkmcnt(4)
mf v[136:139],a[240:243],a[144:147],v[136:139]
v_max_f32 v211, v211, v213
v_mov_b32 v212, v210
mf v[144:147],a[192:195],a[128:131],0
ds_read_b128 a[224:227], v204 offset:24576
v_mov_b32 v213, v211
mf v[144:147],a[196:199],a[132:135],v[144:147]
s_nop 1
v_permlane32_swap_b32 v212, v210
mf v[144:147],a[200:203],a[136:139],v[144:147]
ds_read_b128 a[228:231], v204 offset:25600
v_permlane32_swap_b32 v213, v211
mf v[144:147],a[204:207],a[140:143],v[144:147]
s_nop 1
v_max_f32 v210, v210, v212
v_max_f32 v211, v211, v213
mf v[148:151],a[204:207],a[172:175],0
ds_read_b128 a[232:235], v204 offset:26624
v_sub_f32 v132, v132, v211
mf v[148:151],a[200:203],a[168:171],v[148:151]
v_exp_f32 v188, v132
mf v[148:151],a[196:199],a[164:167],v[148:151]
ds_read_b128 a[236:239], v204 offset:27648
s_waitcnt lgkmcnt(4)
mf v[148:151],a[192:195],a[160:163],v[148:151]
v_sub_f32 v133, v133, v211
v_sub_f32 v134, v134, v211
mf v[148:151],a[208:211],a[176:179],v[148:151]
ds_read_b128 a[240:243], v204 offset:28672
v_sub_f32 v135, v135, v211
mf v[148:151],a[212:215],a[180:183],v[148:151]
v_exp_f32 v189, v133
mf v[148:151],a[216:219],a[184:187],v[148:151]
ds_read_b128 a[244:247], v204 offset:29696
v_sub_f32 v128, v128, v210
mf v[148:151],a[220:223],a[188:191],v[148:151]
v_exp_f32 v190, v134
mf v[144:147],a[220:223],a[156:159],v[144:147]
ds_read_b128 a[248:251], v204 offset:30720
v_sub_f32 v129, v129, v210
mf v[144:147],a[216:219],a[152:155],v[144:147]
v_exp_f32 v191, v135
mf v[144:147],a[212:215],a[148:151],v[144:147]
ds_read_b128 a[252:255], v204 offset:31744
s_waitcnt lgkmcnt(4)
mf v[144:147],a[208:211],a[144:147],v[144:147]
v_exp_f32 v184, v128
mf v[152:155],a[224:227],a[128:131],0
v_xor_b32 v204, 0x38000, v204
ds_read_b128 a[192:195], v204 offset:0
mf v[152:155],a[228:231],a[132:135],v[152:155]
v_exp_f32 v185, v129
mf v[152:155],a[232:235],a[136:139],v[152:155]
ds_read_b128 a[196:199], v204 offset:1024
v_sub_f32 v130, v130, v210
mf v[152:155],a[236:239],a[140:143],v[152:155]
v_exp_f32 v186, v130
mf v[156:159],a[236:239],a[172:175],0
ds_read_b128 a[200:203], v204 offset:2048
v_sub_f32 v131, v131, v210
mf v[156:159],a[232:235],a[168:171],v[156:159]
v_exp_f32 v187, v131
mf v[156:159],a[228:231],a[164:167],v[156:159]
ds_read_b128 a[204:207], v204 offset:3072
s_waitcnt lgkmcnt(4)
mf v[156:159],a[224:227],a[160:163],v[156:159]
v_sub_f32 v140, v140, v211
v_sub_f32 v141, v141, v211
mf v[156:159],a[240:243],a[176:179],v[156:159]
ds_read_b128 a[208:211], v204 offset:4096
v_sub_f32 v142, v142, v211
mf v[156:159],a[244:247],a[180:183],v[156:159]
v_exp_f32 v196, v140
mf v[156:159],a[248:251],a[184:187],v[156:159]
ds_read_b128 a[212:215], v204 offset:5120
v_sub_f32 v143, v143, v211
mf v[156:159],a[252:255],a[188:191],v[156:159]
v_exp_f32 v197, v141
mf v[152:155],a[252:255],a[156:159],v[152:155]
ds_read_b128 a[216:219], v204 offset:6144
v_sub_f32 v136, v136, v210
mf v[152:155],a[248:251],a[152:155],v[152:155]
v_exp_f32 v198, v142
mf v[152:155],a[244:247],a[148:151],v[152:155]
ds_read_b128 a[220:223], v204 offset:7168
s_waitcnt lgkmcnt(4)
mf v[152:155],a[240:243],a[144:147],v[152:155]
v_exp_f32 v199, v143
s_barrier
v_sub_f32 v176, 0, v210
v_sub_f32 v177, 0, v210
v_sub_f32 v178, 0, v210
v_sub_f32 v179, 0, v210
v_sub_f32 v180, 0, v211
v_sub_f32 v181, 0, v211
v_sub_f32 v182, 0, v211
v_sub_f32 v183, 0, v211
v_sub_f32 v137, v137, v210
s_mov_b32 s33, s32
s_add_u32 s32, s32, 32768
s_cmp_eq_u32 s32, s4
s_cselect_b32 s32, s34, s32
s_add_u32 m0, s41, 0
s_nop 0
buffer_load_dwordx4 v206, s[20:23], s32 offen offset:0 sc1 lds
v_sub_f32 v138, v138, v210
v_sub_f32 v139, v139, v210
v_sub_f32 v148, v148, v211
v_sub_f32 v149, v149, v211
v_sub_f32 v150, v150, v211
v_sub_f32 v151, v151, v211
v_sub_f32 v144, v144, v210
v_sub_f32 v145, v145, v210
v_sub_f32 v146, v146, v210
s_add_u32 s43, s32, 16384
buffer_load_dwordx4 v206, s[20:23], s32 offen offset:1024 sc1 lds
v_sub_f32 v147, v147, v210
v_sub_f32 v156, v156, v211
v_sub_f32 v157, v157, v211
v_sub_f32 v158, v158, v211
v_sub_f32 v159, v159, v211
v_sub_f32 v152, v152, v210
v_sub_f32 v153, v153, v210
v_sub_f32 v154, v154, v210
v_sub_f32 v155, v155, v210
buffer_load_dwordx4 v206, s[20:23], s32 offen offset:2048 sc1 lds
v_exp_f32 v192, v136
v_exp_f32 v193, v137
v_exp_f32 v194, v138
v_exp_f32 v195, v139
v_exp_f32 v228, v148
v_exp_f32 v229, v149
v_exp_f32 v230, v150
v_exp_f32 v231, v151
v_exp_f32 v224, v144
buffer_load_dwordx4 v206, s[20:23], s32 offen offset:3072 sc1 lds
v_exp_f32 v225, v145
v_exp_f32 v226, v146
v_exp_f32 v227, v147
v_exp_f32 v236, v156
v_exp_f32 v237, v157
v_exp_f32 v238, v158
v_exp_f32 v239, v159
v_exp_f32 v232, v152
v_exp_f32 v233, v153
s_add_u32 m0, s41, 16384
s_nop 0
buffer_load_dwordx4 v206, s[20:23], s43 offen offset:0 sc1 lds
v_exp_f32 v234, v154
v_exp_f32 v235, v155
s_nop 0
v_add_f32 v201, v188, v189
v_add_f32 v201, v201, v190
v_add_f32 v201, v201, v191
v_add_f32 v200, v184, v185
v_add_f32 v200, v200, v186
v_add_f32 v200, v200, v187
s_xor_b32 s41, s41, 0x38000
buffer_load_dwordx4 v206, s[20:23], s43 offen offset:1024 sc1 lds
v_add_f32 v201, v201, v196
v_add_f32 v201, v201, v197
v_add_f32 v201, v201, v198
v_add_f32 v201, v201, v199
v_add_f32 v200, v200, v192
v_add_f32 v200, v200, v193
v_add_f32 v200, v200, v194
v_add_f32 v200, v200, v195
v_add_f32 v201, v201, v228
buffer_load_dwordx4 v206, s[20:23], s43 offen offset:2048 sc1 lds
v_add_f32 v201, v201, v229
v_add_f32 v201, v201, v230
v_add_f32 v201, v201, v231
v_add_f32 v200, v200, v224
v_add_f32 v200, v200, v225
v_add_f32 v200, v200, v226
v_add_f32 v200, v200, v227
v_add_f32 v201, v201, v236
v_add_f32 v201, v201, v237
buffer_load_dwordx4 v206, s[20:23], s43 offen offset:3072 sc1 lds
v_add_f32 v201, v201, v238
v_add_f32 v201, v201, v239
v_add_f32 v200, v200, v232
v_add_f32 v200, v200, v233
v_add_f32 v200, v200, v234
v_add_f32 v200, v200, v235
v_max_f32 v210, v200, v201
v_cmp_nge_f32 vcc, s39, v210
s_cbranch_vccnz slow_45
back_46:
stj_44:
s_cmp_eq_u32 s36, 0
s_cbranch_scc1 lmend_42
lm_41:
s_barrier
mf v[128:131],a[192:195],a[128:131],v[176:179]
ds_read_b128 a[224:227], v204 offset:8192
mf v[128:131],a[196:199],a[132:135],v[128:131]
buffer_store_dwordx4 v[246:249], v206, s[92:95], s91 offen sc1
mf v[128:131],a[200:203],a[136:139],v[128:131]
ds_read_b128 a[228:231], v204 offset:9216
s_add_u32 s43, s33, 16384
mf v[128:131],a[204:207],a[140:143],v[128:131]
v_add_f32 v202, v202, v200
v_add_f32 v203, v203, v201
mf v[132:135],a[204:207],a[172:175],v[180:183]
ds_read_b128 a[232:235], v204 offset:10240
s_add_u32 m0, s40, 0
mf v[132:135],a[200:203],a[168:171],v[132:135]
buffer_load_dwordx4 v206, s[24:27], s33 offen offset:0 sc1 lds
mf v[132:135],a[196:199],a[164:167],v[132:135]
ds_read_b128 a[236:239], v204 offset:11264
s_waitcnt lgkmcnt(4)
mf v[132:135],a[192:195],a[160:163],v[132:135]
v_cvt_pk_bf16_f32 v160, v184, v185
v_cvt_pk_bf16_f32 v161, v186, v187
mf v[132:135],a[208:211],a[176:179],v[132:135]
ds_read_b128 a[240:243], v204 offset:12288
s_add_u32 s91, s91, 1024
mf v[132:135],a[212:215],a[180:183],v[132:135]
v_cvt_pk_bf16_f32 v164, v188, v189
v_cvt_pk_bf16_f32 v165, v190, v191
mf v[132:135],a[216:219],a[184:187],v[132:135]
ds_read_b128 a[244:247], v204 offset:13312
v_cvt_pk_bf16_f32 v162, v192, v193
mf v[132:135],a[220:223],a[188:191],v[132:135]
buffer_load_dwordx4 v206, s[24:27], s33 offen offset:1024 sc1 lds
mf v[128:131],a[220:223],a[156:159],v[128:131]
ds_read_b128 a[248:251], v204 offset:14336
v_cvt_pk_bf16_f32 v163, v194, v195
mf v[128:131],a[216:219],a[152:155],v[128:131]
v_cvt_pk_bf16_f32 v166, v196, v197
v_cvt_pk_bf16_f32 v167, v198, v199
mf v[128:131],a[212:215],a[148:151],v[128:131]
ds_read_b128 a[252:255], v204 offset:15360
s_waitcnt lgkmcnt(4)
mf v[128:131],a[208:211],a[144:147],v[128:131]
v_cvt_pk_bf16_f32 v168, v224, v225
v_cvt_pk_bf16_f32 v169, v226, v227
mf v[136:139],a[224:227],a[128:131],v[176:179]
ds_read_b128 a[192:195], v204 offset:16384
v_cvt_pk_bf16_f32 v172, v228, v229
mf v[136:139],a[228:231],a[132:135],v[136:139]
buffer_load_dwordx4 v206, s[24:27], s33 offen offset:2048 sc1 lds
mf v[136:139],a[232:235],a[136:139],v[136:139]
ds_read_b128 a[196:199], v204 offset:17408
v_cvt_pk_bf16_f32 v173, v230, v231
mf v[136:139],a[236:239],a[140:143],v[136:139]
v_exp_f32 v188, v132
mf v[140:143],a[236:239],a[172:175],v[180:183]
ds_read_b128 a[200:203], v204 offset:18432
v_cvt_pk_bf16_f32 v170, v232, v233
mf v[140:143],a[232:235],a[168:171],v[140:143]
v_exp_f32 v189, v133
mf v[140:143],a[228:231],a[164:167],v[140:143]
ds_read_b128 a[204:207], v204 offset:19456
s_waitcnt lgkmcnt(4)
mf v[140:143],a[224:227],a[160:163],v[140:143]
buffer_load_dwordx4 v206, s[24:27], s33 offen offset:3072 sc1 lds
mf v[140:143],a[240:243],a[176:179],v[140:143]
ds_read_b128 a[208:211], v204 offset:20480
v_cvt_pk_bf16_f32 v171, v234, v235
mf v[140:143],a[244:247],a[180:183],v[140:143]
v_exp_f32 v190, v134
mf v[140:143],a[248:251],a[184:187],v[140:143]
ds_read_b128 a[212:215], v204 offset:21504
v_cvt_pk_bf16_f32 v174, v236, v237
mf v[140:143],a[252:255],a[188:191],v[140:143]
v_exp_f32 v191, v135
mf v[136:139],a[252:255],a[156:159],v[136:139]
ds_read_b128 a[216:219], v204 offset:22528
s_add_u32 m0, s40, 16384
mf v[136:139],a[248:251],a[152:155],v[136:139]
buffer_load_dwordx4 v206, s[24:27], s43 offen offset:0 sc1 lds
mf v[136:139],a[244:247],a[148:151],v[136:139]
ds_read_b128 a[220:223], v204 offset:23552
s_waitcnt lgkmcnt(4)
mf v[136:139],a[240:243],a[144:147],v[136:139]
v_exp_f32 v184, v128
mf v[144:147],a[192:195],a[128:131],v[176:179]
ds_read_b128 a[224:227], v204 offset:24576
v_cvt_pk_bf16_f32 v175, v238, v239
mf v[144:147],a[196:199],a[132:135],v[144:147]
v_exp_f32 v185, v129
mf v[144:147],a[200:203],a[136:139],v[144:147]
ds_read_b128 a[228:231], v204 offset:25600
s_xor_b32 s40, s40, 0x8000
mf v[144:147],a[204:207],a[140:143],v[144:147]
buffer_load_dwordx4 v206, s[24:27], s43 offen offset:1024 sc1 lds
mf v[148:151],a[204:207],a[172:175],v[180:183]
ds_read_b128 a[232:235], v204 offset:26624
v_add_f32 v201, v188, v189
mf v[148:151],a[200:203],a[168:171],v[148:151]
v_exp_f32 v186, v130
mf v[148:151],a[196:199],a[164:167],v[148:151]
ds_read_b128 a[236:239], v204 offset:27648
s_waitcnt lgkmcnt(4)
mf v[148:151],a[192:195],a[160:163],v[148:151]
v_exp_f32 v187, v131
mf v[148:151],a[208:211],a[176:179],v[148:151]
ds_read_b128 a[240:243], v204 offset:28672
v_add_f32 v201, v201, v190
mf v[148:151],a[212:215],a[180:183],v[148:151]
buffer_load_dwordx4 v206, s[24:27], s43 offen offset:2048 sc1 lds
mf v[148:151],a[216:219],a[184:187],v[148:151]
ds_read_b128 a[244:247], v204 offset:29696
v_add_f32 v201, v201, v191
mf v[148:151],a[220:223],a[188:191],v[148:151]
v_exp_f32 v196, v140
mf v[144:147],a[220:223],a[156:159],v[144:147]
ds_read_b128 a[248:251], v204 offset:30720
v_add_f32 v200, v184, v185
mf v[144:147],a[216:219],a[152:155],v[144:147]
v_exp_f32 v197, v141
mf v[144:147],a[212:215],a[148:151],v[144:147]
ds_read_b128 a[252:255], v204 offset:31744
s_waitcnt lgkmcnt(4)
mf v[144:147],a[208:211],a[144:147],v[144:147]
buffer_load_dwordx4 v206, s[24:27], s43 offen offset:3072 sc1 lds
mf v[152:155],a[224:227],a[128:131],v[176:179]
v_xor_b32 v204, 0x38000, v204
ds_read_b128 a[192:195], v205 offset:0
mf v[152:155],a[228:231],a[132:135],v[152:155]
v_exp_f32 v198, v142
mf v[152:155],a[232:235],a[136:139],v[152:155]
ds_read_b128 a[196:199], v205 offset:16384
s_mov_b32 s33, s32
mf v[152:155],a[236:239],a[140:143],v[152:155]
v_exp_f32 v199, v143
mf v[156:159],a[236:239],a[172:175],v[180:183]
ds_read_b128 a[200:203], v205 offset:1024
s_add_u32 s32, s32, 32768
mf v[156:159],a[232:235],a[168:171],v[156:159]
v_exp_f32 v192, v136
mf v[156:159],a[228:231],a[164:167],v[156:159]
ds_read_b128 a[204:207], v205 offset:17408
s_waitcnt lgkmcnt(4)
mf v[156:159],a[224:227],a[160:163],v[156:159]
v_exp_f32 v193, v137
mf v[156:159],a[240:243],a[176:179],v[156:159]
ds_read_b128 a[208:211], v205 offset:2048
s_cmp_eq_u32 s32, s4
mf v[156:159],a[244:247],a[180:183],v[156:159]
v_exp_f32 v194, v138
mf v[156:159],a[248:251],a[184:187],v[156:159]
ds_read_b128 a[212:215], v205 offset:18432
s_cselect_b32 s32, s34, s32
mf v[156:159],a[252:255],a[188:191],v[156:159]
v_exp_f32 v195, v139
mf v[152:155],a[252:255],a[156:159],v[152:155]
ds_read_b128 a[216:219], v205 offset:3072
v_add_f32 v200, v200, v186
mf v[152:155],a[248:251],a[152:155],v[152:155]
v_exp_f32 v228, v148
mf v[152:155],a[244:247],a[148:151],v[152:155]
ds_read_b128 a[220:223], v205 offset:19456
s_waitcnt lgkmcnt(4)
mf v[152:155],a[240:243],a[144:147],v[152:155]
s_waitcnt vmcnt(9)
v_add_f32 v200, v200, v187
s_barrier
mf v[0:3],a[192:195],v[160:163],v[0:3]
ds_read_b128 a[224:227], v205 offset:4096
v_add_f32 v201, v201, v196
mf v[0:3],a[196:199],v[168:171],v[0:3]
v_exp_f32 v229, v149
mf v[64:67],a[196:199],v[172:175],v[64:67]
ds_read_b128 a[228:231], v205 offset:20480
v_add_f32 v201, v201, v197
mf v[64:67],a[192:195],v[164:167],v[64:67]
v_exp_f32 v230, v150
mf v[68:71],a[200:203],v[164:167],v[68:71]
ds_read_b128 a[232:235], v205 offset:5120
s_add_u32 m0, s41, 0
mf v[68:71],a[204:207],v[172:175],v[68:71]
buffer_load_dwordx4 v206, s[20:23], s32 offen offset:0 sc1 lds
mf v[4:7],a[204:207],v[168:171],v[4:7]
ds_read_b128 a[236:239], v205 offset:21504
s_waitcnt lgkmcnt(4)
mf v[4:7],a[200:203],v[160:163],v[4:7]
v_exp_f32 v231, v151
mf v[8:11],a[208:211],v[160:163],v[8:11]
ds_read_b128 a[240:243], v205 offset:6144
v_add_f32 v201, v201, v198
mf v[8:11],a[212:215],v[168:171],v[8:11]
v_exp_f32 v224, v144
mf v[72:75],a[212:215],v[172:175],v[72:75]
ds_read_b128 a[244:247], v205 offset:22528
s_add_u32 s43, s32, 16384
mf v[72:75],a[208:211],v[164:167],v[72:75]
buffer_load_dwordx4 v206, s[20:23], s32 offen offset:1024 sc1 lds
mf v[76:79],a[216:219],v[164:167],v[76:79]
ds_read_b128 a[248:251], v205 offset:7168
v_add_f32 v201, v201, v199
mf v[76:79],a[220:223],v[172:175],v[76:79]
v_exp_f32 v225, v145
mf v[12:15],a[220:223],v[168:171],v[12:15]
ds_read_b128 a[252:255], v205 offset:23552
s_waitcnt lgkmcnt(4)
mf v[12:15],a[216:219],v[160:163],v[12:15]
v_exp_f32 v226, v146
mf v[16:19],a[224:227],v[160:163],v[16:19]
ds_read_b128 a[192:195], v205 offset:8192
v_add_f32 v200, v200, v192
mf v[16:19],a[228:231],v[168:171],v[16:19]
buffer_load_dwordx4 v206, s[20:23], s32 offen offset:2048 sc1 lds
mf v[80:83],a[228:231],v[172:175],v[80:83]
ds_read_b128 a[196:199], v205 offset:24576
v_add_f32 v200, v200, v193
mf v[80:83],a[224:227],v[164:167],v[80:83]
v_exp_f32 v227, v147
mf v[84:87],a[232:235],v[164:167],v[84:87]
ds_read_b128 a[200:203], v205 offset:9216
v_add_f32 v200, v200, v194
mf v[84:87],a[236:239],v[172:175],v[84:87]
v_exp_f32 v236, v156
mf v[20:23],a[236:239],v[168:171],v[20:23]
ds_read_b128 a[204:207], v205 offset:25600
s_waitcnt lgkmcnt(4)
mf v[20:23],a[232:235],v[160:163],v[20:23]
buffer_load_dwordx4 v206, s[20:23], s32 offen offset:3072 sc1 lds
mf v[24:27],a[240:243],v[160:163],v[24:27]
ds_read_b128 a[208:211], v205 offset:10240
v_add_f32 v200, v200, v195
mf v[24:27],a[244:247],v[168:171],v[24:27]
v_exp_f32 v237, v157
mf v[88:91],a[244:247],v[172:175],v[88:91]
ds_read_b128 a[212:215], v205 offset:26624
v_add_f32 v201, v201, v228
mf v[88:91],a[240:243],v[164:167],v[88:91]
v_exp_f32 v238, v158
mf v[92:95],a[248:251],v[164:167],v[92:95]
ds_read_b128 a[216:219], v205 offset:11264
s_add_u32 m0, s41, 16384
mf v[92:95],a[252:255],v[172:175],v[92:95]
buffer_load_dwordx4 v206, s[20:23], s43 offen offset:0 sc1 lds
mf v[28:31],a[252:255],v[168:171],v[28:31]
ds_read_b128 a[220:223], v205 offset:27648
s_waitcnt lgkmcnt(4)
mf v[28:31],a[248:251],v[160:163],v[28:31]
v_exp_f32 v239, v159
mf v[32:35],a[192:195],v[160:163],v[32:35]
ds_read_b128 a[224:227], v205 offset:12288
v_add_f32 v201, v201, v229
mf v[32:35],a[196:199],v[168:171],v[32:35]
v_exp_f32 v232, v152
mf v[96:99],a[196:199],v[172:175],v[96:99]
ds_read_b128 a[228:231], v205 offset:28672
s_xor_b32 s41, s41, 0x38000
mf v[96:99],a[192:195],v[164:167],v[96:99]
buffer_load_dwordx4 v206, s[20:23], s43 offen offset:1024 sc1 lds
mf v[100:103],a[200:203],v[164:167],v[100:103]
ds_read_b128 a[232:235], v205 offset:13312
v_add_f32 v201, v201, v230
mf v[100:103],a[204:207],v[172:175],v[100:103]
v_exp_f32 v233, v153
mf v[36:39],a[204:207],v[168:171],v[36:39]
ds_read_b128 a[236:239], v205 offset:29696
s_waitcnt lgkmcnt(4)
mf v[36:39],a[200:203],v[160:163],v[36:39]
v_exp_f32 v234, v154
mf v[40:43],a[208:211],v[160:163],v[40:43]
ds_read_b128 a[240:243], v205 offset:14336
v_add_f32 v201, v201, v231
mf v[40:43],a[212:215],v[168:171],v[40:43]
buffer_load_dwordx4 v206, s[20:23], s43 offen offset:2048 sc1 lds
mf v[104:107],a[212:215],v[172:175],v[104:107]
ds_read_b128 a[244:247], v205 offset:30720
v_add_f32 v200, v200, v224
mf v[104:107],a[208:211],v[164:167],v[104:107]
v_exp_f32 v235, v155
mf v[108:111],a[216:219],v[164:167],v[108:111]
ds_read_b128 a[248:251], v205 offset:15360
v_add_f32 v200, v200, v225
mf v[108:111],a[220:223],v[172:175],v[108:111]
v_add_f32 v200, v200, v226
v_add_f32 v200, v200, v227
mf v[44:47],a[220:223],v[168:171],v[44:47]
ds_read_b128 a[252:255], v205 offset:31744
s_waitcnt lgkmcnt(4)
mf v[44:47],a[216:219],v[160:163],v[44:47]
buffer_load_dwordx4 v206, s[20:23], s43 offen offset:3072 sc1 lds
mf v[48:51],a[224:227],v[160:163],v[48:51]
v_xor_b32 v205, 0x8000, v205
ds_read_b128 a[192:195], v204 offset:0
mf v[48:51],a[228:231],v[168:171],v[48:51]
v_add_f32 v201, v201, v236
v_add_f32 v201, v201, v237
mf v[112:115],a[228:231],v[172:175],v[112:115]
ds_read_b128 a[196:199], v204 offset:1024
v_add_f32 v201, v201, v238
mf v[112:115],a[224:227],v[164:167],v[112:115]
v_add_f32 v201, v201, v239
v_add_f32 v200, v200, v232
mf v[116:119],a[232:235],v[164:167],v[116:119]
ds_read_b128 a[200:203], v204 offset:2048
v_add_f32 v200, v200, v233
mf v[116:119],a[236:239],v[172:175],v[116:119]
v_add_f32 v200, v200, v234
v_add_f32 v200, v200, v235
mf v[52:55],a[236:239],v[168:171],v[52:55]
ds_read_b128 a[204:207], v204 offset:3072
s_waitcnt lgkmcnt(4)
mf v[52:55],a[232:235],v[160:163],v[52:55]
v_max_f32 v210, v200, v201
v_cmp_nge_f32 vcc, s39, v210
mf v[56:59],a[240:243],v[160:163],v[56:59]
ds_read_b128 a[208:211], v204 offset:4096
mf v[56:59],a[244:247],v[168:171],v[56:59]
mf v[120:123],a[244:247],v[172:175],v[120:123]
ds_read_b128 a[212:215], v204 offset:5120
mf v[120:123],a[240:243],v[164:167],v[120:123]
mf v[124:127],a[248:251],v[164:167],v[124:127]
ds_read_b128 a[216:219], v204 offset:6144
mf v[124:127],a[252:255],v[172:175],v[124:127]
s_sub_u32 s36, s36, 1
s_cmp_lg_u32 s36, 0
mf v[60:63],a[252:255],v[168:171],v[60:63]
ds_read_b128 a[220:223], v204 offset:7168
s_waitcnt lgkmcnt(4)
mf v[60:63],a[248:251],v[160:163],v[60:63]
s_waitcnt vmcnt(8)
s_cbranch_vccnz slow_47
back_48:
s_cbranch_scc1 lm_41
s_add_u32 s38, s38, 1
s_cmp_eq_u32 s38, 2
s_cbranch_scc1 c2_49
s_cmp_eq_u32 s38, 3
s_cbranch_scc1 c3_50
s_cmp_eq_u32 s35, 0
s_cbranch_scc1 nopub_52
s_cmp_lg_u32 s16, 0
s_cbranch_scc1 nofl_53
v_mov_b32 v210, s35
v_mov_b32 v211, 0
s_mov_b64 exec, 1
buffer_store_dword v210, v211, s[28:31], s3 offen sc1
s_mov_b64 exec, -1
nofl_53:
s_mov_b32 s35, 0
nopub_52:
s_min_u32 s36, s19, 5
s_branch cj_51
c2_49:
buffer_load_dword v254, v252, s[28:31], 0 offen sc1
s_min_u32 s36, s19, 1
s_branch cj_51
c3_50:
s_waitcnt vmcnt(17)
s_mov_b64 exec, 0xffff
v_cmp_gt_u32 vcc, v253, v254
s_mov_b64 exec, -1
s_cbranch_vccz chk_54
s_mov_b32 s17, 0x80000
s_mov_b64 exec, 0xffff
poll_55:
buffer_load_dword v254, v252, s[28:31], 0 offen sc1
s_waitcnt vmcnt(0)
v_cmp_gt_u32 vcc, v253, v254
s_cbranch_vccz pollok_56
s_sleep 2
s_sub_u32 s17, s17, 1
s_cmp_lg_u32 s17, 0
s_cbranch_scc1 poll_55
pollok_56:
s_mov_b64 exec, -1
chk_54:
s_mov_b32 s36, s19
cj_51:
s_and_b32 s17, s42, 15
s_lshl_b32 s17, s17, 2
s_add_u32 s17, s17, s16
s_mul_i32 s17, s17, 2560
v_mul_u32_u24 v209, 40, v255
v_add_u32 v209, s17, v209
v_min_u32 v209, code_end-go-4, v209
global_load_dword v223, v209, s[100:101]
s_sub_u32 s19, s19, s36
s_cmp_lg_u32 s36, 0
s_cbranch_scc1 lm_41
lmend_42:
s_cmp_eq_u32 s35, 0
s_cbranch_scc1 nopub_57
s_waitcnt vmcnt(8)
s_barrier
s_cmp_lg_u32 s16, 0
s_cbranch_scc1 nofl_58
v_mov_b32 v210, s35
v_mov_b32 v211, 0
s_mov_b64 exec, 1
buffer_store_dword v210, v211, s[28:31], s3 offen sc1
s_mov_b64 exec, -1
nofl_58:
s_mov_b32 s35, 0
nopub_57:
s_cmp_lg_u32 s11, 0
s_cbranch_scc1 fin_59
s_barrier
ds_read_b128 a[192:195], v205 offset:0
ds_read_b128 a[196:199], v205 offset:16384
ds_read_b128 a[200:203], v205 offset:1024
ds_read_b128 a[204:207], v205 offset:17408
ds_read_b128 a[208:211], v205 offset:2048
ds_read_b128 a[212:215], v205 offset:18432
ds_read_b128 a[216:219], v205 offset:3072
ds_read_b128 a[220:223], v205 offset:19456
v_add_f32 v202, v202, v200
v_add_f32 v203, v203, v201
v_cvt_pk_bf16_f32 v160, v184, v185
v_cvt_pk_bf16_f32 v161, v186, v187
v_cvt_pk_bf16_f32 v164, v188, v189
v_cvt_pk_bf16_f32 v165, v190, v191
v_cvt_pk_bf16_f32 v162, v192, v193
v_cvt_pk_bf16_f32 v163, v194, v195
v_cvt_pk_bf16_f32 v166, v196, v197
v_cvt_pk_bf16_f32 v167, v198, v199
v_cvt_pk_bf16_f32 v168, v224, v225
v_cvt_pk_bf16_f32 v169, v226, v227
v_cvt_pk_bf16_f32 v172, v228, v229
v_cvt_pk_bf16_f32 v173, v230, v231
v_cvt_pk_bf16_f32 v170, v232, v233
v_cvt_pk_bf16_f32 v171, v234, v235
v_cvt_pk_bf16_f32 v174, v236, v237
v_cvt_pk_bf16_f32 v175, v238, v239
s_waitcnt lgkmcnt(4)
mf v[0:3],a[192:195],v[160:163],v[0:3]
ds_read_b128 a[224:227], v205 offset:4096
v_accvgpr_mov_b32 a128, a0
mf v[0:3],a[196:199],v[168:171],v[0:3]
v_accvgpr_mov_b32 a129, a1
v_accvgpr_mov_b32 a130, a2
mf v[64:67],a[196:199],v[172:175],v[64:67]
ds_read_b128 a[228:231], v205 offset:20480
v_accvgpr_mov_b32 a131, a3
mf v[64:67],a[192:195],v[164:167],v[64:67]
s_add_u32 s43, s33, 16384
mf v[68:71],a[200:203],v[164:167],v[68:71]
ds_read_b128 a[232:235], v205 offset:5120
s_add_u32 m0, s40, 0
mf v[68:71],a[204:207],v[172:175],v[68:71]
s_nop 0
buffer_load_dwordx4 v206, s[24:27], s33 offen offset:0 sc1 lds
mf v[4:7],a[204:207],v[168:171],v[4:7]
ds_read_b128 a[236:239], v205 offset:21504
s_waitcnt lgkmcnt(4)
mf v[4:7],a[200:203],v[160:163],v[4:7]
v_accvgpr_mov_b32 a132, a4
v_accvgpr_mov_b32 a133, a5
mf v[8:11],a[208:211],v[160:163],v[8:11]
ds_read_b128 a[240:243], v205 offset:6144
v_accvgpr_mov_b32 a134, a6
mf v[8:11],a[212:215],v[168:171],v[8:11]
v_accvgpr_mov_b32 a135, a7
buffer_load_dwordx4 v206, s[24:27], s33 offen offset:1024 sc1 lds
mf v[72:75],a[212:215],v[172:175],v[72:75]
ds_read_b128 a[244:247], v205 offset:22528
v_accvgpr_mov_b32 a136, a8
mf v[72:75],a[208:211],v[164:167],v[72:75]
v_accvgpr_mov_b32 a137, a9
mf v[76:79],a[216:219],v[164:167],v[76:79]
ds_read_b128 a[248:251], v205 offset:7168
v_accvgpr_mov_b32 a138, a10
mf v[76:79],a[220:223],v[172:175],v[76:79]
buffer_load_dwordx4 v206, s[24:27], s33 offen offset:2048 sc1 lds
v_accvgpr_mov_b32 a139, a11
mf v[12:15],a[220:223],v[168:171],v[12:15]
ds_read_b128 a[252:255], v205 offset:23552
s_waitcnt lgkmcnt(4)
mf v[12:15],a[216:219],v[160:163],v[12:15]
v_accvgpr_mov_b32 a140, a12
v_accvgpr_mov_b32 a141, a13
mf v[16:19],a[224:227],v[160:163],v[16:19]
ds_read_b128 a[192:195], v205 offset:8192
v_accvgpr_mov_b32 a142, a14
mf v[16:19],a[228:231],v[168:171],v[16:19]
buffer_load_dwordx4 v206, s[24:27], s33 offen offset:3072 sc1 lds
mf v[80:83],a[228:231],v[172:175],v[80:83]
ds_read_b128 a[196:199], v205 offset:24576
v_accvgpr_mov_b32 a143, a15
mf v[80:83],a[224:227],v[164:167],v[80:83]
v_accvgpr_mov_b32 a144, a16
v_accvgpr_mov_b32 a145, a17
mf v[84:87],a[232:235],v[164:167],v[84:87]
ds_read_b128 a[200:203], v205 offset:9216
s_add_u32 m0, s40, 16384
mf v[84:87],a[236:239],v[172:175],v[84:87]
s_nop 0
mf v[20:23],a[236:239],v[168:171],v[20:23]
ds_read_b128 a[204:207], v205 offset:25600
s_waitcnt lgkmcnt(4)
mf v[20:23],a[232:235],v[160:163],v[20:23]
buffer_load_dwordx4 v206, s[24:27], s43 offen offset:0 sc1 lds
v_accvgpr_mov_b32 a146, a18
mf v[24:27],a[240:243],v[160:163],v[24:27]
ds_read_b128 a[208:211], v205 offset:10240
v_accvgpr_mov_b32 a147, a19
mf v[24:27],a[244:247],v[168:171],v[24:27]
v_accvgpr_mov_b32 a148, a20
v_accvgpr_mov_b32 a149, a21
mf v[88:91],a[244:247],v[172:175],v[88:91]
ds_read_b128 a[212:215], v205 offset:26624
s_xor_b32 s40, s40, 0x8000
mf v[88:91],a[240:243],v[164:167],v[88:91]
buffer_load_dwordx4 v206, s[24:27], s43 offen offset:1024 sc1 lds
v_accvgpr_mov_b32 a150, a22
mf v[92:95],a[248:251],v[164:167],v[92:95]
ds_read_b128 a[216:219], v205 offset:11264
v_accvgpr_mov_b32 a151, a23
mf v[92:95],a[252:255],v[172:175],v[92:95]
v_accvgpr_mov_b32 a152, a24
mf v[28:31],a[252:255],v[168:171],v[28:31]
ds_read_b128 a[220:223], v205 offset:27648
s_waitcnt lgkmcnt(4)
mf v[28:31],a[248:251],v[160:163],v[28:31]
buffer_load_dwordx4 v206, s[24:27], s43 offen offset:2048 sc1 lds
v_accvgpr_mov_b32 a153, a25
mf v[32:35],a[192:195],v[160:163],v[32:35]
ds_read_b128 a[224:227], v205 offset:12288
v_accvgpr_mov_b32 a154, a26
mf v[32:35],a[196:199],v[168:171],v[32:35]
v_accvgpr_mov_b32 a155, a27
v_accvgpr_mov_b32 a156, a28
mf v[96:99],a[196:199],v[172:175],v[96:99]
ds_read_b128 a[228:231], v205 offset:28672
buffer_load_dwordx4 v206, s[24:27], s43 offen offset:3072 sc1 lds
mf v[96:99],a[192:195],v[164:167],v[96:99]
v_accvgpr_mov_b32 a157, a29
mf v[100:103],a[200:203],v[164:167],v[100:103]
ds_read_b128 a[232:235], v205 offset:13312
v_accvgpr_mov_b32 a158, a30
mf v[100:103],a[204:207],v[172:175],v[100:103]
v_accvgpr_mov_b32 a159, a31
v_accvgpr_mov_b32 a160, a32
mf v[36:39],a[204:207],v[168:171],v[36:39]
ds_read_b128 a[236:239], v205 offset:29696
s_waitcnt lgkmcnt(4)
mf v[36:39],a[200:203],v[160:163],v[36:39]
v_accvgpr_mov_b32 a161, a33
v_accvgpr_mov_b32 a162, a34
mf v[40:43],a[208:211],v[160:163],v[40:43]
ds_read_b128 a[240:243], v205 offset:14336
v_accvgpr_mov_b32 a163, a35
mf v[40:43],a[212:215],v[168:171],v[40:43]
v_accvgpr_mov_b32 a164, a36
v_accvgpr_mov_b32 a165, a37
mf v[104:107],a[212:215],v[172:175],v[104:107]
ds_read_b128 a[244:247], v205 offset:30720
v_accvgpr_mov_b32 a166, a38
mf v[104:107],a[208:211],v[164:167],v[104:107]
v_accvgpr_mov_b32 a167, a39
mf v[108:111],a[216:219],v[164:167],v[108:111]
ds_read_b128 a[248:251], v205 offset:15360
v_accvgpr_mov_b32 a168, a40
mf v[108:111],a[220:223],v[172:175],v[108:111]
v_accvgpr_mov_b32 a169, a41
v_accvgpr_mov_b32 a170, a42
mf v[44:47],a[220:223],v[168:171],v[44:47]
ds_read_b128 a[252:255], v205 offset:31744
s_waitcnt lgkmcnt(4)
mf v[44:47],a[216:219],v[160:163],v[44:47]
v_accvgpr_mov_b32 a171, a43
v_accvgpr_mov_b32 a172, a44
mf v[48:51],a[224:227],v[160:163],v[48:51]
v_accvgpr_mov_b32 a173, a45
mf v[48:51],a[228:231],v[168:171],v[48:51]
v_accvgpr_mov_b32 a174, a46
mf v[112:115],a[228:231],v[172:175],v[112:115]
v_accvgpr_mov_b32 a175, a47
v_accvgpr_mov_b32 a176, a48
mf v[112:115],a[224:227],v[164:167],v[112:115]
v_accvgpr_mov_b32 a177, a49
mf v[116:119],a[232:235],v[164:167],v[116:119]
v_accvgpr_mov_b32 a178, a50
mf v[116:119],a[236:239],v[172:175],v[116:119]
v_accvgpr_mov_b32 a179, a51
mf v[52:55],a[236:239],v[168:171],v[52:55]
s_waitcnt lgkmcnt(0)
v_accvgpr_mov_b32 a180, a52
mf v[52:55],a[232:235],v[160:163],v[52:55]
v_accvgpr_mov_b32 a181, a53
v_accvgpr_mov_b32 a182, a54
mf v[56:59],a[240:243],v[160:163],v[56:59]
v_accvgpr_mov_b32 a183, a55
mf v[56:59],a[244:247],v[168:171],v[56:59]
v_accvgpr_mov_b32 a184, a56
mf v[120:123],a[244:247],v[172:175],v[120:123]
v_accvgpr_mov_b32 a185, a57
mf v[120:123],a[240:243],v[164:167],v[120:123]
v_accvgpr_mov_b32 a186, a58
v_accvgpr_mov_b32 a187, a59
mf v[124:127],a[248:251],v[164:167],v[124:127]
v_accvgpr_mov_b32 a188, a60
mf v[124:127],a[252:255],v[172:175],v[124:127]
v_accvgpr_mov_b32 a189, a61
mf v[60:63],a[252:255],v[168:171],v[60:63]
v_accvgpr_mov_b32 a190, a62
mf v[60:63],a[248:251],v[160:163],v[60:63]
v_accvgpr_mov_b32 a191, a63
v_xor_b32 v205, 0x8000, v205
v_mov_b32 v210, v202
v_mov_b32 v211, v203
s_nop 1
v_permlane16_swap_b32 v210, v202
v_permlane16_swap_b32 v211, v203
s_nop 1
v_add_f32 v202, v202, v210
v_add_f32 v203, v203, v211
v_mov_b32 v210, v202
v_mov_b32 v211, v203
s_nop 1
v_permlane32_swap_b32 v210, v202
v_permlane32_swap_b32 v211, v203
s_nop 1
v_add_f32 v202, v202, v210
v_add_f32 v203, v203, v211
s_mul_i32 s36, s5, 69632
s_mul_i32 s17, s16, 17408
s_add_u32 s36, s36, s17
s_add_u32 s36, s36, 83886080
v_mov_b32 v210, v176
v_mov_b32 v211, v180
v_mov_b32 v212, v202
v_mov_b32 v213, v203
s_waitcnt vmcnt(0)
s_barrier
v_cvt_pk_bf16_f32 v0, v0, v1
v_cvt_pk_bf16_f32 v1, v2, v3
v_cvt_pk_bf16_f32 v2, v4, v5
v_cvt_pk_bf16_f32 v3, v6, v7
buffer_store_dwordx4 v[0:3], v206, s[28:31], s36 offen offset:0 sc1
v_cvt_pk_bf16_f32 v4, v8, v9
v_cvt_pk_bf16_f32 v5, v10, v11
v_cvt_pk_bf16_f32 v6, v12, v13
v_cvt_pk_bf16_f32 v7, v14, v15
buffer_store_dwordx4 v[4:7], v206, s[28:31], s36 offen offset:1024 sc1
v_pk_mov_b32 v[0:1], 0, 0
v_pk_mov_b32 v[2:3], 0, 0
v_cvt_pk_bf16_f32 v8, v16, v17
v_cvt_pk_bf16_f32 v9, v18, v19
v_cvt_pk_bf16_f32 v10, v20, v21
v_cvt_pk_bf16_f32 v11, v22, v23
buffer_store_dwordx4 v[8:11], v206, s[28:31], s36 offen offset:2048 sc1
v_pk_mov_b32 v[4:5], 0, 0
v_pk_mov_b32 v[6:7], 0, 0
v_cvt_pk_bf16_f32 v12, v24, v25
v_cvt_pk_bf16_f32 v13, v26, v27
v_cvt_pk_bf16_f32 v14, v28, v29
v_cvt_pk_bf16_f32 v15, v30, v31
buffer_store_dwordx4 v[12:15], v206, s[28:31], s36 offen offset:3072 sc1
s_add_u32 s36, s36, 4096
v_pk_mov_b32 v[8:9], 0, 0
v_pk_mov_b32 v[10:11], 0, 0
v_cvt_pk_bf16_f32 v16, v32, v33
v_cvt_pk_bf16_f32 v17, v34, v35
v_cvt_pk_bf16_f32 v18, v36, v37
v_cvt_pk_bf16_f32 v19, v38, v39
buffer_store_dwordx4 v[16:19], v206, s[28:31], s36 offen offset:0 sc1
v_pk_mov_b32 v[12:13], 0, 0
v_pk_mov_b32 v[14:15], 0, 0
v_cvt_pk_bf16_f32 v20, v40, v41
v_cvt_pk_bf16_f32 v21, v42, v43
v_cvt_pk_bf16_f32 v22, v44, v45
v_cvt_pk_bf16_f32 v23, v46, v47
buffer_store_dwordx4 v[20:23], v206, s[28:31], s36 offen offset:1024 sc1
v_pk_mov_b32 v[16:17], 0, 0
v_pk_mov_b32 v[18:19], 0, 0
v_cvt_pk_bf16_f32 v24, v48, v49
v_cvt_pk_bf16_f32 v25, v50, v51
v_cvt_pk_bf16_f32 v26, v52, v53
v_cvt_pk_bf16_f32 v27, v54, v55
buffer_store_dwordx4 v[24:27], v206, s[28:31], s36 offen offset:2048 sc1
v_pk_mov_b32 v[20:21], 0, 0
v_pk_mov_b32 v[22:23], 0, 0
v_cvt_pk_bf16_f32 v28, v56, v57
v_cvt_pk_bf16_f32 v29, v58, v59
v_cvt_pk_bf16_f32 v30, v60, v61
v_cvt_pk_bf16_f32 v31, v62, v63
buffer_store_dwordx4 v[28:31], v206, s[28:31], s36 offen offset:3072 sc1
s_add_u32 s36, s36, 4096
v_pk_mov_b32 v[24:25], 0, 0
v_pk_mov_b32 v[26:27], 0, 0
v_cvt_pk_bf16_f32 v32, v64, v65
v_cvt_pk_bf16_f32 v33, v66, v67
v_cvt_pk_bf16_f32 v34, v68, v69
v_cvt_pk_bf16_f32 v35, v70, v71
buffer_store_dwordx4 v[32:35], v206, s[28:31], s36 offen offset:0 sc1
v_pk_mov_b32 v[64:65], 0, 0
v_pk_mov_b32 v[66:67], 0, 0
v_pk_mov_b32 v[68:69], 0, 0
v_pk_mov_b32 v[70:71], 0, 0
v_pk_mov_b32 v[28:29], 0, 0
v_pk_mov_b32 v[30:31], 0, 0
v_cvt_pk_bf16_f32 v36, v72, v73
v_cvt_pk_bf16_f32 v37, v74, v75
v_cvt_pk_bf16_f32 v38, v76, v77
v_cvt_pk_bf16_f32 v39, v78, v79
buffer_store_dwordx4 v[36:39], v206, s[28:31], s36 offen offset:1024 sc1
v_pk_mov_b32 v[72:73], 0, 0
v_pk_mov_b32 v[74:75], 0, 0
v_pk_mov_b32 v[76:77], 0, 0
v_pk_mov_b32 v[78:79], 0, 0
v_pk_mov_b32 v[32:33], 0, 0
v_pk_mov_b32 v[34:35], 0, 0
v_cvt_pk_bf16_f32 v40, v80, v81
v_cvt_pk_bf16_f32 v41, v82, v83
v_cvt_pk_bf16_f32 v42, v84, v85
v_cvt_pk_bf16_f32 v43, v86, v87
buffer_store_dwordx4 v[40:43], v206, s[28:31], s36 offen offset:2048 sc1
v_pk_mov_b32 v[80:81], 0, 0
v_pk_mov_b32 v[82:83], 0, 0
v_pk_mov_b32 v[84:85], 0, 0
v_pk_mov_b32 v[86:87], 0, 0
v_pk_mov_b32 v[36:37], 0, 0
v_pk_mov_b32 v[38:39], 0, 0
v_cvt_pk_bf16_f32 v44, v88, v89
v_cvt_pk_bf16_f32 v45, v90, v91
v_cvt_pk_bf16_f32 v46, v92, v93
v_cvt_pk_bf16_f32 v47, v94, v95
buffer_store_dwordx4 v[44:47], v206, s[28:31], s36 offen offset:3072 sc1
s_add_u32 s36, s36, 4096
v_pk_mov_b32 v[88:89], 0, 0
v_pk_mov_b32 v[90:91], 0, 0
v_pk_mov_b32 v[92:93], 0, 0
v_pk_mov_b32 v[94:95], 0, 0
v_pk_mov_b32 v[40:41], 0, 0
v_pk_mov_b32 v[42:43], 0, 0
v_cvt_pk_bf16_f32 v48, v96, v97
v_cvt_pk_bf16_f32 v49, v98, v99
v_cvt_pk_bf16_f32 v50, v100, v101
v_cvt_pk_bf16_f32 v51, v102, v103
buffer_store_dwordx4 v[48:51], v206, s[28:31], s36 offen offset:0 sc1
v_pk_mov_b32 v[96:97], 0, 0
v_pk_mov_b32 v[98:99], 0, 0
v_pk_mov_b32 v[100:101], 0, 0
v_pk_mov_b32 v[102:103], 0, 0
v_pk_mov_b32 v[44:45], 0, 0
v_pk_mov_b32 v[46:47], 0, 0
v_cvt_pk_bf16_f32 v52, v104, v105
v_cvt_pk_bf16_f32 v53, v106, v107
v_cvt_pk_bf16_f32 v54, v108, v109
v_cvt_pk_bf16_f32 v55, v110, v111
buffer_store_dwordx4 v[52:55], v206, s[28:31], s36 offen offset:1024 sc1
v_pk_mov_b32 v[104:105], 0, 0
v_pk_mov_b32 v[106:107], 0, 0
v_pk_mov_b32 v[108:109], 0, 0
v_pk_mov_b32 v[110:111], 0, 0
v_pk_mov_b32 v[48:49], 0, 0
v_pk_mov_b32 v[50:51], 0, 0
v_cvt_pk_bf16_f32 v56, v112, v113
v_cvt_pk_bf16_f32 v57, v114, v115
v_cvt_pk_bf16_f32 v58, v116, v117
v_cvt_pk_bf16_f32 v59, v118, v119
buffer_store_dwordx4 v[56:59], v206, s[28:31], s36 offen offset:2048 sc1
v_pk_mov_b32 v[112:113], 0, 0
v_pk_mov_b32 v[114:115], 0, 0
v_pk_mov_b32 v[116:117], 0, 0
v_pk_mov_b32 v[118:119], 0, 0
v_pk_mov_b32 v[52:53], 0, 0
v_pk_mov_b32 v[54:55], 0, 0
v_cvt_pk_bf16_f32 v60, v120, v121
v_cvt_pk_bf16_f32 v61, v122, v123
v_cvt_pk_bf16_f32 v62, v124, v125
v_cvt_pk_bf16_f32 v63, v126, v127
buffer_store_dwordx4 v[60:63], v206, s[28:31], s36 offen offset:3072 sc1
s_add_u32 s36, s36, 4096
v_pk_mov_b32 v[120:121], 0, 0
v_pk_mov_b32 v[122:123], 0, 0
v_pk_mov_b32 v[124:125], 0, 0
v_pk_mov_b32 v[126:127], 0, 0
v_pk_mov_b32 v[56:57], 0, 0
v_pk_mov_b32 v[58:59], 0, 0
buffer_store_dwordx4 v[210:213], v206, s[28:31], s36 offen sc1
s_nop 0
v_pk_mov_b32 v[60:61], 0, 0
v_pk_mov_b32 v[62:63], 0, 0
s_mov_b32 s35, 3
s_mov_b32 s8, s14
s_mov_b32 s9, 0
s_lshl_b32 s10, s14, 2
s_add_u32 s10, s10, 4
s_mov_b32 s11, 1
s_lshl_b32 s4, s10, 14
s_add_u32 s4, s4, s34
s_mov_b32 s34, 0x70000000
s_branch seg_40
fin_59:
s_lshr_b32 s36, s12, 2
s_lshl_b32 s36, s36, 2
s_bfe_u32 s19, s42, 0x20001
s_add_u32 s36, s36, s19
s_add_u32 s36, s36, 64
s_lshr_b32 s17, s8, 1
s_and_b32 s19, s8, 1
s_lshl_b32 s19, s19, 6
s_add_u32 s17, s17, s19
s_add_u32 s17, s17, 128
v_mov_b32 v221, s36
s_mov_b64 exec, 0xff
v_mov_b32 v221, s17
s_mov_b64 exec, -1
v_min_u32 v210, 23, v255
v_lshl_add_u32 v221, v210, 3, v221
s_and_b32 s17, s2, 127
v_writelane_b32 v221, s17, 24
v_lshlrev_b32 v221, 7, v221
v_add_u32 v221, 105906176, v221
buffer_load_dword v220, v221, s[28:31], 0 offen sc1
s_barrier
mf v[128:131],a[192:195],a[128:131],v[176:179]
ds_read_b128 a[224:227], v204 offset:8192
mf v[128:131],a[196:199],a[132:135],v[128:131]
v_add_f32 v202, v202, v200
v_add_f32 v203, v203, v201
mf v[128:131],a[200:203],a[136:139],v[128:131]
ds_read_b128 a[228:231], v204 offset:9216
s_add_u32 s43, s33, 16384
mf v[128:131],a[204:207],a[140:143],v[128:131]
v_cvt_pk_bf16_f32 v160, v184, v185
v_cvt_pk_bf16_f32 v161, v186, v187
v_cvt_pk_bf16_f32 v164, v188, v189
mf v[132:135],a[204:207],a[172:175],v[180:183]
ds_read_b128 a[232:235], v204 offset:10240
s_add_u32 m0, s40, 0
mf v[132:135],a[200:203],a[168:171],v[132:135]
buffer_load_dwordx4 v206, s[24:27], s33 offen offset:0 sc1 lds
mf v[132:135],a[196:199],a[164:167],v[132:135]
ds_read_b128 a[236:239], v204 offset:11264
s_waitcnt lgkmcnt(4)
v_cvt_pk_bf16_f32 v165, v190, v191
mf v[132:135],a[192:195],a[160:163],v[132:135]
v_cvt_pk_bf16_f32 v162, v192, v193
v_cvt_pk_bf16_f32 v163, v194, v195
mf v[132:135],a[208:211],a[176:179],v[132:135]
ds_read_b128 a[240:243], v204 offset:12288
v_cvt_pk_bf16_f32 v166, v196, v197
mf v[132:135],a[212:215],a[180:183],v[132:135]
v_cvt_pk_bf16_f32 v167, v198, v199
v_cvt_pk_bf16_f32 v168, v224, v225
v_cvt_pk_bf16_f32 v169, v226, v227
mf v[132:135],a[216:219],a[184:187],v[132:135]
ds_read_b128 a[244:247], v204 offset:13312
v_cvt_pk_bf16_f32 v172, v228, v229
mf v[132:135],a[220:223],a[188:191],v[132:135]
buffer_load_dwordx4 v206, s[24:27], s33 offen offset:1024 sc1 lds
mf v[128:131],a[220:223],a[156:159],v[128:131]
ds_read_b128 a[248:251], v204 offset:14336
v_cvt_pk_bf16_f32 v173, v230, v231
v_cvt_pk_bf16_f32 v170, v232, v233
mf v[128:131],a[216:219],a[152:155],v[128:131]
v_cvt_pk_bf16_f32 v171, v234, v235
v_cvt_pk_bf16_f32 v174, v236, v237
mf v[128:131],a[212:215],a[148:151],v[128:131]
ds_read_b128 a[252:255], v204 offset:15360
s_waitcnt lgkmcnt(4)
mf v[128:131],a[208:211],a[144:147],v[128:131]
v_cvt_pk_bf16_f32 v175, v238, v239
v_cmp_gt_i32 s[44:45], 0, v207
v_cmp_gt_i32 s[46:47], 1, v207
mf v[136:139],a[224:227],a[128:131],v[176:179]
ds_read_b128 a[192:195], v204 offset:16384
v_cmp_gt_i32 s[48:49], 2, v207
mf v[136:139],a[228:231],a[132:135],v[136:139]
buffer_load_dwordx4 v206, s[24:27], s33 offen offset:2048 sc1 lds
mf v[136:139],a[232:235],a[136:139],v[136:139]
ds_read_b128 a[196:199], v204 offset:17408
v_cmp_gt_i32 s[50:51], 3, v207
v_cmp_gt_i32 s[52:53], 16, v207
mf v[136:139],a[236:239],a[140:143],v[136:139]
v_exp_f32 v188, v132
mf v[140:143],a[236:239],a[172:175],v[180:183]
ds_read_b128 a[200:203], v204 offset:18432
v_cmp_gt_i32 s[54:55], 32, v207
mf v[140:143],a[232:235],a[168:171],v[140:143]
v_exp_f32 v189, v133
v_cmp_gt_i32 s[56:57], 33, v207
mf v[140:143],a[228:231],a[164:167],v[140:143]
ds_read_b128 a[204:207], v204 offset:19456
s_waitcnt lgkmcnt(4)
mf v[140:143],a[224:227],a[160:163],v[140:143]
buffer_load_dwordx4 v206, s[24:27], s33 offen offset:3072 sc1 lds
mf v[140:143],a[240:243],a[176:179],v[140:143]
ds_read_b128 a[208:211], v204 offset:20480
v_exp_f32 v190, v134
mf v[140:143],a[244:247],a[180:183],v[140:143]
v_exp_f32 v191, v135
mf v[140:143],a[248:251],a[184:187],v[140:143]
ds_read_b128 a[212:215], v204 offset:21504
v_cmp_gt_i32 s[58:59], 34, v207
mf v[140:143],a[252:255],a[188:191],v[140:143]
v_cmp_gt_i32 s[60:61], 35, v207
v_cmp_gt_i32 s[62:63], 48, v207
mf v[136:139],a[252:255],a[156:159],v[136:139]
ds_read_b128 a[216:219], v204 offset:22528
s_add_u32 m0, s40, 16384
v_subrev_u32 v207, 64, v207
mf v[136:139],a[248:251],a[152:155],v[136:139]
buffer_load_dwordx4 v206, s[24:27], s43 offen offset:0 sc1 lds
mf v[136:139],a[244:247],a[148:151],v[136:139]
ds_read_b128 a[220:223], v204 offset:23552
s_waitcnt lgkmcnt(4)
mf v[136:139],a[240:243],a[144:147],v[136:139]
v_cndmask_b32 v128, v128, v208, s[44:45]
v_exp_f32 v184, v128
mf v[144:147],a[192:195],a[128:131],v[176:179]
ds_read_b128 a[224:227], v204 offset:24576
v_cndmask_b32 v129, v129, v208, s[46:47]
mf v[144:147],a[196:199],a[132:135],v[144:147]
v_exp_f32 v185, v129
mf v[144:147],a[200:203],a[136:139],v[144:147]
ds_read_b128 a[228:231], v204 offset:25600
s_xor_b32 s40, s40, 0x8000
v_cndmask_b32 v130, v130, v208, s[48:49]
mf v[144:147],a[204:207],a[140:143],v[144:147]
buffer_load_dwordx4 v206, s[24:27], s43 offen offset:1024 sc1 lds
mf v[148:151],a[204:207],a[172:175],v[180:183]
ds_read_b128 a[232:235], v204 offset:26624
v_cndmask_b32 v131, v131, v208, s[50:51]
mf v[148:151],a[200:203],a[168:171],v[148:151]
v_exp_f32 v186, v130
v_cndmask_b32 v140, v140, v208, s[44:45]
mf v[148:151],a[196:199],a[164:167],v[148:151]
ds_read_b128 a[236:239], v204 offset:27648
s_waitcnt lgkmcnt(4)
mf v[148:151],a[192:195],a[160:163],v[148:151]
v_exp_f32 v187, v131
mf v[148:151],a[208:211],a[176:179],v[148:151]
ds_read_b128 a[240:243], v204 offset:28672
v_exp_f32 v196, v140
mf v[148:151],a[212:215],a[180:183],v[148:151]
buffer_load_dwordx4 v206, s[24:27], s43 offen offset:2048 sc1 lds
mf v[148:151],a[216:219],a[184:187],v[148:151]
ds_read_b128 a[244:247], v204 offset:29696
v_cndmask_b32 v141, v141, v208, s[46:47]
mf v[148:151],a[220:223],a[188:191],v[148:151]
v_exp_f32 v197, v141
v_cndmask_b32 v142, v142, v208, s[48:49]
mf v[144:147],a[220:223],a[156:159],v[144:147]
ds_read_b128 a[248:251], v204 offset:30720
v_cndmask_b32 v143, v143, v208, s[50:51]
mf v[144:147],a[216:219],a[152:155],v[144:147]
v_exp_f32 v198, v142
mf v[144:147],a[212:215],a[148:151],v[144:147]
ds_read_b128 a[252:255], v204 offset:31744
s_waitcnt lgkmcnt(4)
v_cndmask_b32 v136, v136, v208, s[52:53]
mf v[144:147],a[208:211],a[144:147],v[144:147]
buffer_load_dwordx4 v206, s[24:27], s43 offen offset:3072 sc1 lds
mf v[152:155],a[224:227],a[128:131],v[176:179]
v_xor_b32 v204, 0x38000, v204
ds_read_b128 a[192:195], v205 offset:0
mf v[152:155],a[228:231],a[132:135],v[152:155]
v_exp_f32 v199, v143
v_cndmask_b32 v137, v137, v208, s[52:53]
mf v[152:155],a[232:235],a[136:139],v[152:155]
ds_read_b128 a[196:199], v205 offset:16384
v_cndmask_b32 v138, v138, v208, s[52:53]
mf v[152:155],a[236:239],a[140:143],v[152:155]
v_exp_f32 v192, v136
mf v[156:159],a[236:239],a[172:175],v[180:183]
ds_read_b128 a[200:203], v205 offset:1024
v_cndmask_b32 v139, v139, v208, s[52:53]
mf v[156:159],a[232:235],a[168:171],v[156:159]
v_exp_f32 v193, v137
v_cndmask_b32 v148, v148, v208, s[52:53]
mf v[156:159],a[228:231],a[164:167],v[156:159]
ds_read_b128 a[204:207], v205 offset:17408
s_waitcnt lgkmcnt(4)
mf v[156:159],a[224:227],a[160:163],v[156:159]
v_exp_f32 v194, v138
mf v[156:159],a[240:243],a[176:179],v[156:159]
ds_read_b128 a[208:211], v205 offset:2048
v_exp_f32 v195, v139
mf v[156:159],a[244:247],a[180:183],v[156:159]
v_exp_f32 v228, v148
mf v[156:159],a[248:251],a[184:187],v[156:159]
ds_read_b128 a[212:215], v205 offset:18432
v_cndmask_b32 v149, v149, v208, s[52:53]
mf v[156:159],a[252:255],a[188:191],v[156:159]
v_exp_f32 v229, v149
v_cndmask_b32 v150, v150, v208, s[52:53]
mf v[152:155],a[252:255],a[156:159],v[152:155]
ds_read_b128 a[216:219], v205 offset:3072
v_cndmask_b32 v151, v151, v208, s[52:53]
mf v[152:155],a[248:251],a[152:155],v[152:155]
v_exp_f32 v230, v150
mf v[152:155],a[244:247],a[148:151],v[152:155]
ds_read_b128 a[220:223], v205 offset:19456
s_waitcnt lgkmcnt(4)
v_cndmask_b32 v144, v144, v208, s[54:55]
mf v[152:155],a[240:243],a[144:147],v[152:155]
s_waitcnt vmcnt(8)
v_cndmask_b32 v145, v145, v208, s[56:57]
s_mov_b64 exec, 0xffffff
v_cmp_gt_u32 vcc, 3, v220
s_mov_b64 exec, -1
s_cbranch_vccz chk_64
s_mov_b32 s36, 0x80000
s_mov_b64 exec, 0xffffff
poll_65:
buffer_load_dword v220, v221, s[28:31], 0 offen sc1
s_waitcnt vmcnt(0)
v_cmp_gt_u32 vcc, 3, v220
s_cbranch_vccz pollok_66
s_sleep 2
s_sub_u32 s36, s36, 1
s_cmp_lg_u32 s36, 0
s_cbranch_scc1 poll_65
pollok_66:
s_mov_b64 exec, -1
chk_64:
s_mov_b32 s97, s41
s_lshr_b32 s4, s12, 2
s_lshl_b32 s4, s4, 3
s_and_b32 s17, s42, 7
s_add_u32 s4, s4, s17
s_lshr_b32 s10, s42, 3
s_and_b32 s41, s12, 3
v_lshrrev_b32 v242, 4, v255
s_lshl_b32 s17, s16, 2
v_add_u32 v242, s17, v242
v_and_b32 v243, 7, v242
v_lshlrev_b32 v243, 1, v243
v_and_b32 v244, 15, v255
v_xor_b32 v243, v243, v244
v_lshlrev_b32 v243, 4, v243
v_mul_u32_u24 v244, 896, v242
v_add_u32 v240, v244, v243
v_lshrrev_b32 v243, 7, v243
s_cmp_eq_u32 s10, 3
s_cselect_b32 s19, 1, 0
v_and_b32 v243, s19, v243
v_lshl_add_u32 v240, v243, 30, v240
v_add_u32 v241, 13312, v240
v_add_u32 v222, 188416, v206
s_mov_b32 s20, s68
s_and_b32 s21, s69, 0xffff
s_mov_b32 s22, 1605632
s_mov_b32 s23, 0x20000
s_lshl_b32 s34, s16, 11
s_lshl_b32 s17, s10, 8
s_mul_i32 s99, s41, 401408
s_add_u32 s99, s99, s17
s_lshl_b32 s43, s4, 2
s_add_u32 s43, s43, s16
s_mul_i32 s43, s43, 376832
s_add_u32 s43, s43, 50331648
s_mul_i32 s17, s41, 14336
s_add_u32 s98, s43, s17
s_add_u32 s98, s98, 131072
s_lshl_b32 s17, s12, 14
s_add_u32 s43, s43, s17
s_lshl_b32 s17, s42, 2
s_add_u32 s17, s17, s16
s_lshl_b32 s17, s17, 11
v_lshl_add_u32 v209, v255, 5, s17
v_min_u32 v209, code_end-go-4, v209
s_lshl_b32 s35, s18, 7
s_add_u32 s35, s35, 104857600
v_lshlrev_b32 v214, 2, v219
s_barrier
mf v[0:3],a[192:195],v[160:163],v[0:3]
ds_read_b128 a[224:227], v205 offset:4096
v_cndmask_b32 v146, v146, v208, s[58:59]
mf v[0:3],a[196:199],v[168:171],v[0:3]
v_exp_f32 v231, v151
v_cndmask_b32 v147, v147, v208, s[60:61]
mf v[64:67],a[196:199],v[172:175],v[64:67]
ds_read_b128 a[228:231], v205 offset:20480
s_add_u32 s96, s32, 16384
mf v[64:67],a[192:195],v[164:167],v[64:67]
v_exp_f32 v224, v144
mf v[68:71],a[200:203],v[164:167],v[68:71]
ds_read_b128 a[232:235], v205 offset:5120
s_add_u32 m0, s97, 0
v_cndmask_b32 v156, v156, v208, s[54:55]
mf v[68:71],a[204:207],v[172:175],v[68:71]
buffer_load_dwordx4 v206, s[24:27], s32 offen offset:0 sc1 lds
mf v[4:7],a[204:207],v[168:171],v[4:7]
ds_read_b128 a[236:239], v205 offset:21504
s_waitcnt lgkmcnt(4)
mf v[4:7],a[200:203],v[160:163],v[4:7]
buffer_load_dwordx4 v206, s[24:27], s32 offen offset:1024 sc1 lds
mf v[8:11],a[208:211],v[160:163],v[8:11]
ds_read_b128 a[240:243], v205 offset:6144
v_cndmask_b32 v157, v157, v208, s[56:57]
mf v[8:11],a[212:215],v[168:171],v[8:11]
v_exp_f32 v225, v145
mf v[72:75],a[212:215],v[172:175],v[72:75]
ds_read_b128 a[244:247], v205 offset:22528
v_exp_f32 v226, v146
mf v[72:75],a[208:211],v[164:167],v[72:75]
buffer_load_dwordx4 v206, s[24:27], s32 offen offset:2048 sc1 lds
mf v[76:79],a[216:219],v[164:167],v[76:79]
ds_read_b128 a[248:251], v205 offset:7168
v_cndmask_b32 v158, v158, v208, s[58:59]
mf v[76:79],a[220:223],v[172:175],v[76:79]
v_exp_f32 v227, v147
mf v[12:15],a[220:223],v[168:171],v[12:15]
ds_read_b128 a[252:255], v205 offset:23552
s_waitcnt lgkmcnt(4)
v_cndmask_b32 v159, v159, v208, s[60:61]
mf v[12:15],a[216:219],v[160:163],v[12:15]
buffer_load_dwordx4 v206, s[24:27], s32 offen offset:3072 sc1 lds
mf v[16:19],a[224:227],v[160:163],v[16:19]
ds_read_b128 a[192:195], v205 offset:8192
v_cndmask_b32 v152, v152, v208, s[62:63]
mf v[16:19],a[228:231],v[168:171],v[16:19]
v_exp_f32 v236, v156
v_cndmask_b32 v153, v153, v208, s[62:63]
mf v[80:83],a[228:231],v[172:175],v[80:83]
ds_read_b128 a[196:199], v205 offset:24576
s_add_u32 m0, s97, 16384
mf v[80:83],a[224:227],v[164:167],v[80:83]
buffer_load_dwordx4 v206, s[24:27], s96 offen offset:0 sc1 lds
mf v[84:87],a[232:235],v[164:167],v[84:87]
ds_read_b128 a[200:203], v205 offset:9216
v_exp_f32 v237, v157
mf v[84:87],a[236:239],v[172:175],v[84:87]
v_exp_f32 v238, v158
mf v[20:23],a[236:239],v[168:171],v[20:23]
ds_read_b128 a[204:207], v205 offset:25600
s_waitcnt lgkmcnt(4)
mf v[20:23],a[232:235],v[160:163],v[20:23]
buffer_load_dwordx4 v206, s[24:27], s96 offen offset:1024 sc1 lds
mf v[24:27],a[240:243],v[160:163],v[24:27]
ds_read_b128 a[208:211], v205 offset:10240
v_cndmask_b32 v154, v154, v208, s[62:63]
mf v[24:27],a[244:247],v[168:171],v[24:27]
v_exp_f32 v239, v159
mf v[88:91],a[244:247],v[172:175],v[88:91]
ds_read_b128 a[212:215], v205 offset:26624
v_exp_f32 v232, v152
mf v[88:91],a[240:243],v[164:167],v[88:91]
buffer_load_dwordx4 v206, s[24:27], s96 offen offset:2048 sc1 lds
mf v[92:95],a[248:251],v[164:167],v[92:95]
ds_read_b128 a[216:219], v205 offset:11264
v_cndmask_b32 v155, v155, v208, s[62:63]
mf v[92:95],a[252:255],v[172:175],v[92:95]
v_exp_f32 v233, v153
v_add_f32 v201, v188, v189
mf v[28:31],a[252:255],v[168:171],v[28:31]
ds_read_b128 a[220:223], v205 offset:27648
s_waitcnt lgkmcnt(4)
mf v[28:31],a[248:251],v[160:163],v[28:31]
buffer_load_dwordx4 v206, s[24:27], s96 offen offset:3072 sc1 lds
mf v[32:35],a[192:195],v[160:163],v[32:35]
ds_read_b128 a[224:227], v205 offset:12288
v_exp_f32 v234, v154
mf v[32:35],a[196:199],v[168:171],v[32:35]
v_exp_f32 v235, v155
mf v[96:99],a[196:199],v[172:175],v[96:99]
ds_read_b128 a[228:231], v205 offset:28672
v_add_f32 v201, v201, v190
mf v[96:99],a[192:195],v[164:167],v[96:99]
buffer_load_dword v216, v214, s[28:31], s35 offen sc1
mf v[100:103],a[200:203],v[164:167],v[100:103]
ds_read_b128 a[232:235], v205 offset:13312
v_add_f32 v201, v201, v191
mf v[100:103],a[204:207],v[172:175],v[100:103]
v_add_f32 v200, v184, v185
v_add_f32 v200, v200, v186
mf v[36:39],a[204:207],v[168:171],v[36:39]
ds_read_b128 a[236:239], v205 offset:29696
s_waitcnt lgkmcnt(4)
mf v[36:39],a[200:203],v[160:163],v[36:39]
buffer_load_dword v217, v214, s[28:31], s35 offen offset:64 sc1
mf v[40:43],a[208:211],v[160:163],v[40:43]
ds_read_b128 a[240:243], v205 offset:14336
v_add_f32 v200, v200, v187
mf v[40:43],a[212:215],v[168:171],v[40:43]
v_add_f32 v201, v201, v196
v_add_f32 v201, v201, v197
mf v[104:107],a[212:215],v[172:175],v[104:107]
ds_read_b128 a[244:247], v205 offset:30720
v_add_f32 v201, v201, v198
v_add_f32 v201, v201, v199
mf v[104:107],a[208:211],v[164:167],v[104:107]
global_load_dword v223, v209, s[100:101]
mf v[108:111],a[216:219],v[164:167],v[108:111]
ds_read_b128 a[248:251], v205 offset:15360
v_add_f32 v200, v200, v192
mf v[108:111],a[220:223],v[172:175],v[108:111]
v_add_f32 v200, v200, v193
v_add_f32 v200, v200, v194
v_add_f32 v200, v200, v195
mf v[44:47],a[220:223],v[168:171],v[44:47]
ds_read_b128 a[252:255], v205 offset:31744
s_waitcnt lgkmcnt(4)
s_add_u32 m0, s34, 65536
s_add_u32 s37, s99, 0
mf v[44:47],a[216:219],v[160:163],v[44:47]
buffer_load_dwordx4 v240, s[20:23], s37 offen lds
mf v[48:51],a[224:227],v[160:163],v[48:51]
v_xor_b32 v205, 0x8000, v205
ds_read_b128 a[192:195], v204 offset:0
v_add_f32 v201, v201, v228
mf v[48:51],a[228:231],v[168:171],v[48:51]
v_add_f32 v201, v201, v229
v_add_f32 v201, v201, v230
mf v[112:115],a[228:231],v[172:175],v[112:115]
ds_read_b128 a[196:199], v204 offset:1024
v_add_f32 v201, v201, v231
mf v[112:115],a[224:227],v[164:167],v[112:115]
buffer_load_dwordx4 v241, s[20:23], s37 offen offset:1024 lds
mf v[116:119],a[232:235],v[164:167],v[116:119]
ds_read_b128 a[200:203], v204 offset:2048
v_add_f32 v200, v200, v224
mf v[116:119],a[236:239],v[172:175],v[116:119]
v_add_f32 v200, v200, v225
v_add_f32 v200, v200, v226
mf v[52:55],a[236:239],v[168:171],v[52:55]
ds_read_b128 a[204:207], v204 offset:3072
s_waitcnt lgkmcnt(4)
s_add_u32 s38, s98, 0
mf v[52:55],a[232:235],v[160:163],v[52:55]
buffer_load_dwordx4 a[72:75], v206, s[28:31], s38 offen sc1
mf v[56:59],a[240:243],v[160:163],v[56:59]
ds_read_b128 a[208:211], v204 offset:4096
v_add_f32 v200, v200, v227
mf v[56:59],a[244:247],v[168:171],v[56:59]
v_add_f32 v201, v201, v236
v_add_f32 v201, v201, v237
v_add_f32 v201, v201, v238
mf v[120:123],a[244:247],v[172:175],v[120:123]
ds_read_b128 a[212:215], v204 offset:5120
v_add_f32 v201, v201, v239
mf v[120:123],a[240:243],v[164:167],v[120:123]
buffer_load_dwordx4 a[76:79], v222, s[28:31], s38 offen sc1
mf v[124:127],a[248:251],v[164:167],v[124:127]
ds_read_b128 a[216:219], v204 offset:6144
v_add_f32 v200, v200, v232
v_add_f32 v200, v200, v233
mf v[124:127],a[252:255],v[172:175],v[124:127]
v_add_f32 v200, v200, v234
v_add_f32 v200, v200, v235
mf v[60:63],a[252:255],v[168:171],v[60:63]
ds_read_b128 a[220:223], v204 offset:7168
s_waitcnt lgkmcnt(4)
mf v[60:63],a[248:251],v[160:163],v[60:63]
s_waitcnt vmcnt(7)
v_max_f32 v210, v200, v201
v_cmp_nge_f32 vcc, s39, v210
s_cbranch_vccnz slow_67
back_68:
s_branch d1_61
st2_43:
s_lshr_b32 s36, s12, 2
s_lshl_b32 s36, s36, 2
s_bfe_u32 s19, s42, 0x20001
s_add_u32 s36, s36, s19
s_add_u32 s36, s36, 64
s_lshr_b32 s17, s8, 1
s_and_b32 s19, s8, 1
s_lshl_b32 s19, s19, 6
s_add_u32 s17, s17, s19
s_add_u32 s17, s17, 128
v_mov_b32 v221, s36
s_mov_b64 exec, 0xff
v_mov_b32 v221, s17
s_mov_b64 exec, -1
v_min_u32 v210, 23, v255
v_lshl_add_u32 v221, v210, 3, v221
s_and_b32 s17, s2, 127
v_writelane_b32 v221, s17, 24
v_lshlrev_b32 v221, 7, v221
v_add_u32 v221, 105906176, v221
buffer_load_dword v220, v221, s[28:31], 0 offen sc1
ds_read_b128 a[192:195], v204 offset:0
ds_read_b128 a[196:199], v204 offset:1024
ds_read_b128 a[200:203], v204 offset:2048
ds_read_b128 a[204:207], v204 offset:3072
ds_read_b128 a[208:211], v204 offset:4096
ds_read_b128 a[212:215], v204 offset:5120
ds_read_b128 a[216:219], v204 offset:6144
ds_read_b128 a[220:223], v204 offset:7168
v_mov_b32 v202, 0
v_mov_b32 v203, 0
s_waitcnt lgkmcnt(4)
mf v[128:131],a[192:195],a[128:131],0
ds_read_b128 a[224:227], v204 offset:8192
mf v[128:131],a[196:199],a[132:135],v[128:131]
mf v[128:131],a[200:203],a[136:139],v[128:131]
ds_read_b128 a[228:231], v204 offset:9216
mf v[128:131],a[204:207],a[140:143],v[128:131]
mf v[132:135],a[204:207],a[172:175],0
ds_read_b128 a[232:235], v204 offset:10240
mf v[132:135],a[200:203],a[168:171],v[132:135]
mf v[132:135],a[196:199],a[164:167],v[132:135]
ds_read_b128 a[236:239], v204 offset:11264
s_waitcnt lgkmcnt(4)
mf v[132:135],a[192:195],a[160:163],v[132:135]
mf v[132:135],a[208:211],a[176:179],v[132:135]
ds_read_b128 a[240:243], v204 offset:12288
mf v[132:135],a[212:215],a[180:183],v[132:135]
mf v[132:135],a[216:219],a[184:187],v[132:135]
ds_read_b128 a[244:247], v204 offset:13312
mf v[132:135],a[220:223],a[188:191],v[132:135]
mf v[128:131],a[220:223],a[156:159],v[128:131]
ds_read_b128 a[248:251], v204 offset:14336
mf v[128:131],a[216:219],a[152:155],v[128:131]
mf v[128:131],a[212:215],a[148:151],v[128:131]
ds_read_b128 a[252:255], v204 offset:15360
s_waitcnt lgkmcnt(4)
mf v[128:131],a[208:211],a[144:147],v[128:131]
mf v[136:139],a[224:227],a[128:131],0
ds_read_b128 a[192:195], v204 offset:16384
mf v[136:139],a[228:231],a[132:135],v[136:139]
mf v[136:139],a[232:235],a[136:139],v[136:139]
ds_read_b128 a[196:199], v204 offset:17408
mf v[136:139],a[236:239],a[140:143],v[136:139]
mf v[140:143],a[236:239],a[172:175],0
ds_read_b128 a[200:203], v204 offset:18432
mf v[140:143],a[232:235],a[168:171],v[140:143]
mf v[140:143],a[228:231],a[164:167],v[140:143]
ds_read_b128 a[204:207], v204 offset:19456
s_waitcnt lgkmcnt(4)
mf v[140:143],a[224:227],a[160:163],v[140:143]
mf v[140:143],a[240:243],a[176:179],v[140:143]
ds_read_b128 a[208:211], v204 offset:20480
mf v[140:143],a[244:247],a[180:183],v[140:143]
mf v[140:143],a[248:251],a[184:187],v[140:143]
ds_read_b128 a[212:215], v204 offset:21504
mf v[140:143],a[252:255],a[188:191],v[140:143]
mf v[136:139],a[252:255],a[156:159],v[136:139]
ds_read_b128 a[216:219], v204 offset:22528
mf v[136:139],a[248:251],a[152:155],v[136:139]
mf v[136:139],a[244:247],a[148:151],v[136:139]
ds_read_b128 a[220:223], v204 offset:23552
s_waitcnt lgkmcnt(4)
mf v[136:139],a[240:243],a[144:147],v[136:139]
mf v[144:147],a[192:195],a[128:131],0
ds_read_b128 a[224:227], v204 offset:24576
mf v[144:147],a[196:199],a[132:135],v[144:147]
mf v[144:147],a[200:203],a[136:139],v[144:147]
ds_read_b128 a[228:231], v204 offset:25600
mf v[144:147],a[204:207],a[140:143],v[144:147]
mf v[148:151],a[204:207],a[172:175],0
ds_read_b128 a[232:235], v204 offset:26624
mf v[148:151],a[200:203],a[168:171],v[148:151]
mf v[148:151],a[196:199],a[164:167],v[148:151]
ds_read_b128 a[236:239], v204 offset:27648
s_waitcnt lgkmcnt(4)
mf v[148:151],a[192:195],a[160:163],v[148:151]
mf v[148:151],a[208:211],a[176:179],v[148:151]
ds_read_b128 a[240:243], v204 offset:28672
mf v[148:151],a[212:215],a[180:183],v[148:151]
mf v[148:151],a[216:219],a[184:187],v[148:151]
ds_read_b128 a[244:247], v204 offset:29696
mf v[148:151],a[220:223],a[188:191],v[148:151]
mf v[144:147],a[220:223],a[156:159],v[144:147]
ds_read_b128 a[248:251], v204 offset:30720
mf v[144:147],a[216:219],a[152:155],v[144:147]
mf v[144:147],a[212:215],a[148:151],v[144:147]
ds_read_b128 a[252:255], v204 offset:31744
s_waitcnt lgkmcnt(4)
mf v[144:147],a[208:211],a[144:147],v[144:147]
mf v[152:155],a[224:227],a[128:131],0
v_xor_b32 v204, 0x38000, v204
ds_read_b128 a[192:195], v204 offset:0
mf v[152:155],a[228:231],a[132:135],v[152:155]
mf v[152:155],a[232:235],a[136:139],v[152:155]
ds_read_b128 a[196:199], v204 offset:1024
mf v[152:155],a[236:239],a[140:143],v[152:155]
mf v[156:159],a[236:239],a[172:175],0
ds_read_b128 a[200:203], v204 offset:2048
mf v[156:159],a[232:235],a[168:171],v[156:159]
mf v[156:159],a[228:231],a[164:167],v[156:159]
ds_read_b128 a[204:207], v204 offset:3072
s_waitcnt lgkmcnt(4)
mf v[156:159],a[224:227],a[160:163],v[156:159]
mf v[156:159],a[240:243],a[176:179],v[156:159]
ds_read_b128 a[208:211], v204 offset:4096
mf v[156:159],a[244:247],a[180:183],v[156:159]
mf v[156:159],a[248:251],a[184:187],v[156:159]
ds_read_b128 a[212:215], v204 offset:5120
mf v[156:159],a[252:255],a[188:191],v[156:159]
mf v[152:155],a[252:255],a[156:159],v[152:155]
ds_read_b128 a[216:219], v204 offset:6144
mf v[152:155],a[248:251],a[152:155],v[152:155]
mf v[152:155],a[244:247],a[148:151],v[152:155]
ds_read_b128 a[220:223], v204 offset:7168
s_waitcnt lgkmcnt(4)
mf v[152:155],a[240:243],a[144:147],v[152:155]
s_barrier
s_nop 7
v_cmp_gt_i32 s[44:45], 0, v207
v_cmp_gt_i32 s[46:47], 1, v207
v_cmp_gt_i32 s[48:49], 2, v207
v_cmp_gt_i32 s[50:51], 3, v207
v_cmp_gt_i32 s[52:53], 16, v207
v_cmp_gt_i32 s[54:55], 32, v207
v_cmp_gt_i32 s[56:57], 33, v207
v_cmp_gt_i32 s[58:59], 34, v207
v_cmp_gt_i32 s[60:61], 35, v207
v_cmp_gt_i32 s[62:63], 48, v207
v_subrev_u32 v207, 64, v207
v_cndmask_b32 v128, v128, v208, s[44:45]
v_cndmask_b32 v129, v129, v208, s[46:47]
v_cndmask_b32 v130, v130, v208, s[48:49]
v_cndmask_b32 v131, v131, v208, s[50:51]
v_cndmask_b32 v140, v140, v208, s[44:45]
v_cndmask_b32 v141, v141, v208, s[46:47]
v_cndmask_b32 v142, v142, v208, s[48:49]
s_add_u32 s43, s32, 16384
s_add_u32 m0, s41, 0
s_nop 0
buffer_load_dwordx4 v206, s[24:27], s32 offen offset:0 sc1 lds
v_cndmask_b32 v143, v143, v208, s[50:51]
v_cndmask_b32 v136, v136, v208, s[52:53]
v_cndmask_b32 v137, v137, v208, s[52:53]
v_cndmask_b32 v138, v138, v208, s[52:53]
v_cndmask_b32 v139, v139, v208, s[52:53]
v_cndmask_b32 v148, v148, v208, s[52:53]
v_cndmask_b32 v149, v149, v208, s[52:53]
v_cndmask_b32 v150, v150, v208, s[52:53]
v_cndmask_b32 v151, v151, v208, s[52:53]
v_cndmask_b32 v144, v144, v208, s[54:55]
v_cndmask_b32 v145, v145, v208, s[56:57]
v_cndmask_b32 v146, v146, v208, s[58:59]
v_cndmask_b32 v147, v147, v208, s[60:61]
v_cndmask_b32 v156, v156, v208, s[54:55]
v_cndmask_b32 v157, v157, v208, s[56:57]
v_cndmask_b32 v158, v158, v208, s[58:59]
v_cndmask_b32 v159, v159, v208, s[60:61]
v_cndmask_b32 v152, v152, v208, s[62:63]
v_cndmask_b32 v153, v153, v208, s[62:63]
buffer_load_dwordx4 v206, s[24:27], s32 offen offset:1024 sc1 lds
v_cndmask_b32 v154, v154, v208, s[62:63]
v_cndmask_b32 v155, v155, v208, s[62:63]
v_max3_f32 v210, v128, v129, v130
v_max_f32 v210, v210, v131
v_max3_f32 v211, v132, v133, v134
v_max_f32 v211, v211, v135
v_mov_b32 v212, v210
v_mov_b32 v213, v211
s_nop 1
v_permlane16_swap_b32 v212, v210
v_permlane16_swap_b32 v213, v211
s_nop 1
v_max_f32 v210, v210, v212
v_max_f32 v211, v211, v213
v_mov_b32 v212, v210
v_mov_b32 v213, v211
s_nop 1
v_permlane32_swap_b32 v212, v210
buffer_load_dwordx4 v206, s[24:27], s32 offen offset:2048 sc1 lds
v_permlane32_swap_b32 v213, v211
s_nop 1
v_max_f32 v210, v210, v212
v_max_f32 v211, v211, v213
v_sub_f32 v132, v132, v211
v_sub_f32 v133, v133, v211
v_sub_f32 v134, v134, v211
v_sub_f32 v135, v135, v211
v_sub_f32 v128, v128, v210
v_sub_f32 v129, v129, v210
v_sub_f32 v130, v130, v210
v_sub_f32 v131, v131, v210
v_sub_f32 v140, v140, v211
v_sub_f32 v141, v141, v211
v_sub_f32 v142, v142, v211
v_sub_f32 v143, v143, v211
v_sub_f32 v136, v136, v210
v_sub_f32 v137, v137, v210
v_sub_f32 v138, v138, v210
buffer_load_dwordx4 v206, s[24:27], s32 offen offset:3072 sc1 lds
v_sub_f32 v139, v139, v210
v_sub_f32 v148, v148, v211
v_sub_f32 v149, v149, v211
v_sub_f32 v150, v150, v211
v_sub_f32 v151, v151, v211
v_sub_f32 v144, v144, v210
v_sub_f32 v145, v145, v210
v_sub_f32 v146, v146, v210
v_sub_f32 v147, v147, v210
v_sub_f32 v156, v156, v211
v_sub_f32 v157, v157, v211
v_sub_f32 v158, v158, v211
v_sub_f32 v159, v159, v211
v_sub_f32 v152, v152, v210
v_sub_f32 v153, v153, v210
v_sub_f32 v154, v154, v210
v_sub_f32 v155, v155, v210
v_sub_f32 v176, 0, v210
v_sub_f32 v177, 0, v210
s_add_u32 m0, s41, 16384
s_nop 0
buffer_load_dwordx4 v206, s[24:27], s43 offen offset:0 sc1 lds
v_sub_f32 v178, 0, v210
v_sub_f32 v179, 0, v210
v_sub_f32 v180, 0, v211
v_sub_f32 v181, 0, v211
v_sub_f32 v182, 0, v211
v_sub_f32 v183, 0, v211
v_exp_f32 v188, v132
v_exp_f32 v189, v133
v_exp_f32 v190, v134
v_exp_f32 v191, v135
v_exp_f32 v184, v128
v_exp_f32 v185, v129
v_exp_f32 v186, v130
v_exp_f32 v187, v131
s_nop 0
v_add_f32 v201, v188, v189
v_add_f32 v201, v201, v190
v_add_f32 v201, v201, v191
buffer_load_dwordx4 v206, s[24:27], s43 offen offset:1024 sc1 lds
v_add_f32 v200, v184, v185
v_add_f32 v200, v200, v186
v_add_f32 v200, v200, v187
v_exp_f32 v196, v140
v_exp_f32 v197, v141
v_exp_f32 v198, v142
v_exp_f32 v199, v143
v_exp_f32 v192, v136
v_exp_f32 v193, v137
v_exp_f32 v194, v138
v_exp_f32 v195, v139
s_nop 0
v_add_f32 v201, v201, v196
v_add_f32 v201, v201, v197
v_add_f32 v201, v201, v198
v_add_f32 v201, v201, v199
v_add_f32 v200, v200, v192
v_add_f32 v200, v200, v193
v_add_f32 v200, v200, v194
buffer_load_dwordx4 v206, s[24:27], s43 offen offset:2048 sc1 lds
v_add_f32 v200, v200, v195
v_exp_f32 v228, v148
v_exp_f32 v229, v149
v_exp_f32 v230, v150
v_exp_f32 v231, v151
v_exp_f32 v224, v144
v_exp_f32 v225, v145
v_exp_f32 v226, v146
v_exp_f32 v227, v147
s_nop 0
v_add_f32 v201, v201, v228
v_add_f32 v201, v201, v229
v_add_f32 v201, v201, v230
v_add_f32 v201, v201, v231
v_add_f32 v200, v200, v224
v_add_f32 v200, v200, v225
v_add_f32 v200, v200, v226
v_add_f32 v200, v200, v227
v_exp_f32 v236, v156
buffer_load_dwordx4 v206, s[24:27], s43 offen offset:3072 sc1 lds
v_exp_f32 v237, v157
v_exp_f32 v238, v158
v_exp_f32 v239, v159
v_exp_f32 v232, v152
v_exp_f32 v233, v153
v_exp_f32 v234, v154
v_exp_f32 v235, v155
s_nop 0
v_add_f32 v201, v201, v236
v_add_f32 v201, v201, v237
v_add_f32 v201, v201, v238
v_add_f32 v201, v201, v239
v_add_f32 v200, v200, v232
v_add_f32 v200, v200, v233
v_add_f32 v200, v200, v234
v_add_f32 v200, v200, v235
v_max_f32 v210, v200, v201
v_cmp_nge_f32 vcc, s39, v210
s_cbranch_vccnz slow_69
back_70:
s_cmp_eq_u32 s35, 0
s_cbranch_scc1 nopub_71
s_waitcnt vmcnt(8)
s_barrier
s_cmp_lg_u32 s16, 0
s_cbranch_scc1 nofl_72
v_mov_b32 v210, s35
v_mov_b32 v211, 0
s_mov_b64 exec, 1
buffer_store_dword v210, v211, s[28:31], s3 offen sc1
s_mov_b64 exec, -1
nofl_72:
s_mov_b32 s35, 0
nopub_71:
s_mov_b64 exec, 0xffffff
v_cmp_gt_u32 vcc, 3, v220
s_mov_b64 exec, -1
s_cbranch_vccz chk_73
s_mov_b32 s36, 0x80000
s_mov_b64 exec, 0xffffff
poll_74:
buffer_load_dword v220, v221, s[28:31], 0 offen sc1
s_waitcnt vmcnt(0)
v_cmp_gt_u32 vcc, 3, v220
s_cbranch_vccz pollok_75
s_sleep 2
s_sub_u32 s36, s36, 1
s_cmp_lg_u32 s36, 0
s_cbranch_scc1 poll_74
pollok_75:
s_mov_b64 exec, -1
chk_73:
s_mov_b32 s97, s41
s_lshr_b32 s4, s12, 2
s_lshl_b32 s4, s4, 3
s_and_b32 s17, s42, 7
s_add_u32 s4, s4, s17
s_lshr_b32 s10, s42, 3
s_and_b32 s41, s12, 3
v_lshrrev_b32 v242, 4, v255
s_lshl_b32 s17, s16, 2
v_add_u32 v242, s17, v242
v_and_b32 v243, 7, v242
v_lshlrev_b32 v243, 1, v243
v_and_b32 v244, 15, v255
v_xor_b32 v243, v243, v244
v_lshlrev_b32 v243, 4, v243
v_mul_u32_u24 v244, 896, v242
v_add_u32 v240, v244, v243
v_lshrrev_b32 v243, 7, v243
s_cmp_eq_u32 s10, 3
s_cselect_b32 s19, 1, 0
v_and_b32 v243, s19, v243
v_lshl_add_u32 v240, v243, 30, v240
v_add_u32 v241, 13312, v240
v_add_u32 v222, 188416, v206
s_mov_b32 s20, s68
s_and_b32 s21, s69, 0xffff
s_mov_b32 s22, 1605632
s_mov_b32 s23, 0x20000
s_lshl_b32 s34, s16, 11
s_lshl_b32 s17, s10, 8
s_mul_i32 s99, s41, 401408
s_add_u32 s99, s99, s17
s_lshl_b32 s43, s4, 2
s_add_u32 s43, s43, s16
s_mul_i32 s43, s43, 376832
s_add_u32 s43, s43, 50331648
s_mul_i32 s17, s41, 14336
s_add_u32 s98, s43, s17
s_add_u32 s98, s98, 131072
s_lshl_b32 s17, s12, 14
s_add_u32 s43, s43, s17
s_lshl_b32 s17, s42, 2
s_add_u32 s17, s17, s16
s_lshl_b32 s17, s17, 11
v_lshl_add_u32 v209, v255, 5, s17
v_min_u32 v209, code_end-go-4, v209
s_lshl_b32 s35, s18, 7
s_add_u32 s35, s35, 104857600
v_lshlrev_b32 v214, 2, v219
buffer_load_dword v216, v214, s[28:31], s35 offen sc1
buffer_load_dword v217, v214, s[28:31], s35 offen offset:64 sc1
global_load_dword v223, v209, s[100:101]
s_add_u32 m0, s34, 65536
s_add_u32 s37, s99, 0
buffer_load_dwordx4 v240, s[20:23], s37 offen lds
buffer_load_dwordx4 v241, s[20:23], s37 offen offset:1024 lds
s_add_u32 s38, s98, 0
buffer_load_dwordx4 a[72:75], v206, s[28:31], s38 offen sc1
buffer_load_dwordx4 a[76:79], v222, s[28:31], s38 offen sc1
s_waitcnt vmcnt(7)
d1_61:
s_cmp_lt_u32 s16, 2
s_cbranch_scc1 exit_63
s_barrier
mf v[128:131],a[192:195],a[128:131],v[176:179]
ds_read_b128 a[224:227], v204 offset:8192
mf v[128:131],a[196:199],a[132:135],v[128:131]
v_add_f32 v202, v202, v200
v_add_f32 v203, v203, v201
mf v[128:131],a[200:203],a[136:139],v[128:131]
ds_read_b128 a[228:231], v204 offset:9216
v_cvt_pk_bf16_f32 v160, v184, v185
mf v[128:131],a[204:207],a[140:143],v[128:131]
v_cvt_pk_bf16_f32 v161, v186, v187
v_cvt_pk_bf16_f32 v164, v188, v189
mf v[132:135],a[204:207],a[172:175],v[180:183]
ds_read_b128 a[232:235], v204 offset:10240
v_cvt_pk_bf16_f32 v165, v190, v191
v_cvt_pk_bf16_f32 v162, v192, v193
mf v[132:135],a[200:203],a[168:171],v[132:135]
buffer_load_dword v220, v221, s[28:31], 0 offen sc1
mf v[132:135],a[196:199],a[164:167],v[132:135]
ds_read_b128 a[236:239], v204 offset:11264
s_waitcnt lgkmcnt(4)
mf v[132:135],a[192:195],a[160:163],v[132:135]
v_cvt_pk_bf16_f32 v163, v194, v195
v_cvt_pk_bf16_f32 v166, v196, v197
mf v[132:135],a[208:211],a[176:179],v[132:135]
ds_read_b128 a[240:243], v204 offset:12288
v_cvt_pk_bf16_f32 v167, v198, v199
v_cvt_pk_bf16_f32 v168, v224, v225
mf v[132:135],a[212:215],a[180:183],v[132:135]
v_cvt_pk_bf16_f32 v169, v226, v227
v_cvt_pk_bf16_f32 v172, v228, v229
mf v[132:135],a[216:219],a[184:187],v[132:135]
ds_read_b128 a[244:247], v204 offset:13312
s_add_u32 m0, s34, 73728
s_add_u32 s37, s99, 28672
mf v[132:135],a[220:223],a[188:191],v[132:135]
buffer_load_dwordx4 v240, s[20:23], s37 offen lds
mf v[128:131],a[220:223],a[156:159],v[128:131]
ds_read_b128 a[248:251], v204 offset:14336
v_cvt_pk_bf16_f32 v173, v230, v231
mf v[128:131],a[216:219],a[152:155],v[128:131]
v_cvt_pk_bf16_f32 v170, v232, v233
v_cvt_pk_bf16_f32 v171, v234, v235
v_cvt_pk_bf16_f32 v174, v236, v237
mf v[128:131],a[212:215],a[148:151],v[128:131]
ds_read_b128 a[252:255], v204 offset:15360
s_waitcnt lgkmcnt(4)
mf v[128:131],a[208:211],a[144:147],v[128:131]
v_cvt_pk_bf16_f32 v175, v238, v239
v_cmp_gt_i32 s[44:45], 0, v207
mf v[136:139],a[224:227],a[128:131],v[176:179]
ds_read_b128 a[192:195], v204 offset:16384
v_cmp_gt_i32 s[46:47], 1, v207
mf v[136:139],a[228:231],a[132:135],v[136:139]
buffer_load_dwordx4 v241, s[20:23], s37 offen offset:1024 lds
mf v[136:139],a[232:235],a[136:139],v[136:139]
ds_read_b128 a[196:199], v204 offset:17408
v_cmp_gt_i32 s[48:49], 2, v207
mf v[136:139],a[236:239],a[140:143],v[136:139]
v_exp_f32 v188, v132
mf v[140:143],a[236:239],a[172:175],v[180:183]
ds_read_b128 a[200:203], v204 offset:18432
v_cmp_gt_i32 s[50:51], 3, v207
mf v[140:143],a[232:235],a[168:171],v[140:143]
v_exp_f32 v189, v133
mf v[140:143],a[228:231],a[164:167],v[140:143]
ds_read_b128 a[204:207], v204 offset:19456
s_waitcnt lgkmcnt(4)
s_add_u32 s38, s98, 1024
mf v[140:143],a[224:227],a[160:163],v[140:143]
buffer_load_dwordx4 a[80:83], v206, s[28:31], s38 offen sc1
mf v[140:143],a[240:243],a[176:179],v[140:143]
ds_read_b128 a[208:211], v204 offset:20480
v_cmp_gt_i32 s[52:53], 16, v207
mf v[140:143],a[244:247],a[180:183],v[140:143]
v_exp_f32 v190, v134
mf v[140:143],a[248:251],a[184:187],v[140:143]
ds_read_b128 a[212:215], v204 offset:21504
v_exp_f32 v191, v135
mf v[140:143],a[252:255],a[188:191],v[140:143]
v_cmp_gt_i32 s[54:55], 32, v207
v_cmp_gt_i32 s[56:57], 33, v207
mf v[136:139],a[252:255],a[156:159],v[136:139]
ds_read_b128 a[216:219], v204 offset:22528
v_cmp_gt_i32 s[58:59], 34, v207
mf v[136:139],a[248:251],a[152:155],v[136:139]
buffer_load_dwordx4 a[84:87], v222, s[28:31], s38 offen sc1
mf v[136:139],a[244:247],a[148:151],v[136:139]
ds_read_b128 a[220:223], v204 offset:23552
s_waitcnt lgkmcnt(4)
v_cmp_gt_i32 s[60:61], 35, v207
mf v[136:139],a[240:243],a[144:147],v[136:139]
v_cmp_gt_i32 s[62:63], 48, v207
v_subrev_u32 v207, 64, v207
mf v[144:147],a[192:195],a[128:131],v[176:179]
ds_read_b128 a[224:227], v204 offset:24576
v_cndmask_b32 v128, v128, v208, s[44:45]
mf v[144:147],a[196:199],a[132:135],v[144:147]
v_exp_f32 v184, v128
mf v[144:147],a[200:203],a[136:139],v[144:147]
ds_read_b128 a[228:231], v204 offset:25600
v_cndmask_b32 v129, v129, v208, s[46:47]
mf v[144:147],a[204:207],a[140:143],v[144:147]
v_exp_f32 v185, v129
v_cndmask_b32 v130, v130, v208, s[48:49]
mf v[148:151],a[204:207],a[172:175],v[180:183]
ds_read_b128 a[232:235], v204 offset:26624
s_add_u32 m0, s34, 81920
s_add_u32 s37, s99, 57344
mf v[148:151],a[200:203],a[168:171],v[148:151]
buffer_load_dwordx4 v240, s[20:23], s37 offen lds
mf v[148:151],a[196:199],a[164:167],v[148:151]
ds_read_b128 a[236:239], v204 offset:27648
s_waitcnt lgkmcnt(4)
mf v[148:151],a[192:195],a[160:163],v[148:151]
v_exp_f32 v186, v130
v_cndmask_b32 v131, v131, v208, s[50:51]
mf v[148:151],a[208:211],a[176:179],v[148:151]
ds_read_b128 a[240:243], v204 offset:28672
v_cndmask_b32 v140, v140, v208, s[44:45]
mf v[148:151],a[212:215],a[180:183],v[148:151]
v_exp_f32 v187, v131
mf v[148:151],a[216:219],a[184:187],v[148:151]
ds_read_b128 a[244:247], v204 offset:29696
v_cndmask_b32 v141, v141, v208, s[46:47]
mf v[148:151],a[220:223],a[188:191],v[148:151]
buffer_load_dwordx4 v241, s[20:23], s37 offen offset:1024 lds
mf v[144:147],a[220:223],a[156:159],v[144:147]
ds_read_b128 a[248:251], v204 offset:30720
v_exp_f32 v196, v140
mf v[144:147],a[216:219],a[152:155],v[144:147]
v_exp_f32 v197, v141
mf v[144:147],a[212:215],a[148:151],v[144:147]
ds_read_b128 a[252:255], v204 offset:31744
s_waitcnt lgkmcnt(4)
mf v[144:147],a[208:211],a[144:147],v[144:147]
v_cndmask_b32 v142, v142, v208, s[48:49]
v_cndmask_b32 v143, v143, v208, s[50:51]
mf v[152:155],a[224:227],a[128:131],v[176:179]
v_xor_b32 v204, 0x38000, v204
ds_read_b128 a[192:195], v205 offset:0
s_add_u32 s38, s98, 2048
mf v[152:155],a[228:231],a[132:135],v[152:155]
buffer_load_dwordx4 a[88:91], v206, s[28:31], s38 offen sc1
mf v[152:155],a[232:235],a[136:139],v[152:155]
ds_read_b128 a[196:199], v205 offset:16384
v_cndmask_b32 v136, v136, v208, s[52:53]
mf v[152:155],a[236:239],a[140:143],v[152:155]
v_exp_f32 v198, v142
mf v[156:159],a[236:239],a[172:175],v[180:183]
ds_read_b128 a[200:203], v205 offset:1024
v_exp_f32 v199, v143
mf v[156:159],a[232:235],a[168:171],v[156:159]
v_exp_f32 v192, v136
mf v[156:159],a[228:231],a[164:167],v[156:159]
ds_read_b128 a[204:207], v205 offset:17408
s_waitcnt lgkmcnt(4)
mf v[156:159],a[224:227],a[160:163],v[156:159]
buffer_load_dwordx4 a[92:95], v222, s[28:31], s38 offen sc1
mf v[156:159],a[240:243],a[176:179],v[156:159]
ds_read_b128 a[208:211], v205 offset:2048
v_cndmask_b32 v137, v137, v208, s[52:53]
mf v[156:159],a[244:247],a[180:183],v[156:159]
v_exp_f32 v193, v137
v_cndmask_b32 v138, v138, v208, s[52:53]
mf v[156:159],a[248:251],a[184:187],v[156:159]
ds_read_b128 a[212:215], v205 offset:18432
v_cndmask_b32 v139, v139, v208, s[52:53]
mf v[156:159],a[252:255],a[188:191],v[156:159]
v_exp_f32 v194, v138
mf v[152:155],a[252:255],a[156:159],v[152:155]
ds_read_b128 a[216:219], v205 offset:3072
v_cndmask_b32 v148, v148, v208, s[52:53]
mf v[152:155],a[248:251],a[152:155],v[152:155]
v_exp_f32 v195, v139
v_cndmask_b32 v149, v149, v208, s[52:53]
mf v[152:155],a[244:247],a[148:151],v[152:155]
ds_read_b128 a[220:223], v205 offset:19456
s_waitcnt lgkmcnt(4)
mf v[152:155],a[240:243],a[144:147],v[152:155]
s_waitcnt vmcnt(8)
v_cndmask_b32 v150, v150, v208, s[52:53]
s_mov_b32 s36, 0x40000000
s_cmp_lg_u32 s11, 2
s_cbranch_scc1 nopart_76
s_mov_b64 exec, 0x1000000
v_cmp_gt_u32 vcc, 3, v220
s_mov_b64 exec, -1
s_cbranch_vccz chk_77
s_mov_b32 s36, 0x80000
s_mov_b64 exec, 0x1000000
poll_78:
buffer_load_dword v220, v221, s[28:31], 0 offen sc1
s_waitcnt vmcnt(0)
v_cmp_gt_u32 vcc, 3, v220
s_cbranch_vccz pollok_79
s_sleep 2
s_sub_u32 s36, s36, 1
s_cmp_lg_u32 s36, 0
s_cbranch_scc1 poll_78
pollok_79:
s_mov_b64 exec, -1
chk_77:
s_mul_i32 s36, s5, 69632
s_mul_i32 s17, s16, 17408
s_add_u32 s36, s36, s17
s_add_u32 s36, s36, 83886080
nopart_76:
mf v[0:3],a[192:195],v[160:163],v[0:3]
ds_read_b128 a[224:227], v205 offset:4096
v_cndmask_b32 v151, v151, v208, s[52:53]
mf v[0:3],a[196:199],v[168:171],v[0:3]
v_exp_f32 v228, v148
mf v[64:67],a[196:199],v[172:175],v[64:67]
ds_read_b128 a[228:231], v205 offset:20480
s_add_u32 m0, s34, 90112
v_cndmask_b32 v144, v144, v208, s[54:55]
mf v[64:67],a[192:195],v[164:167],v[64:67]
v_exp_f32 v229, v149
mf v[68:71],a[200:203],v[164:167],v[68:71]
ds_read_b128 a[232:235], v205 offset:5120
s_add_u32 s37, s99, 86016
mf v[68:71],a[204:207],v[172:175],v[68:71]
buffer_load_dwordx4 v240, s[20:23], s37 offen lds
mf v[4:7],a[204:207],v[168:171],v[4:7]
ds_read_b128 a[236:239], v205 offset:21504
s_waitcnt lgkmcnt(4)
v_cndmask_b32 v145, v145, v208, s[56:57]
mf v[4:7],a[200:203],v[160:163],v[4:7]
v_exp_f32 v230, v150
mf v[8:11],a[208:211],v[160:163],v[8:11]
ds_read_b128 a[240:243], v205 offset:6144
v_cndmask_b32 v146, v146, v208, s[58:59]
mf v[8:11],a[212:215],v[168:171],v[8:11]
buffer_load_dwordx4 v241, s[20:23], s37 offen offset:1024 lds
mf v[72:75],a[212:215],v[172:175],v[72:75]
ds_read_b128 a[244:247], v205 offset:22528
v_cndmask_b32 v147, v147, v208, s[60:61]
mf v[72:75],a[208:211],v[164:167],v[72:75]
v_exp_f32 v231, v151
v_cndmask_b32 v156, v156, v208, s[54:55]
mf v[76:79],a[216:219],v[164:167],v[76:79]
ds_read_b128 a[248:251], v205 offset:7168
v_cndmask_b32 v157, v157, v208, s[56:57]
mf v[76:79],a[220:223],v[172:175],v[76:79]
v_exp_f32 v224, v144
mf v[12:15],a[220:223],v[168:171],v[12:15]
ds_read_b128 a[252:255], v205 offset:23552
s_waitcnt lgkmcnt(4)
s_add_u32 s38, s98, 3072
mf v[12:15],a[216:219],v[160:163],v[12:15]
buffer_load_dwordx4 a[96:99], v206, s[28:31], s38 offen sc1
mf v[16:19],a[224:227],v[160:163],v[16:19]
ds_read_b128 a[192:195], v205 offset:8192
v_cndmask_b32 v158, v158, v208, s[58:59]
mf v[16:19],a[228:231],v[168:171],v[16:19]
v_exp_f32 v225, v145
mf v[80:83],a[228:231],v[172:175],v[80:83]
ds_read_b128 a[196:199], v205 offset:24576
v_cndmask_b32 v159, v159, v208, s[60:61]
mf v[80:83],a[224:227],v[164:167],v[80:83]
v_exp_f32 v226, v146
v_cndmask_b32 v152, v152, v208, s[62:63]
mf v[84:87],a[232:235],v[164:167],v[84:87]
ds_read_b128 a[200:203], v205 offset:9216
v_cndmask_b32 v153, v153, v208, s[62:63]
mf v[84:87],a[236:239],v[172:175],v[84:87]
buffer_load_dwordx4 a[100:103], v222, s[28:31], s38 offen sc1
mf v[20:23],a[236:239],v[168:171],v[20:23]
ds_read_b128 a[204:207], v205 offset:25600
s_waitcnt lgkmcnt(4)
mf v[20:23],a[232:235],v[160:163],v[20:23]
v_exp_f32 v227, v147
mf v[24:27],a[240:243],v[160:163],v[24:27]
ds_read_b128 a[208:211], v205 offset:10240
v_exp_f32 v236, v156
mf v[24:27],a[244:247],v[168:171],v[24:27]
v_exp_f32 v237, v157
mf v[88:91],a[244:247],v[172:175],v[88:91]
ds_read_b128 a[212:215], v205 offset:26624
v_cndmask_b32 v154, v154, v208, s[62:63]
mf v[88:91],a[240:243],v[164:167],v[88:91]
buffer_load_dwordx4 a[0:3], v206, s[28:31], s36 offen offset:0 sc1
mf v[92:95],a[248:251],v[164:167],v[92:95]
ds_read_b128 a[216:219], v205 offset:11264
v_exp_f32 v238, v158
mf v[92:95],a[252:255],v[172:175],v[92:95]
v_exp_f32 v239, v159
mf v[28:31],a[252:255],v[168:171],v[28:31]
ds_read_b128 a[220:223], v205 offset:27648
s_waitcnt lgkmcnt(4)
mf v[28:31],a[248:251],v[160:163],v[28:31]
v_exp_f32 v232, v152
mf v[32:35],a[192:195],v[160:163],v[32:35]
ds_read_b128 a[224:227], v205 offset:12288
v_cndmask_b32 v155, v155, v208, s[62:63]
mf v[32:35],a[196:199],v[168:171],v[32:35]
buffer_load_dwordx4 a[4:7], v206, s[28:31], s36 offen offset:1024 sc1
mf v[96:99],a[196:199],v[172:175],v[96:99]
ds_read_b128 a[228:231], v205 offset:28672
v_add_f32 v201, v188, v189
mf v[96:99],a[192:195],v[164:167],v[96:99]
v_exp_f32 v233, v153
mf v[100:103],a[200:203],v[164:167],v[100:103]
ds_read_b128 a[232:235], v205 offset:13312
v_add_f32 v201, v201, v190
mf v[100:103],a[204:207],v[172:175],v[100:103]
v_exp_f32 v234, v154
v_add_f32 v201, v201, v191
mf v[36:39],a[204:207],v[168:171],v[36:39]
ds_read_b128 a[236:239], v205 offset:29696
s_waitcnt lgkmcnt(4)
mf v[36:39],a[200:203],v[160:163],v[36:39]
buffer_load_dwordx4 a[8:11], v206, s[28:31], s36 offen offset:2048 sc1
mf v[40:43],a[208:211],v[160:163],v[40:43]
ds_read_b128 a[240:243], v205 offset:14336
v_add_f32 v200, v184, v185
mf v[40:43],a[212:215],v[168:171],v[40:43]
v_exp_f32 v235, v155
v_add_f32 v200, v200, v186
mf v[104:107],a[212:215],v[172:175],v[104:107]
ds_read_b128 a[244:247], v205 offset:30720
v_add_f32 v200, v200, v187
mf v[104:107],a[208:211],v[164:167],v[104:107]
v_add_f32 v201, v201, v196
v_add_f32 v201, v201, v197
mf v[108:111],a[216:219],v[164:167],v[108:111]
ds_read_b128 a[248:251], v205 offset:15360
v_add_f32 v201, v201, v198
mf v[108:111],a[220:223],v[172:175],v[108:111]
buffer_load_dwordx4 a[12:15], v206, s[28:31], s36 offen offset:3072 sc1
mf v[44:47],a[220:223],v[168:171],v[44:47]
ds_read_b128 a[252:255], v205 offset:31744
s_waitcnt lgkmcnt(4)
v_add_f32 v201, v201, v199
mf v[44:47],a[216:219],v[160:163],v[44:47]
v_add_f32 v200, v200, v192
v_add_f32 v200, v200, v193
mf v[48:51],a[224:227],v[160:163],v[48:51]
v_mov_b32 v205, v204
ds_read_b128 a[192:195], v205 offset:0
mf v[48:51],a[228:231],v[168:171],v[48:51]
v_add_f32 v200, v200, v194
v_add_f32 v200, v200, v195
mf v[112:115],a[228:231],v[172:175],v[112:115]
ds_read_b128 a[196:199], v205 offset:16384
s_add_u32 s36, s36, 4096
v_add_f32 v201, v201, v228
mf v[112:115],a[224:227],v[164:167],v[112:115]
buffer_load_dwordx4 a[16:19], v206, s[28:31], s36 offen offset:0 sc1
mf v[116:119],a[232:235],v[164:167],v[116:119]
ds_read_b128 a[200:203], v205 offset:1024
v_add_f32 v201, v201, v229
mf v[116:119],a[236:239],v[172:175],v[116:119]
v_add_f32 v201, v201, v230
v_add_f32 v201, v201, v231
mf v[52:55],a[236:239],v[168:171],v[52:55]
ds_read_b128 a[204:207], v205 offset:17408
s_waitcnt lgkmcnt(4)
mf v[52:55],a[232:235],v[160:163],v[52:55]
v_add_f32 v200, v200, v224
v_add_f32 v200, v200, v225
v_add_f32 v200, v200, v226
mf v[56:59],a[240:243],v[160:163],v[56:59]
ds_read_b128 a[208:211], v205 offset:2048
v_add_f32 v200, v200, v227
mf v[56:59],a[244:247],v[168:171],v[56:59]
buffer_load_dwordx4 a[20:23], v206, s[28:31], s36 offen offset:1024 sc1
mf v[120:123],a[244:247],v[172:175],v[120:123]
ds_read_b128 a[212:215], v205 offset:18432
v_add_f32 v201, v201, v236
mf v[120:123],a[240:243],v[164:167],v[120:123]
v_add_f32 v201, v201, v237
v_add_f32 v201, v201, v238
v_add_f32 v201, v201, v239
mf v[124:127],a[248:251],v[164:167],v[124:127]
ds_read_b128 a[216:219], v205 offset:3072
v_add_f32 v200, v200, v232
mf v[124:127],a[252:255],v[172:175],v[124:127]
v_add_f32 v200, v200, v233
v_add_f32 v200, v200, v234
mf v[60:63],a[252:255],v[168:171],v[60:63]
ds_read_b128 a[220:223], v205 offset:19456
s_waitcnt lgkmcnt(4)
mf v[60:63],a[248:251],v[160:163],v[60:63]
v_add_f32 v200, v200, v235
v_max_f32 v210, v200, v201
v_cmp_nge_f32 vcc, s39, v210
s_cbranch_vccnz slow_80
back_81:
v_add_f32 v202, v202, v200
v_add_f32 v203, v203, v201
v_cvt_pk_bf16_f32 v160, v184, v185
v_cvt_pk_bf16_f32 v161, v186, v187
v_cvt_pk_bf16_f32 v164, v188, v189
v_cvt_pk_bf16_f32 v165, v190, v191
v_cvt_pk_bf16_f32 v162, v192, v193
v_cvt_pk_bf16_f32 v163, v194, v195
v_cvt_pk_bf16_f32 v166, v196, v197
v_cvt_pk_bf16_f32 v167, v198, v199
v_cvt_pk_bf16_f32 v168, v224, v225
v_cvt_pk_bf16_f32 v169, v226, v227
v_cvt_pk_bf16_f32 v172, v228, v229
v_cvt_pk_bf16_f32 v173, v230, v231
v_cvt_pk_bf16_f32 v170, v232, v233
v_cvt_pk_bf16_f32 v171, v234, v235
v_cvt_pk_bf16_f32 v174, v236, v237
v_cvt_pk_bf16_f32 v175, v238, v239
s_waitcnt lgkmcnt(4)
mf v[0:3],a[192:195],v[160:163],v[0:3]
ds_read_b128 a[224:227], v205 offset:4096
buffer_load_dwordx4 a[24:27], v206, s[28:31], s36 offen offset:2048 sc1
mf v[0:3],a[196:199],v[168:171],v[0:3]
buffer_load_dwordx4 a[28:31], v206, s[28:31], s36 offen offset:3072 sc1
s_add_u32 s36, s36, 4096
mf v[64:67],a[196:199],v[172:175],v[64:67]
ds_read_b128 a[228:231], v205 offset:20480
buffer_load_dwordx4 a[32:35], v206, s[28:31], s36 offen offset:0 sc1
mf v[64:67],a[192:195],v[164:167],v[64:67]
buffer_load_dwordx4 a[36:39], v206, s[28:31], s36 offen offset:1024 sc1
buffer_load_dwordx4 a[40:43], v206, s[28:31], s36 offen offset:2048 sc1
mf v[68:71],a[200:203],v[164:167],v[68:71]
ds_read_b128 a[232:235], v205 offset:5120
buffer_load_dwordx4 a[44:47], v206, s[28:31], s36 offen offset:3072 sc1
mf v[68:71],a[204:207],v[172:175],v[68:71]
s_add_u32 s36, s36, 4096
buffer_load_dwordx4 a[48:51], v206, s[28:31], s36 offen offset:0 sc1
mf v[4:7],a[204:207],v[168:171],v[4:7]
ds_read_b128 a[236:239], v205 offset:21504
s_waitcnt lgkmcnt(4)
mf v[4:7],a[200:203],v[160:163],v[4:7]
buffer_load_dwordx4 a[52:55], v206, s[28:31], s36 offen offset:1024 sc1
buffer_load_dwordx4 a[56:59], v206, s[28:31], s36 offen offset:2048 sc1
mf v[8:11],a[208:211],v[160:163],v[8:11]
ds_read_b128 a[240:243], v205 offset:6144
buffer_load_dwordx4 a[60:63], v206, s[28:31], s36 offen offset:3072 sc1
mf v[8:11],a[212:215],v[168:171],v[8:11]
s_add_u32 s36, s36, 4096
buffer_load_dwordx4 a[64:67], v206, s[28:31], s36 offen offset:0 sc1
mf v[72:75],a[212:215],v[172:175],v[72:75]
ds_read_b128 a[244:247], v205 offset:22528
s_load_dwordx2 s[60:61], s[0:1], 40
mf v[72:75],a[208:211],v[164:167],v[72:75]
s_load_dwordx2 s[62:63], s[0:1], 96
s_mov_b32 s44, s4
mf v[76:79],a[216:219],v[164:167],v[76:79]
ds_read_b128 a[248:251], v205 offset:7168
s_mov_b32 s45, s10
mf v[76:79],a[220:223],v[172:175],v[76:79]
s_mov_b32 s46, s41
s_xor_b32 s17, s46, 3
mf v[12:15],a[220:223],v[168:171],v[12:15]
ds_read_b128 a[252:255], v205 offset:23552
s_waitcnt lgkmcnt(4)
mf v[12:15],a[216:219],v[160:163],v[12:15]
s_lshl_b32 s17, s17, 1
v_lshrrev_b32 v242, 4, v255
mf v[16:19],a[224:227],v[160:163],v[16:19]
ds_read_b128 a[192:195], v205 offset:8192
v_lshlrev_b32 v242, 11, v242
mf v[16:19],a[228:231],v[168:171],v[16:19]
v_bfe_u32 v243, v255, 2, 2
v_lshl_add_u32 v242, v243, 8, v242
mf v[80:83],a[228:231],v[172:175],v[80:83]
ds_read_b128 a[196:199], v205 offset:24576
v_and_b32 v244, 3, v255
mf v[80:83],a[224:227],v[164:167],v[80:83]
v_lshl_add_u32 v242, v244, 3, v242
v_bfe_u32 v243, v255, 2, 3
mf v[84:87],a[232:235],v[164:167],v[84:87]
ds_read_b128 a[200:203], v205 offset:9216
v_xor_b32 v243, s17, v243
mf v[84:87],a[236:239],v[172:175],v[84:87]
v_xor_b32 v244, 0, v243
v_lshl_add_u32 v224, v244, 5, v242
mf v[20:23],a[236:239],v[168:171],v[20:23]
ds_read_b128 a[204:207], v205 offset:25600
s_waitcnt lgkmcnt(4)
mf v[20:23],a[232:235],v[160:163],v[20:23]
v_add_u32 v232, 0x10000, v224
v_xor_b32 v244, 1, v243
mf v[24:27],a[240:243],v[160:163],v[24:27]
ds_read_b128 a[208:211], v205 offset:10240
v_lshl_add_u32 v225, v244, 5, v242
mf v[24:27],a[244:247],v[168:171],v[24:27]
v_add_u32 v233, 0x10000, v225
v_xor_b32 v244, 2, v243
mf v[88:91],a[244:247],v[172:175],v[88:91]
ds_read_b128 a[212:215], v205 offset:26624
v_lshl_add_u32 v226, v244, 5, v242
mf v[88:91],a[240:243],v[164:167],v[88:91]
v_add_u32 v234, 0x10000, v226
v_xor_b32 v244, 3, v243
mf v[92:95],a[248:251],v[164:167],v[92:95]
ds_read_b128 a[216:219], v205 offset:11264
v_lshl_add_u32 v227, v244, 5, v242
mf v[92:95],a[252:255],v[172:175],v[92:95]
v_add_u32 v235, 0x10000, v227
v_xor_b32 v244, 4, v243
mf v[28:31],a[252:255],v[168:171],v[28:31]
ds_read_b128 a[220:223], v205 offset:27648
s_waitcnt lgkmcnt(4)
mf v[28:31],a[248:251],v[160:163],v[28:31]
v_lshl_add_u32 v228, v244, 5, v242
v_add_u32 v236, 0x10000, v228
mf v[32:35],a[192:195],v[160:163],v[32:35]
ds_read_b128 a[224:227], v205 offset:12288
v_xor_b32 v244, 5, v243
mf v[32:35],a[196:199],v[168:171],v[32:35]
v_lshl_add_u32 v229, v244, 5, v242
v_add_u32 v237, 0x10000, v229
mf v[96:99],a[196:199],v[172:175],v[96:99]
ds_read_b128 a[228:231], v205 offset:28672
v_xor_b32 v244, 6, v243
mf v[96:99],a[192:195],v[164:167],v[96:99]
v_lshl_add_u32 v230, v244, 5, v242
v_add_u32 v238, 0x10000, v230
mf v[100:103],a[200:203],v[164:167],v[100:103]
ds_read_b128 a[232:235], v205 offset:13312
v_xor_b32 v244, 7, v243
mf v[100:103],a[204:207],v[172:175],v[100:103]
v_lshl_add_u32 v231, v244, 5, v242
v_add_u32 v239, 0x10000, v231
mf v[36:39],a[204:207],v[168:171],v[36:39]
ds_read_b128 a[236:239], v205 offset:29696
s_waitcnt lgkmcnt(4)
mf v[36:39],a[200:203],v[160:163],v[36:39]
s_lshl_b32 s17, s45, 8
s_mul_i32 s40, s12, 458752
mf v[40:43],a[208:211],v[160:163],v[40:43]
ds_read_b128 a[240:243], v205 offset:14336
s_add_u32 s40, s40, s17
mf v[40:43],a[212:215],v[168:171],v[40:43]
s_xor_b32 s17, s12, 4
s_sub_u32 s17, s17, s12
mf v[104:107],a[212:215],v[172:175],v[104:107]
ds_read_b128 a[244:247], v205 offset:30720
s_mul_i32 s47, s17, 458752
mf v[104:107],a[208:211],v[164:167],v[104:107]
s_add_u32 s47, s47, s40
s_lshl_b32 s48, s17, 14
mf v[108:111],a[216:219],v[164:167],v[108:111]
ds_read_b128 a[248:251], v205 offset:15360
s_add_u32 s48, s48, s43
mf v[108:111],a[220:223],v[172:175],v[108:111]
s_sub_u32 s17, 31, s44
s_cmp_lt_u32 s44, 8
mf v[44:47],a[220:223],v[168:171],v[44:47]
ds_read_b128 a[252:255], v205 offset:31744
s_waitcnt lgkmcnt(4)
mf v[44:47],a[216:219],v[160:163],v[44:47]
s_cselect_b32 s17, s44, s17
s_lshl_b32 s17, s17, 3
mf v[48:51],a[224:227],v[160:163],v[48:51]
s_add_u32 s17, s17, s12
v_and_b32 v252, 1, v255
mf v[48:51],a[228:231],v[168:171],v[48:51]
v_lshl_add_u32 v252, v252, 6, s17
mf v[112:115],a[228:231],v[172:175],v[112:115]
v_and_b32 v242, 2, v255
v_lshlrev_b32 v242, 1, v242
mf v[112:115],a[224:227],v[164:167],v[112:115]
v_xor_b32 v252, v252, v242
mf v[116:119],a[232:235],v[164:167],v[116:119]
s_and_b32 s17, s2, 0xfc
mf v[116:119],a[236:239],v[172:175],v[116:119]
v_and_b32 v242, 3, v255
v_add_u32 v242, s17, v242
mf v[52:55],a[236:239],v[168:171],v[52:55]
s_waitcnt lgkmcnt(0)
v_cmp_lt_u32 vcc, 3, v255
mf v[52:55],a[232:235],v[160:163],v[52:55]
s_waitcnt lgkmcnt(0)
mf v[56:59],a[240:243],v[160:163],v[56:59]
s_mov_b32 s24, s60
s_and_b32 s25, s61, 0xffff
mf v[56:59],a[244:247],v[168:171],v[56:59]
s_mov_b32 s26, 3670016
mf v[120:123],a[244:247],v[172:175],v[120:123]
s_mov_b32 s27, 0x20000
s_mov_b32 s52, s62
mf v[120:123],a[240:243],v[164:167],v[120:123]
s_and_b32 s53, s63, 0xffff
mf v[124:127],a[248:251],v[164:167],v[124:127]
s_mov_b32 s54, 1835008
mf v[124:127],a[252:255],v[172:175],v[124:127]
s_mov_b32 s55, 0x20000
v_cndmask_b32 v252, v252, v242, vcc
mf v[60:63],a[252:255],v[168:171],v[60:63]
v_lshlrev_b32 v252, 7, v252
mf v[60:63],a[248:251],v[160:163],v[60:63]
v_add_u32 v252, 105906176, v252
s_branch epi_62
exit_63:
s_barrier
ds_read_b128 a[192:195], v205 offset:0
ds_read_b128 a[196:199], v205 offset:16384
ds_read_b128 a[200:203], v205 offset:1024
ds_read_b128 a[204:207], v205 offset:17408
ds_read_b128 a[208:211], v205 offset:2048
ds_read_b128 a[212:215], v205 offset:18432
ds_read_b128 a[216:219], v205 offset:3072
ds_read_b128 a[220:223], v205 offset:19456
v_add_f32 v202, v202, v200
v_add_f32 v203, v203, v201
v_cvt_pk_bf16_f32 v160, v184, v185
v_cvt_pk_bf16_f32 v161, v186, v187
v_cvt_pk_bf16_f32 v164, v188, v189
v_cvt_pk_bf16_f32 v165, v190, v191
v_cvt_pk_bf16_f32 v162, v192, v193
v_cvt_pk_bf16_f32 v163, v194, v195
v_cvt_pk_bf16_f32 v166, v196, v197
v_cvt_pk_bf16_f32 v167, v198, v199
v_cvt_pk_bf16_f32 v168, v224, v225
v_cvt_pk_bf16_f32 v169, v226, v227
v_cvt_pk_bf16_f32 v172, v228, v229
v_cvt_pk_bf16_f32 v173, v230, v231
v_cvt_pk_bf16_f32 v170, v232, v233
v_cvt_pk_bf16_f32 v171, v234, v235
v_cvt_pk_bf16_f32 v174, v236, v237
v_cvt_pk_bf16_f32 v175, v238, v239
s_waitcnt lgkmcnt(4)
mf v[0:3],a[192:195],v[160:163],v[0:3]
ds_read_b128 a[224:227], v205 offset:4096
buffer_load_dword v220, v221, s[28:31], 0 offen sc1
mf v[0:3],a[196:199],v[168:171],v[0:3]
mf v[64:67],a[196:199],v[172:175],v[64:67]
ds_read_b128 a[228:231], v205 offset:20480
s_add_u32 m0, s34, 73728
mf v[64:67],a[192:195],v[164:167],v[64:67]
mf v[68:71],a[200:203],v[164:167],v[68:71]
ds_read_b128 a[232:235], v205 offset:5120
mf v[68:71],a[204:207],v[172:175],v[68:71]
s_add_u32 s37, s99, 28672
mf v[4:7],a[204:207],v[168:171],v[4:7]
ds_read_b128 a[236:239], v205 offset:21504
s_waitcnt lgkmcnt(4)
mf v[4:7],a[200:203],v[160:163],v[4:7]
mf v[8:11],a[208:211],v[160:163],v[8:11]
ds_read_b128 a[240:243], v205 offset:6144
buffer_load_dwordx4 v240, s[20:23], s37 offen lds
mf v[8:11],a[212:215],v[168:171],v[8:11]
mf v[72:75],a[212:215],v[172:175],v[72:75]
ds_read_b128 a[244:247], v205 offset:22528
mf v[72:75],a[208:211],v[164:167],v[72:75]
buffer_load_dwordx4 v241, s[20:23], s37 offen offset:1024 lds
mf v[76:79],a[216:219],v[164:167],v[76:79]
ds_read_b128 a[248:251], v205 offset:7168
mf v[76:79],a[220:223],v[172:175],v[76:79]
mf v[12:15],a[220:223],v[168:171],v[12:15]
ds_read_b128 a[252:255], v205 offset:23552
s_waitcnt lgkmcnt(4)
mf v[12:15],a[216:219],v[160:163],v[12:15]
s_add_u32 s38, s98, 1024
mf v[16:19],a[224:227],v[160:163],v[16:19]
ds_read_b128 a[192:195], v205 offset:8192
mf v[16:19],a[228:231],v[168:171],v[16:19]
buffer_load_dwordx4 a[80:83], v206, s[28:31], s38 offen sc1
mf v[80:83],a[228:231],v[172:175],v[80:83]
ds_read_b128 a[196:199], v205 offset:24576
mf v[80:83],a[224:227],v[164:167],v[80:83]
mf v[84:87],a[232:235],v[164:167],v[84:87]
ds_read_b128 a[200:203], v205 offset:9216
buffer_load_dwordx4 a[84:87], v222, s[28:31], s38 offen sc1
mf v[84:87],a[236:239],v[172:175],v[84:87]
mf v[20:23],a[236:239],v[168:171],v[20:23]
ds_read_b128 a[204:207], v205 offset:25600
s_waitcnt lgkmcnt(4)
mf v[20:23],a[232:235],v[160:163],v[20:23]
s_add_u32 m0, s34, 81920
mf v[24:27],a[240:243],v[160:163],v[24:27]
ds_read_b128 a[208:211], v205 offset:10240
mf v[24:27],a[244:247],v[168:171],v[24:27]
mf v[88:91],a[244:247],v[172:175],v[88:91]
ds_read_b128 a[212:215], v205 offset:26624
s_add_u32 s37, s99, 57344
mf v[88:91],a[240:243],v[164:167],v[88:91]
mf v[92:95],a[248:251],v[164:167],v[92:95]
ds_read_b128 a[216:219], v205 offset:11264
mf v[92:95],a[252:255],v[172:175],v[92:95]
buffer_load_dwordx4 v240, s[20:23], s37 offen lds
mf v[28:31],a[252:255],v[168:171],v[28:31]
ds_read_b128 a[220:223], v205 offset:27648
s_waitcnt lgkmcnt(4)
mf v[28:31],a[248:251],v[160:163],v[28:31]
mf v[32:35],a[192:195],v[160:163],v[32:35]
ds_read_b128 a[224:227], v205 offset:12288
buffer_load_dwordx4 v241, s[20:23], s37 offen offset:1024 lds
mf v[32:35],a[196:199],v[168:171],v[32:35]
mf v[96:99],a[196:199],v[172:175],v[96:99]
ds_read_b128 a[228:231], v205 offset:28672
s_add_u32 s38, s98, 2048
mf v[96:99],a[192:195],v[164:167],v[96:99]
mf v[100:103],a[200:203],v[164:167],v[100:103]
ds_read_b128 a[232:235], v205 offset:13312
mf v[100:103],a[204:207],v[172:175],v[100:103]
buffer_load_dwordx4 a[88:91], v206, s[28:31], s38 offen sc1
mf v[36:39],a[204:207],v[168:171],v[36:39]
ds_read_b128 a[236:239], v205 offset:29696
s_waitcnt lgkmcnt(4)
mf v[36:39],a[200:203],v[160:163],v[36:39]
mf v[40:43],a[208:211],v[160:163],v[40:43]
ds_read_b128 a[240:243], v205 offset:14336
buffer_load_dwordx4 a[92:95], v222, s[28:31], s38 offen sc1
mf v[40:43],a[212:215],v[168:171],v[40:43]
mf v[104:107],a[212:215],v[172:175],v[104:107]
ds_read_b128 a[244:247], v205 offset:30720
mf v[104:107],a[208:211],v[164:167],v[104:107]
s_add_u32 m0, s34, 90112
mf v[108:111],a[216:219],v[164:167],v[108:111]
ds_read_b128 a[248:251], v205 offset:15360
mf v[108:111],a[220:223],v[172:175],v[108:111]
mf v[44:47],a[220:223],v[168:171],v[44:47]
ds_read_b128 a[252:255], v205 offset:31744
s_waitcnt lgkmcnt(4)
mf v[44:47],a[216:219],v[160:163],v[44:47]
s_add_u32 s37, s99, 86016
mf v[48:51],a[224:227],v[160:163],v[48:51]
mf v[48:51],a[228:231],v[168:171],v[48:51]
buffer_load_dwordx4 v240, s[20:23], s37 offen lds
mf v[112:115],a[228:231],v[172:175],v[112:115]
mf v[112:115],a[224:227],v[164:167],v[112:115]
mf v[116:119],a[232:235],v[164:167],v[116:119]
buffer_load_dwordx4 v241, s[20:23], s37 offen offset:1024 lds
mf v[116:119],a[236:239],v[172:175],v[116:119]
mf v[52:55],a[236:239],v[168:171],v[52:55]
s_waitcnt lgkmcnt(0)
mf v[52:55],a[232:235],v[160:163],v[52:55]
s_add_u32 s38, s98, 3072
mf v[56:59],a[240:243],v[160:163],v[56:59]
mf v[56:59],a[244:247],v[168:171],v[56:59]
mf v[120:123],a[244:247],v[172:175],v[120:123]
buffer_load_dwordx4 a[96:99], v206, s[28:31], s38 offen sc1
mf v[120:123],a[240:243],v[164:167],v[120:123]
mf v[124:127],a[248:251],v[164:167],v[124:127]
mf v[124:127],a[252:255],v[172:175],v[124:127]
buffer_load_dwordx4 a[100:103], v222, s[28:31], s38 offen sc1
mf v[60:63],a[252:255],v[168:171],v[60:63]
mf v[60:63],a[248:251],v[160:163],v[60:63]
s_waitcnt vmcnt(12)
s_mov_b32 s36, 0x40000000
s_cmp_lg_u32 s11, 2
s_cbranch_scc1 nopart_82
s_mov_b64 exec, 0x1000000
v_cmp_gt_u32 vcc, 3, v220
s_mov_b64 exec, -1
s_cbranch_vccz chk_83
s_mov_b32 s36, 0x80000
s_mov_b64 exec, 0x1000000
poll_84:
buffer_load_dword v220, v221, s[28:31], 0 offen sc1
s_waitcnt vmcnt(0)
v_cmp_gt_u32 vcc, 3, v220
s_cbranch_vccz pollok_85
s_sleep 2
s_sub_u32 s36, s36, 1
s_cmp_lg_u32 s36, 0
s_cbranch_scc1 poll_84
pollok_85:
s_mov_b64 exec, -1
chk_83:
s_mul_i32 s36, s5, 69632
s_mul_i32 s17, s16, 17408
s_add_u32 s36, s36, s17
s_add_u32 s36, s36, 83886080
nopart_82:
buffer_load_dwordx4 a[0:3], v206, s[28:31], s36 offen offset:0 sc1
buffer_load_dwordx4 a[4:7], v206, s[28:31], s36 offen offset:1024 sc1
buffer_load_dwordx4 a[8:11], v206, s[28:31], s36 offen offset:2048 sc1
buffer_load_dwordx4 a[12:15], v206, s[28:31], s36 offen offset:3072 sc1
s_add_u32 s36, s36, 4096
buffer_load_dwordx4 a[16:19], v206, s[28:31], s36 offen offset:0 sc1
buffer_load_dwordx4 a[20:23], v206, s[28:31], s36 offen offset:1024 sc1
buffer_load_dwordx4 a[24:27], v206, s[28:31], s36 offen offset:2048 sc1
buffer_load_dwordx4 a[28:31], v206, s[28:31], s36 offen offset:3072 sc1
s_add_u32 s36, s36, 4096
buffer_load_dwordx4 a[32:35], v206, s[28:31], s36 offen offset:0 sc1
buffer_load_dwordx4 a[36:39], v206, s[28:31], s36 offen offset:1024 sc1
buffer_load_dwordx4 a[40:43], v206, s[28:31], s36 offen offset:2048 sc1
buffer_load_dwordx4 a[44:47], v206, s[28:31], s36 offen offset:3072 sc1
s_add_u32 s36, s36, 4096
buffer_load_dwordx4 a[48:51], v206, s[28:31], s36 offen offset:0 sc1
buffer_load_dwordx4 a[52:55], v206, s[28:31], s36 offen offset:1024 sc1
buffer_load_dwordx4 a[56:59], v206, s[28:31], s36 offen offset:2048 sc1
buffer_load_dwordx4 a[60:63], v206, s[28:31], s36 offen offset:3072 sc1
s_add_u32 s36, s36, 4096
buffer_load_dwordx4 a[64:67], v206, s[28:31], s36 offen offset:0 sc1
s_load_dwordx2 s[60:61], s[0:1], 40
s_load_dwordx2 s[62:63], s[0:1], 96
s_mov_b32 s44, s4
s_mov_b32 s45, s10
s_mov_b32 s46, s41
s_xor_b32 s17, s46, 3
s_lshl_b32 s17, s17, 1
v_lshrrev_b32 v242, 4, v255
v_lshlrev_b32 v242, 11, v242
v_bfe_u32 v243, v255, 2, 2
v_lshl_add_u32 v242, v243, 8, v242
v_and_b32 v244, 3, v255
v_lshl_add_u32 v242, v244, 3, v242
v_bfe_u32 v243, v255, 2, 3
v_xor_b32 v243, s17, v243
v_xor_b32 v244, 0, v243
v_lshl_add_u32 v224, v244, 5, v242
v_add_u32 v232, 0x10000, v224
v_xor_b32 v244, 1, v243
v_lshl_add_u32 v225, v244, 5, v242
v_add_u32 v233, 0x10000, v225
v_xor_b32 v244, 2, v243
v_lshl_add_u32 v226, v244, 5, v242
v_add_u32 v234, 0x10000, v226
v_xor_b32 v244, 3, v243
v_lshl_add_u32 v227, v244, 5, v242
v_add_u32 v235, 0x10000, v227
v_xor_b32 v244, 4, v243
v_lshl_add_u32 v228, v244, 5, v242
v_add_u32 v236, 0x10000, v228
v_xor_b32 v244, 5, v243
v_lshl_add_u32 v229, v244, 5, v242
v_add_u32 v237, 0x10000, v229
v_xor_b32 v244, 6, v243
v_lshl_add_u32 v230, v244, 5, v242
v_add_u32 v238, 0x10000, v230
v_xor_b32 v244, 7, v243
v_lshl_add_u32 v231, v244, 5, v242
v_add_u32 v239, 0x10000, v231
s_lshl_b32 s17, s45, 8
s_mul_i32 s40, s12, 458752
s_add_u32 s40, s40, s17
s_xor_b32 s17, s12, 4
s_sub_u32 s17, s17, s12
s_mul_i32 s47, s17, 458752
s_add_u32 s47, s47, s40
s_lshl_b32 s48, s17, 14
s_add_u32 s48, s48, s43
s_sub_u32 s17, 31, s44
s_cmp_lt_u32 s44, 8
s_cselect_b32 s17, s44, s17
s_lshl_b32 s17, s17, 3
s_add_u32 s17, s17, s12
v_and_b32 v252, 1, v255
v_lshl_add_u32 v252, v252, 6, s17
v_and_b32 v242, 2, v255
v_lshlrev_b32 v242, 1, v242
v_xor_b32 v252, v252, v242
s_and_b32 s17, s2, 0xfc
v_and_b32 v242, 3, v255
v_add_u32 v242, s17, v242
v_cmp_lt_u32 vcc, 3, v255
s_waitcnt lgkmcnt(0)
s_mov_b32 s24, s60
s_and_b32 s25, s61, 0xffff
s_mov_b32 s26, 3670016
s_mov_b32 s27, 0x20000
s_mov_b32 s52, s62
s_and_b32 s53, s63, 0xffff
s_mov_b32 s54, 1835008
s_mov_b32 s55, 0x20000
v_cndmask_b32 v252, v252, v242, vcc
v_lshlrev_b32 v252, 7, v252
v_add_u32 v252, 105906176, v252
epi_62:
v_mov_b32 v210, v202
v_mov_b32 v211, v203
s_nop 1
v_permlane16_swap_b32 v210, v202
v_permlane16_swap_b32 v211, v203
s_nop 1
v_add_f32 v202, v202, v210
v_add_f32 v203, v203, v211
v_mov_b32 v210, v202
v_mov_b32 v211, v203
s_nop 1
v_permlane32_swap_b32 v210, v202
v_permlane32_swap_b32 v211, v203
s_nop 1
v_add_f32 v202, v202, v210
v_add_f32 v203, v203, v211
s_waitcnt vmcnt(0)
s_mul_i32 s9, s18, 376832
s_lshl_b32 s17, s15, 13
s_add_u32 s9, s9, s17
s_add_u32 s9, s9, 50331648
s_cmp_eq_u32 s11, 1
s_cbranch_scc1 nomerge_86
v_accvgpr_read_b32 v210, a64
v_accvgpr_read_b32 v211, a65
v_accvgpr_read_b32 v212, a66
v_accvgpr_read_b32 v213, a67
v_min_f32 v214, v176, v210
v_sub_f32 v184, v214, v176
v_sub_f32 v188, v214, v210
v_min_f32 v214, v180, v211
v_sub_f32 v186, v214, v180
v_sub_f32 v190, v214, v211
v_exp_f32 v184, v184
v_exp_f32 v188, v188
v_exp_f32 v186, v186
v_exp_f32 v190, v190
s_nop 0
v_mul_f32 v202, v202, v184
v_fmac_f32 v202, v212, v188
v_mul_f32 v203, v203, v186
v_fmac_f32 v203, v213, v190
v_rcp_f32 v210, v202
v_rcp_f32 v211, v203
s_nop 0
v_mul_f32 v210, v210, v216
v_mul_f32 v211, v211, v217
v_mul_f32 v184, v184, v210
v_mul_f32 v188, v188, v210
v_mul_f32 v186, v186, v211
v_mul_f32 v190, v190, v211
v_accvgpr_read_b32 v136, a0
v_accvgpr_read_b32 v137, a1
v_accvgpr_read_b32 v138, a2
v_accvgpr_read_b32 v139, a3
v_pk_mul_f32 v[0:1], v[0:1], v[184:185] op_sel_hi:[1,0]
v_pk_mul_f32 v[2:3], v[2:3], v[184:185] op_sel_hi:[1,0]
v_pk_mul_f32 v[4:5], v[4:5], v[184:185] op_sel_hi:[1,0]
v_pk_mul_f32 v[6:7], v[6:7], v[184:185] op_sel_hi:[1,0]
v_lshlrev_b32 v128, 16, v136
v_and_b32 v129, 0xffff0000, v136
v_lshlrev_b32 v130, 16, v137
v_and_b32 v131, 0xffff0000, v137
v_lshlrev_b32 v132, 16, v138
v_and_b32 v133, 0xffff0000, v138
v_lshlrev_b32 v134, 16, v139
v_and_b32 v135, 0xffff0000, v139
v_pk_fma_f32 v[0:1], v[128:129], v[188:189], v[0:1] op_sel_hi:[1,0,1]
v_pk_fma_f32 v[2:3], v[130:131], v[188:189], v[2:3] op_sel_hi:[1,0,1]
v_pk_fma_f32 v[4:5], v[132:133], v[188:189], v[4:5] op_sel_hi:[1,0,1]
v_pk_fma_f32 v[6:7], v[134:135], v[188:189], v[6:7] op_sel_hi:[1,0,1]
v_cvt_pk_bf16_f32 v0, v0, v1
v_cvt_pk_bf16_f32 v1, v2, v3
v_cvt_pk_bf16_f32 v2, v4, v5
v_cvt_pk_bf16_f32 v3, v6, v7
buffer_store_dwordx4 v[0:3], v206, s[28:31], s9 offen offset:0 sc1
v_accvgpr_read_b32 v148, a4
v_accvgpr_read_b32 v149, a5
v_accvgpr_read_b32 v150, a6
v_accvgpr_read_b32 v151, a7
v_pk_mul_f32 v[8:9], v[8:9], v[184:185] op_sel_hi:[1,0]
v_pk_mul_f32 v[10:11], v[10:11], v[184:185] op_sel_hi:[1,0]
v_pk_mul_f32 v[12:13], v[12:13], v[184:185] op_sel_hi:[1,0]
v_pk_mul_f32 v[14:15], v[14:15], v[184:185] op_sel_hi:[1,0]
v_lshlrev_b32 v140, 16, v148
v_and_b32 v141, 0xffff0000, v148
v_lshlrev_b32 v142, 16, v149
v_and_b32 v143, 0xffff0000, v149
v_lshlrev_b32 v144, 16, v150
v_and_b32 v145, 0xffff0000, v150
v_lshlrev_b32 v146, 16, v151
v_and_b32 v147, 0xffff0000, v151
v_pk_fma_f32 v[8:9], v[140:141], v[188:189], v[8:9] op_sel_hi:[1,0,1]
v_pk_fma_f32 v[10:11], v[142:143], v[188:189], v[10:11] op_sel_hi:[1,0,1]
v_pk_fma_f32 v[12:13], v[144:145], v[188:189], v[12:13] op_sel_hi:[1,0,1]
v_pk_fma_f32 v[14:15], v[146:147], v[188:189], v[14:15] op_sel_hi:[1,0,1]
v_cvt_pk_bf16_f32 v4, v8, v9
v_cvt_pk_bf16_f32 v5, v10, v11
v_cvt_pk_bf16_f32 v6, v12, v13
v_cvt_pk_bf16_f32 v7, v14, v15
buffer_store_dwordx4 v[4:7], v206, s[28:31], s9 offen offset:1024 sc1
v_accvgpr_read_b32 v136, a8
v_accvgpr_read_b32 v137, a9
v_accvgpr_read_b32 v138, a10
v_accvgpr_read_b32 v139, a11
v_pk_mul_f32 v[16:17], v[16:17], v[184:185] op_sel_hi:[1,0]
v_pk_mul_f32 v[18:19], v[18:19], v[184:185] op_sel_hi:[1,0]
v_pk_mul_f32 v[20:21], v[20:21], v[184:185] op_sel_hi:[1,0]
v_pk_mul_f32 v[22:23], v[22:23], v[184:185] op_sel_hi:[1,0]
v_lshlrev_b32 v128, 16, v136
v_and_b32 v129, 0xffff0000, v136
v_lshlrev_b32 v130, 16, v137
v_and_b32 v131, 0xffff0000, v137
v_lshlrev_b32 v132, 16, v138
v_and_b32 v133, 0xffff0000, v138
v_lshlrev_b32 v134, 16, v139
v_and_b32 v135, 0xffff0000, v139
v_pk_fma_f32 v[16:17], v[128:129], v[188:189], v[16:17] op_sel_hi:[1,0,1]
v_pk_fma_f32 v[18:19], v[130:131], v[188:189], v[18:19] op_sel_hi:[1,0,1]
v_pk_fma_f32 v[20:21], v[132:133], v[188:189], v[20:21] op_sel_hi:[1,0,1]
v_pk_fma_f32 v[22:23], v[134:135], v[188:189], v[22:23] op_sel_hi:[1,0,1]
v_cvt_pk_bf16_f32 v8, v16, v17
v_cvt_pk_bf16_f32 v9, v18, v19
v_cvt_pk_bf16_f32 v10, v20, v21
v_cvt_pk_bf16_f32 v11, v22, v23
buffer_store_dwordx4 v[8:11], v206, s[28:31], s9 offen offset:2048 sc1
v_accvgpr_read_b32 v148, a12
v_accvgpr_read_b32 v149, a13
v_accvgpr_read_b32 v150, a14
v_accvgpr_read_b32 v151, a15
v_pk_mul_f32 v[24:25], v[24:25], v[184:185] op_sel_hi:[1,0]
v_pk_mul_f32 v[26:27], v[26:27], v[184:185] op_sel_hi:[1,0]
v_pk_mul_f32 v[28:29], v[28:29], v[184:185] op_sel_hi:[1,0]
v_pk_mul_f32 v[30:31], v[30:31], v[184:185] op_sel_hi:[1,0]
v_lshlrev_b32 v140, 16, v148
v_and_b32 v141, 0xffff0000, v148
v_lshlrev_b32 v142, 16, v149
v_and_b32 v143, 0xffff0000, v149
v_lshlrev_b32 v144, 16, v150
v_and_b32 v145, 0xffff0000, v150
v_lshlrev_b32 v146, 16, v151
v_and_b32 v147, 0xffff0000, v151
v_pk_fma_f32 v[24:25], v[140:141], v[188:189], v[24:25] op_sel_hi:[1,0,1]
v_pk_fma_f32 v[26:27], v[142:143], v[188:189], v[26:27] op_sel_hi:[1,0,1]
v_pk_fma_f32 v[28:29], v[144:145], v[188:189], v[28:29] op_sel_hi:[1,0,1]
v_pk_fma_f32 v[30:31], v[146:147], v[188:189], v[30:31] op_sel_hi:[1,0,1]
v_cvt_pk_bf16_f32 v12, v24, v25
v_cvt_pk_bf16_f32 v13, v26, v27
v_cvt_pk_bf16_f32 v14, v28, v29
v_cvt_pk_bf16_f32 v15, v30, v31
buffer_store_dwordx4 v[12:15], v206, s[28:31], s9 offen offset:3072 sc1
s_add_u32 s9, s9, 4096
v_accvgpr_read_b32 v136, a16
v_accvgpr_read_b32 v137, a17
v_accvgpr_read_b32 v138, a18
v_accvgpr_read_b32 v139, a19
v_pk_mul_f32 v[32:33], v[32:33], v[184:185] op_sel_hi:[1,0]
v_pk_mul_f32 v[34:35], v[34:35], v[184:185] op_sel_hi:[1,0]
v_pk_mul_f32 v[36:37], v[36:37], v[184:185] op_sel_hi:[1,0]
v_pk_mul_f32 v[38:39], v[38:39], v[184:185] op_sel_hi:[1,0]
v_lshlrev_b32 v128, 16, v136
v_and_b32 v129, 0xffff0000, v136
v_lshlrev_b32 v130, 16, v137
v_and_b32 v131, 0xffff0000, v137
v_lshlrev_b32 v132, 16, v138
v_and_b32 v133, 0xffff0000, v138
v_lshlrev_b32 v134, 16, v139
v_and_b32 v135, 0xffff0000, v139
v_pk_fma_f32 v[32:33], v[128:129], v[188:189], v[32:33] op_sel_hi:[1,0,1]
v_pk_fma_f32 v[34:35], v[130:131], v[188:189], v[34:35] op_sel_hi:[1,0,1]
v_pk_fma_f32 v[36:37], v[132:133], v[188:189], v[36:37] op_sel_hi:[1,0,1]
v_pk_fma_f32 v[38:39], v[134:135], v[188:189], v[38:39] op_sel_hi:[1,0,1]
v_cvt_pk_bf16_f32 v16, v32, v33
v_cvt_pk_bf16_f32 v17, v34, v35
v_cvt_pk_bf16_f32 v18, v36, v37
v_cvt_pk_bf16_f32 v19, v38, v39
buffer_store_dwordx4 v[16:19], v206, s[28:31], s9 offen offset:0 sc1
v_accvgpr_read_b32 v148, a20
v_accvgpr_read_b32 v149, a21
v_accvgpr_read_b32 v150, a22
v_accvgpr_read_b32 v151, a23
v_pk_mul_f32 v[40:41], v[40:41], v[184:185] op_sel_hi:[1,0]
v_pk_mul_f32 v[42:43], v[42:43], v[184:185] op_sel_hi:[1,0]
v_pk_mul_f32 v[44:45], v[44:45], v[184:185] op_sel_hi:[1,0]
v_pk_mul_f32 v[46:47], v[46:47], v[184:185] op_sel_hi:[1,0]
v_lshlrev_b32 v140, 16, v148
v_and_b32 v141, 0xffff0000, v148
v_lshlrev_b32 v142, 16, v149
v_and_b32 v143, 0xffff0000, v149
v_lshlrev_b32 v144, 16, v150
v_and_b32 v145, 0xffff0000, v150
v_lshlrev_b32 v146, 16, v151
v_and_b32 v147, 0xffff0000, v151
v_pk_fma_f32 v[40:41], v[140:141], v[188:189], v[40:41] op_sel_hi:[1,0,1]
v_pk_fma_f32 v[42:43], v[142:143], v[188:189], v[42:43] op_sel_hi:[1,0,1]
v_pk_fma_f32 v[44:45], v[144:145], v[188:189], v[44:45] op_sel_hi:[1,0,1]
v_pk_fma_f32 v[46:47], v[146:147], v[188:189], v[46:47] op_sel_hi:[1,0,1]
v_cvt_pk_bf16_f32 v20, v40, v41
v_cvt_pk_bf16_f32 v21, v42, v43
v_cvt_pk_bf16_f32 v22, v44, v45
v_cvt_pk_bf16_f32 v23, v46, v47
buffer_store_dwordx4 v[20:23], v206, s[28:31], s9 offen offset:1024 sc1
v_accvgpr_read_b32 v136, a24
v_accvgpr_read_b32 v137, a25
v_accvgpr_read_b32 v138, a26
v_accvgpr_read_b32 v139, a27
v_pk_mul_f32 v[48:49], v[48:49], v[184:185] op_sel_hi:[1,0]
v_pk_mul_f32 v[50:51], v[50:51], v[184:185] op_sel_hi:[1,0]
v_pk_mul_f32 v[52:53], v[52:53], v[184:185] op_sel_hi:[1,0]
v_pk_mul_f32 v[54:55], v[54:55], v[184:185] op_sel_hi:[1,0]
v_lshlrev_b32 v128, 16, v136
v_and_b32 v129, 0xffff0000, v136
v_lshlrev_b32 v130, 16, v137
v_and_b32 v131, 0xffff0000, v137
v_lshlrev_b32 v132, 16, v138
v_and_b32 v133, 0xffff0000, v138
v_lshlrev_b32 v134, 16, v139
v_and_b32 v135, 0xffff0000, v139
v_pk_fma_f32 v[48:49], v[128:129], v[188:189], v[48:49] op_sel_hi:[1,0,1]
v_pk_fma_f32 v[50:51], v[130:131], v[188:189], v[50:51] op_sel_hi:[1,0,1]
v_pk_fma_f32 v[52:53], v[132:133], v[188:189], v[52:53] op_sel_hi:[1,0,1]
v_pk_fma_f32 v[54:55], v[134:135], v[188:189], v[54:55] op_sel_hi:[1,0,1]
v_cvt_pk_bf16_f32 v24, v48, v49
v_cvt_pk_bf16_f32 v25, v50, v51
v_cvt_pk_bf16_f32 v26, v52, v53
v_cvt_pk_bf16_f32 v27, v54, v55
buffer_store_dwordx4 v[24:27], v206, s[28:31], s9 offen offset:2048 sc1
v_accvgpr_read_b32 v148, a28
v_accvgpr_read_b32 v149, a29
v_accvgpr_read_b32 v150, a30
v_accvgpr_read_b32 v151, a31
v_pk_mul_f32 v[56:57], v[56:57], v[184:185] op_sel_hi:[1,0]
v_pk_mul_f32 v[58:59], v[58:59], v[184:185] op_sel_hi:[1,0]
v_pk_mul_f32 v[60:61], v[60:61], v[184:185] op_sel_hi:[1,0]
v_pk_mul_f32 v[62:63], v[62:63], v[184:185] op_sel_hi:[1,0]
v_lshlrev_b32 v140, 16, v148
v_and_b32 v141, 0xffff0000, v148
v_lshlrev_b32 v142, 16, v149
v_and_b32 v143, 0xffff0000, v149
v_lshlrev_b32 v144, 16, v150
v_and_b32 v145, 0xffff0000, v150
v_lshlrev_b32 v146, 16, v151
v_and_b32 v147, 0xffff0000, v151
v_pk_fma_f32 v[56:57], v[140:141], v[188:189], v[56:57] op_sel_hi:[1,0,1]
v_pk_fma_f32 v[58:59], v[142:143], v[188:189], v[58:59] op_sel_hi:[1,0,1]
v_pk_fma_f32 v[60:61], v[144:145], v[188:189], v[60:61] op_sel_hi:[1,0,1]
v_pk_fma_f32 v[62:63], v[146:147], v[188:189], v[62:63] op_sel_hi:[1,0,1]
v_cvt_pk_bf16_f32 v28, v56, v57
v_cvt_pk_bf16_f32 v29, v58, v59
v_cvt_pk_bf16_f32 v30, v60, v61
v_cvt_pk_bf16_f32 v31, v62, v63
buffer_store_dwordx4 v[28:31], v206, s[28:31], s9 offen offset:3072 sc1
s_add_u32 s9, s9, 184320
v_accvgpr_read_b32 v136, a32
v_accvgpr_read_b32 v137, a33
v_accvgpr_read_b32 v138, a34
v_accvgpr_read_b32 v139, a35
v_pk_mul_f32 v[64:65], v[64:65], v[186:187] op_sel_hi:[1,0]
v_pk_mul_f32 v[66:67], v[66:67], v[186:187] op_sel_hi:[1,0]
v_pk_mul_f32 v[68:69], v[68:69], v[186:187] op_sel_hi:[1,0]
v_pk_mul_f32 v[70:71], v[70:71], v[186:187] op_sel_hi:[1,0]
v_lshlrev_b32 v128, 16, v136
v_and_b32 v129, 0xffff0000, v136
v_lshlrev_b32 v130, 16, v137
v_and_b32 v131, 0xffff0000, v137
v_lshlrev_b32 v132, 16, v138
v_and_b32 v133, 0xffff0000, v138
v_lshlrev_b32 v134, 16, v139
v_and_b32 v135, 0xffff0000, v139
v_pk_fma_f32 v[64:65], v[128:129], v[190:191], v[64:65] op_sel_hi:[1,0,1]
v_pk_fma_f32 v[66:67], v[130:131], v[190:191], v[66:67] op_sel_hi:[1,0,1]
v_pk_fma_f32 v[68:69], v[132:133], v[190:191], v[68:69] op_sel_hi:[1,0,1]
v_pk_fma_f32 v[70:71], v[134:135], v[190:191], v[70:71] op_sel_hi:[1,0,1]
v_cvt_pk_bf16_f32 v32, v64, v65
v_cvt_pk_bf16_f32 v33, v66, v67
v_cvt_pk_bf16_f32 v34, v68, v69
v_cvt_pk_bf16_f32 v35, v70, v71
buffer_store_dwordx4 v[32:35], v206, s[28:31], s9 offen offset:0 sc1
v_accvgpr_read_b32 v148, a36
v_accvgpr_read_b32 v149, a37
v_accvgpr_read_b32 v150, a38
v_accvgpr_read_b32 v151, a39
v_pk_mul_f32 v[72:73], v[72:73], v[186:187] op_sel_hi:[1,0]
v_pk_mul_f32 v[74:75], v[74:75], v[186:187] op_sel_hi:[1,0]
v_pk_mul_f32 v[76:77], v[76:77], v[186:187] op_sel_hi:[1,0]
v_pk_mul_f32 v[78:79], v[78:79], v[186:187] op_sel_hi:[1,0]
v_lshlrev_b32 v140, 16, v148
v_and_b32 v141, 0xffff0000, v148
v_lshlrev_b32 v142, 16, v149
v_and_b32 v143, 0xffff0000, v149
v_lshlrev_b32 v144, 16, v150
v_and_b32 v145, 0xffff0000, v150
v_lshlrev_b32 v146, 16, v151
v_and_b32 v147, 0xffff0000, v151
v_pk_fma_f32 v[72:73], v[140:141], v[190:191], v[72:73] op_sel_hi:[1,0,1]
v_pk_fma_f32 v[74:75], v[142:143], v[190:191], v[74:75] op_sel_hi:[1,0,1]
v_pk_fma_f32 v[76:77], v[144:145], v[190:191], v[76:77] op_sel_hi:[1,0,1]
v_pk_fma_f32 v[78:79], v[146:147], v[190:191], v[78:79] op_sel_hi:[1,0,1]
v_cvt_pk_bf16_f32 v36, v72, v73
v_cvt_pk_bf16_f32 v37, v74, v75
v_cvt_pk_bf16_f32 v38, v76, v77
v_cvt_pk_bf16_f32 v39, v78, v79
buffer_store_dwordx4 v[36:39], v206, s[28:31], s9 offen offset:1024 sc1
v_accvgpr_read_b32 v136, a40
v_accvgpr_read_b32 v137, a41
v_accvgpr_read_b32 v138, a42
v_accvgpr_read_b32 v139, a43
v_pk_mul_f32 v[80:81], v[80:81], v[186:187] op_sel_hi:[1,0]
v_pk_mul_f32 v[82:83], v[82:83], v[186:187] op_sel_hi:[1,0]
v_pk_mul_f32 v[84:85], v[84:85], v[186:187] op_sel_hi:[1,0]
v_pk_mul_f32 v[86:87], v[86:87], v[186:187] op_sel_hi:[1,0]
v_lshlrev_b32 v128, 16, v136
v_and_b32 v129, 0xffff0000, v136
v_lshlrev_b32 v130, 16, v137
v_and_b32 v131, 0xffff0000, v137
v_lshlrev_b32 v132, 16, v138
v_and_b32 v133, 0xffff0000, v138
v_lshlrev_b32 v134, 16, v139
v_and_b32 v135, 0xffff0000, v139
v_pk_fma_f32 v[80:81], v[128:129], v[190:191], v[80:81] op_sel_hi:[1,0,1]
v_pk_fma_f32 v[82:83], v[130:131], v[190:191], v[82:83] op_sel_hi:[1,0,1]
v_pk_fma_f32 v[84:85], v[132:133], v[190:191], v[84:85] op_sel_hi:[1,0,1]
v_pk_fma_f32 v[86:87], v[134:135], v[190:191], v[86:87] op_sel_hi:[1,0,1]
v_cvt_pk_bf16_f32 v40, v80, v81
v_cvt_pk_bf16_f32 v41, v82, v83
v_cvt_pk_bf16_f32 v42, v84, v85
v_cvt_pk_bf16_f32 v43, v86, v87
buffer_store_dwordx4 v[40:43], v206, s[28:31], s9 offen offset:2048 sc1
v_accvgpr_read_b32 v148, a44
v_accvgpr_read_b32 v149, a45
v_accvgpr_read_b32 v150, a46
v_accvgpr_read_b32 v151, a47
v_pk_mul_f32 v[88:89], v[88:89], v[186:187] op_sel_hi:[1,0]
v_pk_mul_f32 v[90:91], v[90:91], v[186:187] op_sel_hi:[1,0]
v_pk_mul_f32 v[92:93], v[92:93], v[186:187] op_sel_hi:[1,0]
v_pk_mul_f32 v[94:95], v[94:95], v[186:187] op_sel_hi:[1,0]
v_lshlrev_b32 v140, 16, v148
v_and_b32 v141, 0xffff0000, v148
v_lshlrev_b32 v142, 16, v149
v_and_b32 v143, 0xffff0000, v149
v_lshlrev_b32 v144, 16, v150
v_and_b32 v145, 0xffff0000, v150
v_lshlrev_b32 v146, 16, v151
v_and_b32 v147, 0xffff0000, v151
v_pk_fma_f32 v[88:89], v[140:141], v[190:191], v[88:89] op_sel_hi:[1,0,1]
v_pk_fma_f32 v[90:91], v[142:143], v[190:191], v[90:91] op_sel_hi:[1,0,1]
v_pk_fma_f32 v[92:93], v[144:145], v[190:191], v[92:93] op_sel_hi:[1,0,1]
v_pk_fma_f32 v[94:95], v[146:147], v[190:191], v[94:95] op_sel_hi:[1,0,1]
v_cvt_pk_bf16_f32 v44, v88, v89
v_cvt_pk_bf16_f32 v45, v90, v91
v_cvt_pk_bf16_f32 v46, v92, v93
v_cvt_pk_bf16_f32 v47, v94, v95
buffer_store_dwordx4 v[44:47], v206, s[28:31], s9 offen offset:3072 sc1
s_add_u32 s9, s9, 4096
v_accvgpr_read_b32 v136, a48
v_accvgpr_read_b32 v137, a49
v_accvgpr_read_b32 v138, a50
v_accvgpr_read_b32 v139, a51
v_pk_mul_f32 v[96:97], v[96:97], v[186:187] op_sel_hi:[1,0]
v_pk_mul_f32 v[98:99], v[98:99], v[186:187] op_sel_hi:[1,0]
v_pk_mul_f32 v[100:101], v[100:101], v[186:187] op_sel_hi:[1,0]
v_pk_mul_f32 v[102:103], v[102:103], v[186:187] op_sel_hi:[1,0]
v_lshlrev_b32 v128, 16, v136
v_and_b32 v129, 0xffff0000, v136
v_lshlrev_b32 v130, 16, v137
v_and_b32 v131, 0xffff0000, v137
v_lshlrev_b32 v132, 16, v138
v_and_b32 v133, 0xffff0000, v138
v_lshlrev_b32 v134, 16, v139
v_and_b32 v135, 0xffff0000, v139
v_pk_fma_f32 v[96:97], v[128:129], v[190:191], v[96:97] op_sel_hi:[1,0,1]
v_pk_fma_f32 v[98:99], v[130:131], v[190:191], v[98:99] op_sel_hi:[1,0,1]
v_pk_fma_f32 v[100:101], v[132:133], v[190:191], v[100:101] op_sel_hi:[1,0,1]
v_pk_fma_f32 v[102:103], v[134:135], v[190:191], v[102:103] op_sel_hi:[1,0,1]
v_cvt_pk_bf16_f32 v48, v96, v97
v_cvt_pk_bf16_f32 v49, v98, v99
v_cvt_pk_bf16_f32 v50, v100, v101
v_cvt_pk_bf16_f32 v51, v102, v103
buffer_store_dwordx4 v[48:51], v206, s[28:31], s9 offen offset:0 sc1
v_accvgpr_read_b32 v148, a52
v_accvgpr_read_b32 v149, a53
v_accvgpr_read_b32 v150, a54
v_accvgpr_read_b32 v151, a55
v_pk_mul_f32 v[104:105], v[104:105], v[186:187] op_sel_hi:[1,0]
v_pk_mul_f32 v[106:107], v[106:107], v[186:187] op_sel_hi:[1,0]
v_pk_mul_f32 v[108:109], v[108:109], v[186:187] op_sel_hi:[1,0]
v_pk_mul_f32 v[110:111], v[110:111], v[186:187] op_sel_hi:[1,0]
v_lshlrev_b32 v140, 16, v148
v_and_b32 v141, 0xffff0000, v148
v_lshlrev_b32 v142, 16, v149
v_and_b32 v143, 0xffff0000, v149
v_lshlrev_b32 v144, 16, v150
v_and_b32 v145, 0xffff0000, v150
v_lshlrev_b32 v146, 16, v151
v_and_b32 v147, 0xffff0000, v151
v_pk_fma_f32 v[104:105], v[140:141], v[190:191], v[104:105] op_sel_hi:[1,0,1]
v_pk_fma_f32 v[106:107], v[142:143], v[190:191], v[106:107] op_sel_hi:[1,0,1]
v_pk_fma_f32 v[108:109], v[144:145], v[190:191], v[108:109] op_sel_hi:[1,0,1]
v_pk_fma_f32 v[110:111], v[146:147], v[190:191], v[110:111] op_sel_hi:[1,0,1]
v_cvt_pk_bf16_f32 v52, v104, v105
v_cvt_pk_bf16_f32 v53, v106, v107
v_cvt_pk_bf16_f32 v54, v108, v109
v_cvt_pk_bf16_f32 v55, v110, v111
buffer_store_dwordx4 v[52:55], v206, s[28:31], s9 offen offset:1024 sc1
v_accvgpr_read_b32 v136, a56
v_accvgpr_read_b32 v137, a57
v_accvgpr_read_b32 v138, a58
v_accvgpr_read_b32 v139, a59
v_pk_mul_f32 v[112:113], v[112:113], v[186:187] op_sel_hi:[1,0]
v_pk_mul_f32 v[114:115], v[114:115], v[186:187] op_sel_hi:[1,0]
v_pk_mul_f32 v[116:117], v[116:117], v[186:187] op_sel_hi:[1,0]
v_pk_mul_f32 v[118:119], v[118:119], v[186:187] op_sel_hi:[1,0]
v_lshlrev_b32 v128, 16, v136
v_and_b32 v129, 0xffff0000, v136
v_lshlrev_b32 v130, 16, v137
v_and_b32 v131, 0xffff0000, v137
v_lshlrev_b32 v132, 16, v138
v_and_b32 v133, 0xffff0000, v138
v_lshlrev_b32 v134, 16, v139
v_and_b32 v135, 0xffff0000, v139
v_pk_fma_f32 v[112:113], v[128:129], v[190:191], v[112:113] op_sel_hi:[1,0,1]
v_pk_fma_f32 v[114:115], v[130:131], v[190:191], v[114:115] op_sel_hi:[1,0,1]
v_pk_fma_f32 v[116:117], v[132:133], v[190:191], v[116:117] op_sel_hi:[1,0,1]
v_pk_fma_f32 v[118:119], v[134:135], v[190:191], v[118:119] op_sel_hi:[1,0,1]
v_cvt_pk_bf16_f32 v56, v112, v113
v_cvt_pk_bf16_f32 v57, v114, v115
v_cvt_pk_bf16_f32 v58, v116, v117
v_cvt_pk_bf16_f32 v59, v118, v119
buffer_store_dwordx4 v[56:59], v206, s[28:31], s9 offen offset:2048 sc1
v_accvgpr_read_b32 v148, a60
v_accvgpr_read_b32 v149, a61
v_accvgpr_read_b32 v150, a62
v_accvgpr_read_b32 v151, a63
v_pk_mul_f32 v[120:121], v[120:121], v[186:187] op_sel_hi:[1,0]
v_pk_mul_f32 v[122:123], v[122:123], v[186:187] op_sel_hi:[1,0]
v_pk_mul_f32 v[124:125], v[124:125], v[186:187] op_sel_hi:[1,0]
v_pk_mul_f32 v[126:127], v[126:127], v[186:187] op_sel_hi:[1,0]
v_lshlrev_b32 v140, 16, v148
v_and_b32 v141, 0xffff0000, v148
v_lshlrev_b32 v142, 16, v149
v_and_b32 v143, 0xffff0000, v149
v_lshlrev_b32 v144, 16, v150
v_and_b32 v145, 0xffff0000, v150
v_lshlrev_b32 v146, 16, v151
v_and_b32 v147, 0xffff0000, v151
v_pk_fma_f32 v[120:121], v[140:141], v[190:191], v[120:121] op_sel_hi:[1,0,1]
v_pk_fma_f32 v[122:123], v[142:143], v[190:191], v[122:123] op_sel_hi:[1,0,1]
v_pk_fma_f32 v[124:125], v[144:145], v[190:191], v[124:125] op_sel_hi:[1,0,1]
v_pk_fma_f32 v[126:127], v[146:147], v[190:191], v[126:127] op_sel_hi:[1,0,1]
v_cvt_pk_bf16_f32 v60, v120, v121
v_cvt_pk_bf16_f32 v61, v122, v123
v_cvt_pk_bf16_f32 v62, v124, v125
v_cvt_pk_bf16_f32 v63, v126, v127
buffer_store_dwordx4 v[60:63], v206, s[28:31], s9 offen offset:3072 sc1
s_branch common_88
nomerge_86:
v_rcp_f32 v210, v202
v_rcp_f32 v211, v203
s_nop 0
v_mul_f32 v184, v210, v216
v_mul_f32 v186, v211, v217
v_pk_mul_f32 v[0:1], v[0:1], v[184:185] op_sel_hi:[1,0]
v_pk_mul_f32 v[2:3], v[2:3], v[184:185] op_sel_hi:[1,0]
v_pk_mul_f32 v[4:5], v[4:5], v[184:185] op_sel_hi:[1,0]
v_pk_mul_f32 v[6:7], v[6:7], v[184:185] op_sel_hi:[1,0]
v_cvt_pk_bf16_f32 v0, v0, v1
v_cvt_pk_bf16_f32 v1, v2, v3
v_cvt_pk_bf16_f32 v2, v4, v5
v_cvt_pk_bf16_f32 v3, v6, v7
buffer_store_dwordx4 v[0:3], v206, s[28:31], s9 offen offset:0 sc1
v_pk_mul_f32 v[8:9], v[8:9], v[184:185] op_sel_hi:[1,0]
v_pk_mul_f32 v[10:11], v[10:11], v[184:185] op_sel_hi:[1,0]
v_pk_mul_f32 v[12:13], v[12:13], v[184:185] op_sel_hi:[1,0]
v_pk_mul_f32 v[14:15], v[14:15], v[184:185] op_sel_hi:[1,0]
v_cvt_pk_bf16_f32 v4, v8, v9
v_cvt_pk_bf16_f32 v5, v10, v11
v_cvt_pk_bf16_f32 v6, v12, v13
v_cvt_pk_bf16_f32 v7, v14, v15
buffer_store_dwordx4 v[4:7], v206, s[28:31], s9 offen offset:1024 sc1
v_pk_mul_f32 v[16:17], v[16:17], v[184:185] op_sel_hi:[1,0]
v_pk_mul_f32 v[18:19], v[18:19], v[184:185] op_sel_hi:[1,0]
v_pk_mul_f32 v[20:21], v[20:21], v[184:185] op_sel_hi:[1,0]
v_pk_mul_f32 v[22:23], v[22:23], v[184:185] op_sel_hi:[1,0]
v_cvt_pk_bf16_f32 v8, v16, v17
v_cvt_pk_bf16_f32 v9, v18, v19
v_cvt_pk_bf16_f32 v10, v20, v21
v_cvt_pk_bf16_f32 v11, v22, v23
buffer_store_dwordx4 v[8:11], v206, s[28:31], s9 offen offset:2048 sc1
v_pk_mul_f32 v[24:25], v[24:25], v[184:185] op_sel_hi:[1,0]
v_pk_mul_f32 v[26:27], v[26:27], v[184:185] op_sel_hi:[1,0]
v_pk_mul_f32 v[28:29], v[28:29], v[184:185] op_sel_hi:[1,0]
v_pk_mul_f32 v[30:31], v[30:31], v[184:185] op_sel_hi:[1,0]
v_cvt_pk_bf16_f32 v12, v24, v25
v_cvt_pk_bf16_f32 v13, v26, v27
v_cvt_pk_bf16_f32 v14, v28, v29
v_cvt_pk_bf16_f32 v15, v30, v31
buffer_store_dwordx4 v[12:15], v206, s[28:31], s9 offen offset:3072 sc1
s_add_u32 s9, s9, 4096
v_pk_mul_f32 v[32:33], v[32:33], v[184:185] op_sel_hi:[1,0]
v_pk_mul_f32 v[34:35], v[34:35], v[184:185] op_sel_hi:[1,0]
v_pk_mul_f32 v[36:37], v[36:37], v[184:185] op_sel_hi:[1,0]
v_pk_mul_f32 v[38:39], v[38:39], v[184:185] op_sel_hi:[1,0]
v_cvt_pk_bf16_f32 v16, v32, v33
v_cvt_pk_bf16_f32 v17, v34, v35
v_cvt_pk_bf16_f32 v18, v36, v37
v_cvt_pk_bf16_f32 v19, v38, v39
buffer_store_dwordx4 v[16:19], v206, s[28:31], s9 offen offset:0 sc1
v_pk_mul_f32 v[40:41], v[40:41], v[184:185] op_sel_hi:[1,0]
v_pk_mul_f32 v[42:43], v[42:43], v[184:185] op_sel_hi:[1,0]
v_pk_mul_f32 v[44:45], v[44:45], v[184:185] op_sel_hi:[1,0]
v_pk_mul_f32 v[46:47], v[46:47], v[184:185] op_sel_hi:[1,0]
v_cvt_pk_bf16_f32 v20, v40, v41
v_cvt_pk_bf16_f32 v21, v42, v43
v_cvt_pk_bf16_f32 v22, v44, v45
v_cvt_pk_bf16_f32 v23, v46, v47
buffer_store_dwordx4 v[20:23], v206, s[28:31], s9 offen offset:1024 sc1
v_pk_mul_f32 v[48:49], v[48:49], v[184:185] op_sel_hi:[1,0]
v_pk_mul_f32 v[50:51], v[50:51], v[184:185] op_sel_hi:[1,0]
v_pk_mul_f32 v[52:53], v[52:53], v[184:185] op_sel_hi:[1,0]
v_pk_mul_f32 v[54:55], v[54:55], v[184:185] op_sel_hi:[1,0]
v_cvt_pk_bf16_f32 v24, v48, v49
v_cvt_pk_bf16_f32 v25, v50, v51
v_cvt_pk_bf16_f32 v26, v52, v53
v_cvt_pk_bf16_f32 v27, v54, v55
buffer_store_dwordx4 v[24:27], v206, s[28:31], s9 offen offset:2048 sc1
v_pk_mul_f32 v[56:57], v[56:57], v[184:185] op_sel_hi:[1,0]
v_pk_mul_f32 v[58:59], v[58:59], v[184:185] op_sel_hi:[1,0]
v_pk_mul_f32 v[60:61], v[60:61], v[184:185] op_sel_hi:[1,0]
v_pk_mul_f32 v[62:63], v[62:63], v[184:185] op_sel_hi:[1,0]
v_cvt_pk_bf16_f32 v28, v56, v57
v_cvt_pk_bf16_f32 v29, v58, v59
v_cvt_pk_bf16_f32 v30, v60, v61
v_cvt_pk_bf16_f32 v31, v62, v63
buffer_store_dwordx4 v[28:31], v206, s[28:31], s9 offen offset:3072 sc1
s_add_u32 s9, s9, 184320
v_pk_mul_f32 v[64:65], v[64:65], v[186:187] op_sel_hi:[1,0]
v_pk_mul_f32 v[66:67], v[66:67], v[186:187] op_sel_hi:[1,0]
v_pk_mul_f32 v[68:69], v[68:69], v[186:187] op_sel_hi:[1,0]
v_pk_mul_f32 v[70:71], v[70:71], v[186:187] op_sel_hi:[1,0]
v_cvt_pk_bf16_f32 v32, v64, v65
v_cvt_pk_bf16_f32 v33, v66, v67
v_cvt_pk_bf16_f32 v34, v68, v69
v_cvt_pk_bf16_f32 v35, v70, v71
buffer_store_dwordx4 v[32:35], v206, s[28:31], s9 offen offset:0 sc1
v_pk_mul_f32 v[72:73], v[72:73], v[186:187] op_sel_hi:[1,0]
v_pk_mul_f32 v[74:75], v[74:75], v[186:187] op_sel_hi:[1,0]
v_pk_mul_f32 v[76:77], v[76:77], v[186:187] op_sel_hi:[1,0]
v_pk_mul_f32 v[78:79], v[78:79], v[186:187] op_sel_hi:[1,0]
v_cvt_pk_bf16_f32 v36, v72, v73
v_cvt_pk_bf16_f32 v37, v74, v75
v_cvt_pk_bf16_f32 v38, v76, v77
v_cvt_pk_bf16_f32 v39, v78, v79
buffer_store_dwordx4 v[36:39], v206, s[28:31], s9 offen offset:1024 sc1
v_pk_mul_f32 v[80:81], v[80:81], v[186:187] op_sel_hi:[1,0]
v_pk_mul_f32 v[82:83], v[82:83], v[186:187] op_sel_hi:[1,0]
v_pk_mul_f32 v[84:85], v[84:85], v[186:187] op_sel_hi:[1,0]
v_pk_mul_f32 v[86:87], v[86:87], v[186:187] op_sel_hi:[1,0]
v_cvt_pk_bf16_f32 v40, v80, v81
v_cvt_pk_bf16_f32 v41, v82, v83
v_cvt_pk_bf16_f32 v42, v84, v85
v_cvt_pk_bf16_f32 v43, v86, v87
buffer_store_dwordx4 v[40:43], v206, s[28:31], s9 offen offset:2048 sc1
v_pk_mul_f32 v[88:89], v[88:89], v[186:187] op_sel_hi:[1,0]
v_pk_mul_f32 v[90:91], v[90:91], v[186:187] op_sel_hi:[1,0]
v_pk_mul_f32 v[92:93], v[92:93], v[186:187] op_sel_hi:[1,0]
v_pk_mul_f32 v[94:95], v[94:95], v[186:187] op_sel_hi:[1,0]
v_cvt_pk_bf16_f32 v44, v88, v89
v_cvt_pk_bf16_f32 v45, v90, v91
v_cvt_pk_bf16_f32 v46, v92, v93
v_cvt_pk_bf16_f32 v47, v94, v95
buffer_store_dwordx4 v[44:47], v206, s[28:31], s9 offen offset:3072 sc1
s_add_u32 s9, s9, 4096
v_pk_mul_f32 v[96:97], v[96:97], v[186:187] op_sel_hi:[1,0]
v_pk_mul_f32 v[98:99], v[98:99], v[186:187] op_sel_hi:[1,0]
v_pk_mul_f32 v[100:101], v[100:101], v[186:187] op_sel_hi:[1,0]
v_pk_mul_f32 v[102:103], v[102:103], v[186:187] op_sel_hi:[1,0]
v_cvt_pk_bf16_f32 v48, v96, v97
v_cvt_pk_bf16_f32 v49, v98, v99
v_cvt_pk_bf16_f32 v50, v100, v101
v_cvt_pk_bf16_f32 v51, v102, v103
buffer_store_dwordx4 v[48:51], v206, s[28:31], s9 offen offset:0 sc1
v_pk_mul_f32 v[104:105], v[104:105], v[186:187] op_sel_hi:[1,0]
v_pk_mul_f32 v[106:107], v[106:107], v[186:187] op_sel_hi:[1,0]
v_pk_mul_f32 v[108:109], v[108:109], v[186:187] op_sel_hi:[1,0]
v_pk_mul_f32 v[110:111], v[110:111], v[186:187] op_sel_hi:[1,0]
v_cvt_pk_bf16_f32 v52, v104, v105
v_cvt_pk_bf16_f32 v53, v106, v107
v_cvt_pk_bf16_f32 v54, v108, v109
v_cvt_pk_bf16_f32 v55, v110, v111
buffer_store_dwordx4 v[52:55], v206, s[28:31], s9 offen offset:1024 sc1
v_pk_mul_f32 v[112:113], v[112:113], v[186:187] op_sel_hi:[1,0]
v_pk_mul_f32 v[114:115], v[114:115], v[186:187] op_sel_hi:[1,0]
v_pk_mul_f32 v[116:117], v[116:117], v[186:187] op_sel_hi:[1,0]
v_pk_mul_f32 v[118:119], v[118:119], v[186:187] op_sel_hi:[1,0]
v_cvt_pk_bf16_f32 v56, v112, v113
v_cvt_pk_bf16_f32 v57, v114, v115
v_cvt_pk_bf16_f32 v58, v116, v117
v_cvt_pk_bf16_f32 v59, v118, v119
buffer_store_dwordx4 v[56:59], v206, s[28:31], s9 offen offset:2048 sc1
v_pk_mul_f32 v[120:121], v[120:121], v[186:187] op_sel_hi:[1,0]
v_pk_mul_f32 v[122:123], v[122:123], v[186:187] op_sel_hi:[1,0]
v_pk_mul_f32 v[124:125], v[124:125], v[186:187] op_sel_hi:[1,0]
v_pk_mul_f32 v[126:127], v[126:127], v[186:187] op_sel_hi:[1,0]
v_cvt_pk_bf16_f32 v60, v120, v121
v_cvt_pk_bf16_f32 v61, v122, v123
v_cvt_pk_bf16_f32 v62, v124, v125
v_cvt_pk_bf16_f32 v63, v126, v127
buffer_store_dwordx4 v[60:63], v206, s[28:31], s9 offen offset:3072 sc1
common_88:
s_waitcnt vmcnt(48)
s_barrier
ds_read_b64_tr_b16 v[64:65], v232 offset:0
ds_read_b64_tr_b16 v[66:67], v232 offset:1024
ds_read_b64_tr_b16 v[68:69], v233 offset:0
ds_read_b64_tr_b16 v[70:71], v233 offset:1024
ds_read_b64_tr_b16 v[72:73], v234 offset:0
ds_read_b64_tr_b16 v[74:75], v234 offset:1024
ds_read_b64_tr_b16 v[76:77], v235 offset:0
ds_read_b64_tr_b16 v[78:79], v235 offset:1024
ds_read_b64_tr_b16 v[80:81], v236 offset:0
ds_read_b64_tr_b16 v[82:83], v236 offset:1024
ds_read_b64_tr_b16 v[84:85], v237 offset:0
ds_read_b64_tr_b16 v[86:87], v237 offset:1024
ds_read_b64_tr_b16 v[88:89], v238 offset:0
ds_read_b64_tr_b16 v[90:91], v238 offset:1024
ds_read_b64_tr_b16 v[92:93], v239 offset:0
ds_read_b64_tr_b16 v[94:95], v239 offset:1024
s_waitcnt vmcnt(39) lgkmcnt(8)
s_barrier
mf v[0:3],v[64:67],a[72:75],0
ds_read_b64_tr_b16 v[96:97], v232 offset:8192
s_add_u32 m0, s34, 98304
mf v[32:35],v[64:67],a[76:79],0
ds_read_b64_tr_b16 v[98:99], v232 offset:9216
s_add_u32 s37, s99, 114688
mf v[36:39],v[68:71],a[76:79],0
ds_read_b64_tr_b16 v[100:101], v233 offset:8192
buffer_load_dwordx4 v240, s[20:23], s37 offen lds
mf v[4:7],v[68:71],a[72:75],0
ds_read_b64_tr_b16 v[102:103], v233 offset:9216
buffer_load_dwordx4 v241, s[20:23], s37 offen offset:1024 lds
mf v[8:11],v[72:75],a[72:75],0
ds_read_b64_tr_b16 v[104:105], v234 offset:8192
s_add_u32 m0, s34, 106496
mf v[40:43],v[72:75],a[76:79],0
ds_read_b64_tr_b16 v[106:107], v234 offset:9216
s_add_u32 s37, s99, 143360
mf v[44:47],v[76:79],a[76:79],0
ds_read_b64_tr_b16 v[108:109], v235 offset:8192
buffer_load_dwordx4 v240, s[20:23], s37 offen lds
mf v[12:15],v[76:79],a[72:75],0
ds_read_b64_tr_b16 v[110:111], v235 offset:9216
s_waitcnt lgkmcnt(8)
mf v[16:19],v[80:83],a[72:75],0
ds_read_b64_tr_b16 v[112:113], v236 offset:8192
buffer_load_dwordx4 v241, s[20:23], s37 offen offset:1024 lds
mf v[48:51],v[80:83],a[76:79],0
ds_read_b64_tr_b16 v[114:115], v236 offset:9216
s_add_u32 s38, s98, 4096
mf v[52:55],v[84:87],a[76:79],0
ds_read_b64_tr_b16 v[116:117], v237 offset:8192
buffer_load_dwordx4 a[104:107], v206, s[28:31], s38 offen sc1
mf v[20:23],v[84:87],a[72:75],0
ds_read_b64_tr_b16 v[118:119], v237 offset:9216
buffer_load_dwordx4 a[108:111], v222, s[28:31], s38 offen sc1
mf v[24:27],v[88:91],a[72:75],0
ds_read_b64_tr_b16 v[120:121], v238 offset:8192
s_add_u32 m0, s34, 114688
mf v[56:59],v[88:91],a[76:79],0
ds_read_b64_tr_b16 v[122:123], v238 offset:9216
s_add_u32 s37, s99, 172032
mf v[60:63],v[92:95],a[76:79],0
ds_read_b64_tr_b16 v[124:125], v239 offset:8192
buffer_load_dwordx4 v240, s[20:23], s37 offen lds
mf v[28:31],v[92:95],a[72:75],0
ds_read_b64_tr_b16 v[126:127], v239 offset:9216
buffer_load_dwordx4 v241, s[20:23], s37 offen offset:1024 lds
s_waitcnt lgkmcnt(8)
mf v[0:3],v[96:99],a[80:83],v[0:3]
ds_read_b64_tr_b16 v[64:65], v232 offset:16384
s_add_u32 s38, s98, 5120
mf v[32:35],v[96:99],a[84:87],v[32:35]
ds_read_b64_tr_b16 v[66:67], v232 offset:17408
buffer_load_dwordx4 a[112:115], v206, s[28:31], s38 offen sc1
mf v[36:39],v[100:103],a[84:87],v[36:39]
ds_read_b64_tr_b16 v[68:69], v233 offset:16384
mf v[4:7],v[100:103],a[80:83],v[4:7]
ds_read_b64_tr_b16 v[70:71], v233 offset:17408
buffer_load_dwordx4 a[116:119], v222, s[28:31], s38 offen sc1
mf v[8:11],v[104:107],a[80:83],v[8:11]
ds_read_b64_tr_b16 v[72:73], v234 offset:16384
s_add_u32 m0, s34, 122880
mf v[40:43],v[104:107],a[84:87],v[40:43]
ds_read_b64_tr_b16 v[74:75], v234 offset:17408
mf v[44:47],v[108:111],a[84:87],v[44:47]
ds_read_b64_tr_b16 v[76:77], v235 offset:16384
s_add_u32 s37, s99, 200704
mf v[12:15],v[108:111],a[80:83],v[12:15]
ds_read_b64_tr_b16 v[78:79], v235 offset:17408
s_waitcnt lgkmcnt(8)
mf v[16:19],v[112:115],a[80:83],v[16:19]
ds_read_b64_tr_b16 v[80:81], v236 offset:16384
buffer_load_dwordx4 v240, s[20:23], s37 offen lds
mf v[48:51],v[112:115],a[84:87],v[48:51]
ds_read_b64_tr_b16 v[82:83], v236 offset:17408
buffer_load_dwordx4 v241, s[20:23], s37 offen offset:1024 lds
mf v[52:55],v[116:119],a[84:87],v[52:55]
ds_read_b64_tr_b16 v[84:85], v237 offset:16384
mf v[20:23],v[116:119],a[80:83],v[20:23]
ds_read_b64_tr_b16 v[86:87], v237 offset:17408
s_add_u32 s38, s98, 6144
mf v[24:27],v[120:123],a[80:83],v[24:27]
ds_read_b64_tr_b16 v[88:89], v238 offset:16384
buffer_load_dwordx4 a[120:123], v206, s[28:31], s38 offen sc1
mf v[56:59],v[120:123],a[84:87],v[56:59]
ds_read_b64_tr_b16 v[90:91], v238 offset:17408
mf v[60:63],v[124:127],a[84:87],v[60:63]
ds_read_b64_tr_b16 v[92:93], v239 offset:16384
buffer_load_dwordx4 a[124:127], v222, s[28:31], s38 offen sc1
mf v[28:31],v[124:127],a[80:83],v[28:31]
ds_read_b64_tr_b16 v[94:95], v239 offset:17408
s_waitcnt vmcnt(12) lgkmcnt(8)
s_barrier
s_cmp_lg_u32 s16, 0
s_cbranch_scc1 nofl_89
v_mov_b32 v242, 4
v_mov_b32 v243, 0
s_mov_b64 exec, 1
buffer_store_dword v242, v243, s[28:31], s3 offen sc1
s_mov_b64 exec, -1
nofl_89:
mf v[0:3],v[64:67],a[88:91],v[0:3]
ds_read_b64_tr_b16 v[96:97], v232 offset:24576
s_add_u32 m0, s34, 0
mf v[32:35],v[64:67],a[92:95],v[32:35]
ds_read_b64_tr_b16 v[98:99], v232 offset:25600
mf v[36:39],v[68:71],a[92:95],v[36:39]
ds_read_b64_tr_b16 v[100:101], v233 offset:24576
s_add_u32 s37, s99, 229376
mf v[4:7],v[68:71],a[88:91],v[4:7]
ds_read_b64_tr_b16 v[102:103], v233 offset:25600
mf v[8:11],v[72:75],a[88:91],v[8:11]
ds_read_b64_tr_b16 v[104:105], v234 offset:24576
buffer_load_dwordx4 v240, s[20:23], s37 offen lds
mf v[40:43],v[72:75],a[92:95],v[40:43]
ds_read_b64_tr_b16 v[106:107], v234 offset:25600
mf v[44:47],v[76:79],a[92:95],v[44:47]
ds_read_b64_tr_b16 v[108:109], v235 offset:24576
buffer_load_dwordx4 v241, s[20:23], s37 offen offset:1024 lds
mf v[12:15],v[76:79],a[88:91],v[12:15]
ds_read_b64_tr_b16 v[110:111], v235 offset:25600
s_waitcnt lgkmcnt(8)
mf v[16:19],v[80:83],a[88:91],v[16:19]
ds_read_b64_tr_b16 v[112:113], v236 offset:24576
mf v[48:51],v[80:83],a[92:95],v[48:51]
ds_read_b64_tr_b16 v[114:115], v236 offset:25600
s_add_u32 s38, s98, 7168
mf v[52:55],v[84:87],a[92:95],v[52:55]
ds_read_b64_tr_b16 v[116:117], v237 offset:24576
mf v[20:23],v[84:87],a[88:91],v[20:23]
ds_read_b64_tr_b16 v[118:119], v237 offset:25600
buffer_load_dwordx4 a[128:131], v206, s[28:31], s38 offen sc1
mf v[24:27],v[88:91],a[88:91],v[24:27]
ds_read_b64_tr_b16 v[120:121], v238 offset:24576
mf v[56:59],v[88:91],a[92:95],v[56:59]
ds_read_b64_tr_b16 v[122:123], v238 offset:25600
buffer_load_dwordx4 a[132:135], v222, s[28:31], s38 offen sc1
mf v[60:63],v[92:95],a[92:95],v[60:63]
ds_read_b64_tr_b16 v[124:125], v239 offset:24576
mf v[28:31],v[92:95],a[88:91],v[28:31]
ds_read_b64_tr_b16 v[126:127], v239 offset:25600
s_waitcnt lgkmcnt(8)
mf v[0:3],v[96:99],a[96:99],v[0:3]
ds_read_b64_tr_b16 v[64:65], v232 offset:32768
s_add_u32 m0, s34, 8192
mf v[32:35],v[96:99],a[100:103],v[32:35]
ds_read_b64_tr_b16 v[66:67], v232 offset:33792
mf v[36:39],v[100:103],a[100:103],v[36:39]
ds_read_b64_tr_b16 v[68:69], v233 offset:32768
s_add_u32 s37, s99, 258048
mf v[4:7],v[100:103],a[96:99],v[4:7]
ds_read_b64_tr_b16 v[70:71], v233 offset:33792
mf v[8:11],v[104:107],a[96:99],v[8:11]
ds_read_b64_tr_b16 v[72:73], v234 offset:32768
buffer_load_dwordx4 v240, s[20:23], s37 offen lds
mf v[40:43],v[104:107],a[100:103],v[40:43]
ds_read_b64_tr_b16 v[74:75], v234 offset:33792
mf v[44:47],v[108:111],a[100:103],v[44:47]
ds_read_b64_tr_b16 v[76:77], v235 offset:32768
buffer_load_dwordx4 v241, s[20:23], s37 offen offset:1024 lds
mf v[12:15],v[108:111],a[96:99],v[12:15]
ds_read_b64_tr_b16 v[78:79], v235 offset:33792
s_waitcnt lgkmcnt(8)
mf v[16:19],v[112:115],a[96:99],v[16:19]
ds_read_b64_tr_b16 v[80:81], v236 offset:32768
mf v[48:51],v[112:115],a[100:103],v[48:51]
ds_read_b64_tr_b16 v[82:83], v236 offset:33792
s_add_u32 s38, s98, 8192
mf v[52:55],v[116:119],a[100:103],v[52:55]
ds_read_b64_tr_b16 v[84:85], v237 offset:32768
mf v[20:23],v[116:119],a[96:99],v[20:23]
ds_read_b64_tr_b16 v[86:87], v237 offset:33792
buffer_load_dwordx4 a[136:139], v206, s[28:31], s38 offen sc1
mf v[24:27],v[120:123],a[96:99],v[24:27]
ds_read_b64_tr_b16 v[88:89], v238 offset:32768
mf v[56:59],v[120:123],a[100:103],v[56:59]
ds_read_b64_tr_b16 v[90:91], v238 offset:33792
buffer_load_dwordx4 a[140:143], v222, s[28:31], s38 offen sc1
mf v[60:63],v[124:127],a[100:103],v[60:63]
ds_read_b64_tr_b16 v[92:93], v239 offset:32768
mf v[28:31],v[124:127],a[96:99],v[28:31]
ds_read_b64_tr_b16 v[94:95], v239 offset:33792
s_waitcnt vmcnt(12) lgkmcnt(8)
s_barrier
mf v[0:3],v[64:67],a[104:107],v[0:3]
ds_read_b64_tr_b16 v[96:97], v232 offset:40960
s_add_u32 m0, s34, 16384
mf v[32:35],v[64:67],a[108:111],v[32:35]
ds_read_b64_tr_b16 v[98:99], v232 offset:41984
mf v[36:39],v[68:71],a[108:111],v[36:39]
ds_read_b64_tr_b16 v[100:101], v233 offset:40960
s_add_u32 s37, s99, 286720
mf v[4:7],v[68:71],a[104:107],v[4:7]
ds_read_b64_tr_b16 v[102:103], v233 offset:41984
mf v[8:11],v[72:75],a[104:107],v[8:11]
ds_read_b64_tr_b16 v[104:105], v234 offset:40960
buffer_load_dwordx4 v240, s[20:23], s37 offen lds
mf v[40:43],v[72:75],a[108:111],v[40:43]
ds_read_b64_tr_b16 v[106:107], v234 offset:41984
mf v[44:47],v[76:79],a[108:111],v[44:47]
ds_read_b64_tr_b16 v[108:109], v235 offset:40960
buffer_load_dwordx4 v241, s[20:23], s37 offen offset:1024 lds
mf v[12:15],v[76:79],a[104:107],v[12:15]
ds_read_b64_tr_b16 v[110:111], v235 offset:41984
s_waitcnt lgkmcnt(8)
mf v[16:19],v[80:83],a[104:107],v[16:19]
ds_read_b64_tr_b16 v[112:113], v236 offset:40960
mf v[48:51],v[80:83],a[108:111],v[48:51]
ds_read_b64_tr_b16 v[114:115], v236 offset:41984
s_add_u32 s38, s98, 9216
mf v[52:55],v[84:87],a[108:111],v[52:55]
ds_read_b64_tr_b16 v[116:117], v237 offset:40960
mf v[20:23],v[84:87],a[104:107],v[20:23]
ds_read_b64_tr_b16 v[118:119], v237 offset:41984
buffer_load_dwordx4 a[144:147], v206, s[28:31], s38 offen sc1
mf v[24:27],v[88:91],a[104:107],v[24:27]
ds_read_b64_tr_b16 v[120:121], v238 offset:40960
mf v[56:59],v[88:91],a[108:111],v[56:59]
ds_read_b64_tr_b16 v[122:123], v238 offset:41984
buffer_load_dwordx4 a[148:151], v222, s[28:31], s38 offen sc1
mf v[60:63],v[92:95],a[108:111],v[60:63]
ds_read_b64_tr_b16 v[124:125], v239 offset:40960
mf v[28:31],v[92:95],a[104:107],v[28:31]
ds_read_b64_tr_b16 v[126:127], v239 offset:41984
s_waitcnt lgkmcnt(8)
mf v[0:3],v[96:99],a[112:115],v[0:3]
ds_read_b64_tr_b16 v[64:65], v232 offset:49152
s_add_u32 m0, s34, 24576
mf v[32:35],v[96:99],a[116:119],v[32:35]
ds_read_b64_tr_b16 v[66:67], v232 offset:50176
mf v[36:39],v[100:103],a[116:119],v[36:39]
ds_read_b64_tr_b16 v[68:69], v233 offset:49152
s_add_u32 s37, s99, 315392
mf v[4:7],v[100:103],a[112:115],v[4:7]
ds_read_b64_tr_b16 v[70:71], v233 offset:50176
mf v[8:11],v[104:107],a[112:115],v[8:11]
ds_read_b64_tr_b16 v[72:73], v234 offset:49152
buffer_load_dwordx4 v240, s[20:23], s37 offen lds
mf v[40:43],v[104:107],a[116:119],v[40:43]
ds_read_b64_tr_b16 v[74:75], v234 offset:50176
mf v[44:47],v[108:111],a[116:119],v[44:47]
ds_read_b64_tr_b16 v[76:77], v235 offset:49152
buffer_load_dwordx4 v241, s[20:23], s37 offen offset:1024 lds
mf v[12:15],v[108:111],a[112:115],v[12:15]
ds_read_b64_tr_b16 v[78:79], v235 offset:50176
s_waitcnt lgkmcnt(8)
mf v[16:19],v[112:115],a[112:115],v[16:19]
ds_read_b64_tr_b16 v[80:81], v236 offset:49152
mf v[48:51],v[112:115],a[116:119],v[48:51]
ds_read_b64_tr_b16 v[82:83], v236 offset:50176
s_add_u32 s38, s98, 10240
mf v[52:55],v[116:119],a[116:119],v[52:55]
ds_read_b64_tr_b16 v[84:85], v237 offset:49152
mf v[20:23],v[116:119],a[112:115],v[20:23]
ds_read_b64_tr_b16 v[86:87], v237 offset:50176
buffer_load_dwordx4 a[152:155], v206, s[28:31], s38 offen sc1
mf v[24:27],v[120:123],a[112:115],v[24:27]
ds_read_b64_tr_b16 v[88:89], v238 offset:49152
mf v[56:59],v[120:123],a[116:119],v[56:59]
ds_read_b64_tr_b16 v[90:91], v238 offset:50176
buffer_load_dwordx4 a[156:159], v222, s[28:31], s38 offen sc1
mf v[60:63],v[124:127],a[116:119],v[60:63]
ds_read_b64_tr_b16 v[92:93], v239 offset:49152
mf v[28:31],v[124:127],a[112:115],v[28:31]
ds_read_b64_tr_b16 v[94:95], v239 offset:50176
s_waitcnt vmcnt(12) lgkmcnt(8)
s_barrier
mf v[0:3],v[64:67],a[120:123],v[0:3]
ds_read_b64_tr_b16 v[96:97], v232 offset:57344
s_add_u32 m0, s34, 32768
mf v[32:35],v[64:67],a[124:127],v[32:35]
ds_read_b64_tr_b16 v[98:99], v232 offset:58368
mf v[36:39],v[68:71],a[124:127],v[36:39]
ds_read_b64_tr_b16 v[100:101], v233 offset:57344
s_add_u32 s37, s99, 344064
mf v[4:7],v[68:71],a[120:123],v[4:7]
ds_read_b64_tr_b16 v[102:103], v233 offset:58368
mf v[8:11],v[72:75],a[120:123],v[8:11]
ds_read_b64_tr_b16 v[104:105], v234 offset:57344
buffer_load_dwordx4 v240, s[20:23], s37 offen lds
mf v[40:43],v[72:75],a[124:127],v[40:43]
ds_read_b64_tr_b16 v[106:107], v234 offset:58368
mf v[44:47],v[76:79],a[124:127],v[44:47]
ds_read_b64_tr_b16 v[108:109], v235 offset:57344
buffer_load_dwordx4 v241, s[20:23], s37 offen offset:1024 lds
mf v[12:15],v[76:79],a[120:123],v[12:15]
ds_read_b64_tr_b16 v[110:111], v235 offset:58368
s_waitcnt lgkmcnt(8)
mf v[16:19],v[80:83],a[120:123],v[16:19]
ds_read_b64_tr_b16 v[112:113], v236 offset:57344
mf v[48:51],v[80:83],a[124:127],v[48:51]
ds_read_b64_tr_b16 v[114:115], v236 offset:58368
s_add_u32 s38, s98, 11264
mf v[52:55],v[84:87],a[124:127],v[52:55]
ds_read_b64_tr_b16 v[116:117], v237 offset:57344
mf v[20:23],v[84:87],a[120:123],v[20:23]
ds_read_b64_tr_b16 v[118:119], v237 offset:58368
buffer_load_dwordx4 a[160:163], v206, s[28:31], s38 offen sc1
mf v[24:27],v[88:91],a[120:123],v[24:27]
ds_read_b64_tr_b16 v[120:121], v238 offset:57344
mf v[56:59],v[88:91],a[124:127],v[56:59]
ds_read_b64_tr_b16 v[122:123], v238 offset:58368
buffer_load_dwordx4 a[164:167], v222, s[28:31], s38 offen sc1
mf v[60:63],v[92:95],a[124:127],v[60:63]
ds_read_b64_tr_b16 v[124:125], v239 offset:57344
mf v[28:31],v[92:95],a[120:123],v[28:31]
ds_read_b64_tr_b16 v[126:127], v239 offset:58368
s_waitcnt lgkmcnt(8)
mf v[0:3],v[96:99],a[128:131],v[0:3]
ds_read_b64_tr_b16 v[64:65], v224 offset:0
s_add_u32 m0, s34, 40960
mf v[32:35],v[96:99],a[132:135],v[32:35]
ds_read_b64_tr_b16 v[66:67], v224 offset:1024
mf v[36:39],v[100:103],a[132:135],v[36:39]
ds_read_b64_tr_b16 v[68:69], v225 offset:0
s_add_u32 s37, s99, 372736
mf v[4:7],v[100:103],a[128:131],v[4:7]
ds_read_b64_tr_b16 v[70:71], v225 offset:1024
mf v[8:11],v[104:107],a[128:131],v[8:11]
ds_read_b64_tr_b16 v[72:73], v226 offset:0
buffer_load_dwordx4 v240, s[20:23], s37 offen lds
mf v[40:43],v[104:107],a[132:135],v[40:43]
ds_read_b64_tr_b16 v[74:75], v226 offset:1024
mf v[44:47],v[108:111],a[132:135],v[44:47]
ds_read_b64_tr_b16 v[76:77], v227 offset:0
buffer_load_dwordx4 v241, s[20:23], s37 offen offset:1024 lds
mf v[12:15],v[108:111],a[128:131],v[12:15]
ds_read_b64_tr_b16 v[78:79], v227 offset:1024
s_waitcnt lgkmcnt(8)
mf v[16:19],v[112:115],a[128:131],v[16:19]
ds_read_b64_tr_b16 v[80:81], v228 offset:0
mf v[48:51],v[112:115],a[132:135],v[48:51]
ds_read_b64_tr_b16 v[82:83], v228 offset:1024
s_add_u32 s38, s98, 12288
mf v[52:55],v[116:119],a[132:135],v[52:55]
ds_read_b64_tr_b16 v[84:85], v229 offset:0
mf v[20:23],v[116:119],a[128:131],v[20:23]
ds_read_b64_tr_b16 v[86:87], v229 offset:1024
buffer_load_dwordx4 a[168:171], v206, s[28:31], s38 offen sc1
mf v[24:27],v[120:123],a[128:131],v[24:27]
ds_read_b64_tr_b16 v[88:89], v230 offset:0
mf v[56:59],v[120:123],a[132:135],v[56:59]
ds_read_b64_tr_b16 v[90:91], v230 offset:1024
buffer_load_dwordx4 a[172:175], v222, s[28:31], s38 offen sc1
mf v[60:63],v[124:127],a[132:135],v[60:63]
ds_read_b64_tr_b16 v[92:93], v231 offset:0
mf v[28:31],v[124:127],a[128:131],v[28:31]
ds_read_b64_tr_b16 v[94:95], v231 offset:1024
s_waitcnt vmcnt(12) lgkmcnt(8)
s_barrier
mf v[0:3],v[64:67],a[136:139],v[0:3]
ds_read_b64_tr_b16 v[96:97], v224 offset:8192
s_add_u32 m0, s34, 49152
mf v[32:35],v[64:67],a[140:143],v[32:35]
ds_read_b64_tr_b16 v[98:99], v224 offset:9216
mf v[36:39],v[68:71],a[140:143],v[36:39]
ds_read_b64_tr_b16 v[100:101], v225 offset:8192
s_add_u32 s37, s40, 0
mf v[4:7],v[68:71],a[136:139],v[4:7]
ds_read_b64_tr_b16 v[102:103], v225 offset:9216
mf v[8:11],v[72:75],a[136:139],v[8:11]
ds_read_b64_tr_b16 v[104:105], v226 offset:8192
buffer_load_dwordx4 v240, s[24:27], s37 offen lds
mf v[40:43],v[72:75],a[140:143],v[40:43]
ds_read_b64_tr_b16 v[106:107], v226 offset:9216
mf v[44:47],v[76:79],a[140:143],v[44:47]
ds_read_b64_tr_b16 v[108:109], v227 offset:8192
buffer_load_dwordx4 v241, s[24:27], s37 offen offset:1024 lds
mf v[12:15],v[76:79],a[136:139],v[12:15]
ds_read_b64_tr_b16 v[110:111], v227 offset:9216
s_waitcnt lgkmcnt(8)
mf v[16:19],v[80:83],a[136:139],v[16:19]
ds_read_b64_tr_b16 v[112:113], v228 offset:8192
mf v[48:51],v[80:83],a[140:143],v[48:51]
ds_read_b64_tr_b16 v[114:115], v228 offset:9216
s_add_u32 s38, s98, 13312
mf v[52:55],v[84:87],a[140:143],v[52:55]
ds_read_b64_tr_b16 v[116:117], v229 offset:8192
mf v[20:23],v[84:87],a[136:139],v[20:23]
ds_read_b64_tr_b16 v[118:119], v229 offset:9216
buffer_load_dwordx4 a[176:179], v206, s[28:31], s38 offen sc1
mf v[24:27],v[88:91],a[136:139],v[24:27]
ds_read_b64_tr_b16 v[120:121], v230 offset:8192
mf v[56:59],v[88:91],a[140:143],v[56:59]
ds_read_b64_tr_b16 v[122:123], v230 offset:9216
buffer_load_dwordx4 a[180:183], v222, s[28:31], s38 offen sc1
mf v[60:63],v[92:95],a[140:143],v[60:63]
ds_read_b64_tr_b16 v[124:125], v231 offset:8192
mf v[28:31],v[92:95],a[136:139],v[28:31]
ds_read_b64_tr_b16 v[126:127], v231 offset:9216
s_waitcnt lgkmcnt(8)
mf v[0:3],v[96:99],a[144:147],v[0:3]
ds_read_b64_tr_b16 v[64:65], v224 offset:16384
s_add_u32 m0, s34, 57344
mf v[32:35],v[96:99],a[148:151],v[32:35]
ds_read_b64_tr_b16 v[66:67], v224 offset:17408
mf v[36:39],v[100:103],a[148:151],v[36:39]
ds_read_b64_tr_b16 v[68:69], v225 offset:16384
s_add_u32 s37, s40, 28672
mf v[4:7],v[100:103],a[144:147],v[4:7]
ds_read_b64_tr_b16 v[70:71], v225 offset:17408
mf v[8:11],v[104:107],a[144:147],v[8:11]
ds_read_b64_tr_b16 v[72:73], v226 offset:16384
buffer_load_dwordx4 v240, s[24:27], s37 offen lds
mf v[40:43],v[104:107],a[148:151],v[40:43]
ds_read_b64_tr_b16 v[74:75], v226 offset:17408
mf v[44:47],v[108:111],a[148:151],v[44:47]
ds_read_b64_tr_b16 v[76:77], v227 offset:16384
buffer_load_dwordx4 v241, s[24:27], s37 offen offset:1024 lds
mf v[12:15],v[108:111],a[144:147],v[12:15]
ds_read_b64_tr_b16 v[78:79], v227 offset:17408
s_waitcnt lgkmcnt(8)
mf v[16:19],v[112:115],a[144:147],v[16:19]
ds_read_b64_tr_b16 v[80:81], v228 offset:16384
s_add_u32 m0, s34, 65536
mf v[48:51],v[112:115],a[148:151],v[48:51]
ds_read_b64_tr_b16 v[82:83], v228 offset:17408
mf v[52:55],v[116:119],a[148:151],v[52:55]
ds_read_b64_tr_b16 v[84:85], v229 offset:16384
s_add_u32 s37, s40, 57344
mf v[20:23],v[116:119],a[144:147],v[20:23]
ds_read_b64_tr_b16 v[86:87], v229 offset:17408
mf v[24:27],v[120:123],a[144:147],v[24:27]
ds_read_b64_tr_b16 v[88:89], v230 offset:16384
buffer_load_dwordx4 v240, s[24:27], s37 offen lds
mf v[56:59],v[120:123],a[148:151],v[56:59]
ds_read_b64_tr_b16 v[90:91], v230 offset:17408
mf v[60:63],v[124:127],a[148:151],v[60:63]
ds_read_b64_tr_b16 v[92:93], v231 offset:16384
buffer_load_dwordx4 v241, s[24:27], s37 offen offset:1024 lds
mf v[28:31],v[124:127],a[144:147],v[28:31]
ds_read_b64_tr_b16 v[94:95], v231 offset:17408
s_waitcnt vmcnt(12) lgkmcnt(8)
s_barrier
mf v[0:3],v[64:67],a[152:155],v[0:3]
ds_read_b64_tr_b16 v[96:97], v224 offset:24576
s_add_u32 m0, s34, 73728
mf v[32:35],v[64:67],a[156:159],v[32:35]
ds_read_b64_tr_b16 v[98:99], v224 offset:25600
s_add_u32 s37, s40, 86016
mf v[36:39],v[68:71],a[156:159],v[36:39]
ds_read_b64_tr_b16 v[100:101], v225 offset:24576
mf v[4:7],v[68:71],a[152:155],v[4:7]
ds_read_b64_tr_b16 v[102:103], v225 offset:25600
buffer_load_dwordx4 v240, s[24:27], s37 offen lds
mf v[8:11],v[72:75],a[152:155],v[8:11]
ds_read_b64_tr_b16 v[104:105], v226 offset:24576
mf v[40:43],v[72:75],a[156:159],v[40:43]
ds_read_b64_tr_b16 v[106:107], v226 offset:25600
buffer_load_dwordx4 v241, s[24:27], s37 offen offset:1024 lds
mf v[44:47],v[76:79],a[156:159],v[44:47]
ds_read_b64_tr_b16 v[108:109], v227 offset:24576
mf v[12:15],v[76:79],a[152:155],v[12:15]
ds_read_b64_tr_b16 v[110:111], v227 offset:25600
s_waitcnt lgkmcnt(8)
mf v[16:19],v[80:83],a[152:155],v[16:19]
ds_read_b64_tr_b16 v[112:113], v228 offset:24576
s_add_u32 m0, s34, 81920
mf v[48:51],v[80:83],a[156:159],v[48:51]
ds_read_b64_tr_b16 v[114:115], v228 offset:25600
s_add_u32 s37, s40, 114688
mf v[52:55],v[84:87],a[156:159],v[52:55]
ds_read_b64_tr_b16 v[116:117], v229 offset:24576
buffer_load_dwordx4 v240, s[24:27], s37 offen lds
mf v[20:23],v[84:87],a[152:155],v[20:23]
ds_read_b64_tr_b16 v[118:119], v229 offset:25600
mf v[24:27],v[88:91],a[152:155],v[24:27]
ds_read_b64_tr_b16 v[120:121], v230 offset:24576
buffer_load_dwordx4 v241, s[24:27], s37 offen offset:1024 lds
mf v[56:59],v[88:91],a[156:159],v[56:59]
ds_read_b64_tr_b16 v[122:123], v230 offset:25600
mf v[60:63],v[92:95],a[156:159],v[60:63]
ds_read_b64_tr_b16 v[124:125], v231 offset:24576
buffer_load_dword v253, v252, s[28:31], 0 offen sc1
mf v[28:31],v[92:95],a[152:155],v[28:31]
ds_read_b64_tr_b16 v[126:127], v231 offset:25600
s_waitcnt lgkmcnt(8)
mf v[0:3],v[96:99],a[160:163],v[0:3]
ds_read_b64_tr_b16 v[64:65], v224 offset:32768
s_add_u32 m0, s34, 90112
mf v[32:35],v[96:99],a[164:167],v[32:35]
ds_read_b64_tr_b16 v[66:67], v224 offset:33792
mf v[36:39],v[100:103],a[164:167],v[36:39]
ds_read_b64_tr_b16 v[68:69], v225 offset:32768
s_add_u32 s37, s40, 143360
mf v[4:7],v[100:103],a[160:163],v[4:7]
ds_read_b64_tr_b16 v[70:71], v225 offset:33792
mf v[8:11],v[104:107],a[160:163],v[8:11]
ds_read_b64_tr_b16 v[72:73], v226 offset:32768
buffer_load_dwordx4 v240, s[24:27], s37 offen lds
mf v[40:43],v[104:107],a[164:167],v[40:43]
ds_read_b64_tr_b16 v[74:75], v226 offset:33792
mf v[44:47],v[108:111],a[164:167],v[44:47]
ds_read_b64_tr_b16 v[76:77], v227 offset:32768
buffer_load_dwordx4 v241, s[24:27], s37 offen offset:1024 lds
mf v[12:15],v[108:111],a[160:163],v[12:15]
ds_read_b64_tr_b16 v[78:79], v227 offset:33792
s_waitcnt lgkmcnt(8)
mf v[16:19],v[112:115],a[160:163],v[16:19]
ds_read_b64_tr_b16 v[80:81], v228 offset:32768
s_add_u32 m0, s34, 98304
mf v[48:51],v[112:115],a[164:167],v[48:51]
ds_read_b64_tr_b16 v[82:83], v228 offset:33792
mf v[52:55],v[116:119],a[164:167],v[52:55]
ds_read_b64_tr_b16 v[84:85], v229 offset:32768
s_add_u32 s37, s40, 172032
mf v[20:23],v[116:119],a[160:163],v[20:23]
ds_read_b64_tr_b16 v[86:87], v229 offset:33792
mf v[24:27],v[120:123],a[160:163],v[24:27]
ds_read_b64_tr_b16 v[88:89], v230 offset:32768
buffer_load_dwordx4 v240, s[24:27], s37 offen lds
mf v[56:59],v[120:123],a[164:167],v[56:59]
ds_read_b64_tr_b16 v[90:91], v230 offset:33792
mf v[60:63],v[124:127],a[164:167],v[60:63]
ds_read_b64_tr_b16 v[92:93], v231 offset:32768
buffer_load_dwordx4 v241, s[24:27], s37 offen offset:1024 lds
mf v[28:31],v[124:127],a[160:163],v[28:31]
ds_read_b64_tr_b16 v[94:95], v231 offset:33792
s_waitcnt vmcnt(4)
s_mov_b64 exec, 0x3
v_cmp_gt_u32 vcc, 4, v253
s_mov_b64 exec, -1
s_cbranch_vccz chk_90
s_mov_b32 s67, 0x80000
s_mov_b64 exec, 0x3
poll_91:
buffer_load_dword v253, v252, s[28:31], 0 offen sc1
s_waitcnt vmcnt(0)
v_cmp_gt_u32 vcc, 4, v253
s_cbranch_vccz pollok_92
s_sleep 2
s_sub_u32 s67, s67, 1
s_cmp_lg_u32 s67, 0
s_cbranch_scc1 poll_91
pollok_92:
s_mov_b64 exec, -1
chk_90:
s_waitcnt vmcnt(13) lgkmcnt(8)
s_barrier
mf v[0:3],v[64:67],a[168:171],v[0:3]
ds_read_b64_tr_b16 v[96:97], v224 offset:40960
s_add_u32 s38, s43, 0
mf v[32:35],v[64:67],a[172:175],v[32:35]
ds_read_b64_tr_b16 v[98:99], v224 offset:41984
buffer_load_dwordx4 a[184:187], v206, s[28:31], s38 offen sc1
mf v[36:39],v[68:71],a[172:175],v[36:39]
ds_read_b64_tr_b16 v[100:101], v225 offset:40960
buffer_load_dwordx4 a[188:191], v222, s[28:31], s38 offen sc1
mf v[4:7],v[68:71],a[168:171],v[4:7]
ds_read_b64_tr_b16 v[102:103], v225 offset:41984
mf v[8:11],v[72:75],a[168:171],v[8:11]
ds_read_b64_tr_b16 v[104:105], v226 offset:40960
s_add_u32 s38, s43, 1024
mf v[40:43],v[72:75],a[172:175],v[40:43]
ds_read_b64_tr_b16 v[106:107], v226 offset:41984
buffer_load_dwordx4 a[192:195], v206, s[28:31], s38 offen sc1
mf v[44:47],v[76:79],a[172:175],v[44:47]
ds_read_b64_tr_b16 v[108:109], v227 offset:40960
buffer_load_dwordx4 a[196:199], v222, s[28:31], s38 offen sc1
mf v[12:15],v[76:79],a[168:171],v[12:15]
ds_read_b64_tr_b16 v[110:111], v227 offset:41984
s_waitcnt lgkmcnt(8)
mf v[16:19],v[80:83],a[168:171],v[16:19]
ds_read_b64_tr_b16 v[112:113], v228 offset:40960
s_add_u32 s38, s43, 2048
mf v[48:51],v[80:83],a[172:175],v[48:51]
ds_read_b64_tr_b16 v[114:115], v228 offset:41984
buffer_load_dwordx4 a[72:75], v206, s[28:31], s38 offen sc1
mf v[52:55],v[84:87],a[172:175],v[52:55]
ds_read_b64_tr_b16 v[116:117], v229 offset:40960
buffer_load_dwordx4 a[76:79], v222, s[28:31], s38 offen sc1
mf v[20:23],v[84:87],a[168:171],v[20:23]
ds_read_b64_tr_b16 v[118:119], v229 offset:41984
mf v[24:27],v[88:91],a[168:171],v[24:27]
ds_read_b64_tr_b16 v[120:121], v230 offset:40960
s_add_u32 s38, s43, 3072
mf v[56:59],v[88:91],a[172:175],v[56:59]
ds_read_b64_tr_b16 v[122:123], v230 offset:41984
buffer_load_dwordx4 a[80:83], v206, s[28:31], s38 offen sc1
mf v[60:63],v[92:95],a[172:175],v[60:63]
ds_read_b64_tr_b16 v[124:125], v231 offset:40960
buffer_load_dwordx4 a[84:87], v222, s[28:31], s38 offen sc1
mf v[28:31],v[92:95],a[168:171],v[28:31]
ds_read_b64_tr_b16 v[126:127], v231 offset:41984
s_waitcnt lgkmcnt(8)
mf v[0:3],v[96:99],a[176:179],v[0:3]
ds_read_b64_tr_b16 v[64:65], v224 offset:49152
s_add_u32 s38, s43, 4096
mf v[32:35],v[96:99],a[180:183],v[32:35]
ds_read_b64_tr_b16 v[66:67], v224 offset:50176
mf v[36:39],v[100:103],a[180:183],v[36:39]
ds_read_b64_tr_b16 v[68:69], v225 offset:49152
buffer_load_dwordx4 a[88:91], v206, s[28:31], s38 offen sc1
mf v[4:7],v[100:103],a[176:179],v[4:7]
ds_read_b64_tr_b16 v[70:71], v225 offset:50176
mf v[8:11],v[104:107],a[176:179],v[8:11]
ds_read_b64_tr_b16 v[72:73], v226 offset:49152
mf v[40:43],v[104:107],a[180:183],v[40:43]
ds_read_b64_tr_b16 v[74:75], v226 offset:50176
buffer_load_dwordx4 a[92:95], v222, s[28:31], s38 offen sc1
mf v[44:47],v[108:111],a[180:183],v[44:47]
ds_read_b64_tr_b16 v[76:77], v227 offset:49152
mf v[12:15],v[108:111],a[176:179],v[12:15]
ds_read_b64_tr_b16 v[78:79], v227 offset:50176
s_waitcnt lgkmcnt(8)
mf v[16:19],v[112:115],a[176:179],v[16:19]
ds_read_b64_tr_b16 v[80:81], v228 offset:49152
s_add_u32 s38, s43, 5120
mf v[48:51],v[112:115],a[180:183],v[48:51]
ds_read_b64_tr_b16 v[82:83], v228 offset:50176
mf v[52:55],v[116:119],a[180:183],v[52:55]
ds_read_b64_tr_b16 v[84:85], v229 offset:49152
buffer_load_dwordx4 a[96:99], v206, s[28:31], s38 offen sc1
mf v[20:23],v[116:119],a[176:179],v[20:23]
ds_read_b64_tr_b16 v[86:87], v229 offset:50176
mf v[24:27],v[120:123],a[176:179],v[24:27]
ds_read_b64_tr_b16 v[88:89], v230 offset:49152
mf v[56:59],v[120:123],a[180:183],v[56:59]
ds_read_b64_tr_b16 v[90:91], v230 offset:50176
buffer_load_dwordx4 a[100:103], v222, s[28:31], s38 offen sc1
mf v[60:63],v[124:127],a[180:183],v[60:63]
ds_read_b64_tr_b16 v[92:93], v231 offset:49152
mf v[28:31],v[124:127],a[176:179],v[28:31]
ds_read_b64_tr_b16 v[94:95], v231 offset:50176
s_waitcnt vmcnt(8) lgkmcnt(8)
s_barrier
mf v[0:3],v[64:67],a[184:187],v[0:3]
ds_read_b64_tr_b16 v[96:97], v224 offset:57344
s_add_u32 m0, s34, 106496
mf v[32:35],v[64:67],a[188:191],v[32:35]
ds_read_b64_tr_b16 v[98:99], v224 offset:58368
mf v[36:39],v[68:71],a[188:191],v[36:39]
ds_read_b64_tr_b16 v[100:101], v225 offset:57344
s_add_u32 s37, s40, 200704
mf v[4:7],v[68:71],a[184:187],v[4:7]
ds_read_b64_tr_b16 v[102:103], v225 offset:58368
mf v[8:11],v[72:75],a[184:187],v[8:11]
ds_read_b64_tr_b16 v[104:105], v226 offset:57344
buffer_load_dwordx4 v240, s[24:27], s37 offen lds
mf v[40:43],v[72:75],a[188:191],v[40:43]
ds_read_b64_tr_b16 v[106:107], v226 offset:58368
mf v[44:47],v[76:79],a[188:191],v[44:47]
ds_read_b64_tr_b16 v[108:109], v227 offset:57344
buffer_load_dwordx4 v241, s[24:27], s37 offen offset:1024 lds
mf v[12:15],v[76:79],a[184:187],v[12:15]
ds_read_b64_tr_b16 v[110:111], v227 offset:58368
s_waitcnt lgkmcnt(8)
mf v[16:19],v[80:83],a[184:187],v[16:19]
ds_read_b64_tr_b16 v[112:113], v228 offset:57344
mf v[48:51],v[80:83],a[188:191],v[48:51]
ds_read_b64_tr_b16 v[114:115], v228 offset:58368
s_add_u32 s38, s43, 6144
mf v[52:55],v[84:87],a[188:191],v[52:55]
ds_read_b64_tr_b16 v[116:117], v229 offset:57344
mf v[20:23],v[84:87],a[184:187],v[20:23]
ds_read_b64_tr_b16 v[118:119], v229 offset:58368
buffer_load_dwordx4 a[104:107], v206, s[28:31], s38 offen sc1
mf v[24:27],v[88:91],a[184:187],v[24:27]
ds_read_b64_tr_b16 v[120:121], v230 offset:57344
mf v[56:59],v[88:91],a[188:191],v[56:59]
ds_read_b64_tr_b16 v[122:123], v230 offset:58368
buffer_load_dwordx4 a[108:111], v222, s[28:31], s38 offen sc1
mf v[60:63],v[92:95],a[188:191],v[60:63]
ds_read_b64_tr_b16 v[124:125], v231 offset:57344
mf v[28:31],v[92:95],a[184:187],v[28:31]
ds_read_b64_tr_b16 v[126:127], v231 offset:58368
s_waitcnt lgkmcnt(8)
mf v[0:3],v[96:99],a[192:195],v[0:3]
ds_read_b64_tr_b16 v[64:65], v232 offset:0
s_add_u32 m0, s34, 114688
mf v[32:35],v[96:99],a[196:199],v[32:35]
ds_read_b64_tr_b16 v[66:67], v232 offset:1024
mf v[36:39],v[100:103],a[196:199],v[36:39]
ds_read_b64_tr_b16 v[68:69], v233 offset:0
s_add_u32 s37, s40, 229376
mf v[4:7],v[100:103],a[192:195],v[4:7]
ds_read_b64_tr_b16 v[70:71], v233 offset:1024
mf v[8:11],v[104:107],a[192:195],v[8:11]
ds_read_b64_tr_b16 v[72:73], v234 offset:0
buffer_load_dwordx4 v240, s[24:27], s37 offen lds
mf v[40:43],v[104:107],a[196:199],v[40:43]
ds_read_b64_tr_b16 v[74:75], v234 offset:1024
mf v[44:47],v[108:111],a[196:199],v[44:47]
ds_read_b64_tr_b16 v[76:77], v235 offset:0
buffer_load_dwordx4 v241, s[24:27], s37 offen offset:1024 lds
mf v[12:15],v[108:111],a[192:195],v[12:15]
ds_read_b64_tr_b16 v[78:79], v235 offset:1024
s_waitcnt lgkmcnt(8)
mf v[16:19],v[112:115],a[192:195],v[16:19]
ds_read_b64_tr_b16 v[80:81], v236 offset:0
mf v[48:51],v[112:115],a[196:199],v[48:51]
ds_read_b64_tr_b16 v[82:83], v236 offset:1024
s_add_u32 s38, s43, 7168
mf v[52:55],v[116:119],a[196:199],v[52:55]
ds_read_b64_tr_b16 v[84:85], v237 offset:0
mf v[20:23],v[116:119],a[192:195],v[20:23]
ds_read_b64_tr_b16 v[86:87], v237 offset:1024
buffer_load_dwordx4 a[112:115], v206, s[28:31], s38 offen sc1
mf v[24:27],v[120:123],a[192:195],v[24:27]
ds_read_b64_tr_b16 v[88:89], v238 offset:0
mf v[56:59],v[120:123],a[196:199],v[56:59]
ds_read_b64_tr_b16 v[90:91], v238 offset:1024
buffer_load_dwordx4 a[116:119], v222, s[28:31], s38 offen sc1
mf v[60:63],v[124:127],a[196:199],v[60:63]
ds_read_b64_tr_b16 v[92:93], v239 offset:0
mf v[28:31],v[124:127],a[192:195],v[28:31]
ds_read_b64_tr_b16 v[94:95], v239 offset:1024
s_waitcnt vmcnt(12) lgkmcnt(8)
s_barrier
mf v[0:3],v[64:67],a[72:75],v[0:3]
ds_read_b64_tr_b16 v[96:97], v232 offset:8192
s_add_u32 m0, s34, 122880
mf v[32:35],v[64:67],a[76:79],v[32:35]
ds_read_b64_tr_b16 v[98:99], v232 offset:9216
mf v[36:39],v[68:71],a[76:79],v[36:39]
ds_read_b64_tr_b16 v[100:101], v233 offset:8192
s_add_u32 s37, s40, 258048
mf v[4:7],v[68:71],a[72:75],v[4:7]
ds_read_b64_tr_b16 v[102:103], v233 offset:9216
mf v[8:11],v[72:75],a[72:75],v[8:11]
ds_read_b64_tr_b16 v[104:105], v234 offset:8192
buffer_load_dwordx4 v240, s[24:27], s37 offen lds
mf v[40:43],v[72:75],a[76:79],v[40:43]
ds_read_b64_tr_b16 v[106:107], v234 offset:9216
mf v[44:47],v[76:79],a[76:79],v[44:47]
ds_read_b64_tr_b16 v[108:109], v235 offset:8192
buffer_load_dwordx4 v241, s[24:27], s37 offen offset:1024 lds
mf v[12:15],v[76:79],a[72:75],v[12:15]
ds_read_b64_tr_b16 v[110:111], v235 offset:9216
s_waitcnt lgkmcnt(8)
mf v[16:19],v[80:83],a[72:75],v[16:19]
ds_read_b64_tr_b16 v[112:113], v236 offset:8192
mf v[48:51],v[80:83],a[76:79],v[48:51]
ds_read_b64_tr_b16 v[114:115], v236 offset:9216
s_add_u32 s38, s43, 8192
mf v[52:55],v[84:87],a[76:79],v[52:55]
ds_read_b64_tr_b16 v[116:117], v237 offset:8192
mf v[20:23],v[84:87],a[72:75],v[20:23]
ds_read_b64_tr_b16 v[118:119], v237 offset:9216
buffer_load_dwordx4 a[120:123], v206, s[28:31], s38 offen sc1
mf v[24:27],v[88:91],a[72:75],v[24:27]
ds_read_b64_tr_b16 v[120:121], v238 offset:8192
mf v[56:59],v[88:91],a[76:79],v[56:59]
ds_read_b64_tr_b16 v[122:123], v238 offset:9216
buffer_load_dwordx4 a[124:127], v222, s[28:31], s38 offen sc1
mf v[60:63],v[92:95],a[76:79],v[60:63]
ds_read_b64_tr_b16 v[124:125], v239 offset:8192
mf v[28:31],v[92:95],a[72:75],v[28:31]
ds_read_b64_tr_b16 v[126:127], v239 offset:9216
s_waitcnt lgkmcnt(8)
mf v[0:3],v[96:99],a[80:83],v[0:3]
ds_read_b64_tr_b16 v[64:65], v232 offset:16384
s_add_u32 m0, s34, 0
mf v[32:35],v[96:99],a[84:87],v[32:35]
ds_read_b64_tr_b16 v[66:67], v232 offset:17408
mf v[36:39],v[100:103],a[84:87],v[36:39]
ds_read_b64_tr_b16 v[68:69], v233 offset:16384
s_add_u32 s37, s40, 286720
mf v[4:7],v[100:103],a[80:83],v[4:7]
ds_read_b64_tr_b16 v[70:71], v233 offset:17408
mf v[8:11],v[104:107],a[80:83],v[8:11]
ds_read_b64_tr_b16 v[72:73], v234 offset:16384
buffer_load_dwordx4 v240, s[24:27], s37 offen lds
mf v[40:43],v[104:107],a[84:87],v[40:43]
ds_read_b64_tr_b16 v[74:75], v234 offset:17408
mf v[44:47],v[108:111],a[84:87],v[44:47]
ds_read_b64_tr_b16 v[76:77], v235 offset:16384
buffer_load_dwordx4 v241, s[24:27], s37 offen offset:1024 lds
mf v[12:15],v[108:111],a[80:83],v[12:15]
ds_read_b64_tr_b16 v[78:79], v235 offset:17408
s_waitcnt lgkmcnt(8)
mf v[16:19],v[112:115],a[80:83],v[16:19]
ds_read_b64_tr_b16 v[80:81], v236 offset:16384
mf v[48:51],v[112:115],a[84:87],v[48:51]
ds_read_b64_tr_b16 v[82:83], v236 offset:17408
s_add_u32 s38, s43, 9216
mf v[52:55],v[116:119],a[84:87],v[52:55]
ds_read_b64_tr_b16 v[84:85], v237 offset:16384
mf v[20:23],v[116:119],a[80:83],v[20:23]
ds_read_b64_tr_b16 v[86:87], v237 offset:17408
buffer_load_dwordx4 a[128:131], v206, s[28:31], s38 offen sc1
mf v[24:27],v[120:123],a[80:83],v[24:27]
ds_read_b64_tr_b16 v[88:89], v238 offset:16384
mf v[56:59],v[120:123],a[84:87],v[56:59]
ds_read_b64_tr_b16 v[90:91], v238 offset:17408
buffer_load_dwordx4 a[132:135], v222, s[28:31], s38 offen sc1
mf v[60:63],v[124:127],a[84:87],v[60:63]
ds_read_b64_tr_b16 v[92:93], v239 offset:16384
mf v[28:31],v[124:127],a[80:83],v[28:31]
ds_read_b64_tr_b16 v[94:95], v239 offset:17408
s_waitcnt vmcnt(16) lgkmcnt(8)
s_barrier
mf v[0:3],v[64:67],a[88:91],v[0:3]
ds_read_b64_tr_b16 v[96:97], v232 offset:24576
s_add_u32 m0, s34, 8192
mf v[32:35],v[64:67],a[92:95],v[32:35]
ds_read_b64_tr_b16 v[98:99], v232 offset:25600
mf v[36:39],v[68:71],a[92:95],v[36:39]
ds_read_b64_tr_b16 v[100:101], v233 offset:24576
s_add_u32 s37, s40, 315392
mf v[4:7],v[68:71],a[88:91],v[4:7]
ds_read_b64_tr_b16 v[102:103], v233 offset:25600
mf v[8:11],v[72:75],a[88:91],v[8:11]
ds_read_b64_tr_b16 v[104:105], v234 offset:24576
buffer_load_dwordx4 v240, s[24:27], s37 offen lds
mf v[40:43],v[72:75],a[92:95],v[40:43]
ds_read_b64_tr_b16 v[106:107], v234 offset:25600
mf v[44:47],v[76:79],a[92:95],v[44:47]
ds_read_b64_tr_b16 v[108:109], v235 offset:24576
buffer_load_dwordx4 v241, s[24:27], s37 offen offset:1024 lds
mf v[12:15],v[76:79],a[88:91],v[12:15]
ds_read_b64_tr_b16 v[110:111], v235 offset:25600
s_waitcnt lgkmcnt(8)
mf v[16:19],v[80:83],a[88:91],v[16:19]
ds_read_b64_tr_b16 v[112:113], v236 offset:24576
mf v[48:51],v[80:83],a[92:95],v[48:51]
ds_read_b64_tr_b16 v[114:115], v236 offset:25600
s_add_u32 s38, s43, 10240
mf v[52:55],v[84:87],a[92:95],v[52:55]
ds_read_b64_tr_b16 v[116:117], v237 offset:24576
mf v[20:23],v[84:87],a[88:91],v[20:23]
ds_read_b64_tr_b16 v[118:119], v237 offset:25600
buffer_load_dwordx4 a[136:139], v206, s[28:31], s38 offen sc1
mf v[24:27],v[88:91],a[88:91],v[24:27]
ds_read_b64_tr_b16 v[120:121], v238 offset:24576
mf v[56:59],v[88:91],a[92:95],v[56:59]
ds_read_b64_tr_b16 v[122:123], v238 offset:25600
buffer_load_dwordx4 a[140:143], v222, s[28:31], s38 offen sc1
mf v[60:63],v[92:95],a[92:95],v[60:63]
ds_read_b64_tr_b16 v[124:125], v239 offset:24576
mf v[28:31],v[92:95],a[88:91],v[28:31]
ds_read_b64_tr_b16 v[126:127], v239 offset:25600
s_waitcnt lgkmcnt(8)
mf v[0:3],v[96:99],a[96:99],v[0:3]
ds_read_b64_tr_b16 v[64:65], v232 offset:32768
s_add_u32 m0, s34, 16384
mf v[32:35],v[96:99],a[100:103],v[32:35]
ds_read_b64_tr_b16 v[66:67], v232 offset:33792
mf v[36:39],v[100:103],a[100:103],v[36:39]
ds_read_b64_tr_b16 v[68:69], v233 offset:32768
s_add_u32 s37, s40, 344064
mf v[4:7],v[100:103],a[96:99],v[4:7]
ds_read_b64_tr_b16 v[70:71], v233 offset:33792
mf v[8:11],v[104:107],a[96:99],v[8:11]
ds_read_b64_tr_b16 v[72:73], v234 offset:32768
buffer_load_dwordx4 v240, s[24:27], s37 offen lds
mf v[40:43],v[104:107],a[100:103],v[40:43]
ds_read_b64_tr_b16 v[74:75], v234 offset:33792
mf v[44:47],v[108:111],a[100:103],v[44:47]
ds_read_b64_tr_b16 v[76:77], v235 offset:32768
buffer_load_dwordx4 v241, s[24:27], s37 offen offset:1024 lds
mf v[12:15],v[108:111],a[96:99],v[12:15]
ds_read_b64_tr_b16 v[78:79], v235 offset:33792
s_waitcnt lgkmcnt(8)
mf v[16:19],v[112:115],a[96:99],v[16:19]
ds_read_b64_tr_b16 v[80:81], v236 offset:32768
mf v[48:51],v[112:115],a[100:103],v[48:51]
ds_read_b64_tr_b16 v[82:83], v236 offset:33792
s_add_u32 s38, s43, 11264
mf v[52:55],v[116:119],a[100:103],v[52:55]
ds_read_b64_tr_b16 v[84:85], v237 offset:32768
mf v[20:23],v[116:119],a[96:99],v[20:23]
ds_read_b64_tr_b16 v[86:87], v237 offset:33792
buffer_load_dwordx4 a[144:147], v206, s[28:31], s38 offen sc1
mf v[24:27],v[120:123],a[96:99],v[24:27]
ds_read_b64_tr_b16 v[88:89], v238 offset:32768
mf v[56:59],v[120:123],a[100:103],v[56:59]
ds_read_b64_tr_b16 v[90:91], v238 offset:33792
buffer_load_dwordx4 a[148:151], v222, s[28:31], s38 offen sc1
mf v[60:63],v[124:127],a[100:103],v[60:63]
ds_read_b64_tr_b16 v[92:93], v239 offset:32768
mf v[28:31],v[124:127],a[96:99],v[28:31]
ds_read_b64_tr_b16 v[94:95], v239 offset:33792
s_waitcnt vmcnt(16) lgkmcnt(8)
s_barrier
mf v[0:3],v[64:67],a[104:107],v[0:3]
ds_read_b64_tr_b16 v[96:97], v232 offset:40960
s_add_u32 m0, s34, 24576
mf v[32:35],v[64:67],a[108:111],v[32:35]
ds_read_b64_tr_b16 v[98:99], v232 offset:41984
mf v[36:39],v[68:71],a[108:111],v[36:39]
ds_read_b64_tr_b16 v[100:101], v233 offset:40960
s_add_u32 s37, s40, 372736
mf v[4:7],v[68:71],a[104:107],v[4:7]
ds_read_b64_tr_b16 v[102:103], v233 offset:41984
mf v[8:11],v[72:75],a[104:107],v[8:11]
ds_read_b64_tr_b16 v[104:105], v234 offset:40960
buffer_load_dwordx4 v240, s[24:27], s37 offen lds
mf v[40:43],v[72:75],a[108:111],v[40:43]
ds_read_b64_tr_b16 v[106:107], v234 offset:41984
mf v[44:47],v[76:79],a[108:111],v[44:47]
ds_read_b64_tr_b16 v[108:109], v235 offset:40960
buffer_load_dwordx4 v241, s[24:27], s37 offen offset:1024 lds
mf v[12:15],v[76:79],a[104:107],v[12:15]
ds_read_b64_tr_b16 v[110:111], v235 offset:41984
s_waitcnt lgkmcnt(8)
mf v[16:19],v[80:83],a[104:107],v[16:19]
ds_read_b64_tr_b16 v[112:113], v236 offset:40960
mf v[48:51],v[80:83],a[108:111],v[48:51]
ds_read_b64_tr_b16 v[114:115], v236 offset:41984
s_add_u32 s38, s43, 12288
mf v[52:55],v[84:87],a[108:111],v[52:55]
ds_read_b64_tr_b16 v[116:117], v237 offset:40960
mf v[20:23],v[84:87],a[104:107],v[20:23]
ds_read_b64_tr_b16 v[118:119], v237 offset:41984
buffer_load_dwordx4 a[152:155], v206, s[28:31], s38 offen sc1
mf v[24:27],v[88:91],a[104:107],v[24:27]
ds_read_b64_tr_b16 v[120:121], v238 offset:40960
mf v[56:59],v[88:91],a[108:111],v[56:59]
ds_read_b64_tr_b16 v[122:123], v238 offset:41984
buffer_load_dwordx4 a[156:159], v222, s[28:31], s38 offen sc1
mf v[60:63],v[92:95],a[108:111],v[60:63]
ds_read_b64_tr_b16 v[124:125], v239 offset:40960
mf v[28:31],v[92:95],a[104:107],v[28:31]
ds_read_b64_tr_b16 v[126:127], v239 offset:41984
s_waitcnt lgkmcnt(8)
mf v[0:3],v[96:99],a[112:115],v[0:3]
ds_read_b64_tr_b16 v[64:65], v232 offset:49152
s_add_u32 m0, s34, 32768
mf v[32:35],v[96:99],a[116:119],v[32:35]
ds_read_b64_tr_b16 v[66:67], v232 offset:50176
mf v[36:39],v[100:103],a[116:119],v[36:39]
ds_read_b64_tr_b16 v[68:69], v233 offset:49152
s_add_u32 s37, s40, 401408
mf v[4:7],v[100:103],a[112:115],v[4:7]
ds_read_b64_tr_b16 v[70:71], v233 offset:50176
mf v[8:11],v[104:107],a[112:115],v[8:11]
ds_read_b64_tr_b16 v[72:73], v234 offset:49152
buffer_load_dwordx4 v240, s[24:27], s37 offen lds
mf v[40:43],v[104:107],a[116:119],v[40:43]
ds_read_b64_tr_b16 v[74:75], v234 offset:50176
mf v[44:47],v[108:111],a[116:119],v[44:47]
ds_read_b64_tr_b16 v[76:77], v235 offset:49152
buffer_load_dwordx4 v241, s[24:27], s37 offen offset:1024 lds
mf v[12:15],v[108:111],a[112:115],v[12:15]
ds_read_b64_tr_b16 v[78:79], v235 offset:50176
s_waitcnt lgkmcnt(8)
mf v[16:19],v[112:115],a[112:115],v[16:19]
ds_read_b64_tr_b16 v[80:81], v236 offset:49152
s_add_u32 s38, s43, 13312
mf v[48:51],v[112:115],a[116:119],v[48:51]
ds_read_b64_tr_b16 v[82:83], v236 offset:50176
mf v[52:55],v[116:119],a[116:119],v[52:55]
ds_read_b64_tr_b16 v[84:85], v237 offset:49152
buffer_load_dwordx4 a[160:163], v206, s[28:31], s38 offen sc1
mf v[20:23],v[116:119],a[112:115],v[20:23]
ds_read_b64_tr_b16 v[86:87], v237 offset:50176
mf v[24:27],v[120:123],a[112:115],v[24:27]
ds_read_b64_tr_b16 v[88:89], v238 offset:49152
buffer_load_dwordx4 a[164:167], v222, s[28:31], s38 offen sc1
mf v[56:59],v[120:123],a[116:119],v[56:59]
ds_read_b64_tr_b16 v[90:91], v238 offset:50176
mf v[60:63],v[124:127],a[116:119],v[60:63]
ds_read_b64_tr_b16 v[92:93], v239 offset:49152
buffer_load_dword v253, v252, s[28:31], 0 offen sc1
mf v[28:31],v[124:127],a[112:115],v[28:31]
ds_read_b64_tr_b16 v[94:95], v239 offset:50176
s_waitcnt vmcnt(17) lgkmcnt(8)
s_barrier
mf v[0:3],v[64:67],a[120:123],v[0:3]
ds_read_b64_tr_b16 v[96:97], v232 offset:57344
s_add_u32 m0, s34, 40960
mf v[32:35],v[64:67],a[124:127],v[32:35]
ds_read_b64_tr_b16 v[98:99], v232 offset:58368
mf v[36:39],v[68:71],a[124:127],v[36:39]
ds_read_b64_tr_b16 v[100:101], v233 offset:57344
s_add_u32 s37, s40, 430080
mf v[4:7],v[68:71],a[120:123],v[4:7]
ds_read_b64_tr_b16 v[102:103], v233 offset:58368
mf v[8:11],v[72:75],a[120:123],v[8:11]
ds_read_b64_tr_b16 v[104:105], v234 offset:57344
buffer_load_dwordx4 v240, s[24:27], s37 offen lds
mf v[40:43],v[72:75],a[124:127],v[40:43]
ds_read_b64_tr_b16 v[106:107], v234 offset:58368
mf v[44:47],v[76:79],a[124:127],v[44:47]
ds_read_b64_tr_b16 v[108:109], v235 offset:57344
buffer_load_dwordx4 v241, s[24:27], s37 offen offset:1024 lds
mf v[12:15],v[76:79],a[120:123],v[12:15]
ds_read_b64_tr_b16 v[110:111], v235 offset:58368
s_waitcnt lgkmcnt(8)
mf v[16:19],v[80:83],a[120:123],v[16:19]
ds_read_b64_tr_b16 v[112:113], v236 offset:57344
mf v[48:51],v[80:83],a[124:127],v[48:51]
ds_read_b64_tr_b16 v[114:115], v236 offset:58368
s_add_u32 s38, s43, 14336
mf v[52:55],v[84:87],a[124:127],v[52:55]
ds_read_b64_tr_b16 v[116:117], v237 offset:57344
mf v[20:23],v[84:87],a[120:123],v[20:23]
ds_read_b64_tr_b16 v[118:119], v237 offset:58368
buffer_load_dwordx4 a[168:171], v206, s[28:31], s38 offen sc1
mf v[24:27],v[88:91],a[120:123],v[24:27]
ds_read_b64_tr_b16 v[120:121], v238 offset:57344
mf v[56:59],v[88:91],a[124:127],v[56:59]
ds_read_b64_tr_b16 v[122:123], v238 offset:58368
buffer_load_dwordx4 a[172:175], v222, s[28:31], s38 offen sc1
mf v[60:63],v[92:95],a[124:127],v[60:63]
ds_read_b64_tr_b16 v[124:125], v239 offset:57344
mf v[28:31],v[92:95],a[120:123],v[28:31]
ds_read_b64_tr_b16 v[126:127], v239 offset:58368
s_waitcnt lgkmcnt(8)
mf v[0:3],v[96:99],a[128:131],v[0:3]
ds_read_b64_tr_b16 v[64:65], v224 offset:0
s_add_u32 m0, s34, 49152
mf v[32:35],v[96:99],a[132:135],v[32:35]
ds_read_b64_tr_b16 v[66:67], v224 offset:1024
mf v[36:39],v[100:103],a[132:135],v[36:39]
ds_read_b64_tr_b16 v[68:69], v225 offset:0
s_add_u32 s37, s47, 0
mf v[4:7],v[100:103],a[128:131],v[4:7]
ds_read_b64_tr_b16 v[70:71], v225 offset:1024
mf v[8:11],v[104:107],a[128:131],v[8:11]
ds_read_b64_tr_b16 v[72:73], v226 offset:0
buffer_load_dwordx4 v240, s[24:27], s37 offen lds
mf v[40:43],v[104:107],a[132:135],v[40:43]
ds_read_b64_tr_b16 v[74:75], v226 offset:1024
mf v[44:47],v[108:111],a[132:135],v[44:47]
ds_read_b64_tr_b16 v[76:77], v227 offset:0
buffer_load_dwordx4 v241, s[24:27], s37 offen offset:1024 lds
mf v[12:15],v[108:111],a[128:131],v[12:15]
ds_read_b64_tr_b16 v[78:79], v227 offset:1024
s_waitcnt lgkmcnt(8)
mf v[16:19],v[112:115],a[128:131],v[16:19]
ds_read_b64_tr_b16 v[80:81], v228 offset:0
mf v[48:51],v[112:115],a[132:135],v[48:51]
ds_read_b64_tr_b16 v[82:83], v228 offset:1024
s_add_u32 s38, s43, 15360
mf v[52:55],v[116:119],a[132:135],v[52:55]
ds_read_b64_tr_b16 v[84:85], v229 offset:0
mf v[20:23],v[116:119],a[128:131],v[20:23]
ds_read_b64_tr_b16 v[86:87], v229 offset:1024
buffer_load_dwordx4 a[176:179], v206, s[28:31], s38 offen sc1
mf v[24:27],v[120:123],a[128:131],v[24:27]
ds_read_b64_tr_b16 v[88:89], v230 offset:0
mf v[56:59],v[120:123],a[132:135],v[56:59]
ds_read_b64_tr_b16 v[90:91], v230 offset:1024
buffer_load_dwordx4 a[180:183], v222, s[28:31], s38 offen sc1
mf v[60:63],v[124:127],a[132:135],v[60:63]
ds_read_b64_tr_b16 v[92:93], v231 offset:0
mf v[28:31],v[124:127],a[128:131],v[28:31]
ds_read_b64_tr_b16 v[94:95], v231 offset:1024
s_waitcnt vmcnt(8)
s_mov_b64 exec, 0xff
v_cmp_gt_u32 vcc, 4, v253
s_mov_b64 exec, -1
s_cbranch_vccz chk_93
s_mov_b32 s67, 0x80000
s_mov_b64 exec, 0xff
poll_94:
buffer_load_dword v253, v252, s[28:31], 0 offen sc1
s_waitcnt vmcnt(0)
v_cmp_gt_u32 vcc, 4, v253
s_cbranch_vccz pollok_95
s_sleep 2
s_sub_u32 s67, s67, 1
s_cmp_lg_u32 s67, 0
s_cbranch_scc1 poll_94
pollok_95:
s_mov_b64 exec, -1
chk_93:
s_waitcnt vmcnt(17) lgkmcnt(8)
s_barrier
mf v[0:3],v[64:67],a[136:139],v[0:3]
ds_read_b64_tr_b16 v[96:97], v224 offset:8192
s_add_u32 m0, s34, 57344
mf v[32:35],v[64:67],a[140:143],v[32:35]
ds_read_b64_tr_b16 v[98:99], v224 offset:9216
mf v[36:39],v[68:71],a[140:143],v[36:39]
ds_read_b64_tr_b16 v[100:101], v225 offset:8192
s_add_u32 s37, s47, 28672
mf v[4:7],v[68:71],a[136:139],v[4:7]
ds_read_b64_tr_b16 v[102:103], v225 offset:9216
mf v[8:11],v[72:75],a[136:139],v[8:11]
ds_read_b64_tr_b16 v[104:105], v226 offset:8192
buffer_load_dwordx4 v240, s[24:27], s37 offen lds
mf v[40:43],v[72:75],a[140:143],v[40:43]
ds_read_b64_tr_b16 v[106:107], v226 offset:9216
mf v[44:47],v[76:79],a[140:143],v[44:47]
ds_read_b64_tr_b16 v[108:109], v227 offset:8192
buffer_load_dwordx4 v241, s[24:27], s37 offen offset:1024 lds
mf v[12:15],v[76:79],a[136:139],v[12:15]
ds_read_b64_tr_b16 v[110:111], v227 offset:9216
s_waitcnt lgkmcnt(8)
mf v[16:19],v[80:83],a[136:139],v[16:19]
ds_read_b64_tr_b16 v[112:113], v228 offset:8192
mf v[48:51],v[80:83],a[140:143],v[48:51]
ds_read_b64_tr_b16 v[114:115], v228 offset:9216
s_add_u32 s38, s48, 0
mf v[52:55],v[84:87],a[140:143],v[52:55]
ds_read_b64_tr_b16 v[116:117], v229 offset:8192
mf v[20:23],v[84:87],a[136:139],v[20:23]
ds_read_b64_tr_b16 v[118:119], v229 offset:9216
buffer_load_dwordx4 a[184:187], v206, s[28:31], s38 offen sc1
mf v[24:27],v[88:91],a[136:139],v[24:27]
ds_read_b64_tr_b16 v[120:121], v230 offset:8192
mf v[56:59],v[88:91],a[140:143],v[56:59]
ds_read_b64_tr_b16 v[122:123], v230 offset:9216
buffer_load_dwordx4 a[188:191], v222, s[28:31], s38 offen sc1
mf v[60:63],v[92:95],a[140:143],v[60:63]
ds_read_b64_tr_b16 v[124:125], v231 offset:8192
mf v[28:31],v[92:95],a[136:139],v[28:31]
ds_read_b64_tr_b16 v[126:127], v231 offset:9216
s_waitcnt lgkmcnt(8)
mf v[0:3],v[96:99],a[144:147],v[0:3]
ds_read_b64_tr_b16 v[64:65], v224 offset:16384
s_add_u32 m0, s34, 65536
mf v[32:35],v[96:99],a[148:151],v[32:35]
ds_read_b64_tr_b16 v[66:67], v224 offset:17408
mf v[36:39],v[100:103],a[148:151],v[36:39]
ds_read_b64_tr_b16 v[68:69], v225 offset:16384
s_add_u32 s37, s47, 57344
mf v[4:7],v[100:103],a[144:147],v[4:7]
ds_read_b64_tr_b16 v[70:71], v225 offset:17408
mf v[8:11],v[104:107],a[144:147],v[8:11]
ds_read_b64_tr_b16 v[72:73], v226 offset:16384
buffer_load_dwordx4 v240, s[24:27], s37 offen lds
mf v[40:43],v[104:107],a[148:151],v[40:43]
ds_read_b64_tr_b16 v[74:75], v226 offset:17408
mf v[44:47],v[108:111],a[148:151],v[44:47]
ds_read_b64_tr_b16 v[76:77], v227 offset:16384
buffer_load_dwordx4 v241, s[24:27], s37 offen offset:1024 lds
mf v[12:15],v[108:111],a[144:147],v[12:15]
ds_read_b64_tr_b16 v[78:79], v227 offset:17408
s_waitcnt lgkmcnt(8)
mf v[16:19],v[112:115],a[144:147],v[16:19]
ds_read_b64_tr_b16 v[80:81], v228 offset:16384
mf v[48:51],v[112:115],a[148:151],v[48:51]
ds_read_b64_tr_b16 v[82:83], v228 offset:17408
s_add_u32 s38, s48, 1024
mf v[52:55],v[116:119],a[148:151],v[52:55]
ds_read_b64_tr_b16 v[84:85], v229 offset:16384
mf v[20:23],v[116:119],a[144:147],v[20:23]
ds_read_b64_tr_b16 v[86:87], v229 offset:17408
buffer_load_dwordx4 a[192:195], v206, s[28:31], s38 offen sc1
mf v[24:27],v[120:123],a[144:147],v[24:27]
ds_read_b64_tr_b16 v[88:89], v230 offset:16384
mf v[56:59],v[120:123],a[148:151],v[56:59]
ds_read_b64_tr_b16 v[90:91], v230 offset:17408
buffer_load_dwordx4 a[196:199], v222, s[28:31], s38 offen sc1
mf v[60:63],v[124:127],a[148:151],v[60:63]
ds_read_b64_tr_b16 v[92:93], v231 offset:16384
mf v[28:31],v[124:127],a[144:147],v[28:31]
ds_read_b64_tr_b16 v[94:95], v231 offset:17408
s_waitcnt vmcnt(17) lgkmcnt(8)
s_barrier
mf v[0:3],v[64:67],a[152:155],v[0:3]
ds_read_b64_tr_b16 v[96:97], v224 offset:24576
s_add_u32 m0, s34, 73728
mf v[32:35],v[64:67],a[156:159],v[32:35]
ds_read_b64_tr_b16 v[98:99], v224 offset:25600
mf v[36:39],v[68:71],a[156:159],v[36:39]
ds_read_b64_tr_b16 v[100:101], v225 offset:24576
s_add_u32 s37, s47, 86016
mf v[4:7],v[68:71],a[152:155],v[4:7]
ds_read_b64_tr_b16 v[102:103], v225 offset:25600
mf v[8:11],v[72:75],a[152:155],v[8:11]
ds_read_b64_tr_b16 v[104:105], v226 offset:24576
buffer_load_dwordx4 v240, s[24:27], s37 offen lds
mf v[40:43],v[72:75],a[156:159],v[40:43]
ds_read_b64_tr_b16 v[106:107], v226 offset:25600
mf v[44:47],v[76:79],a[156:159],v[44:47]
ds_read_b64_tr_b16 v[108:109], v227 offset:24576
buffer_load_dwordx4 v241, s[24:27], s37 offen offset:1024 lds
mf v[12:15],v[76:79],a[152:155],v[12:15]
ds_read_b64_tr_b16 v[110:111], v227 offset:25600
s_waitcnt lgkmcnt(8)
mf v[16:19],v[80:83],a[152:155],v[16:19]
ds_read_b64_tr_b16 v[112:113], v228 offset:24576
mf v[48:51],v[80:83],a[156:159],v[48:51]
ds_read_b64_tr_b16 v[114:115], v228 offset:25600
s_add_u32 s38, s48, 2048
mf v[52:55],v[84:87],a[156:159],v[52:55]
ds_read_b64_tr_b16 v[116:117], v229 offset:24576
mf v[20:23],v[84:87],a[152:155],v[20:23]
ds_read_b64_tr_b16 v[118:119], v229 offset:25600
buffer_load_dwordx4 a[72:75], v206, s[28:31], s38 offen sc1
mf v[24:27],v[88:91],a[152:155],v[24:27]
ds_read_b64_tr_b16 v[120:121], v230 offset:24576
mf v[56:59],v[88:91],a[156:159],v[56:59]
ds_read_b64_tr_b16 v[122:123], v230 offset:25600
buffer_load_dwordx4 a[76:79], v222, s[28:31], s38 offen sc1
mf v[60:63],v[92:95],a[156:159],v[60:63]
ds_read_b64_tr_b16 v[124:125], v231 offset:24576
mf v[28:31],v[92:95],a[152:155],v[28:31]
ds_read_b64_tr_b16 v[126:127], v231 offset:25600
s_waitcnt lgkmcnt(8)
mf v[0:3],v[96:99],a[160:163],v[0:3]
ds_read_b64_tr_b16 v[64:65], v224 offset:32768
s_add_u32 m0, s34, 81920
mf v[32:35],v[96:99],a[164:167],v[32:35]
ds_read_b64_tr_b16 v[66:67], v224 offset:33792
mf v[36:39],v[100:103],a[164:167],v[36:39]
ds_read_b64_tr_b16 v[68:69], v225 offset:32768
s_add_u32 s37, s47, 114688
mf v[4:7],v[100:103],a[160:163],v[4:7]
ds_read_b64_tr_b16 v[70:71], v225 offset:33792
mf v[8:11],v[104:107],a[160:163],v[8:11]
ds_read_b64_tr_b16 v[72:73], v226 offset:32768
buffer_load_dwordx4 v240, s[24:27], s37 offen lds
mf v[40:43],v[104:107],a[164:167],v[40:43]
ds_read_b64_tr_b16 v[74:75], v226 offset:33792
mf v[44:47],v[108:111],a[164:167],v[44:47]
ds_read_b64_tr_b16 v[76:77], v227 offset:32768
buffer_load_dwordx4 v241, s[24:27], s37 offen offset:1024 lds
mf v[12:15],v[108:111],a[160:163],v[12:15]
ds_read_b64_tr_b16 v[78:79], v227 offset:33792
s_waitcnt lgkmcnt(8)
mf v[16:19],v[112:115],a[160:163],v[16:19]
ds_read_b64_tr_b16 v[80:81], v228 offset:32768
mf v[48:51],v[112:115],a[164:167],v[48:51]
ds_read_b64_tr_b16 v[82:83], v228 offset:33792
s_add_u32 s38, s48, 3072
mf v[52:55],v[116:119],a[164:167],v[52:55]
ds_read_b64_tr_b16 v[84:85], v229 offset:32768
mf v[20:23],v[116:119],a[160:163],v[20:23]
ds_read_b64_tr_b16 v[86:87], v229 offset:33792
buffer_load_dwordx4 a[80:83], v206, s[28:31], s38 offen sc1
mf v[24:27],v[120:123],a[160:163],v[24:27]
ds_read_b64_tr_b16 v[88:89], v230 offset:32768
mf v[56:59],v[120:123],a[164:167],v[56:59]
ds_read_b64_tr_b16 v[90:91], v230 offset:33792
buffer_load_dwordx4 a[84:87], v222, s[28:31], s38 offen sc1
mf v[60:63],v[124:127],a[164:167],v[60:63]
ds_read_b64_tr_b16 v[92:93], v231 offset:32768
mf v[28:31],v[124:127],a[160:163],v[28:31]
ds_read_b64_tr_b16 v[94:95], v231 offset:33792
s_waitcnt vmcnt(16) lgkmcnt(8)
s_barrier
mf v[0:3],v[64:67],a[168:171],v[0:3]
ds_read_b64_tr_b16 v[96:97], v224 offset:40960
s_add_u32 m0, s34, 90112
mf v[32:35],v[64:67],a[172:175],v[32:35]
ds_read_b64_tr_b16 v[98:99], v224 offset:41984
mf v[36:39],v[68:71],a[172:175],v[36:39]
ds_read_b64_tr_b16 v[100:101], v225 offset:40960
s_add_u32 s37, s47, 143360
mf v[4:7],v[68:71],a[168:171],v[4:7]
ds_read_b64_tr_b16 v[102:103], v225 offset:41984
mf v[8:11],v[72:75],a[168:171],v[8:11]
ds_read_b64_tr_b16 v[104:105], v226 offset:40960
buffer_load_dwordx4 v240, s[24:27], s37 offen lds
mf v[40:43],v[72:75],a[172:175],v[40:43]
ds_read_b64_tr_b16 v[106:107], v226 offset:41984
mf v[44:47],v[76:79],a[172:175],v[44:47]
ds_read_b64_tr_b16 v[108:109], v227 offset:40960
buffer_load_dwordx4 v241, s[24:27], s37 offen offset:1024 lds
mf v[12:15],v[76:79],a[168:171],v[12:15]
ds_read_b64_tr_b16 v[110:111], v227 offset:41984
s_waitcnt lgkmcnt(8)
mf v[16:19],v[80:83],a[168:171],v[16:19]
ds_read_b64_tr_b16 v[112:113], v228 offset:40960
mf v[48:51],v[80:83],a[172:175],v[48:51]
ds_read_b64_tr_b16 v[114:115], v228 offset:41984
s_add_u32 s38, s48, 4096
mf v[52:55],v[84:87],a[172:175],v[52:55]
ds_read_b64_tr_b16 v[116:117], v229 offset:40960
mf v[20:23],v[84:87],a[168:171],v[20:23]
ds_read_b64_tr_b16 v[118:119], v229 offset:41984
buffer_load_dwordx4 a[88:91], v206, s[28:31], s38 offen sc1
mf v[24:27],v[88:91],a[168:171],v[24:27]
ds_read_b64_tr_b16 v[120:121], v230 offset:40960
mf v[56:59],v[88:91],a[172:175],v[56:59]
ds_read_b64_tr_b16 v[122:123], v230 offset:41984
buffer_load_dwordx4 a[92:95], v222, s[28:31], s38 offen sc1
mf v[60:63],v[92:95],a[172:175],v[60:63]
ds_read_b64_tr_b16 v[124:125], v231 offset:40960
mf v[28:31],v[92:95],a[168:171],v[28:31]
ds_read_b64_tr_b16 v[126:127], v231 offset:41984
s_waitcnt lgkmcnt(8)
mf v[0:3],v[96:99],a[176:179],v[0:3]
ds_read_b64_tr_b16 v[64:65], v224 offset:49152
s_add_u32 m0, s34, 98304
mf v[32:35],v[96:99],a[180:183],v[32:35]
ds_read_b64_tr_b16 v[66:67], v224 offset:50176
mf v[36:39],v[100:103],a[180:183],v[36:39]
ds_read_b64_tr_b16 v[68:69], v225 offset:49152
s_add_u32 s37, s47, 172032
mf v[4:7],v[100:103],a[176:179],v[4:7]
ds_read_b64_tr_b16 v[70:71], v225 offset:50176
mf v[8:11],v[104:107],a[176:179],v[8:11]
ds_read_b64_tr_b16 v[72:73], v226 offset:49152
buffer_load_dwordx4 v240, s[24:27], s37 offen lds
mf v[40:43],v[104:107],a[180:183],v[40:43]
ds_read_b64_tr_b16 v[74:75], v226 offset:50176
mf v[44:47],v[108:111],a[180:183],v[44:47]
ds_read_b64_tr_b16 v[76:77], v227 offset:49152
buffer_load_dwordx4 v241, s[24:27], s37 offen offset:1024 lds
mf v[12:15],v[108:111],a[176:179],v[12:15]
ds_read_b64_tr_b16 v[78:79], v227 offset:50176
s_waitcnt lgkmcnt(8)
mf v[16:19],v[112:115],a[176:179],v[16:19]
ds_read_b64_tr_b16 v[80:81], v228 offset:49152
mf v[48:51],v[112:115],a[180:183],v[48:51]
ds_read_b64_tr_b16 v[82:83], v228 offset:50176
s_add_u32 s38, s48, 5120
mf v[52:55],v[116:119],a[180:183],v[52:55]
ds_read_b64_tr_b16 v[84:85], v229 offset:49152
mf v[20:23],v[116:119],a[176:179],v[20:23]
ds_read_b64_tr_b16 v[86:87], v229 offset:50176
buffer_load_dwordx4 a[96:99], v206, s[28:31], s38 offen sc1
mf v[24:27],v[120:123],a[176:179],v[24:27]
ds_read_b64_tr_b16 v[88:89], v230 offset:49152
mf v[56:59],v[120:123],a[180:183],v[56:59]
ds_read_b64_tr_b16 v[90:91], v230 offset:50176
buffer_load_dwordx4 a[100:103], v222, s[28:31], s38 offen sc1
mf v[60:63],v[124:127],a[180:183],v[60:63]
ds_read_b64_tr_b16 v[92:93], v231 offset:49152
mf v[28:31],v[124:127],a[176:179],v[28:31]
ds_read_b64_tr_b16 v[94:95], v231 offset:50176
s_waitcnt vmcnt(16) lgkmcnt(8)
s_barrier
mf v[0:3],v[64:67],a[184:187],v[0:3]
ds_read_b64_tr_b16 v[96:97], v224 offset:57344
s_add_u32 m0, s34, 106496
mf v[32:35],v[64:67],a[188:191],v[32:35]
ds_read_b64_tr_b16 v[98:99], v224 offset:58368
mf v[36:39],v[68:71],a[188:191],v[36:39]
ds_read_b64_tr_b16 v[100:101], v225 offset:57344
s_add_u32 s37, s47, 200704
mf v[4:7],v[68:71],a[184:187],v[4:7]
ds_read_b64_tr_b16 v[102:103], v225 offset:58368
mf v[8:11],v[72:75],a[184:187],v[8:11]
ds_read_b64_tr_b16 v[104:105], v226 offset:57344
buffer_load_dwordx4 v240, s[24:27], s37 offen lds
mf v[40:43],v[72:75],a[188:191],v[40:43]
ds_read_b64_tr_b16 v[106:107], v226 offset:58368
mf v[44:47],v[76:79],a[188:191],v[44:47]
ds_read_b64_tr_b16 v[108:109], v227 offset:57344
buffer_load_dwordx4 v241, s[24:27], s37 offen offset:1024 lds
mf v[12:15],v[76:79],a[184:187],v[12:15]
ds_read_b64_tr_b16 v[110:111], v227 offset:58368
s_waitcnt lgkmcnt(8)
mf v[16:19],v[80:83],a[184:187],v[16:19]
ds_read_b64_tr_b16 v[112:113], v228 offset:57344
mf v[48:51],v[80:83],a[188:191],v[48:51]
ds_read_b64_tr_b16 v[114:115], v228 offset:58368
s_add_u32 s38, s48, 6144
mf v[52:55],v[84:87],a[188:191],v[52:55]
ds_read_b64_tr_b16 v[116:117], v229 offset:57344
mf v[20:23],v[84:87],a[184:187],v[20:23]
ds_read_b64_tr_b16 v[118:119], v229 offset:58368
buffer_load_dwordx4 a[104:107], v206, s[28:31], s38 offen sc1
mf v[24:27],v[88:91],a[184:187],v[24:27]
ds_read_b64_tr_b16 v[120:121], v230 offset:57344
mf v[56:59],v[88:91],a[188:191],v[56:59]
ds_read_b64_tr_b16 v[122:123], v230 offset:58368
buffer_load_dwordx4 a[108:111], v222, s[28:31], s38 offen sc1
mf v[60:63],v[92:95],a[188:191],v[60:63]
ds_read_b64_tr_b16 v[124:125], v231 offset:57344
mf v[28:31],v[92:95],a[184:187],v[28:31]
ds_read_b64_tr_b16 v[126:127], v231 offset:58368
s_waitcnt lgkmcnt(8)
mf v[0:3],v[96:99],a[192:195],v[0:3]
ds_read_b64_tr_b16 v[64:65], v232 offset:0
s_add_u32 m0, s34, 114688
mf v[32:35],v[96:99],a[196:199],v[32:35]
ds_read_b64_tr_b16 v[66:67], v232 offset:1024
s_add_u32 s37, s47, 229376
mf v[36:39],v[100:103],a[196:199],v[36:39]
ds_read_b64_tr_b16 v[68:69], v233 offset:0
buffer_load_dwordx4 v240, s[24:27], s37 offen lds
mf v[4:7],v[100:103],a[192:195],v[4:7]
ds_read_b64_tr_b16 v[70:71], v233 offset:1024
mf v[8:11],v[104:107],a[192:195],v[8:11]
ds_read_b64_tr_b16 v[72:73], v234 offset:0
buffer_load_dwordx4 v241, s[24:27], s37 offen offset:1024 lds
mf v[40:43],v[104:107],a[196:199],v[40:43]
ds_read_b64_tr_b16 v[74:75], v234 offset:1024
s_add_u32 s38, s48, 7168
mf v[44:47],v[108:111],a[196:199],v[44:47]
ds_read_b64_tr_b16 v[76:77], v235 offset:0
buffer_load_dwordx4 a[112:115], v206, s[28:31], s38 offen sc1
mf v[12:15],v[108:111],a[192:195],v[12:15]
ds_read_b64_tr_b16 v[78:79], v235 offset:1024
s_waitcnt lgkmcnt(8)
mf v[16:19],v[112:115],a[192:195],v[16:19]
ds_read_b64_tr_b16 v[80:81], v236 offset:0
buffer_load_dwordx4 a[116:119], v222, s[28:31], s38 offen sc1
mf v[48:51],v[112:115],a[196:199],v[48:51]
ds_read_b64_tr_b16 v[82:83], v236 offset:1024
s_lshl_b32 s19, s44, 2
mf v[52:55],v[116:119],a[196:199],v[52:55]
ds_read_b64_tr_b16 v[84:85], v237 offset:0
s_add_u32 s19, s19, s45
mf v[20:23],v[116:119],a[192:195],v[20:23]
ds_read_b64_tr_b16 v[86:87], v237 offset:1024
mf v[24:27],v[120:123],a[192:195],v[24:27]
ds_read_b64_tr_b16 v[88:89], v238 offset:0
s_lshl_b32 s32, s19, 17
mf v[56:59],v[120:123],a[196:199],v[56:59]
ds_read_b64_tr_b16 v[90:91], v238 offset:1024
s_lshl_b32 s17, s16, 11
mf v[60:63],v[124:127],a[196:199],v[60:63]
ds_read_b64_tr_b16 v[92:93], v239 offset:0
s_add_u32 s32, s32, s17
mf v[28:31],v[124:127],a[192:195],v[28:31]
ds_read_b64_tr_b16 v[94:95], v239 offset:1024
s_waitcnt vmcnt(16) lgkmcnt(8)
s_barrier
mf v[0:3],v[64:67],a[72:75],v[0:3]
ds_read_b64_tr_b16 v[96:97], v232 offset:8192
s_add_u32 m0, s34, 122880
mf v[32:35],v[64:67],a[76:79],v[32:35]
ds_read_b64_tr_b16 v[98:99], v232 offset:9216
s_add_u32 s37, s47, 258048
mf v[36:39],v[68:71],a[76:79],v[36:39]
ds_read_b64_tr_b16 v[100:101], v233 offset:8192
buffer_load_dwordx4 v240, s[24:27], s37 offen lds
mf v[4:7],v[68:71],a[72:75],v[4:7]
ds_read_b64_tr_b16 v[102:103], v233 offset:9216
mf v[8:11],v[72:75],a[72:75],v[8:11]
ds_read_b64_tr_b16 v[104:105], v234 offset:8192
buffer_load_dwordx4 v241, s[24:27], s37 offen offset:1024 lds
mf v[40:43],v[72:75],a[76:79],v[40:43]
ds_read_b64_tr_b16 v[106:107], v234 offset:9216
s_add_u32 s38, s48, 8192
mf v[44:47],v[76:79],a[76:79],v[44:47]
ds_read_b64_tr_b16 v[108:109], v235 offset:8192
buffer_load_dwordx4 a[120:123], v206, s[28:31], s38 offen sc1
mf v[12:15],v[76:79],a[72:75],v[12:15]
ds_read_b64_tr_b16 v[110:111], v235 offset:9216
s_waitcnt lgkmcnt(8)
mf v[16:19],v[80:83],a[72:75],v[16:19]
ds_read_b64_tr_b16 v[112:113], v236 offset:8192
buffer_load_dwordx4 a[124:127], v222, s[28:31], s38 offen sc1
mf v[48:51],v[80:83],a[76:79],v[48:51]
ds_read_b64_tr_b16 v[114:115], v236 offset:9216
s_add_u32 s32, s32, 115343360
mf v[52:55],v[84:87],a[76:79],v[52:55]
ds_read_b64_tr_b16 v[116:117], v237 offset:8192
s_mov_b32 s33, s32
mf v[20:23],v[84:87],a[72:75],v[20:23]
ds_read_b64_tr_b16 v[118:119], v237 offset:9216
mf v[24:27],v[88:91],a[72:75],v[24:27]
ds_read_b64_tr_b16 v[120:121], v238 offset:8192
s_lshl_b32 s17, s46, 15
mf v[56:59],v[88:91],a[76:79],v[56:59]
ds_read_b64_tr_b16 v[122:123], v238 offset:9216
s_add_u32 s32, s32, s17
mf v[60:63],v[92:95],a[76:79],v[60:63]
ds_read_b64_tr_b16 v[124:125], v239 offset:8192
s_lshl_b32 s35, s44, 2
mf v[28:31],v[92:95],a[72:75],v[28:31]
ds_read_b64_tr_b16 v[126:127], v239 offset:9216
s_waitcnt lgkmcnt(8)
mf v[0:3],v[96:99],a[80:83],v[0:3]
ds_read_b64_tr_b16 v[64:65], v232 offset:16384
s_add_u32 m0, s34, 0
mf v[32:35],v[96:99],a[84:87],v[32:35]
ds_read_b64_tr_b16 v[66:67], v232 offset:17408
s_add_u32 s37, s47, 286720
mf v[36:39],v[100:103],a[84:87],v[36:39]
ds_read_b64_tr_b16 v[68:69], v233 offset:16384
buffer_load_dwordx4 v240, s[24:27], s37 offen lds
mf v[4:7],v[100:103],a[80:83],v[4:7]
ds_read_b64_tr_b16 v[70:71], v233 offset:17408
mf v[8:11],v[104:107],a[80:83],v[8:11]
ds_read_b64_tr_b16 v[72:73], v234 offset:16384
buffer_load_dwordx4 v241, s[24:27], s37 offen offset:1024 lds
mf v[40:43],v[104:107],a[84:87],v[40:43]
ds_read_b64_tr_b16 v[74:75], v234 offset:17408
s_add_u32 s38, s48, 9216
mf v[44:47],v[108:111],a[84:87],v[44:47]
ds_read_b64_tr_b16 v[76:77], v235 offset:16384
buffer_load_dwordx4 a[128:131], v206, s[28:31], s38 offen sc1
mf v[12:15],v[108:111],a[80:83],v[12:15]
ds_read_b64_tr_b16 v[78:79], v235 offset:17408
s_waitcnt lgkmcnt(8)
mf v[16:19],v[112:115],a[80:83],v[16:19]
ds_read_b64_tr_b16 v[80:81], v236 offset:16384
buffer_load_dwordx4 a[132:135], v222, s[28:31], s38 offen sc1
mf v[48:51],v[112:115],a[84:87],v[48:51]
ds_read_b64_tr_b16 v[82:83], v236 offset:17408
s_add_u32 s35, s35, s16
mf v[52:55],v[116:119],a[84:87],v[52:55]
ds_read_b64_tr_b16 v[84:85], v237 offset:16384
s_mul_i32 s36, s35, 57344
mf v[20:23],v[116:119],a[80:83],v[20:23]
ds_read_b64_tr_b16 v[86:87], v237 offset:17408
mf v[24:27],v[120:123],a[80:83],v[24:27]
ds_read_b64_tr_b16 v[88:89], v238 offset:16384
s_lshl_b32 s18, s45, 2
mf v[56:59],v[120:123],a[84:87],v[56:59]
ds_read_b64_tr_b16 v[90:91], v238 offset:17408
s_add_u32 s18, s18, s46
mf v[60:63],v[124:127],a[84:87],v[60:63]
ds_read_b64_tr_b16 v[92:93], v239 offset:16384
s_lshl_b32 s39, s18, 11
mf v[28:31],v[124:127],a[80:83],v[28:31]
ds_read_b64_tr_b16 v[94:95], v239 offset:17408
s_waitcnt vmcnt(16) lgkmcnt(8)
s_barrier
mf v[0:3],v[64:67],a[88:91],v[0:3]
ds_read_b64_tr_b16 v[96:97], v232 offset:24576
s_add_u32 m0, s34, 8192
mf v[32:35],v[64:67],a[92:95],v[32:35]
ds_read_b64_tr_b16 v[98:99], v232 offset:25600
s_add_u32 s37, s47, 315392
mf v[36:39],v[68:71],a[92:95],v[36:39]
ds_read_b64_tr_b16 v[100:101], v233 offset:24576
buffer_load_dwordx4 v240, s[24:27], s37 offen lds
mf v[4:7],v[68:71],a[88:91],v[4:7]
ds_read_b64_tr_b16 v[102:103], v233 offset:25600
mf v[8:11],v[72:75],a[88:91],v[8:11]
ds_read_b64_tr_b16 v[104:105], v234 offset:24576
buffer_load_dwordx4 v241, s[24:27], s37 offen offset:1024 lds
mf v[40:43],v[72:75],a[92:95],v[40:43]
ds_read_b64_tr_b16 v[106:107], v234 offset:25600
s_add_u32 s38, s48, 10240
mf v[44:47],v[76:79],a[92:95],v[44:47]
ds_read_b64_tr_b16 v[108:109], v235 offset:24576
buffer_load_dwordx4 a[136:139], v206, s[28:31], s38 offen sc1
mf v[12:15],v[76:79],a[88:91],v[12:15]
ds_read_b64_tr_b16 v[110:111], v235 offset:25600
s_waitcnt lgkmcnt(8)
mf v[16:19],v[80:83],a[88:91],v[16:19]
ds_read_b64_tr_b16 v[112:113], v236 offset:24576
buffer_load_dwordx4 a[140:143], v222, s[28:31], s38 offen sc1
mf v[48:51],v[80:83],a[92:95],v[48:51]
ds_read_b64_tr_b16 v[114:115], v236 offset:25600
s_add_u32 s36, s36, s39
mf v[52:55],v[84:87],a[92:95],v[52:55]
ds_read_b64_tr_b16 v[116:117], v237 offset:24576
s_add_u32 s36, s36, 106954752
mf v[20:23],v[84:87],a[88:91],v[20:23]
ds_read_b64_tr_b16 v[118:119], v237 offset:25600
mf v[24:27],v[88:91],a[88:91],v[24:27]
ds_read_b64_tr_b16 v[120:121], v238 offset:24576
s_cmp_ge_u32 s18, 14
s_cselect_b32 s36, 0x40000000, s36
mf v[56:59],v[88:91],a[92:95],v[56:59]
ds_read_b64_tr_b16 v[122:123], v238 offset:25600
s_add_u32 s39, s36, 0
mf v[60:63],v[92:95],a[92:95],v[60:63]
ds_read_b64_tr_b16 v[124:125], v239 offset:24576
buffer_load_dwordx4 v[128:131], v206, s[28:31], s39 offen sc1
mf v[28:31],v[92:95],a[88:91],v[28:31]
ds_read_b64_tr_b16 v[126:127], v239 offset:25600
s_waitcnt lgkmcnt(8)
mf v[0:3],v[96:99],a[96:99],v[0:3]
ds_read_b64_tr_b16 v[64:65], v232 offset:32768
s_add_u32 m0, s34, 16384
mf v[32:35],v[96:99],a[100:103],v[32:35]
ds_read_b64_tr_b16 v[66:67], v232 offset:33792
s_add_u32 s37, s47, 344064
mf v[36:39],v[100:103],a[100:103],v[36:39]
ds_read_b64_tr_b16 v[68:69], v233 offset:32768
buffer_load_dwordx4 v240, s[24:27], s37 offen lds
mf v[4:7],v[100:103],a[96:99],v[4:7]
ds_read_b64_tr_b16 v[70:71], v233 offset:33792
mf v[8:11],v[104:107],a[96:99],v[8:11]
ds_read_b64_tr_b16 v[72:73], v234 offset:32768
buffer_load_dwordx4 v241, s[24:27], s37 offen offset:1024 lds
mf v[40:43],v[104:107],a[100:103],v[40:43]
ds_read_b64_tr_b16 v[74:75], v234 offset:33792
s_add_u32 s38, s48, 11264
mf v[44:47],v[108:111],a[100:103],v[44:47]
ds_read_b64_tr_b16 v[76:77], v235 offset:32768
buffer_load_dwordx4 a[144:147], v206, s[28:31], s38 offen sc1
mf v[12:15],v[108:111],a[96:99],v[12:15]
ds_read_b64_tr_b16 v[78:79], v235 offset:33792
s_waitcnt lgkmcnt(8)
mf v[16:19],v[112:115],a[96:99],v[16:19]
ds_read_b64_tr_b16 v[80:81], v236 offset:32768
buffer_load_dwordx4 a[148:151], v222, s[28:31], s38 offen sc1
mf v[48:51],v[112:115],a[100:103],v[48:51]
ds_read_b64_tr_b16 v[82:83], v236 offset:33792
s_add_u32 s39, s36, 1024
mf v[52:55],v[116:119],a[100:103],v[52:55]
ds_read_b64_tr_b16 v[84:85], v237 offset:32768
buffer_load_dwordx4 v[132:135], v206, s[28:31], s39 offen sc1
mf v[20:23],v[116:119],a[96:99],v[20:23]
ds_read_b64_tr_b16 v[86:87], v237 offset:33792
mf v[24:27],v[120:123],a[96:99],v[24:27]
ds_read_b64_tr_b16 v[88:89], v238 offset:32768
s_add_u32 s39, s36, 28672
mf v[56:59],v[120:123],a[100:103],v[56:59]
ds_read_b64_tr_b16 v[90:91], v238 offset:33792
buffer_load_dwordx4 v[136:139], v206, s[28:31], s39 offen sc1
mf v[60:63],v[124:127],a[100:103],v[60:63]
ds_read_b64_tr_b16 v[92:93], v239 offset:32768
s_add_u32 s39, s36, 29696
mf v[28:31],v[124:127],a[96:99],v[28:31]
ds_read_b64_tr_b16 v[94:95], v239 offset:33792
s_waitcnt vmcnt(19) lgkmcnt(8)
s_barrier
mf v[0:3],v[64:67],a[104:107],v[0:3]
ds_read_b64_tr_b16 v[96:97], v232 offset:40960
s_add_u32 m0, s34, 24576
mf v[32:35],v[64:67],a[108:111],v[32:35]
ds_read_b64_tr_b16 v[98:99], v232 offset:41984
s_add_u32 s37, s47, 372736
mf v[36:39],v[68:71],a[108:111],v[36:39]
ds_read_b64_tr_b16 v[100:101], v233 offset:40960
buffer_load_dwordx4 v240, s[24:27], s37 offen lds
mf v[4:7],v[68:71],a[104:107],v[4:7]
ds_read_b64_tr_b16 v[102:103], v233 offset:41984
mf v[8:11],v[72:75],a[104:107],v[8:11]
ds_read_b64_tr_b16 v[104:105], v234 offset:40960
buffer_load_dwordx4 v241, s[24:27], s37 offen offset:1024 lds
mf v[40:43],v[72:75],a[108:111],v[40:43]
ds_read_b64_tr_b16 v[106:107], v234 offset:41984
s_add_u32 s38, s48, 12288
mf v[44:47],v[76:79],a[108:111],v[44:47]
ds_read_b64_tr_b16 v[108:109], v235 offset:40960
buffer_load_dwordx4 a[152:155], v206, s[28:31], s38 offen sc1
mf v[12:15],v[76:79],a[104:107],v[12:15]
ds_read_b64_tr_b16 v[110:111], v235 offset:41984
s_waitcnt lgkmcnt(8)
mf v[16:19],v[80:83],a[104:107],v[16:19]
ds_read_b64_tr_b16 v[112:113], v236 offset:40960
buffer_load_dwordx4 a[156:159], v222, s[28:31], s38 offen sc1
mf v[48:51],v[80:83],a[108:111],v[48:51]
ds_read_b64_tr_b16 v[114:115], v236 offset:41984
buffer_load_dwordx4 v[140:143], v206, s[28:31], s39 offen sc1
mf v[52:55],v[84:87],a[108:111],v[52:55]
ds_read_b64_tr_b16 v[116:117], v237 offset:40960
s_xor_b32 s39, s46, 1
mf v[20:23],v[84:87],a[104:107],v[20:23]
ds_read_b64_tr_b16 v[118:119], v237 offset:41984
mf v[24:27],v[88:91],a[104:107],v[24:27]
s_lshl_b32 s57, s39, 15
mf v[56:59],v[88:91],a[108:111],v[56:59]
s_add_u32 s57, s57, s33
mf v[60:63],v[92:95],a[108:111],v[60:63]
s_add_u32 s57, s57, 0
mf v[28:31],v[92:95],a[104:107],v[28:31]
s_waitcnt lgkmcnt(4)
mf v[0:3],v[96:99],a[112:115],v[0:3]
ds_read_b64_tr_b16 v[64:65], v232 offset:49152
s_add_u32 m0, s34, 32768
mf v[32:35],v[96:99],a[116:119],v[32:35]
ds_read_b64_tr_b16 v[66:67], v232 offset:50176
s_add_u32 s37, s47, 401408
mf v[36:39],v[100:103],a[116:119],v[36:39]
ds_read_b64_tr_b16 v[68:69], v233 offset:49152
buffer_load_dwordx4 v240, s[24:27], s37 offen lds
mf v[4:7],v[100:103],a[112:115],v[4:7]
ds_read_b64_tr_b16 v[70:71], v233 offset:50176
buffer_load_dwordx4 v241, s[24:27], s37 offen offset:1024 lds
mf v[8:11],v[104:107],a[112:115],v[8:11]
ds_read_b64_tr_b16 v[72:73], v234 offset:49152
s_add_u32 s38, s48, 13312
mf v[40:43],v[104:107],a[116:119],v[40:43]
ds_read_b64_tr_b16 v[74:75], v234 offset:50176
buffer_load_dwordx4 a[160:163], v206, s[28:31], s38 offen sc1
mf v[44:47],v[108:111],a[116:119],v[44:47]
ds_read_b64_tr_b16 v[76:77], v235 offset:49152
buffer_load_dwordx4 a[164:167], v222, s[28:31], s38 offen sc1
mf v[12:15],v[108:111],a[112:115],v[12:15]
ds_read_b64_tr_b16 v[78:79], v235 offset:50176
s_waitcnt lgkmcnt(8)
mf v[16:19],v[112:115],a[112:115],v[16:19]
ds_read_b64_tr_b16 v[80:81], v236 offset:49152
s_add_u32 s61, s32, 0
mf v[48:51],v[112:115],a[116:119],v[48:51]
ds_read_b64_tr_b16 v[82:83], v236 offset:50176
s_xor_b32 s39, s46, 2
mf v[52:55],v[116:119],a[116:119],v[52:55]
ds_read_b64_tr_b16 v[84:85], v237 offset:49152
s_lshl_b32 s58, s39, 15
mf v[20:23],v[116:119],a[112:115],v[20:23]
ds_read_b64_tr_b16 v[86:87], v237 offset:50176
s_add_u32 s58, s58, s33
s_add_u32 s58, s58, 8192
s_waitcnt vmcnt(20) lgkmcnt(4)
s_barrier
mf v[0:3],v[64:67],a[120:123],v[0:3]
ds_read_b64_tr_b16 v[96:97], v232 offset:57344
s_add_u32 m0, s34, 40960
mf v[32:35],v[64:67],a[124:127],v[32:35]
ds_read_b64_tr_b16 v[98:99], v232 offset:58368
s_add_u32 s37, s47, 430080
mf v[36:39],v[68:71],a[124:127],v[36:39]
ds_read_b64_tr_b16 v[100:101], v233 offset:57344
buffer_load_dwordx4 v240, s[24:27], s37 offen lds
mf v[4:7],v[68:71],a[120:123],v[4:7]
ds_read_b64_tr_b16 v[102:103], v233 offset:58368
buffer_load_dwordx4 v241, s[24:27], s37 offen offset:1024 lds
mf v[8:11],v[72:75],a[120:123],v[8:11]
ds_read_b64_tr_b16 v[104:105], v234 offset:57344
s_add_u32 s38, s48, 14336
mf v[40:43],v[72:75],a[124:127],v[40:43]
ds_read_b64_tr_b16 v[106:107], v234 offset:58368
buffer_load_dwordx4 a[168:171], v206, s[28:31], s38 offen sc1
mf v[44:47],v[76:79],a[124:127],v[44:47]
ds_read_b64_tr_b16 v[108:109], v235 offset:57344
buffer_load_dwordx4 a[172:175], v222, s[28:31], s38 offen sc1
mf v[12:15],v[76:79],a[120:123],v[12:15]
ds_read_b64_tr_b16 v[110:111], v235 offset:58368
s_waitcnt lgkmcnt(8)
mf v[16:19],v[80:83],a[120:123],v[16:19]
ds_read_b64_tr_b16 v[112:113], v236 offset:57344
s_add_u32 s62, s32, 8192
mf v[48:51],v[80:83],a[124:127],v[48:51]
ds_read_b64_tr_b16 v[114:115], v236 offset:58368
s_xor_b32 s39, s46, 3
mf v[52:55],v[84:87],a[124:127],v[52:55]
ds_read_b64_tr_b16 v[116:117], v237 offset:57344
s_lshl_b32 s59, s39, 15
mf v[20:23],v[84:87],a[120:123],v[20:23]
ds_read_b64_tr_b16 v[118:119], v237 offset:58368
s_add_u32 s59, s59, s33
s_add_u32 s59, s59, 16384
s_waitcnt lgkmcnt(4)
mf v[0:3],v[96:99],a[128:131],v[0:3]
ds_read_b64_tr_b16 v[64:65], v224 offset:0
s_add_u32 s38, s48, 15360
mf v[32:35],v[96:99],a[132:135],v[32:35]
ds_read_b64_tr_b16 v[66:67], v224 offset:1024
buffer_load_dwordx4 a[176:179], v206, s[28:31], s38 offen sc1
mf v[36:39],v[100:103],a[132:135],v[36:39]
ds_read_b64_tr_b16 v[68:69], v225 offset:0
mf v[4:7],v[100:103],a[128:131],v[4:7]
ds_read_b64_tr_b16 v[70:71], v225 offset:1024
buffer_load_dwordx4 a[180:183], v222, s[28:31], s38 offen sc1
mf v[8:11],v[104:107],a[128:131],v[8:11]
ds_read_b64_tr_b16 v[72:73], v226 offset:0
s_add_u32 s63, s32, 16384
mf v[40:43],v[104:107],a[132:135],v[40:43]
ds_read_b64_tr_b16 v[74:75], v226 offset:1024
mf v[44:47],v[108:111],a[132:135],v[44:47]
ds_read_b64_tr_b16 v[76:77], v227 offset:0
v_lshrrev_b32 v243, 2, v255
mf v[12:15],v[108:111],a[128:131],v[12:15]
ds_read_b64_tr_b16 v[78:79], v227 offset:1024
s_waitcnt lgkmcnt(8)
mf v[16:19],v[112:115],a[128:131],v[16:19]
ds_read_b64_tr_b16 v[80:81], v228 offset:0
v_and_b32 v244, 3, v255
mf v[48:51],v[112:115],a[132:135],v[48:51]
ds_read_b64_tr_b16 v[82:83], v228 offset:1024
v_lshlrev_b32 v244, 4, v244
mf v[52:55],v[116:119],a[132:135],v[52:55]
ds_read_b64_tr_b16 v[84:85], v229 offset:0
v_mul_u32_u24 v242, 896, v243
mf v[20:23],v[116:119],a[128:131],v[20:23]
ds_read_b64_tr_b16 v[86:87], v229 offset:1024
s_waitcnt vmcnt(17) lgkmcnt(4)
s_barrier
mf v[0:3],v[64:67],a[136:139],v[0:3]
ds_read_b64_tr_b16 v[96:97], v224 offset:8192
v_add_u32 v242, v242, v244
mf v[32:35],v[64:67],a[140:143],v[32:35]
ds_read_b64_tr_b16 v[98:99], v224 offset:9216
v_mul_u32_u24 v245, 80, v243
mf v[36:39],v[68:71],a[140:143],v[36:39]
ds_read_b64_tr_b16 v[100:101], v225 offset:8192
mf v[4:7],v[68:71],a[136:139],v[4:7]
ds_read_b64_tr_b16 v[102:103], v225 offset:9216
s_lshl_b32 s39, s16, 12
mf v[8:11],v[72:75],a[136:139],v[8:11]
ds_read_b64_tr_b16 v[104:105], v226 offset:8192
s_add_u32 s39, s39, 0x20000
mf v[40:43],v[72:75],a[140:143],v[40:43]
ds_read_b64_tr_b16 v[106:107], v226 offset:9216
mf v[44:47],v[76:79],a[140:143],v[44:47]
ds_read_b64_tr_b16 v[108:109], v227 offset:8192
v_add3_u32 v245, v245, v244, s39
mf v[12:15],v[76:79],a[136:139],v[12:15]
ds_read_b64_tr_b16 v[110:111], v227 offset:9216
s_waitcnt lgkmcnt(8)
mf v[16:19],v[80:83],a[136:139],v[16:19]
ds_read_b64_tr_b16 v[112:113], v228 offset:8192
v_and_b32 v244, 15, v255
mf v[48:51],v[80:83],a[140:143],v[48:51]
ds_read_b64_tr_b16 v[114:115], v228 offset:9216
v_mul_u32_u24 v244, 80, v244
mf v[52:55],v[84:87],a[140:143],v[52:55]
ds_read_b64_tr_b16 v[116:117], v229 offset:8192
v_lshrrev_b32 v243, 4, v255
mf v[20:23],v[84:87],a[136:139],v[20:23]
ds_read_b64_tr_b16 v[118:119], v229 offset:9216
s_waitcnt lgkmcnt(4)
mf v[0:3],v[96:99],a[144:147],v[0:3]
ds_read_b64_tr_b16 v[64:65], v224 offset:16384
v_lshlrev_b32 v243, 3, v243
mf v[32:35],v[96:99],a[148:151],v[32:35]
ds_read_b64_tr_b16 v[66:67], v224 offset:17408
v_add3_u32 v244, v244, v243, s39
mf v[36:39],v[100:103],a[148:151],v[36:39]
ds_read_b64_tr_b16 v[68:69], v225 offset:16384
mf v[4:7],v[100:103],a[144:147],v[4:7]
ds_read_b64_tr_b16 v[70:71], v225 offset:17408
v_add_u32 v243, 14336, v242
mf v[8:11],v[104:107],a[144:147],v[8:11]
ds_read_b64_tr_b16 v[72:73], v226 offset:16384
mf v[40:43],v[104:107],a[148:151],v[40:43]
ds_read_b64_tr_b16 v[74:75], v226 offset:17408
s_mul_i32 s17, s35, 28672
mf v[44:47],v[108:111],a[148:151],v[44:47]
ds_read_b64_tr_b16 v[76:77], v227 offset:16384
s_lshl_b32 s39, s18, 6
mf v[12:15],v[108:111],a[144:147],v[12:15]
ds_read_b64_tr_b16 v[78:79], v227 offset:17408
s_waitcnt lgkmcnt(8)
mf v[16:19],v[112:115],a[144:147],v[16:19]
ds_read_b64_tr_b16 v[80:81], v228 offset:16384
s_add_u32 s17, s17, s39
mf v[48:51],v[112:115],a[148:151],v[48:51]
ds_read_b64_tr_b16 v[82:83], v228 offset:17408
mf v[52:55],v[116:119],a[148:151],v[52:55]
ds_read_b64_tr_b16 v[84:85], v229 offset:16384
s_cmp_ge_u32 s18, 14
s_cselect_b32 s17, 0x40000000, s17
mf v[20:23],v[116:119],a[144:147],v[20:23]
ds_read_b64_tr_b16 v[86:87], v229 offset:17408
s_waitcnt vmcnt(6) lgkmcnt(4)
s_barrier
mf v[0:3],v[64:67],a[152:155],v[0:3]
ds_read_b64_tr_b16 v[96:97], v224 offset:24576
mf v[32:35],v[64:67],a[156:159],v[32:35]
ds_read_b64_tr_b16 v[98:99], v224 offset:25600
mf v[36:39],v[68:71],a[156:159],v[36:39]
ds_read_b64_tr_b16 v[100:101], v225 offset:24576
mf v[4:7],v[68:71],a[152:155],v[4:7]
ds_read_b64_tr_b16 v[102:103], v225 offset:25600
mf v[8:11],v[72:75],a[152:155],v[8:11]
ds_read_b64_tr_b16 v[104:105], v226 offset:24576
mf v[40:43],v[72:75],a[156:159],v[40:43]
ds_read_b64_tr_b16 v[106:107], v226 offset:25600
mf v[44:47],v[76:79],a[156:159],v[44:47]
ds_read_b64_tr_b16 v[108:109], v227 offset:24576
mf v[12:15],v[76:79],a[152:155],v[12:15]
ds_read_b64_tr_b16 v[110:111], v227 offset:25600
s_waitcnt lgkmcnt(8)
mf v[16:19],v[80:83],a[152:155],v[16:19]
ds_read_b64_tr_b16 v[112:113], v228 offset:24576
mf v[48:51],v[80:83],a[156:159],v[48:51]
ds_read_b64_tr_b16 v[114:115], v228 offset:25600
mf v[52:55],v[84:87],a[156:159],v[52:55]
ds_read_b64_tr_b16 v[116:117], v229 offset:24576
mf v[20:23],v[84:87],a[152:155],v[20:23]
ds_read_b64_tr_b16 v[118:119], v229 offset:25600
s_waitcnt lgkmcnt(4)
mf v[0:3],v[96:99],a[160:163],v[0:3]
ds_read_b64_tr_b16 v[64:65], v224 offset:32768
buffer_load_dwordx4 v[144:147], v206, s[28:31], s61 offen offset:0 sc1
mf v[32:35],v[96:99],a[164:167],v[32:35]
ds_read_b64_tr_b16 v[66:67], v224 offset:33792
mf v[36:39],v[100:103],a[164:167],v[36:39]
ds_read_b64_tr_b16 v[68:69], v225 offset:32768
buffer_load_dwordx4 v[148:151], v206, s[28:31], s61 offen offset:1024 sc1
mf v[4:7],v[100:103],a[160:163],v[4:7]
ds_read_b64_tr_b16 v[70:71], v225 offset:33792
mf v[8:11],v[104:107],a[160:163],v[8:11]
ds_read_b64_tr_b16 v[72:73], v226 offset:32768
buffer_load_dwordx4 v[152:155], v206, s[28:31], s62 offen offset:0 sc1
mf v[40:43],v[104:107],a[164:167],v[40:43]
ds_read_b64_tr_b16 v[74:75], v226 offset:33792
mf v[44:47],v[108:111],a[164:167],v[44:47]
ds_read_b64_tr_b16 v[76:77], v227 offset:32768
buffer_load_dwordx4 v[156:159], v206, s[28:31], s62 offen offset:1024 sc1
mf v[12:15],v[108:111],a[160:163],v[12:15]
ds_read_b64_tr_b16 v[78:79], v227 offset:33792
s_waitcnt lgkmcnt(8)
mf v[16:19],v[112:115],a[160:163],v[16:19]
ds_read_b64_tr_b16 v[80:81], v228 offset:32768
buffer_load_dwordx4 v[160:163], v206, s[28:31], s63 offen offset:0 sc1
mf v[48:51],v[112:115],a[164:167],v[48:51]
ds_read_b64_tr_b16 v[82:83], v228 offset:33792
mf v[52:55],v[116:119],a[164:167],v[52:55]
ds_read_b64_tr_b16 v[84:85], v229 offset:32768
buffer_load_dwordx4 v[164:167], v206, s[28:31], s63 offen offset:1024 sc1
mf v[20:23],v[116:119],a[160:163],v[20:23]
ds_read_b64_tr_b16 v[86:87], v229 offset:33792
s_waitcnt vmcnt(6) lgkmcnt(4)
s_barrier
mf v[0:3],v[64:67],a[168:171],v[0:3]
ds_read_b64_tr_b16 v[96:97], v224 offset:40960
mf v[32:35],v[64:67],a[172:175],v[32:35]
ds_read_b64_tr_b16 v[98:99], v224 offset:41984
mf v[36:39],v[68:71],a[172:175],v[36:39]
ds_read_b64_tr_b16 v[100:101], v225 offset:40960
mf v[4:7],v[68:71],a[168:171],v[4:7]
ds_read_b64_tr_b16 v[102:103], v225 offset:41984
mf v[8:11],v[72:75],a[168:171],v[8:11]
ds_read_b64_tr_b16 v[104:105], v226 offset:40960
mf v[40:43],v[72:75],a[172:175],v[40:43]
ds_read_b64_tr_b16 v[106:107], v226 offset:41984
mf v[44:47],v[76:79],a[172:175],v[44:47]
ds_read_b64_tr_b16 v[108:109], v227 offset:40960
mf v[12:15],v[76:79],a[168:171],v[12:15]
ds_read_b64_tr_b16 v[110:111], v227 offset:41984
s_waitcnt lgkmcnt(8)
mf v[16:19],v[80:83],a[168:171],v[16:19]
ds_read_b64_tr_b16 v[112:113], v228 offset:40960
mf v[48:51],v[80:83],a[172:175],v[48:51]
ds_read_b64_tr_b16 v[114:115], v228 offset:41984
mf v[52:55],v[84:87],a[172:175],v[52:55]
ds_read_b64_tr_b16 v[116:117], v229 offset:40960
mf v[20:23],v[84:87],a[168:171],v[20:23]
ds_read_b64_tr_b16 v[118:119], v229 offset:41984
s_waitcnt lgkmcnt(4)
mf v[0:3],v[96:99],a[176:179],v[0:3]
mf v[32:35],v[96:99],a[180:183],v[32:35]
mf v[36:39],v[100:103],a[180:183],v[36:39]
mf v[4:7],v[100:103],a[176:179],v[4:7]
mf v[8:11],v[104:107],a[176:179],v[8:11]
mf v[40:43],v[104:107],a[180:183],v[40:43]
mf v[44:47],v[108:111],a[180:183],v[44:47]
mf v[12:15],v[108:111],a[176:179],v[12:15]
s_waitcnt lgkmcnt(0)
mf v[16:19],v[112:115],a[176:179],v[16:19]
ds_read_b64_tr_b16 a[0:1], v238 offset:40960
mf v[48:51],v[112:115],a[180:183],v[48:51]
ds_read_b64_tr_b16 a[2:3], v238 offset:41984
mf v[52:55],v[116:119],a[180:183],v[52:55]
ds_read_b64_tr_b16 a[4:5], v239 offset:40960
mf v[20:23],v[116:119],a[176:179],v[20:23]
ds_read_b64_tr_b16 a[6:7], v239 offset:41984
ds_read_b64_tr_b16 a[8:9], v238 offset:49152
ds_read_b64_tr_b16 a[10:11], v238 offset:50176
ds_read_b64_tr_b16 a[12:13], v239 offset:49152
ds_read_b64_tr_b16 a[14:15], v239 offset:50176
ds_read_b64_tr_b16 a[16:17], v238 offset:57344
ds_read_b64_tr_b16 a[18:19], v238 offset:58368
ds_read_b64_tr_b16 a[20:21], v239 offset:57344
ds_read_b64_tr_b16 a[22:23], v239 offset:58368
v_cvt_pk_bf16_f32 v64, v0, v1
v_cvt_pk_bf16_f32 v65, v2, v3
v_cvt_pk_bf16_f32 v66, v4, v5
v_cvt_pk_bf16_f32 v67, v6, v7
buffer_store_dwordx4 v[64:67], v206, s[28:31], s59 offen offset:0 sc1
v_cvt_pk_bf16_f32 v68, v32, v33
v_cvt_pk_bf16_f32 v69, v34, v35
v_cvt_pk_bf16_f32 v70, v36, v37
v_cvt_pk_bf16_f32 v71, v38, v39
buffer_store_dwordx4 v[68:71], v206, s[28:31], s59 offen offset:1024 sc1
v_cvt_pk_bf16_f32 v72, v8, v9
v_cvt_pk_bf16_f32 v73, v10, v11
v_cvt_pk_bf16_f32 v74, v12, v13
v_cvt_pk_bf16_f32 v75, v14, v15
buffer_store_dwordx4 v[72:75], v206, s[28:31], s58 offen offset:0 sc1
v_cvt_pk_bf16_f32 v76, v40, v41
v_cvt_pk_bf16_f32 v77, v42, v43
v_cvt_pk_bf16_f32 v78, v44, v45
v_cvt_pk_bf16_f32 v79, v46, v47
buffer_store_dwordx4 v[76:79], v206, s[28:31], s58 offen offset:1024 sc1
v_cvt_pk_bf16_f32 v80, v16, v17
v_cvt_pk_bf16_f32 v81, v18, v19
v_cvt_pk_bf16_f32 v82, v20, v21
v_cvt_pk_bf16_f32 v83, v22, v23
buffer_store_dwordx4 v[80:83], v206, s[28:31], s57 offen offset:0 sc1
v_cvt_pk_bf16_f32 v84, v48, v49
v_cvt_pk_bf16_f32 v85, v50, v51
v_cvt_pk_bf16_f32 v86, v52, v53
v_cvt_pk_bf16_f32 v87, v54, v55
buffer_store_dwordx4 v[84:87], v206, s[28:31], s57 offen offset:1024 sc1
s_waitcnt lgkmcnt(8)
mf v[28:31],a[4:7],a[112:115],v[28:31]
ds_read_b64_tr_b16 a[24:25], v230 offset:0
mf v[60:63],a[4:7],a[116:119],v[60:63]
ds_read_b64_tr_b16 a[26:27], v230 offset:1024
mf v[56:59],a[0:3],a[116:119],v[56:59]
ds_read_b64_tr_b16 a[28:29], v231 offset:0
mf v[24:27],a[0:3],a[112:115],v[24:27]
ds_read_b64_tr_b16 a[30:31], v231 offset:1024
s_waitcnt lgkmcnt(8)
mf v[24:27],a[8:11],a[120:123],v[24:27]
ds_read_b64_tr_b16 a[32:33], v230 offset:8192
mf v[56:59],a[8:11],a[124:127],v[56:59]
ds_read_b64_tr_b16 a[34:35], v230 offset:9216
mf v[60:63],a[12:15],a[124:127],v[60:63]
ds_read_b64_tr_b16 a[36:37], v231 offset:8192
mf v[28:31],a[12:15],a[120:123],v[28:31]
ds_read_b64_tr_b16 a[38:39], v231 offset:9216
s_waitcnt lgkmcnt(8)
mf v[28:31],a[20:23],a[128:131],v[28:31]
ds_read_b64_tr_b16 a[40:41], v230 offset:16384
mf v[60:63],a[20:23],a[132:135],v[60:63]
ds_read_b64_tr_b16 a[42:43], v230 offset:17408
mf v[56:59],a[16:19],a[132:135],v[56:59]
ds_read_b64_tr_b16 a[44:45], v231 offset:16384
mf v[24:27],a[16:19],a[128:131],v[24:27]
ds_read_b64_tr_b16 a[46:47], v231 offset:17408
s_waitcnt lgkmcnt(8)
mf v[24:27],a[24:27],a[136:139],v[24:27]
ds_read_b64_tr_b16 a[48:49], v230 offset:24576
mf v[56:59],a[24:27],a[140:143],v[56:59]
ds_read_b64_tr_b16 a[50:51], v230 offset:25600
mf v[60:63],a[28:31],a[140:143],v[60:63]
ds_read_b64_tr_b16 a[52:53], v231 offset:24576
mf v[28:31],a[28:31],a[136:139],v[28:31]
ds_read_b64_tr_b16 a[54:55], v231 offset:25600
s_waitcnt lgkmcnt(8)
mf v[28:31],a[36:39],a[144:147],v[28:31]
ds_read_b64_tr_b16 a[56:57], v230 offset:32768
mf v[60:63],a[36:39],a[148:151],v[60:63]
ds_read_b64_tr_b16 a[58:59], v230 offset:33792
mf v[56:59],a[32:35],a[148:151],v[56:59]
ds_read_b64_tr_b16 a[60:61], v231 offset:32768
mf v[24:27],a[32:35],a[144:147],v[24:27]
ds_read_b64_tr_b16 a[62:63], v231 offset:33792
s_waitcnt lgkmcnt(8)
mf v[24:27],a[40:43],a[152:155],v[24:27]
ds_read_b64_tr_b16 a[64:65], v230 offset:40960
mf v[56:59],a[40:43],a[156:159],v[56:59]
ds_read_b64_tr_b16 a[66:67], v230 offset:41984
mf v[60:63],a[44:47],a[156:159],v[60:63]
ds_read_b64_tr_b16 a[68:69], v231 offset:40960
mf v[28:31],a[44:47],a[152:155],v[28:31]
ds_read_b64_tr_b16 a[70:71], v231 offset:41984
s_waitcnt lgkmcnt(8)
mf v[28:31],a[52:55],a[160:163],v[28:31]
mf v[60:63],a[52:55],a[164:167],v[60:63]
mf v[56:59],a[48:51],a[164:167],v[56:59]
mf v[24:27],a[48:51],a[160:163],v[24:27]
s_waitcnt lgkmcnt(4)
mf v[24:27],a[56:59],a[168:171],v[24:27]
mf v[56:59],a[56:59],a[172:175],v[56:59]
mf v[60:63],a[60:63],a[172:175],v[60:63]
mf v[28:31],a[60:63],a[168:171],v[28:31]
s_waitcnt lgkmcnt(0)
mf v[28:31],a[68:71],a[176:179],v[28:31]
mf v[60:63],a[68:71],a[180:183],v[60:63]
mf v[56:59],a[64:67],a[180:183],v[56:59]
mf v[24:27],a[64:67],a[176:179],v[24:27]
s_waitcnt vmcnt(6)
s_mov_b32 s67, 0x80000
s_mov_b32 s66, 7
s_mov_b32 s65, -1
s_nop 4
v_pk_add_f32 v[128:129], v[128:129], v[24:25]
v_pk_add_f32 v[130:131], v[130:131], v[26:27]
v_pk_add_f32 v[132:133], v[132:133], v[28:29]
v_pk_add_f32 v[134:135], v[134:135], v[30:31]
v_pk_add_f32 v[136:137], v[136:137], v[56:57]
v_pk_add_f32 v[138:139], v[138:139], v[58:59]
v_pk_add_f32 v[140:141], v[140:141], v[60:61]
v_pk_add_f32 v[142:143], v[142:143], v[62:63]
ex_96:
s_bitcmp0_b32 s66, 0
s_cbranch_scc1 exn_98
v_max3_u32 v120, v144, v145, v146
v_max3_u32 v121, v147, v148, v149
v_max3_u32 v120, v120, v150, v151
v_max_u32 v120, v120, v121
v_cmp_eq_u32 vcc, s65, v120
s_cbranch_vccnz exr_99
s_bitset0_b32 s66, 0
v_lshlrev_b32 v0, 16, v144
v_and_b32 v1, 0xffff0000, v144
v_lshlrev_b32 v2, 16, v145
v_and_b32 v3, 0xffff0000, v145
v_lshlrev_b32 v4, 16, v146
v_and_b32 v5, 0xffff0000, v146
v_lshlrev_b32 v6, 16, v147
v_and_b32 v7, 0xffff0000, v147
v_lshlrev_b32 v8, 16, v148
v_and_b32 v9, 0xffff0000, v148
v_lshlrev_b32 v10, 16, v149
v_and_b32 v11, 0xffff0000, v149
v_lshlrev_b32 v12, 16, v150
v_and_b32 v13, 0xffff0000, v150
v_lshlrev_b32 v14, 16, v151
v_and_b32 v15, 0xffff0000, v151
s_branch exn_98
exr_99:
buffer_load_dwordx4 v[144:147], v206, s[28:31], s61 offen offset:0 sc1
buffer_load_dwordx4 v[148:151], v206, s[28:31], s61 offen offset:1024 sc1
exn_98:
s_bitcmp0_b32 s66, 1
s_cbranch_scc1 exn_100
v_max3_u32 v120, v152, v153, v154
v_max3_u32 v121, v155, v156, v157
v_max3_u32 v120, v120, v158, v159
v_max_u32 v120, v120, v121
v_cmp_eq_u32 vcc, s65, v120
s_cbranch_vccnz exr_101
s_bitset0_b32 s66, 1
v_lshlrev_b32 v16, 16, v152
v_and_b32 v17, 0xffff0000, v152
v_lshlrev_b32 v18, 16, v153
v_and_b32 v19, 0xffff0000, v153
v_lshlrev_b32 v20, 16, v154
v_and_b32 v21, 0xffff0000, v154
v_lshlrev_b32 v22, 16, v155
v_and_b32 v23, 0xffff0000, v155
v_lshlrev_b32 v24, 16, v156
v_and_b32 v25, 0xffff0000, v156
v_lshlrev_b32 v26, 16, v157
v_and_b32 v27, 0xffff0000, v157
v_lshlrev_b32 v28, 16, v158
v_and_b32 v29, 0xffff0000, v158
v_lshlrev_b32 v30, 16, v159
v_and_b32 v31, 0xffff0000, v159
s_branch exn_100
exr_101:
buffer_load_dwordx4 v[152:155], v206, s[28:31], s62 offen offset:0 sc1
buffer_load_dwordx4 v[156:159], v206, s[28:31], s62 offen offset:1024 sc1
exn_100:
s_bitcmp0_b32 s66, 2
s_cbranch_scc1 exn_102
v_max3_u32 v120, v160, v161, v162
v_max3_u32 v121, v163, v164, v165
v_max3_u32 v120, v120, v166, v167
v_max_u32 v120, v120, v121
v_cmp_eq_u32 vcc, s65, v120
s_cbranch_vccnz exr_103
s_bitset0_b32 s66, 2
v_lshlrev_b32 v32, 16, v160
v_and_b32 v33, 0xffff0000, v160
v_lshlrev_b32 v34, 16, v161
v_and_b32 v35, 0xffff0000, v161
v_lshlrev_b32 v36, 16, v162
v_and_b32 v37, 0xffff0000, v162
v_lshlrev_b32 v38, 16, v163
v_and_b32 v39, 0xffff0000, v163
v_lshlrev_b32 v40, 16, v164
v_and_b32 v41, 0xffff0000, v164
v_lshlrev_b32 v42, 16, v165
v_and_b32 v43, 0xffff0000, v165
v_lshlrev_b32 v44, 16, v166
v_and_b32 v45, 0xffff0000, v166
v_lshlrev_b32 v46, 16, v167
v_and_b32 v47, 0xffff0000, v167
s_branch exn_102
exr_103:
buffer_load_dwordx4 v[160:163], v206, s[28:31], s63 offen offset:0 sc1
buffer_load_dwordx4 v[164:167], v206, s[28:31], s63 offen offset:1024 sc1
exn_102:
s_cmp_eq_u32 s66, 0
s_cbranch_scc1 exok_97
s_sub_u32 s67, s67, 1
s_cmp_eq_u32 s67, 0
s_cselect_b32 s65, 1, s65
s_waitcnt vmcnt(0)
s_cmp_gt_i32 s67, -2
s_cbranch_scc1 ex_96
exok_97:
v_pk_add_f32 v[128:129], v[128:129], v[0:1]
v_pk_add_f32 v[130:131], v[130:131], v[2:3]
v_pk_add_f32 v[132:133], v[132:133], v[4:5]
v_pk_add_f32 v[134:135], v[134:135], v[6:7]
v_pk_add_f32 v[128:129], v[128:129], v[16:17]
v_pk_add_f32 v[130:131], v[130:131], v[18:19]
v_pk_add_f32 v[132:133], v[132:133], v[20:21]
v_pk_add_f32 v[134:135], v[134:135], v[22:23]
v_pk_add_f32 v[128:129], v[128:129], v[32:33]
v_pk_add_f32 v[130:131], v[130:131], v[34:35]
v_pk_add_f32 v[132:133], v[132:133], v[36:37]
v_pk_add_f32 v[134:135], v[134:135], v[38:39]
v_cvt_pk_bf16_f32 v104, v128, v129
v_cvt_pk_bf16_f32 v105, v130, v131
v_cvt_pk_bf16_f32 v106, v132, v133
v_cvt_pk_bf16_f32 v107, v134, v135
ds_write_b64 v244, v[104:105] offset:0
ds_write_b64 v244, v[106:107] offset:32
v_pk_add_f32 v[136:137], v[136:137], v[8:9]
v_pk_add_f32 v[138:139], v[138:139], v[10:11]
v_pk_add_f32 v[140:141], v[140:141], v[12:13]
v_pk_add_f32 v[142:143], v[142:143], v[14:15]
v_pk_add_f32 v[136:137], v[136:137], v[24:25]
v_pk_add_f32 v[138:139], v[138:139], v[26:27]
v_pk_add_f32 v[140:141], v[140:141], v[28:29]
v_pk_add_f32 v[142:143], v[142:143], v[30:31]
v_pk_add_f32 v[136:137], v[136:137], v[40:41]
v_pk_add_f32 v[138:139], v[138:139], v[42:43]
v_pk_add_f32 v[140:141], v[140:141], v[44:45]
v_pk_add_f32 v[142:143], v[142:143], v[46:47]
v_cvt_pk_bf16_f32 v108, v136, v137
v_cvt_pk_bf16_f32 v109, v138, v139
v_cvt_pk_bf16_f32 v110, v140, v141
v_cvt_pk_bf16_f32 v111, v142, v143
ds_write_b64 v244, v[108:109] offset:1280
ds_write_b64 v244, v[110:111] offset:1312
ds_read_b128 v[112:115], v245 offset:0
ds_read_b128 v[116:119], v245 offset:1280
s_waitcnt lgkmcnt(1)
buffer_store_dwordx4 v[112:115], v242, s[52:55], s17 offen sc1
s_waitcnt lgkmcnt(0)
buffer_store_dwordx4 v[116:119], v243, s[52:55], s17 offen sc1
done_1:
s_endpgm
code_end:
slow_45:
s_nop 15
v_max3_f32 v210, v128, v129, v130
v_max3_f32 v210, v210, v131, v136
v_max3_f32 v210, v210, v137, v138
v_max3_f32 v210, v210, v139, v144
v_max3_f32 v210, v210, v145, v146
v_max3_f32 v210, v210, v147, v152
v_max3_f32 v210, v210, v153, v154
v_max_f32 v210, v210, v155
v_max3_f32 v211, v132, v133, v134
v_max3_f32 v211, v211, v135, v140
v_max3_f32 v211, v211, v141, v142
v_max3_f32 v211, v211, v143, v148
v_max3_f32 v211, v211, v149, v150
v_max3_f32 v211, v211, v151, v156
v_max3_f32 v211, v211, v157, v158
v_max_f32 v211, v211, v159
v_mov_b32 v212, v210
v_mov_b32 v213, v211
s_nop 1
v_permlane16_swap_b32 v212, v210
v_permlane16_swap_b32 v213, v211
s_nop 1
v_max_f32 v210, v210, v212
v_max_f32 v211, v211, v213
v_mov_b32 v212, v210
v_mov_b32 v213, v211
s_nop 1
v_permlane32_swap_b32 v212, v210
v_permlane32_swap_b32 v213, v211
s_nop 1
v_max_f32 v210, v210, v212
v_max_f32 v211, v211, v213
v_max_f32 v210, 0, v210
v_sub_f32 v212, 0, v210
v_max_f32 v211, 0, v211
v_sub_f32 v213, 0, v211
v_exp_f32 v212, v212
v_exp_f32 v213, v213
v_sub_f32 v128, v128, v210
v_sub_f32 v129, v129, v210
v_sub_f32 v130, v130, v210
v_sub_f32 v131, v131, v210
v_sub_f32 v136, v136, v210
v_sub_f32 v137, v137, v210
v_sub_f32 v138, v138, v210
v_sub_f32 v139, v139, v210
v_sub_f32 v144, v144, v210
v_sub_f32 v145, v145, v210
v_sub_f32 v146, v146, v210
v_sub_f32 v147, v147, v210
v_sub_f32 v152, v152, v210
v_sub_f32 v153, v153, v210
v_sub_f32 v154, v154, v210
v_sub_f32 v155, v155, v210
v_sub_f32 v176, v176, v210
v_sub_f32 v177, v177, v210
v_sub_f32 v178, v178, v210
v_sub_f32 v179, v179, v210
v_mul_f32 v202, v202, v212
v_mul_f32 v0, v0, v212
v_mul_f32 v1, v1, v212
v_mul_f32 v2, v2, v212
v_mul_f32 v3, v3, v212
v_mul_f32 v4, v4, v212
v_mul_f32 v5, v5, v212
v_mul_f32 v6, v6, v212
v_mul_f32 v7, v7, v212
v_mul_f32 v8, v8, v212
v_mul_f32 v9, v9, v212
v_mul_f32 v10, v10, v212
v_mul_f32 v11, v11, v212
v_mul_f32 v12, v12, v212
v_mul_f32 v13, v13, v212
v_mul_f32 v14, v14, v212
v_mul_f32 v15, v15, v212
v_mul_f32 v16, v16, v212
v_mul_f32 v17, v17, v212
v_mul_f32 v18, v18, v212
v_mul_f32 v19, v19, v212
v_mul_f32 v20, v20, v212
v_mul_f32 v21, v21, v212
v_mul_f32 v22, v22, v212
v_mul_f32 v23, v23, v212
v_mul_f32 v24, v24, v212
v_mul_f32 v25, v25, v212
v_mul_f32 v26, v26, v212
v_mul_f32 v27, v27, v212
v_mul_f32 v28, v28, v212
v_mul_f32 v29, v29, v212
v_mul_f32 v30, v30, v212
v_mul_f32 v31, v31, v212
v_mul_f32 v32, v32, v212
v_mul_f32 v33, v33, v212
v_mul_f32 v34, v34, v212
v_mul_f32 v35, v35, v212
v_mul_f32 v36, v36, v212
v_mul_f32 v37, v37, v212
v_mul_f32 v38, v38, v212
v_mul_f32 v39, v39, v212
v_mul_f32 v40, v40, v212
v_mul_f32 v41, v41, v212
v_mul_f32 v42, v42, v212
v_mul_f32 v43, v43, v212
v_mul_f32 v44, v44, v212
v_mul_f32 v45, v45, v212
v_mul_f32 v46, v46, v212
v_mul_f32 v47, v47, v212
v_mul_f32 v48, v48, v212
v_mul_f32 v49, v49, v212
v_mul_f32 v50, v50, v212
v_mul_f32 v51, v51, v212
v_mul_f32 v52, v52, v212
v_mul_f32 v53, v53, v212
v_mul_f32 v54, v54, v212
v_mul_f32 v55, v55, v212
v_mul_f32 v56, v56, v212
v_mul_f32 v57, v57, v212
v_mul_f32 v58, v58, v212
v_mul_f32 v59, v59, v212
v_mul_f32 v60, v60, v212
v_mul_f32 v61, v61, v212
v_mul_f32 v62, v62, v212
v_mul_f32 v63, v63, v212
v_sub_f32 v132, v132, v211
v_sub_f32 v133, v133, v211
v_sub_f32 v134, v134, v211
v_sub_f32 v135, v135, v211
v_sub_f32 v140, v140, v211
v_sub_f32 v141, v141, v211
v_sub_f32 v142, v142, v211
v_sub_f32 v143, v143, v211
v_sub_f32 v148, v148, v211
v_sub_f32 v149, v149, v211
v_sub_f32 v150, v150, v211
v_sub_f32 v151, v151, v211
v_sub_f32 v156, v156, v211
v_sub_f32 v157, v157, v211
v_sub_f32 v158, v158, v211
v_sub_f32 v159, v159, v211
v_sub_f32 v180, v180, v211
v_sub_f32 v181, v181, v211
v_sub_f32 v182, v182, v211
v_sub_f32 v183, v183, v211
v_mul_f32 v203, v203, v213
v_mul_f32 v64, v64, v213
v_mul_f32 v65, v65, v213
v_mul_f32 v66, v66, v213
v_mul_f32 v67, v67, v213
v_mul_f32 v68, v68, v213
v_mul_f32 v69, v69, v213
v_mul_f32 v70, v70, v213
v_mul_f32 v71, v71, v213
v_mul_f32 v72, v72, v213
v_mul_f32 v73, v73, v213
v_mul_f32 v74, v74, v213
v_mul_f32 v75, v75, v213
v_mul_f32 v76, v76, v213
v_mul_f32 v77, v77, v213
v_mul_f32 v78, v78, v213
v_mul_f32 v79, v79, v213
v_mul_f32 v80, v80, v213
v_mul_f32 v81, v81, v213
v_mul_f32 v82, v82, v213
v_mul_f32 v83, v83, v213
v_mul_f32 v84, v84, v213
v_mul_f32 v85, v85, v213
v_mul_f32 v86, v86, v213
v_mul_f32 v87, v87, v213
v_mul_f32 v88, v88, v213
v_mul_f32 v89, v89, v213
v_mul_f32 v90, v90, v213
v_mul_f32 v91, v91, v213
v_mul_f32 v92, v92, v213
v_mul_f32 v93, v93, v213
v_mul_f32 v94, v94, v213
v_mul_f32 v95, v95, v213
v_mul_f32 v96, v96, v213
v_mul_f32 v97, v97, v213
v_mul_f32 v98, v98, v213
v_mul_f32 v99, v99, v213
v_mul_f32 v100, v100, v213
v_mul_f32 v101, v101, v213
v_mul_f32 v102, v102, v213
v_mul_f32 v103, v103, v213
v_mul_f32 v104, v104, v213
v_mul_f32 v105, v105, v213
v_mul_f32 v106, v106, v213
v_mul_f32 v107, v107, v213
v_mul_f32 v108, v108, v213
v_mul_f32 v109, v109, v213
v_mul_f32 v110, v110, v213
v_mul_f32 v111, v111, v213
v_mul_f32 v112, v112, v213
v_mul_f32 v113, v113, v213
v_mul_f32 v114, v114, v213
v_mul_f32 v115, v115, v213
v_mul_f32 v116, v116, v213
v_mul_f32 v117, v117, v213
v_mul_f32 v118, v118, v213
v_mul_f32 v119, v119, v213
v_mul_f32 v120, v120, v213
v_mul_f32 v121, v121, v213
v_mul_f32 v122, v122, v213
v_mul_f32 v123, v123, v213
v_mul_f32 v124, v124, v213
v_mul_f32 v125, v125, v213
v_mul_f32 v126, v126, v213
v_mul_f32 v127, v127, v213
v_exp_f32 v188, v132
v_exp_f32 v189, v133
v_exp_f32 v190, v134
v_exp_f32 v191, v135
v_exp_f32 v184, v128
v_exp_f32 v185, v129
v_exp_f32 v186, v130
v_exp_f32 v187, v131
s_nop 0
v_add_f32 v201, v188, v189
v_add_f32 v201, v201, v190
v_add_f32 v201, v201, v191
v_add_f32 v200, v184, v185
v_add_f32 v200, v200, v186
v_add_f32 v200, v200, v187
v_exp_f32 v196, v140
v_exp_f32 v197, v141
v_exp_f32 v198, v142
v_exp_f32 v199, v143
v_exp_f32 v192, v136
v_exp_f32 v193, v137
v_exp_f32 v194, v138
v_exp_f32 v195, v139
s_nop 0
v_add_f32 v201, v201, v196
v_add_f32 v201, v201, v197
v_add_f32 v201, v201, v198
v_add_f32 v201, v201, v199
v_add_f32 v200, v200, v192
v_add_f32 v200, v200, v193
v_add_f32 v200, v200, v194
v_add_f32 v200, v200, v195
v_exp_f32 v228, v148
v_exp_f32 v229, v149
v_exp_f32 v230, v150
v_exp_f32 v231, v151
v_exp_f32 v224, v144
v_exp_f32 v225, v145
v_exp_f32 v226, v146
v_exp_f32 v227, v147
s_nop 0
v_add_f32 v201, v201, v228
v_add_f32 v201, v201, v229
v_add_f32 v201, v201, v230
v_add_f32 v201, v201, v231
v_add_f32 v200, v200, v224
v_add_f32 v200, v200, v225
v_add_f32 v200, v200, v226
v_add_f32 v200, v200, v227
v_exp_f32 v236, v156
v_exp_f32 v237, v157
v_exp_f32 v238, v158
v_exp_f32 v239, v159
v_exp_f32 v232, v152
v_exp_f32 v233, v153
v_exp_f32 v234, v154
v_exp_f32 v235, v155
s_nop 0
v_add_f32 v201, v201, v236
v_add_f32 v201, v201, v237
v_add_f32 v201, v201, v238
v_add_f32 v201, v201, v239
v_add_f32 v200, v200, v232
v_add_f32 v200, v200, v233
v_add_f32 v200, v200, v234
v_add_f32 v200, v200, v235
s_nop 1
s_branch back_46
slow_47:
s_nop 15
v_max3_f32 v210, v128, v129, v130
v_max3_f32 v210, v210, v131, v136
v_max3_f32 v210, v210, v137, v138
v_max3_f32 v210, v210, v139, v144
v_max3_f32 v210, v210, v145, v146
v_max3_f32 v210, v210, v147, v152
v_max3_f32 v210, v210, v153, v154
v_max_f32 v210, v210, v155
v_max3_f32 v211, v132, v133, v134
v_max3_f32 v211, v211, v135, v140
v_max3_f32 v211, v211, v141, v142
v_max3_f32 v211, v211, v143, v148
v_max3_f32 v211, v211, v149, v150
v_max3_f32 v211, v211, v151, v156
v_max3_f32 v211, v211, v157, v158
v_max_f32 v211, v211, v159
v_mov_b32 v212, v210
v_mov_b32 v213, v211
s_nop 1
v_permlane16_swap_b32 v212, v210
v_permlane16_swap_b32 v213, v211
s_nop 1
v_max_f32 v210, v210, v212
v_max_f32 v211, v211, v213
v_mov_b32 v212, v210
v_mov_b32 v213, v211
s_nop 1
v_permlane32_swap_b32 v212, v210
v_permlane32_swap_b32 v213, v211
s_nop 1
v_max_f32 v210, v210, v212
v_max_f32 v211, v211, v213
v_max_f32 v210, 0, v210
v_sub_f32 v212, 0, v210
v_max_f32 v211, 0, v211
v_sub_f32 v213, 0, v211
v_exp_f32 v212, v212
v_exp_f32 v213, v213
v_sub_f32 v128, v128, v210
v_sub_f32 v129, v129, v210
v_sub_f32 v130, v130, v210
v_sub_f32 v131, v131, v210
v_sub_f32 v136, v136, v210
v_sub_f32 v137, v137, v210
v_sub_f32 v138, v138, v210
v_sub_f32 v139, v139, v210
v_sub_f32 v144, v144, v210
v_sub_f32 v145, v145, v210
v_sub_f32 v146, v146, v210
v_sub_f32 v147, v147, v210
v_sub_f32 v152, v152, v210
v_sub_f32 v153, v153, v210
v_sub_f32 v154, v154, v210
v_sub_f32 v155, v155, v210
v_sub_f32 v176, v176, v210
v_sub_f32 v177, v177, v210
v_sub_f32 v178, v178, v210
v_sub_f32 v179, v179, v210
v_mul_f32 v202, v202, v212
v_mul_f32 v0, v0, v212
v_mul_f32 v1, v1, v212
v_mul_f32 v2, v2, v212
v_mul_f32 v3, v3, v212
v_mul_f32 v4, v4, v212
v_mul_f32 v5, v5, v212
v_mul_f32 v6, v6, v212
v_mul_f32 v7, v7, v212
v_mul_f32 v8, v8, v212
v_mul_f32 v9, v9, v212
v_mul_f32 v10, v10, v212
v_mul_f32 v11, v11, v212
v_mul_f32 v12, v12, v212
v_mul_f32 v13, v13, v212
v_mul_f32 v14, v14, v212
v_mul_f32 v15, v15, v212
v_mul_f32 v16, v16, v212
v_mul_f32 v17, v17, v212
v_mul_f32 v18, v18, v212
v_mul_f32 v19, v19, v212
v_mul_f32 v20, v20, v212
v_mul_f32 v21, v21, v212
v_mul_f32 v22, v22, v212
v_mul_f32 v23, v23, v212
v_mul_f32 v24, v24, v212
v_mul_f32 v25, v25, v212
v_mul_f32 v26, v26, v212
v_mul_f32 v27, v27, v212
v_mul_f32 v28, v28, v212
v_mul_f32 v29, v29, v212
v_mul_f32 v30, v30, v212
v_mul_f32 v31, v31, v212
v_mul_f32 v32, v32, v212
v_mul_f32 v33, v33, v212
v_mul_f32 v34, v34, v212
v_mul_f32 v35, v35, v212
v_mul_f32 v36, v36, v212
v_mul_f32 v37, v37, v212
v_mul_f32 v38, v38, v212
v_mul_f32 v39, v39, v212
v_mul_f32 v40, v40, v212
v_mul_f32 v41, v41, v212
v_mul_f32 v42, v42, v212
v_mul_f32 v43, v43, v212
v_mul_f32 v44, v44, v212
v_mul_f32 v45, v45, v212
v_mul_f32 v46, v46, v212
v_mul_f32 v47, v47, v212
v_mul_f32 v48, v48, v212
v_mul_f32 v49, v49, v212
v_mul_f32 v50, v50, v212
v_mul_f32 v51, v51, v212
v_mul_f32 v52, v52, v212
v_mul_f32 v53, v53, v212
v_mul_f32 v54, v54, v212
v_mul_f32 v55, v55, v212
v_mul_f32 v56, v56, v212
v_mul_f32 v57, v57, v212
v_mul_f32 v58, v58, v212
v_mul_f32 v59, v59, v212
v_mul_f32 v60, v60, v212
v_mul_f32 v61, v61, v212
v_mul_f32 v62, v62, v212
v_mul_f32 v63, v63, v212
v_sub_f32 v132, v132, v211
v_sub_f32 v133, v133, v211
v_sub_f32 v134, v134, v211
v_sub_f32 v135, v135, v211
v_sub_f32 v140, v140, v211
v_sub_f32 v141, v141, v211
v_sub_f32 v142, v142, v211
v_sub_f32 v143, v143, v211
v_sub_f32 v148, v148, v211
v_sub_f32 v149, v149, v211
v_sub_f32 v150, v150, v211
v_sub_f32 v151, v151, v211
v_sub_f32 v156, v156, v211
v_sub_f32 v157, v157, v211
v_sub_f32 v158, v158, v211
v_sub_f32 v159, v159, v211
v_sub_f32 v180, v180, v211
v_sub_f32 v181, v181, v211
v_sub_f32 v182, v182, v211
v_sub_f32 v183, v183, v211
v_mul_f32 v203, v203, v213
v_mul_f32 v64, v64, v213
v_mul_f32 v65, v65, v213
v_mul_f32 v66, v66, v213
v_mul_f32 v67, v67, v213
v_mul_f32 v68, v68, v213
v_mul_f32 v69, v69, v213
v_mul_f32 v70, v70, v213
v_mul_f32 v71, v71, v213
v_mul_f32 v72, v72, v213
v_mul_f32 v73, v73, v213
v_mul_f32 v74, v74, v213
v_mul_f32 v75, v75, v213
v_mul_f32 v76, v76, v213
v_mul_f32 v77, v77, v213
v_mul_f32 v78, v78, v213
v_mul_f32 v79, v79, v213
v_mul_f32 v80, v80, v213
v_mul_f32 v81, v81, v213
v_mul_f32 v82, v82, v213
v_mul_f32 v83, v83, v213
v_mul_f32 v84, v84, v213
v_mul_f32 v85, v85, v213
v_mul_f32 v86, v86, v213
v_mul_f32 v87, v87, v213
v_mul_f32 v88, v88, v213
v_mul_f32 v89, v89, v213
v_mul_f32 v90, v90, v213
v_mul_f32 v91, v91, v213
v_mul_f32 v92, v92, v213
v_mul_f32 v93, v93, v213
v_mul_f32 v94, v94, v213
v_mul_f32 v95, v95, v213
v_mul_f32 v96, v96, v213
v_mul_f32 v97, v97, v213
v_mul_f32 v98, v98, v213
v_mul_f32 v99, v99, v213
v_mul_f32 v100, v100, v213
v_mul_f32 v101, v101, v213
v_mul_f32 v102, v102, v213
v_mul_f32 v103, v103, v213
v_mul_f32 v104, v104, v213
v_mul_f32 v105, v105, v213
v_mul_f32 v106, v106, v213
v_mul_f32 v107, v107, v213
v_mul_f32 v108, v108, v213
v_mul_f32 v109, v109, v213
v_mul_f32 v110, v110, v213
v_mul_f32 v111, v111, v213
v_mul_f32 v112, v112, v213
v_mul_f32 v113, v113, v213
v_mul_f32 v114, v114, v213
v_mul_f32 v115, v115, v213
v_mul_f32 v116, v116, v213
v_mul_f32 v117, v117, v213
v_mul_f32 v118, v118, v213
v_mul_f32 v119, v119, v213
v_mul_f32 v120, v120, v213
v_mul_f32 v121, v121, v213
v_mul_f32 v122, v122, v213
v_mul_f32 v123, v123, v213
v_mul_f32 v124, v124, v213
v_mul_f32 v125, v125, v213
v_mul_f32 v126, v126, v213
v_mul_f32 v127, v127, v213
v_exp_f32 v188, v132
v_exp_f32 v189, v133
v_exp_f32 v190, v134
v_exp_f32 v191, v135
v_exp_f32 v184, v128
v_exp_f32 v185, v129
v_exp_f32 v186, v130
v_exp_f32 v187, v131
s_nop 0
v_add_f32 v201, v188, v189
v_add_f32 v201, v201, v190
v_add_f32 v201, v201, v191
v_add_f32 v200, v184, v185
v_add_f32 v200, v200, v186
v_add_f32 v200, v200, v187
v_exp_f32 v196, v140
v_exp_f32 v197, v141
v_exp_f32 v198, v142
v_exp_f32 v199, v143
v_exp_f32 v192, v136
v_exp_f32 v193, v137
v_exp_f32 v194, v138
v_exp_f32 v195, v139
s_nop 0
v_add_f32 v201, v201, v196
v_add_f32 v201, v201, v197
v_add_f32 v201, v201, v198
v_add_f32 v201, v201, v199
v_add_f32 v200, v200, v192
v_add_f32 v200, v200, v193
v_add_f32 v200, v200, v194
v_add_f32 v200, v200, v195
v_exp_f32 v228, v148
v_exp_f32 v229, v149
v_exp_f32 v230, v150
v_exp_f32 v231, v151
v_exp_f32 v224, v144
v_exp_f32 v225, v145
v_exp_f32 v226, v146
v_exp_f32 v227, v147
s_nop 0
v_add_f32 v201, v201, v228
v_add_f32 v201, v201, v229
v_add_f32 v201, v201, v230
v_add_f32 v201, v201, v231
v_add_f32 v200, v200, v224
v_add_f32 v200, v200, v225
v_add_f32 v200, v200, v226
v_add_f32 v200, v200, v227
v_exp_f32 v236, v156
v_exp_f32 v237, v157
v_exp_f32 v238, v158
v_exp_f32 v239, v159
v_exp_f32 v232, v152
v_exp_f32 v233, v153
v_exp_f32 v234, v154
v_exp_f32 v235, v155
s_nop 0
v_add_f32 v201, v201, v236
v_add_f32 v201, v201, v237
v_add_f32 v201, v201, v238
v_add_f32 v201, v201, v239
v_add_f32 v200, v200, v232
v_add_f32 v200, v200, v233
v_add_f32 v200, v200, v234
v_add_f32 v200, v200, v235
s_nop 1
s_branch back_48
slow_67:
s_nop 15
v_max3_f32 v210, v128, v129, v130
v_max3_f32 v210, v210, v131, v136
v_max3_f32 v210, v210, v137, v138
v_max3_f32 v210, v210, v139, v144
v_max3_f32 v210, v210, v145, v146
v_max3_f32 v210, v210, v147, v152
v_max3_f32 v210, v210, v153, v154
v_max_f32 v210, v210, v155
v_max3_f32 v211, v132, v133, v134
v_max3_f32 v211, v211, v135, v140
v_max3_f32 v211, v211, v141, v142
v_max3_f32 v211, v211, v143, v148
v_max3_f32 v211, v211, v149, v150
v_max3_f32 v211, v211, v151, v156
v_max3_f32 v211, v211, v157, v158
v_max_f32 v211, v211, v159
v_mov_b32 v212, v210
v_mov_b32 v213, v211
s_nop 1
v_permlane16_swap_b32 v212, v210
v_permlane16_swap_b32 v213, v211
s_nop 1
v_max_f32 v210, v210, v212
v_max_f32 v211, v211, v213
v_mov_b32 v212, v210
v_mov_b32 v213, v211
s_nop 1
v_permlane32_swap_b32 v212, v210
v_permlane32_swap_b32 v213, v211
s_nop 1
v_max_f32 v210, v210, v212
v_max_f32 v211, v211, v213
v_max_f32 v210, 0, v210
v_sub_f32 v212, 0, v210
v_max_f32 v211, 0, v211
v_sub_f32 v213, 0, v211
v_exp_f32 v212, v212
v_exp_f32 v213, v213
v_sub_f32 v128, v128, v210
v_sub_f32 v129, v129, v210
v_sub_f32 v130, v130, v210
v_sub_f32 v131, v131, v210
v_sub_f32 v136, v136, v210
v_sub_f32 v137, v137, v210
v_sub_f32 v138, v138, v210
v_sub_f32 v139, v139, v210
v_sub_f32 v144, v144, v210
v_sub_f32 v145, v145, v210
v_sub_f32 v146, v146, v210
v_sub_f32 v147, v147, v210
v_sub_f32 v152, v152, v210
v_sub_f32 v153, v153, v210
v_sub_f32 v154, v154, v210
v_sub_f32 v155, v155, v210
v_sub_f32 v176, v176, v210
v_sub_f32 v177, v177, v210
v_sub_f32 v178, v178, v210
v_sub_f32 v179, v179, v210
v_mul_f32 v202, v202, v212
v_mul_f32 v0, v0, v212
v_mul_f32 v1, v1, v212
v_mul_f32 v2, v2, v212
v_mul_f32 v3, v3, v212
v_mul_f32 v4, v4, v212
v_mul_f32 v5, v5, v212
v_mul_f32 v6, v6, v212
v_mul_f32 v7, v7, v212
v_mul_f32 v8, v8, v212
v_mul_f32 v9, v9, v212
v_mul_f32 v10, v10, v212
v_mul_f32 v11, v11, v212
v_mul_f32 v12, v12, v212
v_mul_f32 v13, v13, v212
v_mul_f32 v14, v14, v212
v_mul_f32 v15, v15, v212
v_mul_f32 v16, v16, v212
v_mul_f32 v17, v17, v212
v_mul_f32 v18, v18, v212
v_mul_f32 v19, v19, v212
v_mul_f32 v20, v20, v212
v_mul_f32 v21, v21, v212
v_mul_f32 v22, v22, v212
v_mul_f32 v23, v23, v212
v_mul_f32 v24, v24, v212
v_mul_f32 v25, v25, v212
v_mul_f32 v26, v26, v212
v_mul_f32 v27, v27, v212
v_mul_f32 v28, v28, v212
v_mul_f32 v29, v29, v212
v_mul_f32 v30, v30, v212
v_mul_f32 v31, v31, v212
v_mul_f32 v32, v32, v212
v_mul_f32 v33, v33, v212
v_mul_f32 v34, v34, v212
v_mul_f32 v35, v35, v212
v_mul_f32 v36, v36, v212
v_mul_f32 v37, v37, v212
v_mul_f32 v38, v38, v212
v_mul_f32 v39, v39, v212
v_mul_f32 v40, v40, v212
v_mul_f32 v41, v41, v212
v_mul_f32 v42, v42, v212
v_mul_f32 v43, v43, v212
v_mul_f32 v44, v44, v212
v_mul_f32 v45, v45, v212
v_mul_f32 v46, v46, v212
v_mul_f32 v47, v47, v212
v_mul_f32 v48, v48, v212
v_mul_f32 v49, v49, v212
v_mul_f32 v50, v50, v212
v_mul_f32 v51, v51, v212
v_mul_f32 v52, v52, v212
v_mul_f32 v53, v53, v212
v_mul_f32 v54, v54, v212
v_mul_f32 v55, v55, v212
v_mul_f32 v56, v56, v212
v_mul_f32 v57, v57, v212
v_mul_f32 v58, v58, v212
v_mul_f32 v59, v59, v212
v_mul_f32 v60, v60, v212
v_mul_f32 v61, v61, v212
v_mul_f32 v62, v62, v212
v_mul_f32 v63, v63, v212
v_sub_f32 v132, v132, v211
v_sub_f32 v133, v133, v211
v_sub_f32 v134, v134, v211
v_sub_f32 v135, v135, v211
v_sub_f32 v140, v140, v211
v_sub_f32 v141, v141, v211
v_sub_f32 v142, v142, v211
v_sub_f32 v143, v143, v211
v_sub_f32 v148, v148, v211
v_sub_f32 v149, v149, v211
v_sub_f32 v150, v150, v211
v_sub_f32 v151, v151, v211
v_sub_f32 v156, v156, v211
v_sub_f32 v157, v157, v211
v_sub_f32 v158, v158, v211
v_sub_f32 v159, v159, v211
v_sub_f32 v180, v180, v211
v_sub_f32 v181, v181, v211
v_sub_f32 v182, v182, v211
v_sub_f32 v183, v183, v211
v_mul_f32 v203, v203, v213
v_mul_f32 v64, v64, v213
v_mul_f32 v65, v65, v213
v_mul_f32 v66, v66, v213
v_mul_f32 v67, v67, v213
v_mul_f32 v68, v68, v213
v_mul_f32 v69, v69, v213
v_mul_f32 v70, v70, v213
v_mul_f32 v71, v71, v213
v_mul_f32 v72, v72, v213
v_mul_f32 v73, v73, v213
v_mul_f32 v74, v74, v213
v_mul_f32 v75, v75, v213
v_mul_f32 v76, v76, v213
v_mul_f32 v77, v77, v213
v_mul_f32 v78, v78, v213
v_mul_f32 v79, v79, v213
v_mul_f32 v80, v80, v213
v_mul_f32 v81, v81, v213
v_mul_f32 v82, v82, v213
v_mul_f32 v83, v83, v213
v_mul_f32 v84, v84, v213
v_mul_f32 v85, v85, v213
v_mul_f32 v86, v86, v213
v_mul_f32 v87, v87, v213
v_mul_f32 v88, v88, v213
v_mul_f32 v89, v89, v213
v_mul_f32 v90, v90, v213
v_mul_f32 v91, v91, v213
v_mul_f32 v92, v92, v213
v_mul_f32 v93, v93, v213
v_mul_f32 v94, v94, v213
v_mul_f32 v95, v95, v213
v_mul_f32 v96, v96, v213
v_mul_f32 v97, v97, v213
v_mul_f32 v98, v98, v213
v_mul_f32 v99, v99, v213
v_mul_f32 v100, v100, v213
v_mul_f32 v101, v101, v213
v_mul_f32 v102, v102, v213
v_mul_f32 v103, v103, v213
v_mul_f32 v104, v104, v213
v_mul_f32 v105, v105, v213
v_mul_f32 v106, v106, v213
v_mul_f32 v107, v107, v213
v_mul_f32 v108, v108, v213
v_mul_f32 v109, v109, v213
v_mul_f32 v110, v110, v213
v_mul_f32 v111, v111, v213
v_mul_f32 v112, v112, v213
v_mul_f32 v113, v113, v213
v_mul_f32 v114, v114, v213
v_mul_f32 v115, v115, v213
v_mul_f32 v116, v116, v213
v_mul_f32 v117, v117, v213
v_mul_f32 v118, v118, v213
v_mul_f32 v119, v119, v213
v_mul_f32 v120, v120, v213
v_mul_f32 v121, v121, v213
v_mul_f32 v122, v122, v213
v_mul_f32 v123, v123, v213
v_mul_f32 v124, v124, v213
v_mul_f32 v125, v125, v213
v_mul_f32 v126, v126, v213
v_mul_f32 v127, v127, v213
v_exp_f32 v188, v132
v_exp_f32 v189, v133
v_exp_f32 v190, v134
v_exp_f32 v191, v135
v_exp_f32 v184, v128
v_exp_f32 v185, v129
v_exp_f32 v186, v130
v_exp_f32 v187, v131
s_nop 0
v_add_f32 v201, v188, v189
v_add_f32 v201, v201, v190
v_add_f32 v201, v201, v191
v_add_f32 v200, v184, v185
v_add_f32 v200, v200, v186
v_add_f32 v200, v200, v187
v_exp_f32 v196, v140
v_exp_f32 v197, v141
v_exp_f32 v198, v142
v_exp_f32 v199, v143
v_exp_f32 v192, v136
v_exp_f32 v193, v137
v_exp_f32 v194, v138
v_exp_f32 v195, v139
s_nop 0
v_add_f32 v201, v201, v196
v_add_f32 v201, v201, v197
v_add_f32 v201, v201, v198
v_add_f32 v201, v201, v199
v_add_f32 v200, v200, v192
v_add_f32 v200, v200, v193
v_add_f32 v200, v200, v194
v_add_f32 v200, v200, v195
v_exp_f32 v228, v148
v_exp_f32 v229, v149
v_exp_f32 v230, v150
v_exp_f32 v231, v151
v_exp_f32 v224, v144
v_exp_f32 v225, v145
v_exp_f32 v226, v146
v_exp_f32 v227, v147
s_nop 0
v_add_f32 v201, v201, v228
v_add_f32 v201, v201, v229
v_add_f32 v201, v201, v230
v_add_f32 v201, v201, v231
v_add_f32 v200, v200, v224
v_add_f32 v200, v200, v225
v_add_f32 v200, v200, v226
v_add_f32 v200, v200, v227
v_exp_f32 v236, v156
v_exp_f32 v237, v157
v_exp_f32 v238, v158
v_exp_f32 v239, v159
v_exp_f32 v232, v152
v_exp_f32 v233, v153
v_exp_f32 v234, v154
v_exp_f32 v235, v155
s_nop 0
v_add_f32 v201, v201, v236
v_add_f32 v201, v201, v237
v_add_f32 v201, v201, v238
v_add_f32 v201, v201, v239
v_add_f32 v200, v200, v232
v_add_f32 v200, v200, v233
v_add_f32 v200, v200, v234
v_add_f32 v200, v200, v235
s_nop 1
s_branch back_68
slow_69:
s_nop 15
v_max3_f32 v210, v128, v129, v130
v_max3_f32 v210, v210, v131, v136
v_max3_f32 v210, v210, v137, v138
v_max3_f32 v210, v210, v139, v144
v_max3_f32 v210, v210, v145, v146
v_max3_f32 v210, v210, v147, v152
v_max3_f32 v210, v210, v153, v154
v_max_f32 v210, v210, v155
v_max3_f32 v211, v132, v133, v134
v_max3_f32 v211, v211, v135, v140
v_max3_f32 v211, v211, v141, v142
v_max3_f32 v211, v211, v143, v148
v_max3_f32 v211, v211, v149, v150
v_max3_f32 v211, v211, v151, v156
v_max3_f32 v211, v211, v157, v158
v_max_f32 v211, v211, v159
v_mov_b32 v212, v210
v_mov_b32 v213, v211
s_nop 1
v_permlane16_swap_b32 v212, v210
v_permlane16_swap_b32 v213, v211
s_nop 1
v_max_f32 v210, v210, v212
v_max_f32 v211, v211, v213
v_mov_b32 v212, v210
v_mov_b32 v213, v211
s_nop 1
v_permlane32_swap_b32 v212, v210
v_permlane32_swap_b32 v213, v211
s_nop 1
v_max_f32 v210, v210, v212
v_max_f32 v211, v211, v213
v_max_f32 v210, 0, v210
v_sub_f32 v212, 0, v210
v_max_f32 v211, 0, v211
v_sub_f32 v213, 0, v211
v_exp_f32 v212, v212
v_exp_f32 v213, v213
v_sub_f32 v128, v128, v210
v_sub_f32 v129, v129, v210
v_sub_f32 v130, v130, v210
v_sub_f32 v131, v131, v210
v_sub_f32 v136, v136, v210
v_sub_f32 v137, v137, v210
v_sub_f32 v138, v138, v210
v_sub_f32 v139, v139, v210
v_sub_f32 v144, v144, v210
v_sub_f32 v145, v145, v210
v_sub_f32 v146, v146, v210
v_sub_f32 v147, v147, v210
v_sub_f32 v152, v152, v210
v_sub_f32 v153, v153, v210
v_sub_f32 v154, v154, v210
v_sub_f32 v155, v155, v210
v_sub_f32 v176, v176, v210
v_sub_f32 v177, v177, v210
v_sub_f32 v178, v178, v210
v_sub_f32 v179, v179, v210
v_mul_f32 v202, v202, v212
v_mul_f32 v0, v0, v212
v_mul_f32 v1, v1, v212
v_mul_f32 v2, v2, v212
v_mul_f32 v3, v3, v212
v_mul_f32 v4, v4, v212
v_mul_f32 v5, v5, v212
v_mul_f32 v6, v6, v212
v_mul_f32 v7, v7, v212
v_mul_f32 v8, v8, v212
v_mul_f32 v9, v9, v212
v_mul_f32 v10, v10, v212
v_mul_f32 v11, v11, v212
v_mul_f32 v12, v12, v212
v_mul_f32 v13, v13, v212
v_mul_f32 v14, v14, v212
v_mul_f32 v15, v15, v212
v_mul_f32 v16, v16, v212
v_mul_f32 v17, v17, v212
v_mul_f32 v18, v18, v212
v_mul_f32 v19, v19, v212
v_mul_f32 v20, v20, v212
v_mul_f32 v21, v21, v212
v_mul_f32 v22, v22, v212
v_mul_f32 v23, v23, v212
v_mul_f32 v24, v24, v212
v_mul_f32 v25, v25, v212
v_mul_f32 v26, v26, v212
v_mul_f32 v27, v27, v212
v_mul_f32 v28, v28, v212
v_mul_f32 v29, v29, v212
v_mul_f32 v30, v30, v212
v_mul_f32 v31, v31, v212
v_mul_f32 v32, v32, v212
v_mul_f32 v33, v33, v212
v_mul_f32 v34, v34, v212
v_mul_f32 v35, v35, v212
v_mul_f32 v36, v36, v212
v_mul_f32 v37, v37, v212
v_mul_f32 v38, v38, v212
v_mul_f32 v39, v39, v212
v_mul_f32 v40, v40, v212
v_mul_f32 v41, v41, v212
v_mul_f32 v42, v42, v212
v_mul_f32 v43, v43, v212
v_mul_f32 v44, v44, v212
v_mul_f32 v45, v45, v212
v_mul_f32 v46, v46, v212
v_mul_f32 v47, v47, v212
v_mul_f32 v48, v48, v212
v_mul_f32 v49, v49, v212
v_mul_f32 v50, v50, v212
v_mul_f32 v51, v51, v212
v_mul_f32 v52, v52, v212
v_mul_f32 v53, v53, v212
v_mul_f32 v54, v54, v212
v_mul_f32 v55, v55, v212
v_mul_f32 v56, v56, v212
v_mul_f32 v57, v57, v212
v_mul_f32 v58, v58, v212
v_mul_f32 v59, v59, v212
v_mul_f32 v60, v60, v212
v_mul_f32 v61, v61, v212
v_mul_f32 v62, v62, v212
v_mul_f32 v63, v63, v212
v_sub_f32 v132, v132, v211
v_sub_f32 v133, v133, v211
v_sub_f32 v134, v134, v211
v_sub_f32 v135, v135, v211
v_sub_f32 v140, v140, v211
v_sub_f32 v141, v141, v211
v_sub_f32 v142, v142, v211
v_sub_f32 v143, v143, v211
v_sub_f32 v148, v148, v211
v_sub_f32 v149, v149, v211
v_sub_f32 v150, v150, v211
v_sub_f32 v151, v151, v211
v_sub_f32 v156, v156, v211
v_sub_f32 v157, v157, v211
v_sub_f32 v158, v158, v211
v_sub_f32 v159, v159, v211
v_sub_f32 v180, v180, v211
v_sub_f32 v181, v181, v211
v_sub_f32 v182, v182, v211
v_sub_f32 v183, v183, v211
v_mul_f32 v203, v203, v213
v_mul_f32 v64, v64, v213
v_mul_f32 v65, v65, v213
v_mul_f32 v66, v66, v213
v_mul_f32 v67, v67, v213
v_mul_f32 v68, v68, v213
v_mul_f32 v69, v69, v213
v_mul_f32 v70, v70, v213
v_mul_f32 v71, v71, v213
v_mul_f32 v72, v72, v213
v_mul_f32 v73, v73, v213
v_mul_f32 v74, v74, v213
v_mul_f32 v75, v75, v213
v_mul_f32 v76, v76, v213
v_mul_f32 v77, v77, v213
v_mul_f32 v78, v78, v213
v_mul_f32 v79, v79, v213
v_mul_f32 v80, v80, v213
v_mul_f32 v81, v81, v213
v_mul_f32 v82, v82, v213
v_mul_f32 v83, v83, v213
v_mul_f32 v84, v84, v213
v_mul_f32 v85, v85, v213
v_mul_f32 v86, v86, v213
v_mul_f32 v87, v87, v213
v_mul_f32 v88, v88, v213
v_mul_f32 v89, v89, v213
v_mul_f32 v90, v90, v213
v_mul_f32 v91, v91, v213
v_mul_f32 v92, v92, v213
v_mul_f32 v93, v93, v213
v_mul_f32 v94, v94, v213
v_mul_f32 v95, v95, v213
v_mul_f32 v96, v96, v213
v_mul_f32 v97, v97, v213
v_mul_f32 v98, v98, v213
v_mul_f32 v99, v99, v213
v_mul_f32 v100, v100, v213
v_mul_f32 v101, v101, v213
v_mul_f32 v102, v102, v213
v_mul_f32 v103, v103, v213
v_mul_f32 v104, v104, v213
v_mul_f32 v105, v105, v213
v_mul_f32 v106, v106, v213
v_mul_f32 v107, v107, v213
v_mul_f32 v108, v108, v213
v_mul_f32 v109, v109, v213
v_mul_f32 v110, v110, v213
v_mul_f32 v111, v111, v213
v_mul_f32 v112, v112, v213
v_mul_f32 v113, v113, v213
v_mul_f32 v114, v114, v213
v_mul_f32 v115, v115, v213
v_mul_f32 v116, v116, v213
v_mul_f32 v117, v117, v213
v_mul_f32 v118, v118, v213
v_mul_f32 v119, v119, v213
v_mul_f32 v120, v120, v213
v_mul_f32 v121, v121, v213
v_mul_f32 v122, v122, v213
v_mul_f32 v123, v123, v213
v_mul_f32 v124, v124, v213
v_mul_f32 v125, v125, v213
v_mul_f32 v126, v126, v213
v_mul_f32 v127, v127, v213
v_exp_f32 v188, v132
v_exp_f32 v189, v133
v_exp_f32 v190, v134
v_exp_f32 v191, v135
v_exp_f32 v184, v128
v_exp_f32 v185, v129
v_exp_f32 v186, v130
v_exp_f32 v187, v131
s_nop 0
v_add_f32 v201, v188, v189
v_add_f32 v201, v201, v190
v_add_f32 v201, v201, v191
v_add_f32 v200, v184, v185
v_add_f32 v200, v200, v186
v_add_f32 v200, v200, v187
v_exp_f32 v196, v140
v_exp_f32 v197, v141
v_exp_f32 v198, v142
v_exp_f32 v199, v143
v_exp_f32 v192, v136
v_exp_f32 v193, v137
v_exp_f32 v194, v138
v_exp_f32 v195, v139
s_nop 0
v_add_f32 v201, v201, v196
v_add_f32 v201, v201, v197
v_add_f32 v201, v201, v198
v_add_f32 v201, v201, v199
v_add_f32 v200, v200, v192
v_add_f32 v200, v200, v193
v_add_f32 v200, v200, v194
v_add_f32 v200, v200, v195
v_exp_f32 v228, v148
v_exp_f32 v229, v149
v_exp_f32 v230, v150
v_exp_f32 v231, v151
v_exp_f32 v224, v144
v_exp_f32 v225, v145
v_exp_f32 v226, v146
v_exp_f32 v227, v147
s_nop 0
v_add_f32 v201, v201, v228
v_add_f32 v201, v201, v229
v_add_f32 v201, v201, v230
v_add_f32 v201, v201, v231
v_add_f32 v200, v200, v224
v_add_f32 v200, v200, v225
v_add_f32 v200, v200, v226
v_add_f32 v200, v200, v227
v_exp_f32 v236, v156
v_exp_f32 v237, v157
v_exp_f32 v238, v158
v_exp_f32 v239, v159
v_exp_f32 v232, v152
v_exp_f32 v233, v153
v_exp_f32 v234, v154
v_exp_f32 v235, v155
s_nop 0
v_add_f32 v201, v201, v236
v_add_f32 v201, v201, v237
v_add_f32 v201, v201, v238
v_add_f32 v201, v201, v239
v_add_f32 v200, v200, v232
v_add_f32 v200, v200, v233
v_add_f32 v200, v200, v234
v_add_f32 v200, v200, v235
s_nop 1
s_branch back_70
slow_80:
s_nop 15
v_max3_f32 v210, v128, v129, v130
v_max3_f32 v210, v210, v131, v136
v_max3_f32 v210, v210, v137, v138
v_max3_f32 v210, v210, v139, v144
v_max3_f32 v210, v210, v145, v146
v_max3_f32 v210, v210, v147, v152
v_max3_f32 v210, v210, v153, v154
v_max_f32 v210, v210, v155
v_max3_f32 v211, v132, v133, v134
v_max3_f32 v211, v211, v135, v140
v_max3_f32 v211, v211, v141, v142
v_max3_f32 v211, v211, v143, v148
v_max3_f32 v211, v211, v149, v150
v_max3_f32 v211, v211, v151, v156
v_max3_f32 v211, v211, v157, v158
v_max_f32 v211, v211, v159
v_mov_b32 v212, v210
v_mov_b32 v213, v211
s_nop 1
v_permlane16_swap_b32 v212, v210
v_permlane16_swap_b32 v213, v211
s_nop 1
v_max_f32 v210, v210, v212
v_max_f32 v211, v211, v213
v_mov_b32 v212, v210
v_mov_b32 v213, v211
s_nop 1
v_permlane32_swap_b32 v212, v210
v_permlane32_swap_b32 v213, v211
s_nop 1
v_max_f32 v210, v210, v212
v_max_f32 v211, v211, v213
v_max_f32 v210, 0, v210
v_sub_f32 v212, 0, v210
v_max_f32 v211, 0, v211
v_sub_f32 v213, 0, v211
v_exp_f32 v212, v212
v_exp_f32 v213, v213
v_sub_f32 v128, v128, v210
v_sub_f32 v129, v129, v210
v_sub_f32 v130, v130, v210
v_sub_f32 v131, v131, v210
v_sub_f32 v136, v136, v210
v_sub_f32 v137, v137, v210
v_sub_f32 v138, v138, v210
v_sub_f32 v139, v139, v210
v_sub_f32 v144, v144, v210
v_sub_f32 v145, v145, v210
v_sub_f32 v146, v146, v210
v_sub_f32 v147, v147, v210
v_sub_f32 v152, v152, v210
v_sub_f32 v153, v153, v210
v_sub_f32 v154, v154, v210
v_sub_f32 v155, v155, v210
v_sub_f32 v176, v176, v210
v_sub_f32 v177, v177, v210
v_sub_f32 v178, v178, v210
v_sub_f32 v179, v179, v210
v_mul_f32 v202, v202, v212
v_mul_f32 v0, v0, v212
v_mul_f32 v1, v1, v212
v_mul_f32 v2, v2, v212
v_mul_f32 v3, v3, v212
v_mul_f32 v4, v4, v212
v_mul_f32 v5, v5, v212
v_mul_f32 v6, v6, v212
v_mul_f32 v7, v7, v212
v_mul_f32 v8, v8, v212
v_mul_f32 v9, v9, v212
v_mul_f32 v10, v10, v212
v_mul_f32 v11, v11, v212
v_mul_f32 v12, v12, v212
v_mul_f32 v13, v13, v212
v_mul_f32 v14, v14, v212
v_mul_f32 v15, v15, v212
v_mul_f32 v16, v16, v212
v_mul_f32 v17, v17, v212
v_mul_f32 v18, v18, v212
v_mul_f32 v19, v19, v212
v_mul_f32 v20, v20, v212
v_mul_f32 v21, v21, v212
v_mul_f32 v22, v22, v212
v_mul_f32 v23, v23, v212
v_mul_f32 v24, v24, v212
v_mul_f32 v25, v25, v212
v_mul_f32 v26, v26, v212
v_mul_f32 v27, v27, v212
v_mul_f32 v28, v28, v212
v_mul_f32 v29, v29, v212
v_mul_f32 v30, v30, v212
v_mul_f32 v31, v31, v212
v_mul_f32 v32, v32, v212
v_mul_f32 v33, v33, v212
v_mul_f32 v34, v34, v212
v_mul_f32 v35, v35, v212
v_mul_f32 v36, v36, v212
v_mul_f32 v37, v37, v212
v_mul_f32 v38, v38, v212
v_mul_f32 v39, v39, v212
v_mul_f32 v40, v40, v212
v_mul_f32 v41, v41, v212
v_mul_f32 v42, v42, v212
v_mul_f32 v43, v43, v212
v_mul_f32 v44, v44, v212
v_mul_f32 v45, v45, v212
v_mul_f32 v46, v46, v212
v_mul_f32 v47, v47, v212
v_mul_f32 v48, v48, v212
v_mul_f32 v49, v49, v212
v_mul_f32 v50, v50, v212
v_mul_f32 v51, v51, v212
v_mul_f32 v52, v52, v212
v_mul_f32 v53, v53, v212
v_mul_f32 v54, v54, v212
v_mul_f32 v55, v55, v212
v_mul_f32 v56, v56, v212
v_mul_f32 v57, v57, v212
v_mul_f32 v58, v58, v212
v_mul_f32 v59, v59, v212
v_mul_f32 v60, v60, v212
v_mul_f32 v61, v61, v212
v_mul_f32 v62, v62, v212
v_mul_f32 v63, v63, v212
v_sub_f32 v132, v132, v211
v_sub_f32 v133, v133, v211
v_sub_f32 v134, v134, v211
v_sub_f32 v135, v135, v211
v_sub_f32 v140, v140, v211
v_sub_f32 v141, v141, v211
v_sub_f32 v142, v142, v211
v_sub_f32 v143, v143, v211
v_sub_f32 v148, v148, v211
v_sub_f32 v149, v149, v211
v_sub_f32 v150, v150, v211
v_sub_f32 v151, v151, v211
v_sub_f32 v156, v156, v211
v_sub_f32 v157, v157, v211
v_sub_f32 v158, v158, v211
v_sub_f32 v159, v159, v211
v_sub_f32 v180, v180, v211
v_sub_f32 v181, v181, v211
v_sub_f32 v182, v182, v211
v_sub_f32 v183, v183, v211
v_mul_f32 v203, v203, v213
v_mul_f32 v64, v64, v213
v_mul_f32 v65, v65, v213
v_mul_f32 v66, v66, v213
v_mul_f32 v67, v67, v213
v_mul_f32 v68, v68, v213
v_mul_f32 v69, v69, v213
v_mul_f32 v70, v70, v213
v_mul_f32 v71, v71, v213
v_mul_f32 v72, v72, v213
v_mul_f32 v73, v73, v213
v_mul_f32 v74, v74, v213
v_mul_f32 v75, v75, v213
v_mul_f32 v76, v76, v213
v_mul_f32 v77, v77, v213
v_mul_f32 v78, v78, v213
v_mul_f32 v79, v79, v213
v_mul_f32 v80, v80, v213
v_mul_f32 v81, v81, v213
v_mul_f32 v82, v82, v213
v_mul_f32 v83, v83, v213
v_mul_f32 v84, v84, v213
v_mul_f32 v85, v85, v213
v_mul_f32 v86, v86, v213
v_mul_f32 v87, v87, v213
v_mul_f32 v88, v88, v213
v_mul_f32 v89, v89, v213
v_mul_f32 v90, v90, v213
v_mul_f32 v91, v91, v213
v_mul_f32 v92, v92, v213
v_mul_f32 v93, v93, v213
v_mul_f32 v94, v94, v213
v_mul_f32 v95, v95, v213
v_mul_f32 v96, v96, v213
v_mul_f32 v97, v97, v213
v_mul_f32 v98, v98, v213
v_mul_f32 v99, v99, v213
v_mul_f32 v100, v100, v213
v_mul_f32 v101, v101, v213
v_mul_f32 v102, v102, v213
v_mul_f32 v103, v103, v213
v_mul_f32 v104, v104, v213
v_mul_f32 v105, v105, v213
v_mul_f32 v106, v106, v213
v_mul_f32 v107, v107, v213
v_mul_f32 v108, v108, v213
v_mul_f32 v109, v109, v213
v_mul_f32 v110, v110, v213
v_mul_f32 v111, v111, v213
v_mul_f32 v112, v112, v213
v_mul_f32 v113, v113, v213
v_mul_f32 v114, v114, v213
v_mul_f32 v115, v115, v213
v_mul_f32 v116, v116, v213
v_mul_f32 v117, v117, v213
v_mul_f32 v118, v118, v213
v_mul_f32 v119, v119, v213
v_mul_f32 v120, v120, v213
v_mul_f32 v121, v121, v213
v_mul_f32 v122, v122, v213
v_mul_f32 v123, v123, v213
v_mul_f32 v124, v124, v213
v_mul_f32 v125, v125, v213
v_mul_f32 v126, v126, v213
v_mul_f32 v127, v127, v213
v_exp_f32 v188, v132
v_exp_f32 v189, v133
v_exp_f32 v190, v134
v_exp_f32 v191, v135
v_exp_f32 v184, v128
v_exp_f32 v185, v129
v_exp_f32 v186, v130
v_exp_f32 v187, v131
s_nop 0
v_add_f32 v201, v188, v189
v_add_f32 v201, v201, v190
v_add_f32 v201, v201, v191
v_add_f32 v200, v184, v185
v_add_f32 v200, v200, v186
v_add_f32 v200, v200, v187
v_exp_f32 v196, v140
v_exp_f32 v197, v141
v_exp_f32 v198, v142
v_exp_f32 v199, v143
v_exp_f32 v192, v136
v_exp_f32 v193, v137
v_exp_f32 v194, v138
v_exp_f32 v195, v139
s_nop 0
v_add_f32 v201, v201, v196
v_add_f32 v201, v201, v197
v_add_f32 v201, v201, v198
v_add_f32 v201, v201, v199
v_add_f32 v200, v200, v192
v_add_f32 v200, v200, v193
v_add_f32 v200, v200, v194
v_add_f32 v200, v200, v195
v_exp_f32 v228, v148
v_exp_f32 v229, v149
v_exp_f32 v230, v150
v_exp_f32 v231, v151
v_exp_f32 v224, v144
v_exp_f32 v225, v145
v_exp_f32 v226, v146
v_exp_f32 v227, v147
s_nop 0
v_add_f32 v201, v201, v228
v_add_f32 v201, v201, v229
v_add_f32 v201, v201, v230
v_add_f32 v201, v201, v231
v_add_f32 v200, v200, v224
v_add_f32 v200, v200, v225
v_add_f32 v200, v200, v226
v_add_f32 v200, v200, v227
v_exp_f32 v236, v156
v_exp_f32 v237, v157
v_exp_f32 v238, v158
v_exp_f32 v239, v159
v_exp_f32 v232, v152
v_exp_f32 v233, v153
v_exp_f32 v234, v154
v_exp_f32 v235, v155
s_nop 0
v_add_f32 v201, v201, v236
v_add_f32 v201, v201, v237
v_add_f32 v201, v201, v238
v_add_f32 v201, v201, v239
v_add_f32 v200, v200, v232
v_add_f32 v200, v200, v233
v_add_f32 v200, v200, v234
v_add_f32 v200, v200, v235
s_nop 1
s_branch back_81
.section .rodata,"a"
.p2align 6
.amdhsa_kernel gated_mix__compressed_kv_cla__mixer_s_mlp__prompt_kernel
  .amdhsa_next_free_vgpr 512
  .amdhsa_next_free_sgpr 102
  .amdhsa_accum_offset 256
  .amdhsa_group_segment_fixed_size 0
  .amdhsa_kernarg_size 120
  .amdhsa_user_sgpr_count 2
  .amdhsa_user_sgpr_kernarg_segment_ptr 1
  .amdhsa_system_sgpr_workgroup_id_x 1
  .amdhsa_float_denorm_mode_32 3
.end_amdhsa_kernel
```
